```python
import torch

def _softmax(x, axis=-1):
    return torch.softmax(x, dim=axis)
def _gelu(x):
    return torch.nn.functional.gelu(x, approximate="tanh")
def _silu(x):
    return torch.nn.functional.silu(x)
def _sigmoid(x):
    return torch.sigmoid(x)
def _layernorm(x, axis=-1, eps=1e-5):
    m = x.mean(dim=axis, keepdim=True)
    v = x.var(dim=axis, keepdim=True, unbiased=False)
    return (x - m) / torch.sqrt(v + eps)
def _scatter_add(tgt, idx, src, axis=0):
    return tgt.clone().index_add_(axis, idx, src)
def _segment_sum(src, seg, n):
    out = torch.zeros((n,) + src.shape[1:], dtype=src.dtype)
    return out.index_add_(0, seg, src)
def _pad(x, pw):
    flat = tuple(v for pair in reversed(pw) for v in pair)
    return torch.nn.functional.pad(x, flat)

kernel_name = 'interleave_layers__sliding_block__glu_gated_glu__prompt'

def setup_inputs():

    _w = (lambda a: (lambda t: t.to(torch.bfloat16) if t.is_floating_point() else t)(torch.as_tensor(a)))
    def _A_setup():
        B, S, D = 1, 2048, 640
        return {
            "x": _w((lambda *s: torch.randn(*s, dtype=torch.bfloat16) * 0.05)(B, S, D)),
            "wqkv": _w((lambda *s: torch.randn(*s, dtype=torch.bfloat16) * 0.05)(D, 3 * D)),
            "wo": _w((lambda *s: torch.randn(*s, dtype=torch.bfloat16) * 0.05)(D, D)),
        }
    _A_in = _A_setup()

    def _B_setup():
        B, S, D, F = 1, 2048, 640, 1536
        return {
            "x": _w((lambda *s: torch.randn(*s, dtype=torch.bfloat16) * 0.05)(B, S, D)),
            "w_gate": _w((lambda *s: torch.randn(*s, dtype=torch.bfloat16) * 0.05)(D, F)),
            "w_up": _w((lambda *s: torch.randn(*s, dtype=torch.bfloat16) * 0.05)(D, F)),
            "w_down": _w((lambda *s: torch.randn(*s, dtype=torch.bfloat16) * 0.05)(F, D)),
        }
    _B_in = _B_setup()

    return {
        "A_x": _A_in["x"],
        "A_wqkv": _A_in["wqkv"],
        "A_wo": _A_in["wo"],
        "B_x": _B_in["x"],
        "B_w_gate": _B_in["w_gate"],
        "B_w_up": _B_in["w_up"],
        "B_w_down": _B_in["w_down"],
    }

def reference(A_x, A_wqkv, A_wo, B_x, B_w_gate, B_w_up, B_w_down):
    def _A_ref(x, wqkv, wo):
        B, S, D = x.shape
        H = 32; Dh = D // H; W = 256
        qkv = (lambda x, *d: x.permute(*d))((x @ wqkv).reshape(B, S, 3, H, Dh), 2, 0, 3, 1, 4)
        q, k, v = qkv[0], qkv[1], qkv[2]
        scores = torch.einsum("bhqd,bhkd->bhqk", q, k) * (Dh ** -0.5)
        idx = torch.arange(S)
        mask = (idx[:, None] - idx[None, :] >= 0) & (idx[:, None] - idx[None, :] < W)
        scores = torch.where(mask[None, None], scores, -1e9)
        p = _softmax(scores, axis=-1)
        o = torch.einsum("bhqk,bhkd->bhqd", p, v)
        return (lambda x, *d: x.permute(*d))(o, 0, 2, 1, 3).reshape(B, S, D) @ wo

    def _B_ref(x, w_gate, w_up, w_down):
        g = torch.einsum("bsd,df->bsf", x, w_gate)
        u = torch.einsum("bsd,df->bsf", x, w_up)
        h = _sigmoid(g) * u
        return torch.einsum("bsf,fd->bsd", h, w_down)

    x = A_x
    x = x + _A_ref(_layernorm(x, axis=-1), A_wqkv, A_wo)
    x = x + _B_ref(_layernorm(x, axis=-1), B_w_gate, B_w_up, B_w_down)
    x = x + _A_ref(_layernorm(x, axis=-1), A_wqkv, A_wo)
    x = x + _B_ref(_layernorm(x, axis=-1), B_w_gate, B_w_up, B_w_down)
    return x
```

```asm
; @launch kernel=prep_kernel grid=(606,1,1) block=(256,1,1) lds=4096
; @launch kernel=mega_kernel grid=(256,1,1) block=(512,1,1) lds=163840
.amdgcn_target "amdgcn-amd-amdhsa--gfx950"
.text
.globl prep_kernel
.p2align 8
.type prep_kernel,@function
prep_kernel:
    s_load_dwordx2 s[68:69], s[0:1], 0
    s_load_dwordx2 s[70:71], s[0:1], 8
    s_load_dwordx2 s[72:73], s[0:1], 32
    s_load_dwordx2 s[74:75], s[0:1], 40
    s_load_dwordx2 s[76:77], s[0:1], 72
    s_load_dwordx2 s[78:79], s[0:1], 72
    s_load_dwordx2 s[80:81], s[0:1], 16
    s_load_dwordx2 s[82:83], s[0:1], 48
    s_load_dwordx2 s[84:85], s[0:1], 72
    s_load_dwordx2 s[86:87], s[0:1], 72
    s_load_dwordx2 s[88:89], s[0:1], 72
    s_load_dwordx2 s[90:91], s[0:1], 72
    s_cmp_ge_u32 s2, 606
    s_cbranch_scc1 done_prep_kernel_1
    s_waitcnt lgkmcnt(0)
    s_mov_b32 s4, s68
    s_mov_b32 s5, s69
    s_mov_b32 s6, 2621440
    s_and_b32 s5, s5, 0xffff
    s_mov_b32 s7, 0x00020000
    s_mov_b32 s8, s70
    s_mov_b32 s9, s71
    s_mov_b32 s10, 2457600
    s_and_b32 s9, s9, 0xffff
    s_mov_b32 s11, 0x00020000
    s_mov_b32 s12, s72
    s_mov_b32 s13, s73
    s_mov_b32 s14, 1966080
    s_and_b32 s13, s13, 0xffff
    s_mov_b32 s15, 0x00020000
    s_mov_b32 s16, s74
    s_mov_b32 s17, s75
    s_mov_b32 s18, 1966080
    s_and_b32 s17, s17, 0xffff
    s_mov_b32 s19, 0x00020000
    s_add_u32 s20, s76, 0x19000
    s_addc_u32 s21, s77, 0
    s_mov_b32 s22, 131072
    s_and_b32 s21, s21, 0xffff
    s_mov_b32 s23, 0x00020000
    s_add_u32 s24, s78, 0x14000
    s_addc_u32 s25, s79, 0
    s_mov_b32 s26, 20480
    s_and_b32 s25, s25, 0xffff
    s_mov_b32 s27, 0x00020000
    s_mov_b32 s28, s80
    s_mov_b32 s29, s81
    s_mov_b32 s30, 819200
    s_and_b32 s29, s29, 0xffff
    s_mov_b32 s31, 0x00020000
    s_mov_b32 s32, s82
    s_mov_b32 s33, s83
    s_mov_b32 s34, 1966080
    s_and_b32 s33, s33, 0xffff
    s_mov_b32 s35, 0x00020000
    s_add_u32 s48, s84, 0x1ad9000
    s_addc_u32 s49, s85, 0
    s_mov_b32 s50, 2621440
    s_and_b32 s49, s49, 0xffff
    s_mov_b32 s51, 0x00020000
    s_add_u32 s52, s86, 0x1d59000
    s_addc_u32 s53, s87, 0
    s_mov_b32 s54, 3932160
    s_and_b32 s53, s53, 0xffff
    s_mov_b32 s55, 0x00020000
    s_add_u32 s56, s88, 0x2119000
    s_addc_u32 s57, s89, 0
    s_mov_b32 s58, 983040
    s_and_b32 s57, s57, 0xffff
    s_mov_b32 s59, 0x00020000
    s_add_u32 s60, s90, 0x2209000
    s_addc_u32 s61, s91, 0
    s_mov_b32 s62, 1966080
    s_and_b32 s61, s61, 0xffff
    s_mov_b32 s63, 0x00020000
    s_cmp_ge_u32 s2, 462
    s_cbranch_scc1 od_prep_kernel_5
    s_cmp_ge_u32 s2, 302
    s_cbranch_scc1 gu_prep_kernel_4
    s_cmp_ge_u32 s2, 142
    s_cbranch_scc1 wq_prep_kernel_3
    s_cmp_ge_u32 s2, 64
    s_cbranch_scc1 cs_prep_kernel_2
    s_lshl_b32 s36, s2, 8
    v_add_u32 v1, s36, v0
    v_mul_u32_u24 v2, 160, v1
    buffer_load_dwordx4 v[16:19], v2, s[4:7], 0 offen offset:0
    buffer_load_dwordx4 v[20:23], v2, s[4:7], 0 offen offset:16
    buffer_load_dwordx4 v[24:27], v2, s[4:7], 0 offen offset:32
    buffer_load_dwordx4 v[28:31], v2, s[4:7], 0 offen offset:48
    buffer_load_dwordx4 v[32:35], v2, s[4:7], 0 offen offset:64
    buffer_load_dwordx4 v[36:39], v2, s[4:7], 0 offen offset:80
    buffer_load_dwordx4 v[40:43], v2, s[4:7], 0 offen offset:96
    buffer_load_dwordx4 v[44:47], v2, s[4:7], 0 offen offset:112
    buffer_load_dwordx4 v[48:51], v2, s[4:7], 0 offen offset:128
    buffer_load_dwordx4 v[52:55], v2, s[4:7], 0 offen offset:144
    s_waitcnt vmcnt(0)
    v_mov_b32 v4, 0
    v_mov_b32 v5, 0
    v_lshlrev_b32 v6, 16, v16
    v_and_b32 v7, 0xffff0000, v16
    v_add_f32 v4, v4, v6
    v_add_f32 v5, v5, v7
    v_lshlrev_b32 v6, 16, v17
    v_and_b32 v7, 0xffff0000, v17
    v_add_f32 v4, v4, v6
    v_add_f32 v5, v5, v7
    v_lshlrev_b32 v6, 16, v18
    v_and_b32 v7, 0xffff0000, v18
    v_add_f32 v4, v4, v6
    v_add_f32 v5, v5, v7
    v_lshlrev_b32 v6, 16, v19
    v_and_b32 v7, 0xffff0000, v19
    v_add_f32 v4, v4, v6
    v_add_f32 v5, v5, v7
    v_lshlrev_b32 v6, 16, v20
    v_and_b32 v7, 0xffff0000, v20
    v_add_f32 v4, v4, v6
    v_add_f32 v5, v5, v7
    v_lshlrev_b32 v6, 16, v21
    v_and_b32 v7, 0xffff0000, v21
    v_add_f32 v4, v4, v6
    v_add_f32 v5, v5, v7
    v_lshlrev_b32 v6, 16, v22
    v_and_b32 v7, 0xffff0000, v22
    v_add_f32 v4, v4, v6
    v_add_f32 v5, v5, v7
    v_lshlrev_b32 v6, 16, v23
    v_and_b32 v7, 0xffff0000, v23
    v_add_f32 v4, v4, v6
    v_add_f32 v5, v5, v7
    v_lshlrev_b32 v6, 16, v24
    v_and_b32 v7, 0xffff0000, v24
    v_add_f32 v4, v4, v6
    v_add_f32 v5, v5, v7
    v_lshlrev_b32 v6, 16, v25
    v_and_b32 v7, 0xffff0000, v25
    v_add_f32 v4, v4, v6
    v_add_f32 v5, v5, v7
    v_lshlrev_b32 v6, 16, v26
    v_and_b32 v7, 0xffff0000, v26
    v_add_f32 v4, v4, v6
    v_add_f32 v5, v5, v7
    v_lshlrev_b32 v6, 16, v27
    v_and_b32 v7, 0xffff0000, v27
    v_add_f32 v4, v4, v6
    v_add_f32 v5, v5, v7
    v_lshlrev_b32 v6, 16, v28
    v_and_b32 v7, 0xffff0000, v28
    v_add_f32 v4, v4, v6
    v_add_f32 v5, v5, v7
    v_lshlrev_b32 v6, 16, v29
    v_and_b32 v7, 0xffff0000, v29
    v_add_f32 v4, v4, v6
    v_add_f32 v5, v5, v7
    v_lshlrev_b32 v6, 16, v30
    v_and_b32 v7, 0xffff0000, v30
    v_add_f32 v4, v4, v6
    v_add_f32 v5, v5, v7
    v_lshlrev_b32 v6, 16, v31
    v_and_b32 v7, 0xffff0000, v31
    v_add_f32 v4, v4, v6
    v_add_f32 v5, v5, v7
    v_lshlrev_b32 v6, 16, v32
    v_and_b32 v7, 0xffff0000, v32
    v_add_f32 v4, v4, v6
    v_add_f32 v5, v5, v7
    v_lshlrev_b32 v6, 16, v33
    v_and_b32 v7, 0xffff0000, v33
    v_add_f32 v4, v4, v6
    v_add_f32 v5, v5, v7
    v_lshlrev_b32 v6, 16, v34
    v_and_b32 v7, 0xffff0000, v34
    v_add_f32 v4, v4, v6
    v_add_f32 v5, v5, v7
    v_lshlrev_b32 v6, 16, v35
    v_and_b32 v7, 0xffff0000, v35
    v_add_f32 v4, v4, v6
    v_add_f32 v5, v5, v7
    v_lshlrev_b32 v6, 16, v36
    v_and_b32 v7, 0xffff0000, v36
    v_add_f32 v4, v4, v6
    v_add_f32 v5, v5, v7
    v_lshlrev_b32 v6, 16, v37
    v_and_b32 v7, 0xffff0000, v37
    v_add_f32 v4, v4, v6
    v_add_f32 v5, v5, v7
    v_lshlrev_b32 v6, 16, v38
    v_and_b32 v7, 0xffff0000, v38
    v_add_f32 v4, v4, v6
    v_add_f32 v5, v5, v7
    v_lshlrev_b32 v6, 16, v39
    v_and_b32 v7, 0xffff0000, v39
    v_add_f32 v4, v4, v6
    v_add_f32 v5, v5, v7
    v_lshlrev_b32 v6, 16, v40
    v_and_b32 v7, 0xffff0000, v40
    v_add_f32 v4, v4, v6
    v_add_f32 v5, v5, v7
    v_lshlrev_b32 v6, 16, v41
    v_and_b32 v7, 0xffff0000, v41
    v_add_f32 v4, v4, v6
    v_add_f32 v5, v5, v7
    v_lshlrev_b32 v6, 16, v42
    v_and_b32 v7, 0xffff0000, v42
    v_add_f32 v4, v4, v6
    v_add_f32 v5, v5, v7
    v_lshlrev_b32 v6, 16, v43
    v_and_b32 v7, 0xffff0000, v43
    v_add_f32 v4, v4, v6
    v_add_f32 v5, v5, v7
    v_lshlrev_b32 v6, 16, v44
    v_and_b32 v7, 0xffff0000, v44
    v_add_f32 v4, v4, v6
    v_add_f32 v5, v5, v7
    v_lshlrev_b32 v6, 16, v45
    v_and_b32 v7, 0xffff0000, v45
    v_add_f32 v4, v4, v6
    v_add_f32 v5, v5, v7
    v_lshlrev_b32 v6, 16, v46
    v_and_b32 v7, 0xffff0000, v46
    v_add_f32 v4, v4, v6
    v_add_f32 v5, v5, v7
    v_lshlrev_b32 v6, 16, v47
    v_and_b32 v7, 0xffff0000, v47
    v_add_f32 v4, v4, v6
    v_add_f32 v5, v5, v7
    v_lshlrev_b32 v6, 16, v48
    v_and_b32 v7, 0xffff0000, v48
    v_add_f32 v4, v4, v6
    v_add_f32 v5, v5, v7
    v_lshlrev_b32 v6, 16, v49
    v_and_b32 v7, 0xffff0000, v49
    v_add_f32 v4, v4, v6
    v_add_f32 v5, v5, v7
    v_lshlrev_b32 v6, 16, v50
    v_and_b32 v7, 0xffff0000, v50
    v_add_f32 v4, v4, v6
    v_add_f32 v5, v5, v7
    v_lshlrev_b32 v6, 16, v51
    v_and_b32 v7, 0xffff0000, v51
    v_add_f32 v4, v4, v6
    v_add_f32 v5, v5, v7
    v_lshlrev_b32 v6, 16, v52
    v_and_b32 v7, 0xffff0000, v52
    v_add_f32 v4, v4, v6
    v_add_f32 v5, v5, v7
    v_lshlrev_b32 v6, 16, v53
    v_and_b32 v7, 0xffff0000, v53
    v_add_f32 v4, v4, v6
    v_add_f32 v5, v5, v7
    v_lshlrev_b32 v6, 16, v54
    v_and_b32 v7, 0xffff0000, v54
    v_add_f32 v4, v4, v6
    v_add_f32 v5, v5, v7
    v_lshlrev_b32 v6, 16, v55
    v_and_b32 v7, 0xffff0000, v55
    v_add_f32 v4, v4, v6
    v_add_f32 v5, v5, v7
    v_add_f32 v4, v4, v5
    v_mul_f32 v8, 0x3c4ccccd, v4
    v_mov_b32 v5, 0
    v_mov_b32 v9, 0
    v_lshlrev_b32 v6, 16, v16
    v_and_b32 v7, 0xffff0000, v16
    v_sub_f32 v6, v6, v8
    v_sub_f32 v7, v7, v8
    v_fmac_f32 v5, v6, v6
    v_fmac_f32 v9, v7, v7
    v_lshlrev_b32 v6, 16, v17
    v_and_b32 v7, 0xffff0000, v17
    v_sub_f32 v6, v6, v8
    v_sub_f32 v7, v7, v8
    v_fmac_f32 v5, v6, v6
    v_fmac_f32 v9, v7, v7
    v_lshlrev_b32 v6, 16, v18
    v_and_b32 v7, 0xffff0000, v18
    v_sub_f32 v6, v6, v8
    v_sub_f32 v7, v7, v8
    v_fmac_f32 v5, v6, v6
    v_fmac_f32 v9, v7, v7
    v_lshlrev_b32 v6, 16, v19
    v_and_b32 v7, 0xffff0000, v19
    v_sub_f32 v6, v6, v8
    v_sub_f32 v7, v7, v8
    v_fmac_f32 v5, v6, v6
    v_fmac_f32 v9, v7, v7
    v_lshlrev_b32 v6, 16, v20
    v_and_b32 v7, 0xffff0000, v20
    v_sub_f32 v6, v6, v8
    v_sub_f32 v7, v7, v8
    v_fmac_f32 v5, v6, v6
    v_fmac_f32 v9, v7, v7
    v_lshlrev_b32 v6, 16, v21
    v_and_b32 v7, 0xffff0000, v21
    v_sub_f32 v6, v6, v8
    v_sub_f32 v7, v7, v8
    v_fmac_f32 v5, v6, v6
    v_fmac_f32 v9, v7, v7
    v_lshlrev_b32 v6, 16, v22
    v_and_b32 v7, 0xffff0000, v22
    v_sub_f32 v6, v6, v8
    v_sub_f32 v7, v7, v8
    v_fmac_f32 v5, v6, v6
    v_fmac_f32 v9, v7, v7
    v_lshlrev_b32 v6, 16, v23
    v_and_b32 v7, 0xffff0000, v23
    v_sub_f32 v6, v6, v8
    v_sub_f32 v7, v7, v8
    v_fmac_f32 v5, v6, v6
    v_fmac_f32 v9, v7, v7
    v_lshlrev_b32 v6, 16, v24
    v_and_b32 v7, 0xffff0000, v24
    v_sub_f32 v6, v6, v8
    v_sub_f32 v7, v7, v8
    v_fmac_f32 v5, v6, v6
    v_fmac_f32 v9, v7, v7
    v_lshlrev_b32 v6, 16, v25
    v_and_b32 v7, 0xffff0000, v25
    v_sub_f32 v6, v6, v8
    v_sub_f32 v7, v7, v8
    v_fmac_f32 v5, v6, v6
    v_fmac_f32 v9, v7, v7
    v_lshlrev_b32 v6, 16, v26
    v_and_b32 v7, 0xffff0000, v26
    v_sub_f32 v6, v6, v8
    v_sub_f32 v7, v7, v8
    v_fmac_f32 v5, v6, v6
    v_fmac_f32 v9, v7, v7
    v_lshlrev_b32 v6, 16, v27
    v_and_b32 v7, 0xffff0000, v27
    v_sub_f32 v6, v6, v8
    v_sub_f32 v7, v7, v8
    v_fmac_f32 v5, v6, v6
    v_fmac_f32 v9, v7, v7
    v_lshlrev_b32 v6, 16, v28
    v_and_b32 v7, 0xffff0000, v28
    v_sub_f32 v6, v6, v8
    v_sub_f32 v7, v7, v8
    v_fmac_f32 v5, v6, v6
    v_fmac_f32 v9, v7, v7
    v_lshlrev_b32 v6, 16, v29
    v_and_b32 v7, 0xffff0000, v29
    v_sub_f32 v6, v6, v8
    v_sub_f32 v7, v7, v8
    v_fmac_f32 v5, v6, v6
    v_fmac_f32 v9, v7, v7
    v_lshlrev_b32 v6, 16, v30
    v_and_b32 v7, 0xffff0000, v30
    v_sub_f32 v6, v6, v8
    v_sub_f32 v7, v7, v8
    v_fmac_f32 v5, v6, v6
    v_fmac_f32 v9, v7, v7
    v_lshlrev_b32 v6, 16, v31
    v_and_b32 v7, 0xffff0000, v31
    v_sub_f32 v6, v6, v8
    v_sub_f32 v7, v7, v8
    v_fmac_f32 v5, v6, v6
    v_fmac_f32 v9, v7, v7
    v_lshlrev_b32 v6, 16, v32
    v_and_b32 v7, 0xffff0000, v32
    v_sub_f32 v6, v6, v8
    v_sub_f32 v7, v7, v8
    v_fmac_f32 v5, v6, v6
    v_fmac_f32 v9, v7, v7
    v_lshlrev_b32 v6, 16, v33
    v_and_b32 v7, 0xffff0000, v33
    v_sub_f32 v6, v6, v8
    v_sub_f32 v7, v7, v8
    v_fmac_f32 v5, v6, v6
    v_fmac_f32 v9, v7, v7
    v_lshlrev_b32 v6, 16, v34
    v_and_b32 v7, 0xffff0000, v34
    v_sub_f32 v6, v6, v8
    v_sub_f32 v7, v7, v8
    v_fmac_f32 v5, v6, v6
    v_fmac_f32 v9, v7, v7
    v_lshlrev_b32 v6, 16, v35
    v_and_b32 v7, 0xffff0000, v35
    v_sub_f32 v6, v6, v8
    v_sub_f32 v7, v7, v8
    v_fmac_f32 v5, v6, v6
    v_fmac_f32 v9, v7, v7
    v_lshlrev_b32 v6, 16, v36
    v_and_b32 v7, 0xffff0000, v36
    v_sub_f32 v6, v6, v8
    v_sub_f32 v7, v7, v8
    v_fmac_f32 v5, v6, v6
    v_fmac_f32 v9, v7, v7
    v_lshlrev_b32 v6, 16, v37
    v_and_b32 v7, 0xffff0000, v37
    v_sub_f32 v6, v6, v8
    v_sub_f32 v7, v7, v8
    v_fmac_f32 v5, v6, v6
    v_fmac_f32 v9, v7, v7
    v_lshlrev_b32 v6, 16, v38
    v_and_b32 v7, 0xffff0000, v38
    v_sub_f32 v6, v6, v8
    v_sub_f32 v7, v7, v8
    v_fmac_f32 v5, v6, v6
    v_fmac_f32 v9, v7, v7
    v_lshlrev_b32 v6, 16, v39
    v_and_b32 v7, 0xffff0000, v39
    v_sub_f32 v6, v6, v8
    v_sub_f32 v7, v7, v8
    v_fmac_f32 v5, v6, v6
    v_fmac_f32 v9, v7, v7
    v_lshlrev_b32 v6, 16, v40
    v_and_b32 v7, 0xffff0000, v40
    v_sub_f32 v6, v6, v8
    v_sub_f32 v7, v7, v8
    v_fmac_f32 v5, v6, v6
    v_fmac_f32 v9, v7, v7
    v_lshlrev_b32 v6, 16, v41
    v_and_b32 v7, 0xffff0000, v41
    v_sub_f32 v6, v6, v8
    v_sub_f32 v7, v7, v8
    v_fmac_f32 v5, v6, v6
    v_fmac_f32 v9, v7, v7
    v_lshlrev_b32 v6, 16, v42
    v_and_b32 v7, 0xffff0000, v42
    v_sub_f32 v6, v6, v8
    v_sub_f32 v7, v7, v8
    v_fmac_f32 v5, v6, v6
    v_fmac_f32 v9, v7, v7
    v_lshlrev_b32 v6, 16, v43
    v_and_b32 v7, 0xffff0000, v43
    v_sub_f32 v6, v6, v8
    v_sub_f32 v7, v7, v8
    v_fmac_f32 v5, v6, v6
    v_fmac_f32 v9, v7, v7
    v_lshlrev_b32 v6, 16, v44
    v_and_b32 v7, 0xffff0000, v44
    v_sub_f32 v6, v6, v8
    v_sub_f32 v7, v7, v8
    v_fmac_f32 v5, v6, v6
    v_fmac_f32 v9, v7, v7
    v_lshlrev_b32 v6, 16, v45
    v_and_b32 v7, 0xffff0000, v45
    v_sub_f32 v6, v6, v8
    v_sub_f32 v7, v7, v8
    v_fmac_f32 v5, v6, v6
    v_fmac_f32 v9, v7, v7
    v_lshlrev_b32 v6, 16, v46
    v_and_b32 v7, 0xffff0000, v46
    v_sub_f32 v6, v6, v8
    v_sub_f32 v7, v7, v8
    v_fmac_f32 v5, v6, v6
    v_fmac_f32 v9, v7, v7
    v_lshlrev_b32 v6, 16, v47
    v_and_b32 v7, 0xffff0000, v47
    v_sub_f32 v6, v6, v8
    v_sub_f32 v7, v7, v8
    v_fmac_f32 v5, v6, v6
    v_fmac_f32 v9, v7, v7
    v_lshlrev_b32 v6, 16, v48
    v_and_b32 v7, 0xffff0000, v48
    v_sub_f32 v6, v6, v8
    v_sub_f32 v7, v7, v8
    v_fmac_f32 v5, v6, v6
    v_fmac_f32 v9, v7, v7
    v_lshlrev_b32 v6, 16, v49
    v_and_b32 v7, 0xffff0000, v49
    v_sub_f32 v6, v6, v8
    v_sub_f32 v7, v7, v8
    v_fmac_f32 v5, v6, v6
    v_fmac_f32 v9, v7, v7
    v_lshlrev_b32 v6, 16, v50
    v_and_b32 v7, 0xffff0000, v50
    v_sub_f32 v6, v6, v8
    v_sub_f32 v7, v7, v8
    v_fmac_f32 v5, v6, v6
    v_fmac_f32 v9, v7, v7
    v_lshlrev_b32 v6, 16, v51
    v_and_b32 v7, 0xffff0000, v51
    v_sub_f32 v6, v6, v8
    v_sub_f32 v7, v7, v8
    v_fmac_f32 v5, v6, v6
    v_fmac_f32 v9, v7, v7
    v_lshlrev_b32 v6, 16, v52
    v_and_b32 v7, 0xffff0000, v52
    v_sub_f32 v6, v6, v8
    v_sub_f32 v7, v7, v8
    v_fmac_f32 v5, v6, v6
    v_fmac_f32 v9, v7, v7
    v_lshlrev_b32 v6, 16, v53
    v_and_b32 v7, 0xffff0000, v53
    v_sub_f32 v6, v6, v8
    v_sub_f32 v7, v7, v8
    v_fmac_f32 v5, v6, v6
    v_fmac_f32 v9, v7, v7
    v_lshlrev_b32 v6, 16, v54
    v_and_b32 v7, 0xffff0000, v54
    v_sub_f32 v6, v6, v8
    v_sub_f32 v7, v7, v8
    v_fmac_f32 v5, v6, v6
    v_fmac_f32 v9, v7, v7
    v_lshlrev_b32 v6, 16, v55
    v_and_b32 v7, 0xffff0000, v55
    v_sub_f32 v6, v6, v8
    v_sub_f32 v7, v7, v8
    v_fmac_f32 v5, v6, v6
    v_fmac_f32 v9, v7, v7
    v_add_f32 v5, v5, v9
    v_lshlrev_b32 v1, 3, v1
    buffer_store_dwordx2 v[4:5], v1, s[20:23], 0 offen sc1
    s_load_dwordx2 s[64:65], s[0:1], 72
    s_waitcnt lgkmcnt(0)
    s_add_u32 s64, s64, 0x0
    s_addc_u32 s65, s65, 0
    s_and_b32 s65, s65, 0xffff
    s_mov_b32 s66, 81920
    s_mov_b32 s67, 0x00020000
    v_lshlrev_b32 v1, 1, v1
    v_mov_b32 v4, 0
    v_mov_b32 v5, 0
    v_mov_b32 v6, 0
    v_mov_b32 v7, 0
    s_nop 1
    buffer_store_dwordx4 v[4:7], v1, s[64:67], 0 offen sc1
    s_branch done_prep_kernel_1
cs_prep_kernel_2:
    s_sub_u32 s36, s2, 64
    s_mov_b32 s37, 3840
    s_mov_b32 s38, 0
    s_mov_b64 s[40:41], s[8:9]
    s_mov_b32 s42, s10
    s_mov_b32 s39, s36
    s_cmp_lt_u32 s36, 30
    s_cbranch_scc1 m_prep_kernel_6
    s_mov_b32 s37, 3072
    s_mov_b32 s38, 2048
    s_mov_b64 s[40:41], s[12:13]
    s_mov_b32 s42, s14
    s_sub_u32 s39, s36, 30
    s_cmp_lt_u32 s36, 54
    s_cbranch_scc1 m_prep_kernel_6
    s_mov_b32 s38, 3584
    s_mov_b64 s[40:41], s[16:17]
    s_sub_u32 s39, s36, 54
m_prep_kernel_6:
    s_mov_b32 s43, 0x00020000
    v_lshrrev_b32 v1, 4, v0
    v_mul_u32_u24 v1, 40, v1
    v_mul_lo_u32 v1, v1, s37
    v_and_b32 v2, 15, v0
    v_lshl_add_u32 v1, v2, 3, v1
    s_lshl_b32 s44, s39, 7
    v_add_u32 v1, s44, v1
    s_mov_b32 s45, 0
    buffer_load_dwordx2 v[16:17], v1, s[40:43], s45 offen
    s_add_u32 s45, s45, s37
    buffer_load_dwordx2 v[18:19], v1, s[40:43], s45 offen
    s_add_u32 s45, s45, s37
    buffer_load_dwordx2 v[20:21], v1, s[40:43], s45 offen
    s_add_u32 s45, s45, s37
    buffer_load_dwordx2 v[22:23], v1, s[40:43], s45 offen
    s_add_u32 s45, s45, s37
    buffer_load_dwordx2 v[24:25], v1, s[40:43], s45 offen
    s_add_u32 s45, s45, s37
    buffer_load_dwordx2 v[26:27], v1, s[40:43], s45 offen
    s_add_u32 s45, s45, s37
    buffer_load_dwordx2 v[28:29], v1, s[40:43], s45 offen
    s_add_u32 s45, s45, s37
    buffer_load_dwordx2 v[30:31], v1, s[40:43], s45 offen
    s_add_u32 s45, s45, s37
    buffer_load_dwordx2 v[32:33], v1, s[40:43], s45 offen
    s_add_u32 s45, s45, s37
    buffer_load_dwordx2 v[34:35], v1, s[40:43], s45 offen
    s_add_u32 s45, s45, s37
    buffer_load_dwordx2 v[36:37], v1, s[40:43], s45 offen
    s_add_u32 s45, s45, s37
    buffer_load_dwordx2 v[38:39], v1, s[40:43], s45 offen
    s_add_u32 s45, s45, s37
    buffer_load_dwordx2 v[40:41], v1, s[40:43], s45 offen
    s_add_u32 s45, s45, s37
    buffer_load_dwordx2 v[42:43], v1, s[40:43], s45 offen
    s_add_u32 s45, s45, s37
    buffer_load_dwordx2 v[44:45], v1, s[40:43], s45 offen
    s_add_u32 s45, s45, s37
    buffer_load_dwordx2 v[46:47], v1, s[40:43], s45 offen
    s_add_u32 s45, s45, s37
    buffer_load_dwordx2 v[48:49], v1, s[40:43], s45 offen
    s_add_u32 s45, s45, s37
    buffer_load_dwordx2 v[50:51], v1, s[40:43], s45 offen
    s_add_u32 s45, s45, s37
    buffer_load_dwordx2 v[52:53], v1, s[40:43], s45 offen
    s_add_u32 s45, s45, s37
    buffer_load_dwordx2 v[54:55], v1, s[40:43], s45 offen
    s_add_u32 s45, s45, s37
    buffer_load_dwordx2 v[56:57], v1, s[40:43], s45 offen
    s_add_u32 s45, s45, s37
    buffer_load_dwordx2 v[58:59], v1, s[40:43], s45 offen
    s_add_u32 s45, s45, s37
    buffer_load_dwordx2 v[60:61], v1, s[40:43], s45 offen
    s_add_u32 s45, s45, s37
    buffer_load_dwordx2 v[62:63], v1, s[40:43], s45 offen
    s_add_u32 s45, s45, s37
    buffer_load_dwordx2 v[64:65], v1, s[40:43], s45 offen
    s_add_u32 s45, s45, s37
    buffer_load_dwordx2 v[66:67], v1, s[40:43], s45 offen
    s_add_u32 s45, s45, s37
    buffer_load_dwordx2 v[68:69], v1, s[40:43], s45 offen
    s_add_u32 s45, s45, s37
    buffer_load_dwordx2 v[70:71], v1, s[40:43], s45 offen
    s_add_u32 s45, s45, s37
    buffer_load_dwordx2 v[72:73], v1, s[40:43], s45 offen
    s_add_u32 s45, s45, s37
    buffer_load_dwordx2 v[74:75], v1, s[40:43], s45 offen
    s_add_u32 s45, s45, s37
    buffer_load_dwordx2 v[76:77], v1, s[40:43], s45 offen
    s_add_u32 s45, s45, s37
    buffer_load_dwordx2 v[78:79], v1, s[40:43], s45 offen
    s_add_u32 s45, s45, s37
    buffer_load_dwordx2 v[80:81], v1, s[40:43], s45 offen
    s_add_u32 s45, s45, s37
    buffer_load_dwordx2 v[82:83], v1, s[40:43], s45 offen
    s_add_u32 s45, s45, s37
    buffer_load_dwordx2 v[84:85], v1, s[40:43], s45 offen
    s_add_u32 s45, s45, s37
    buffer_load_dwordx2 v[86:87], v1, s[40:43], s45 offen
    s_add_u32 s45, s45, s37
    buffer_load_dwordx2 v[88:89], v1, s[40:43], s45 offen
    s_add_u32 s45, s45, s37
    buffer_load_dwordx2 v[90:91], v1, s[40:43], s45 offen
    s_add_u32 s45, s45, s37
    buffer_load_dwordx2 v[92:93], v1, s[40:43], s45 offen
    s_add_u32 s45, s45, s37
    buffer_load_dwordx2 v[94:95], v1, s[40:43], s45 offen
    s_add_u32 s45, s45, s37
    v_mov_b32 v4, 0
    v_mov_b32 v5, 0
    v_mov_b32 v6, 0
    v_mov_b32 v7, 0
    s_waitcnt vmcnt(0)
    v_lshlrev_b32 v8, 16, v16
    v_and_b32 v9, 0xffff0000, v16
    v_lshlrev_b32 v10, 16, v17
    v_and_b32 v11, 0xffff0000, v17
    v_add_f32 v4, v4, v8
    v_add_f32 v5, v5, v9
    v_add_f32 v6, v6, v10
    v_add_f32 v7, v7, v11
    v_lshlrev_b32 v8, 16, v18
    v_and_b32 v9, 0xffff0000, v18
    v_lshlrev_b32 v10, 16, v19
    v_and_b32 v11, 0xffff0000, v19
    v_add_f32 v4, v4, v8
    v_add_f32 v5, v5, v9
    v_add_f32 v6, v6, v10
    v_add_f32 v7, v7, v11
    v_lshlrev_b32 v8, 16, v20
    v_and_b32 v9, 0xffff0000, v20
    v_lshlrev_b32 v10, 16, v21
    v_and_b32 v11, 0xffff0000, v21
    v_add_f32 v4, v4, v8
    v_add_f32 v5, v5, v9
    v_add_f32 v6, v6, v10
    v_add_f32 v7, v7, v11
    v_lshlrev_b32 v8, 16, v22
    v_and_b32 v9, 0xffff0000, v22
    v_lshlrev_b32 v10, 16, v23
    v_and_b32 v11, 0xffff0000, v23
    v_add_f32 v4, v4, v8
    v_add_f32 v5, v5, v9
    v_add_f32 v6, v6, v10
    v_add_f32 v7, v7, v11
    v_lshlrev_b32 v8, 16, v24
    v_and_b32 v9, 0xffff0000, v24
    v_lshlrev_b32 v10, 16, v25
    v_and_b32 v11, 0xffff0000, v25
    v_add_f32 v4, v4, v8
    v_add_f32 v5, v5, v9
    v_add_f32 v6, v6, v10
    v_add_f32 v7, v7, v11
    v_lshlrev_b32 v8, 16, v26
    v_and_b32 v9, 0xffff0000, v26
    v_lshlrev_b32 v10, 16, v27
    v_and_b32 v11, 0xffff0000, v27
    v_add_f32 v4, v4, v8
    v_add_f32 v5, v5, v9
    v_add_f32 v6, v6, v10
    v_add_f32 v7, v7, v11
    v_lshlrev_b32 v8, 16, v28
    v_and_b32 v9, 0xffff0000, v28
    v_lshlrev_b32 v10, 16, v29
    v_and_b32 v11, 0xffff0000, v29
    v_add_f32 v4, v4, v8
    v_add_f32 v5, v5, v9
    v_add_f32 v6, v6, v10
    v_add_f32 v7, v7, v11
    v_lshlrev_b32 v8, 16, v30
    v_and_b32 v9, 0xffff0000, v30
    v_lshlrev_b32 v10, 16, v31
    v_and_b32 v11, 0xffff0000, v31
    v_add_f32 v4, v4, v8
    v_add_f32 v5, v5, v9
    v_add_f32 v6, v6, v10
    v_add_f32 v7, v7, v11
    v_lshlrev_b32 v8, 16, v32
    v_and_b32 v9, 0xffff0000, v32
    v_lshlrev_b32 v10, 16, v33
    v_and_b32 v11, 0xffff0000, v33
    v_add_f32 v4, v4, v8
    v_add_f32 v5, v5, v9
    v_add_f32 v6, v6, v10
    v_add_f32 v7, v7, v11
    v_lshlrev_b32 v8, 16, v34
    v_and_b32 v9, 0xffff0000, v34
    v_lshlrev_b32 v10, 16, v35
    v_and_b32 v11, 0xffff0000, v35
    v_add_f32 v4, v4, v8
    v_add_f32 v5, v5, v9
    v_add_f32 v6, v6, v10
    v_add_f32 v7, v7, v11
    v_lshlrev_b32 v8, 16, v36
    v_and_b32 v9, 0xffff0000, v36
    v_lshlrev_b32 v10, 16, v37
    v_and_b32 v11, 0xffff0000, v37
    v_add_f32 v4, v4, v8
    v_add_f32 v5, v5, v9
    v_add_f32 v6, v6, v10
    v_add_f32 v7, v7, v11
    v_lshlrev_b32 v8, 16, v38
    v_and_b32 v9, 0xffff0000, v38
    v_lshlrev_b32 v10, 16, v39
    v_and_b32 v11, 0xffff0000, v39
    v_add_f32 v4, v4, v8
    v_add_f32 v5, v5, v9
    v_add_f32 v6, v6, v10
    v_add_f32 v7, v7, v11
    v_lshlrev_b32 v8, 16, v40
    v_and_b32 v9, 0xffff0000, v40
    v_lshlrev_b32 v10, 16, v41
    v_and_b32 v11, 0xffff0000, v41
    v_add_f32 v4, v4, v8
    v_add_f32 v5, v5, v9
    v_add_f32 v6, v6, v10
    v_add_f32 v7, v7, v11
    v_lshlrev_b32 v8, 16, v42
    v_and_b32 v9, 0xffff0000, v42
    v_lshlrev_b32 v10, 16, v43
    v_and_b32 v11, 0xffff0000, v43
    v_add_f32 v4, v4, v8
    v_add_f32 v5, v5, v9
    v_add_f32 v6, v6, v10
    v_add_f32 v7, v7, v11
    v_lshlrev_b32 v8, 16, v44
    v_and_b32 v9, 0xffff0000, v44
    v_lshlrev_b32 v10, 16, v45
    v_and_b32 v11, 0xffff0000, v45
    v_add_f32 v4, v4, v8
    v_add_f32 v5, v5, v9
    v_add_f32 v6, v6, v10
    v_add_f32 v7, v7, v11
    v_lshlrev_b32 v8, 16, v46
    v_and_b32 v9, 0xffff0000, v46
    v_lshlrev_b32 v10, 16, v47
    v_and_b32 v11, 0xffff0000, v47
    v_add_f32 v4, v4, v8
    v_add_f32 v5, v5, v9
    v_add_f32 v6, v6, v10
    v_add_f32 v7, v7, v11
    v_lshlrev_b32 v8, 16, v48
    v_and_b32 v9, 0xffff0000, v48
    v_lshlrev_b32 v10, 16, v49
    v_and_b32 v11, 0xffff0000, v49
    v_add_f32 v4, v4, v8
    v_add_f32 v5, v5, v9
    v_add_f32 v6, v6, v10
    v_add_f32 v7, v7, v11
    v_lshlrev_b32 v8, 16, v50
    v_and_b32 v9, 0xffff0000, v50
    v_lshlrev_b32 v10, 16, v51
    v_and_b32 v11, 0xffff0000, v51
    v_add_f32 v4, v4, v8
    v_add_f32 v5, v5, v9
    v_add_f32 v6, v6, v10
    v_add_f32 v7, v7, v11
    v_lshlrev_b32 v8, 16, v52
    v_and_b32 v9, 0xffff0000, v52
    v_lshlrev_b32 v10, 16, v53
    v_and_b32 v11, 0xffff0000, v53
    v_add_f32 v4, v4, v8
    v_add_f32 v5, v5, v9
    v_add_f32 v6, v6, v10
    v_add_f32 v7, v7, v11
    v_lshlrev_b32 v8, 16, v54
    v_and_b32 v9, 0xffff0000, v54
    v_lshlrev_b32 v10, 16, v55
    v_and_b32 v11, 0xffff0000, v55
    v_add_f32 v4, v4, v8
    v_add_f32 v5, v5, v9
    v_add_f32 v6, v6, v10
    v_add_f32 v7, v7, v11
    v_lshlrev_b32 v8, 16, v56
    v_and_b32 v9, 0xffff0000, v56
    v_lshlrev_b32 v10, 16, v57
    v_and_b32 v11, 0xffff0000, v57
    v_add_f32 v4, v4, v8
    v_add_f32 v5, v5, v9
    v_add_f32 v6, v6, v10
    v_add_f32 v7, v7, v11
    v_lshlrev_b32 v8, 16, v58
    v_and_b32 v9, 0xffff0000, v58
    v_lshlrev_b32 v10, 16, v59
    v_and_b32 v11, 0xffff0000, v59
    v_add_f32 v4, v4, v8
    v_add_f32 v5, v5, v9
    v_add_f32 v6, v6, v10
    v_add_f32 v7, v7, v11
    v_lshlrev_b32 v8, 16, v60
    v_and_b32 v9, 0xffff0000, v60
    v_lshlrev_b32 v10, 16, v61
    v_and_b32 v11, 0xffff0000, v61
    v_add_f32 v4, v4, v8
    v_add_f32 v5, v5, v9
    v_add_f32 v6, v6, v10
    v_add_f32 v7, v7, v11
    v_lshlrev_b32 v8, 16, v62
    v_and_b32 v9, 0xffff0000, v62
    v_lshlrev_b32 v10, 16, v63
    v_and_b32 v11, 0xffff0000, v63
    v_add_f32 v4, v4, v8
    v_add_f32 v5, v5, v9
    v_add_f32 v6, v6, v10
    v_add_f32 v7, v7, v11
    v_lshlrev_b32 v8, 16, v64
    v_and_b32 v9, 0xffff0000, v64
    v_lshlrev_b32 v10, 16, v65
    v_and_b32 v11, 0xffff0000, v65
    v_add_f32 v4, v4, v8
    v_add_f32 v5, v5, v9
    v_add_f32 v6, v6, v10
    v_add_f32 v7, v7, v11
    v_lshlrev_b32 v8, 16, v66
    v_and_b32 v9, 0xffff0000, v66
    v_lshlrev_b32 v10, 16, v67
    v_and_b32 v11, 0xffff0000, v67
    v_add_f32 v4, v4, v8
    v_add_f32 v5, v5, v9
    v_add_f32 v6, v6, v10
    v_add_f32 v7, v7, v11
    v_lshlrev_b32 v8, 16, v68
    v_and_b32 v9, 0xffff0000, v68
    v_lshlrev_b32 v10, 16, v69
    v_and_b32 v11, 0xffff0000, v69
    v_add_f32 v4, v4, v8
    v_add_f32 v5, v5, v9
    v_add_f32 v6, v6, v10
    v_add_f32 v7, v7, v11
    v_lshlrev_b32 v8, 16, v70
    v_and_b32 v9, 0xffff0000, v70
    v_lshlrev_b32 v10, 16, v71
    v_and_b32 v11, 0xffff0000, v71
    v_add_f32 v4, v4, v8
    v_add_f32 v5, v5, v9
    v_add_f32 v6, v6, v10
    v_add_f32 v7, v7, v11
    v_lshlrev_b32 v8, 16, v72
    v_and_b32 v9, 0xffff0000, v72
    v_lshlrev_b32 v10, 16, v73
    v_and_b32 v11, 0xffff0000, v73
    v_add_f32 v4, v4, v8
    v_add_f32 v5, v5, v9
    v_add_f32 v6, v6, v10
    v_add_f32 v7, v7, v11
    v_lshlrev_b32 v8, 16, v74
    v_and_b32 v9, 0xffff0000, v74
    v_lshlrev_b32 v10, 16, v75
    v_and_b32 v11, 0xffff0000, v75
    v_add_f32 v4, v4, v8
    v_add_f32 v5, v5, v9
    v_add_f32 v6, v6, v10
    v_add_f32 v7, v7, v11
    v_lshlrev_b32 v8, 16, v76
    v_and_b32 v9, 0xffff0000, v76
    v_lshlrev_b32 v10, 16, v77
    v_and_b32 v11, 0xffff0000, v77
    v_add_f32 v4, v4, v8
    v_add_f32 v5, v5, v9
    v_add_f32 v6, v6, v10
    v_add_f32 v7, v7, v11
    v_lshlrev_b32 v8, 16, v78
    v_and_b32 v9, 0xffff0000, v78
    v_lshlrev_b32 v10, 16, v79
    v_and_b32 v11, 0xffff0000, v79
    v_add_f32 v4, v4, v8
    v_add_f32 v5, v5, v9
    v_add_f32 v6, v6, v10
    v_add_f32 v7, v7, v11
    v_lshlrev_b32 v8, 16, v80
    v_and_b32 v9, 0xffff0000, v80
    v_lshlrev_b32 v10, 16, v81
    v_and_b32 v11, 0xffff0000, v81
    v_add_f32 v4, v4, v8
    v_add_f32 v5, v5, v9
    v_add_f32 v6, v6, v10
    v_add_f32 v7, v7, v11
    v_lshlrev_b32 v8, 16, v82
    v_and_b32 v9, 0xffff0000, v82
    v_lshlrev_b32 v10, 16, v83
    v_and_b32 v11, 0xffff0000, v83
    v_add_f32 v4, v4, v8
    v_add_f32 v5, v5, v9
    v_add_f32 v6, v6, v10
    v_add_f32 v7, v7, v11
    v_lshlrev_b32 v8, 16, v84
    v_and_b32 v9, 0xffff0000, v84
    v_lshlrev_b32 v10, 16, v85
    v_and_b32 v11, 0xffff0000, v85
    v_add_f32 v4, v4, v8
    v_add_f32 v5, v5, v9
    v_add_f32 v6, v6, v10
    v_add_f32 v7, v7, v11
    v_lshlrev_b32 v8, 16, v86
    v_and_b32 v9, 0xffff0000, v86
    v_lshlrev_b32 v10, 16, v87
    v_and_b32 v11, 0xffff0000, v87
    v_add_f32 v4, v4, v8
    v_add_f32 v5, v5, v9
    v_add_f32 v6, v6, v10
    v_add_f32 v7, v7, v11
    v_lshlrev_b32 v8, 16, v88
    v_and_b32 v9, 0xffff0000, v88
    v_lshlrev_b32 v10, 16, v89
    v_and_b32 v11, 0xffff0000, v89
    v_add_f32 v4, v4, v8
    v_add_f32 v5, v5, v9
    v_add_f32 v6, v6, v10
    v_add_f32 v7, v7, v11
    v_lshlrev_b32 v8, 16, v90
    v_and_b32 v9, 0xffff0000, v90
    v_lshlrev_b32 v10, 16, v91
    v_and_b32 v11, 0xffff0000, v91
    v_add_f32 v4, v4, v8
    v_add_f32 v5, v5, v9
    v_add_f32 v6, v6, v10
    v_add_f32 v7, v7, v11
    v_lshlrev_b32 v8, 16, v92
    v_and_b32 v9, 0xffff0000, v92
    v_lshlrev_b32 v10, 16, v93
    v_and_b32 v11, 0xffff0000, v93
    v_add_f32 v4, v4, v8
    v_add_f32 v5, v5, v9
    v_add_f32 v6, v6, v10
    v_add_f32 v7, v7, v11
    v_lshlrev_b32 v8, 16, v94
    v_and_b32 v9, 0xffff0000, v94
    v_lshlrev_b32 v10, 16, v95
    v_and_b32 v11, 0xffff0000, v95
    v_add_f32 v4, v4, v8
    v_add_f32 v5, v5, v9
    v_add_f32 v6, v6, v10
    v_add_f32 v7, v7, v11
    v_lshlrev_b32 v2, 4, v0
    ds_write_b128 v2, v[4:7]
    s_waitcnt lgkmcnt(0)
    s_barrier
    v_and_b32 v3, 63, v0
    v_lshlrev_b32 v2, 2, v3
    ds_read_b32 v16, v2 offset:0
    ds_read_b32 v17, v2 offset:256
    ds_read_b32 v18, v2 offset:512
    ds_read_b32 v19, v2 offset:768
    ds_read_b32 v20, v2 offset:1024
    ds_read_b32 v21, v2 offset:1280
    ds_read_b32 v22, v2 offset:1536
    ds_read_b32 v23, v2 offset:1792
    ds_read_b32 v24, v2 offset:2048
    ds_read_b32 v25, v2 offset:2304
    ds_read_b32 v26, v2 offset:2560
    ds_read_b32 v27, v2 offset:2816
    ds_read_b32 v28, v2 offset:3072
    ds_read_b32 v29, v2 offset:3328
    ds_read_b32 v30, v2 offset:3584
    ds_read_b32 v31, v2 offset:3840
    s_waitcnt lgkmcnt(0)
    v_add_f32 v16, v16, v17
    v_add_f32 v16, v16, v18
    v_add_f32 v16, v16, v19
    v_add_f32 v16, v16, v20
    v_add_f32 v16, v16, v21
    v_add_f32 v16, v16, v22
    v_add_f32 v16, v16, v23
    v_add_f32 v16, v16, v24
    v_add_f32 v16, v16, v25
    v_add_f32 v16, v16, v26
    v_add_f32 v16, v16, v27
    v_add_f32 v16, v16, v28
    v_add_f32 v16, v16, v29
    v_add_f32 v16, v16, v30
    v_add_f32 v16, v16, v31
    s_lshl_b32 s44, s39, 6
    v_add_u32 v3, s44, v3
    v_add_u32 v2, s38, v3
    s_cmp_lg_u32 s38, 0
    s_cbranch_scc1 nq_prep_kernel_7
    s_mov_b32 s44, 52429
    v_mul_lo_u32 v4, v3, s44
    v_lshrrev_b32 v4, 20, v4
    v_mul_u32_u24 v5, 20, v4
    v_sub_u32 v5, v3, v5
    v_lshrrev_b32 v6, 5, v4
    v_and_b32 v4, 31, v4
    v_mul_u32_u24 v6, 20, v6
    v_add_u32 v5, v5, v6
    v_lshl_add_u32 v2, v4, 6, v5
nq_prep_kernel_7:
    v_lshlrev_b32 v2, 2, v2
    v_cmp_gt_u32 vcc, 64, v0
    s_and_saveexec_b64 s[46:47], vcc
    s_cbranch_execz done_prep_kernel_1
    buffer_store_dword v16, v2, s[24:27], 0 offen sc1
    s_branch done_prep_kernel_1
wq_prep_kernel_3:
    s_sub_u32 s36, s2, 142
    s_mul_hi_u32 s37, s36, 0x1999999a
    s_mul_i32 s38, s37, 10
    s_sub_u32 s38, s36, s38
    v_lshrrev_b32 v1, 5, v0
    v_and_b32 v2, 31, v0
    v_lshrrev_b32 v3, 1, v2
    v_and_b32 v4, 3, v1
    v_lshlrev_b32 v4, 2, v4
    v_xor_b32 v3, v3, v4
    v_and_b32 v4, 1, v2
    v_lshl_add_u32 v3, v3, 1, v4
    v_lshrrev_b32 v4, 4, v3
    v_and_b32 v3, 15, v3
    v_mul_u32_u24 v5, 52, v3
    v_lshrrev_b32 v5, 8, v5
    v_mul_u32_u24 v6, 5, v5
    v_sub_u32 v6, v3, v6
    s_lshl_b32 s39, s37, 1
    v_add_u32 v4, s39, v4
    v_mul_u32_u24 v4, 40, v4
    v_mul_u32_u24 v5, 1280, v5
    v_add_u32 v4, v4, v5
    v_lshl_add_u32 v4, v6, 3, v4
    s_lshl_b32 s39, s38, 6
    v_add_u32 v1, s39, v1
    v_mul_u32_u24 v1, 3840, v1
    v_add_u32 v1, v1, v4
    v_cmp_eq_u32 vcc, 15, v3
    v_mov_b32 v5, 0x7ffffff0
    s_nop 0
    v_cndmask_b32 v1, v1, v5, vcc
    s_mov_b32 s39, 0
    buffer_load_dwordx2 v[16:17], v1, s[8:11], s39 offen
    s_mov_b32 s39, 30720
    buffer_load_dwordx2 v[18:19], v1, s[8:11], s39 offen
    s_mov_b32 s39, 61440
    buffer_load_dwordx2 v[20:21], v1, s[8:11], s39 offen
    s_mov_b32 s39, 92160
    buffer_load_dwordx2 v[22:23], v1, s[8:11], s39 offen
    s_mov_b32 s39, 122880
    buffer_load_dwordx2 v[24:25], v1, s[8:11], s39 offen
    s_mov_b32 s39, 153600
    buffer_load_dwordx2 v[26:27], v1, s[8:11], s39 offen
    s_mov_b32 s39, 184320
    buffer_load_dwordx2 v[28:29], v1, s[8:11], s39 offen
    s_mov_b32 s39, 215040
    buffer_load_dwordx2 v[30:31], v1, s[8:11], s39 offen
    s_lshl_b32 s39, s36, 14
    v_lshlrev_b32 v2, 3, v0
    s_waitcnt vmcnt(7)
    s_add_u32 s40, s39, 0
    buffer_store_dwordx2 v[16:17], v2, s[48:51], s40 offen sc1
    s_waitcnt vmcnt(6)
    s_add_u32 s40, s39, 2048
    buffer_store_dwordx2 v[18:19], v2, s[48:51], s40 offen sc1
    s_waitcnt vmcnt(5)
    s_add_u32 s40, s39, 4096
    buffer_store_dwordx2 v[20:21], v2, s[48:51], s40 offen sc1
    s_waitcnt vmcnt(4)
    s_add_u32 s40, s39, 6144
    buffer_store_dwordx2 v[22:23], v2, s[48:51], s40 offen sc1
    s_waitcnt vmcnt(3)
    s_add_u32 s40, s39, 8192
    buffer_store_dwordx2 v[24:25], v2, s[48:51], s40 offen sc1
    s_waitcnt vmcnt(2)
    s_add_u32 s40, s39, 10240
    buffer_store_dwordx2 v[26:27], v2, s[48:51], s40 offen sc1
    s_waitcnt vmcnt(1)
    s_add_u32 s40, s39, 12288
    buffer_store_dwordx2 v[28:29], v2, s[48:51], s40 offen sc1
    s_waitcnt vmcnt(0)
    s_add_u32 s40, s39, 14336
    buffer_store_dwordx2 v[30:31], v2, s[48:51], s40 offen sc1
    s_branch done_prep_kernel_1
gu_prep_kernel_4:
    s_sub_u32 s36, s2, 302
    s_mul_hi_u32 s37, s36, 0x1999999a
    s_mul_i32 s38, s37, 10
    s_sub_u32 s38, s36, s38
    s_mov_b32 s40, 43691
    s_mul_i32 s41, s37, 192
    s_mul_i32 s42, s38, 196608
    s_add_u32 s41, s41, s42
    v_add_u32 v1, 0, v0
    v_mul_lo_u32 v2, v1, s40
    v_lshrrev_b32 v2, 19, v2
    v_mul_u32_u24 v3, 12, v2
    v_sub_u32 v3, v1, v3
    v_mul_u32_u24 v2, 3072, v2
    v_lshl_add_u32 v2, v3, 4, v2
    buffer_load_dwordx4 v[16:19], v2, s[12:15], s41 offen
    buffer_load_dwordx4 v[32:35], v2, s[16:19], s41 offen
    v_add_u32 v1, 256, v0
    v_mul_lo_u32 v2, v1, s40
    v_lshrrev_b32 v2, 19, v2
    v_mul_u32_u24 v3, 12, v2
    v_sub_u32 v3, v1, v3
    v_mul_u32_u24 v2, 3072, v2
    v_lshl_add_u32 v2, v3, 4, v2
    buffer_load_dwordx4 v[20:23], v2, s[12:15], s41 offen
    buffer_load_dwordx4 v[36:39], v2, s[16:19], s41 offen
    v_add_u32 v1, 512, v0
    v_mul_lo_u32 v2, v1, s40
    v_lshrrev_b32 v2, 19, v2
    v_mul_u32_u24 v3, 12, v2
    v_sub_u32 v3, v1, v3
    v_mul_u32_u24 v2, 3072, v2
    v_lshl_add_u32 v2, v3, 4, v2
    buffer_load_dwordx4 v[24:27], v2, s[12:15], s41 offen
    buffer_load_dwordx4 v[40:43], v2, s[16:19], s41 offen
    s_mul_i32 s39, s36, 24576
    v_lshlrev_b32 v2, 4, v0
    s_waitcnt vmcnt(0)
    s_add_u32 s40, s39, 0
    buffer_store_dwordx4 v[16:19], v2, s[52:55], s40 offen sc1
    s_add_u32 s40, s39, 12288
    buffer_store_dwordx4 v[32:35], v2, s[52:55], s40 offen sc1
    s_add_u32 s40, s39, 4096
    buffer_store_dwordx4 v[20:23], v2, s[52:55], s40 offen sc1
    s_add_u32 s40, s39, 16384
    buffer_store_dwordx4 v[36:39], v2, s[52:55], s40 offen sc1
    s_add_u32 s40, s39, 8192
    buffer_store_dwordx4 v[24:27], v2, s[52:55], s40 offen sc1
    s_add_u32 s40, s39, 20480
    buffer_store_dwordx4 v[40:43], v2, s[52:55], s40 offen sc1
    s_branch done_prep_kernel_1
od_prep_kernel_5:
    s_sub_u32 s36, s2, 462
    s_mul_hi_u32 s37, s36, 0x2aaaaaab
    s_mul_i32 s38, s37, 6
    s_sub_u32 s38, s36, s38
    s_mov_b64 s[40:41], s[28:29]
    s_mov_b32 s42, s30
    s_mov_b64 s[44:45], s[56:57]
    s_mov_b32 s46, s58
    s_mov_b32 s39, s36
    s_mov_b32 s67, 1
    s_cmp_lt_u32 s36, 48
    s_cbranch_scc1 isd_prep_kernel_8
    s_sub_u32 s39, s36, 48
    s_mul_hi_u32 s37, s39, 0x15555556
    s_mul_i32 s38, s37, 12
    s_sub_u32 s38, s39, s38
    s_mov_b64 s[40:41], s[32:33]
    s_mov_b32 s42, s34
    s_mov_b64 s[44:45], s[60:61]
    s_mov_b32 s46, s62
    s_mov_b32 s67, 0
isd_prep_kernel_8:
    s_mov_b32 s43, 0x00020000
    s_mov_b32 s47, 0x00020000
    s_mov_b32 s64, 52429
    s_mul_i32 s65, s37, 160
    s_lshl_b32 s66, s38, 7
    v_mov_b32 v8, 0x7ffffff0
    v_add_u32 v1, 0, v0
    v_mul_lo_u32 v2, v1, s64
    v_lshrrev_b32 v2, 19, v2
    v_mul_u32_u24 v3, 10, v2
    v_sub_u32 v3, v1, v3
    v_add_u32 v2, s66, v2
    s_mov_b64 vcc, 0
    s_cmp_eq_u32 s67, 0
    s_cbranch_scc1 nt_prep_kernel_9
    v_mul_u32_u24 v4, 2731, v2
    v_lshrrev_b32 v4, 16, v4
    v_mul_u32_u24 v5, 24, v4
    v_sub_u32 v5, v2, v5
    v_mul_u32_u24 v4, 20, v4
    v_add_u32 v2, v4, v5
    v_cmp_le_u32 vcc, 20, v5
nt_prep_kernel_9:
    v_mul_u32_u24 v2, 1280, v2
    v_lshl_add_u32 v2, v3, 4, v2
    s_nop 1
    v_cndmask_b32 v2, v2, v8, vcc
    buffer_load_dwordx4 v[16:19], v2, s[40:43], s65 offen
    v_add_u32 v1, 256, v0
    v_mul_lo_u32 v2, v1, s64
    v_lshrrev_b32 v2, 19, v2
    v_mul_u32_u24 v3, 10, v2
    v_sub_u32 v3, v1, v3
    v_add_u32 v2, s66, v2
    s_mov_b64 vcc, 0
    s_cmp_eq_u32 s67, 0
    s_cbranch_scc1 nt_prep_kernel_10
    v_mul_u32_u24 v4, 2731, v2
    v_lshrrev_b32 v4, 16, v4
    v_mul_u32_u24 v5, 24, v4
    v_sub_u32 v5, v2, v5
    v_mul_u32_u24 v4, 20, v4
    v_add_u32 v2, v4, v5
    v_cmp_le_u32 vcc, 20, v5
nt_prep_kernel_10:
    v_mul_u32_u24 v2, 1280, v2
    v_lshl_add_u32 v2, v3, 4, v2
    s_nop 1
    v_cndmask_b32 v2, v2, v8, vcc
    buffer_load_dwordx4 v[20:23], v2, s[40:43], s65 offen
    v_add_u32 v1, 512, v0
    v_mul_lo_u32 v2, v1, s64
    v_lshrrev_b32 v2, 19, v2
    v_mul_u32_u24 v3, 10, v2
    v_sub_u32 v3, v1, v3
    v_add_u32 v2, s66, v2
    s_mov_b64 vcc, 0
    s_cmp_eq_u32 s67, 0
    s_cbranch_scc1 nt_prep_kernel_11
    v_mul_u32_u24 v4, 2731, v2
    v_lshrrev_b32 v4, 16, v4
    v_mul_u32_u24 v5, 24, v4
    v_sub_u32 v5, v2, v5
    v_mul_u32_u24 v4, 20, v4
    v_add_u32 v2, v4, v5
    v_cmp_le_u32 vcc, 20, v5
nt_prep_kernel_11:
    v_mul_u32_u24 v2, 1280, v2
    v_lshl_add_u32 v2, v3, 4, v2
    s_nop 1
    v_cndmask_b32 v2, v2, v8, vcc
    buffer_load_dwordx4 v[24:27], v2, s[40:43], s65 offen
    v_add_u32 v1, 768, v0
    v_mul_lo_u32 v2, v1, s64
    v_lshrrev_b32 v2, 19, v2
    v_mul_u32_u24 v3, 10, v2
    v_sub_u32 v3, v1, v3
    v_add_u32 v2, s66, v2
    s_mov_b64 vcc, 0
    s_cmp_eq_u32 s67, 0
    s_cbranch_scc1 nt_prep_kernel_12
    v_mul_u32_u24 v4, 2731, v2
    v_lshrrev_b32 v4, 16, v4
    v_mul_u32_u24 v5, 24, v4
    v_sub_u32 v5, v2, v5
    v_mul_u32_u24 v4, 20, v4
    v_add_u32 v2, v4, v5
    v_cmp_le_u32 vcc, 20, v5
nt_prep_kernel_12:
    v_mul_u32_u24 v2, 1280, v2
    v_lshl_add_u32 v2, v3, 4, v2
    s_nop 1
    v_cndmask_b32 v2, v2, v8, vcc
    buffer_load_dwordx4 v[28:31], v2, s[40:43], s65 offen
    v_add_u32 v1, 1024, v0
    v_mul_lo_u32 v2, v1, s64
    v_lshrrev_b32 v2, 19, v2
    v_mul_u32_u24 v3, 10, v2
    v_sub_u32 v3, v1, v3
    v_add_u32 v2, s66, v2
    s_mov_b64 vcc, 0
    s_cmp_eq_u32 s67, 0
    s_cbranch_scc1 nt_prep_kernel_13
    v_mul_u32_u24 v4, 2731, v2
    v_lshrrev_b32 v4, 16, v4
    v_mul_u32_u24 v5, 24, v4
    v_sub_u32 v5, v2, v5
    v_mul_u32_u24 v4, 20, v4
    v_add_u32 v2, v4, v5
    v_cmp_le_u32 vcc, 20, v5
nt_prep_kernel_13:
    v_mul_u32_u24 v2, 1280, v2
    v_lshl_add_u32 v2, v3, 4, v2
    s_nop 1
    v_cndmask_b32 v2, v2, v8, vcc
    buffer_load_dwordx4 v[32:35], v2, s[40:43], s65 offen
    s_mul_i32 s39, s39, 20480
    v_lshlrev_b32 v2, 4, v0
    s_waitcnt vmcnt(0)
    s_add_u32 s64, s39, 0
    buffer_store_dwordx4 v[16:19], v2, s[44:47], s64 offen sc1
    s_add_u32 s64, s39, 4096
    buffer_store_dwordx4 v[20:23], v2, s[44:47], s64 offen sc1
    s_add_u32 s64, s39, 8192
    buffer_store_dwordx4 v[24:27], v2, s[44:47], s64 offen sc1
    s_add_u32 s64, s39, 12288
    buffer_store_dwordx4 v[28:31], v2, s[44:47], s64 offen sc1
    s_add_u32 s64, s39, 16384
    buffer_store_dwordx4 v[32:35], v2, s[44:47], s64 offen sc1
done_prep_kernel_1:
    s_endpgm
.globl mega_kernel
.p2align 8
.type mega_kernel,@function
mega_kernel:
    s_load_dwordx2 s[84:85], s[0:1], 72
    s_load_dwordx2 s[86:87], s[0:1], 0
    s_load_dwordx2 s[88:89], s[0:1], 56
    s_load_dwordx2 s[96:97], s[0:1], 64
    s_cmp_ge_u32 s2, 256
    s_cbranch_scc1 done_mega_kernel_1
    v_and_b32 v1, 63, v0
    v_lshrrev_b32 v25, 6, v0
    s_nop 0
    v_readfirstlane_b32 s29, v25
    s_nop 3
    s_and_b32 s28, s29, 3
    s_waitcnt lgkmcnt(0)
    s_add_u32 s92, s84, 0x0
    s_addc_u32 s93, s85, 0
    s_mov_b32 s94, 81920
    s_and_b32 s93, s93, 0xffff
    s_mov_b32 s95, 0x00020000
    s_and_b32 s97, s97, 0xffff
    s_mov_b32 s98, 256
    s_mov_b32 s99, 0x00020000
    s_getreg_b32 s24, hwreg(HW_REG_XCC_ID)
    s_and_b32 s24, s24, 7
    v_mov_b32 v253, 1
    s_cmp_lg_u32 s29, 0
    s_cbranch_scc1 noslot_mega_kernel_2
    s_add_u32 s38, s24, 632
    s_lshl_b32 s38, s38, 7
    v_mov_b32 v24, s38
    s_mov_b64 s[36:37], exec
    s_mov_b64 exec, 1
    buffer_atomic_add v253, v24, s[92:95], 0 offen sc0 sc1
    s_mov_b64 exec, s[36:37]
noslot_mega_kernel_2:
    s_cmp_lg_u32 s29, 0
    s_cbranch_scc1 noslot_mega_kernel_3
    v_mov_b32 v22, 0
    s_mov_b64 s[36:37], exec
    s_mov_b64 exec, 1
    s_waitcnt vmcnt(0)
    ds_write_b32 v22, v253
    s_waitcnt lgkmcnt(0)
    s_mov_b64 exec, s[36:37]
noslot_mega_kernel_3:
    s_barrier
    v_mov_b32 v22, 0
    ds_read_b32 v23, v22
    s_waitcnt lgkmcnt(0)
    v_readfirstlane_b32 s2, v23
    s_nop 3
    s_and_b32 s2, s2, 31
    s_lshl_b32 s2, s2, 3
    s_add_u32 s2, s2, s24
    s_barrier
    v_mov_b32 v254, 0
    s_cmp_lt_u32 s29, 4
    s_cbranch_scc1 w0_mega_kernel_4
    s_add_u32 s76, s84, 0x1ad9000
    s_addc_u32 s77, s85, 0
    s_mov_b32 s78, 2621440
    s_and_b32 s77, s77, 0xffff
    s_mov_b32 s79, 0x00020000
    s_lshr_b32 s82, s2, 4
    s_mul_i32 s82, s82, 163840
    s_mul_i32 s80, s28, 4096
    s_add_u32 s82, s82, s80
    v_lshlrev_b32 v8, 4, v1
    v_add_u32 v8, s82, v8
    v_add_u32 v9, 4096, v8
    s_add_u32 m0, s80, 65536
    s_mov_b32 s81, 0
    buffer_load_dwordx4 v8, s[76:79], s81 offen offset:0 sc1 lds
    buffer_load_dwordx4 v8, s[76:79], s81 offen offset:1024 sc1 lds
    buffer_load_dwordx4 v8, s[76:79], s81 offen offset:2048 sc1 lds
    buffer_load_dwordx4 v8, s[76:79], s81 offen offset:3072 sc1 lds
    s_add_u32 m0, s80, 90112
    s_mov_b32 s81, 16384
    buffer_load_dwordx4 v8, s[76:79], s81 offen offset:0 sc1 lds
    buffer_load_dwordx4 v8, s[76:79], s81 offen offset:1024 sc1 lds
    buffer_load_dwordx4 v8, s[76:79], s81 offen offset:2048 sc1 lds
    buffer_load_dwordx4 v8, s[76:79], s81 offen offset:3072 sc1 lds
    s_add_u32 m0, s80, 114688
    s_mov_b32 s81, 32768
    buffer_load_dwordx4 v8, s[76:79], s81 offen offset:0 sc1 lds
    buffer_load_dwordx4 v8, s[76:79], s81 offen offset:1024 sc1 lds
    buffer_load_dwordx4 v8, s[76:79], s81 offen offset:2048 sc1 lds
    buffer_load_dwordx4 v8, s[76:79], s81 offen offset:3072 sc1 lds
    s_add_u32 m0, s80, 139264
    s_mov_b32 s81, 49152
    buffer_load_dwordx4 v8, s[76:79], s81 offen offset:0 sc1 lds
    buffer_load_dwordx4 v8, s[76:79], s81 offen offset:1024 sc1 lds
    buffer_load_dwordx4 v8, s[76:79], s81 offen offset:2048 sc1 lds
    buffer_load_dwordx4 v8, s[76:79], s81 offen offset:3072 sc1 lds
w0_mega_kernel_4:
    s_and_b32 s24, s2, 7
    s_lshr_b32 s25, s2, 3
    s_lshl_b32 s26, s24, 1
    s_and_b32 s27, s25, 1
    s_add_u32 s26, s26, s27
    s_lshr_b32 s27, s25, 1
    s_mov_b32 s4, s86
    s_mov_b32 s5, s87
    s_mov_b32 s6, 2621440
    s_and_b32 s5, s5, 0xffff
    s_mov_b32 s7, 0x00020000
    s_add_u32 s16, s84, 0xbd9000
    s_addc_u32 s17, s85, 0
    s_mov_b32 s18, 15728640
    s_and_b32 s17, s17, 0xffff
    s_mov_b32 s19, 0x00020000
    s_add_u32 s20, s84, 0x19000
    s_addc_u32 s21, s85, 0
    s_mov_b32 s22, 131072
    s_and_b32 s21, s21, 0xffff
    s_mov_b32 s23, 0x00020000
    s_add_u32 s12, s84, 0x14000
    s_addc_u32 s13, s85, 0
    s_mov_b32 s14, 20480
    s_and_b32 s13, s13, 0xffff
    s_mov_b32 s15, 0x00020000
    s_cmp_ge_u32 s29, 4
    s_cbranch_scc1 loader_mega_kernel_5
    s_and_b32 s30, s29, 1
    s_lshr_b32 s31, s29, 1
    v_and_b32 v25, 31, v1
    s_lshl_b32 s32, s26, 7
    s_lshl_b32 s33, s31, 6
    s_add_u32 s32, s32, s33
    v_add_u32 v28, s32, v25
    v_lshlrev_b32 v29, 6, v28
    v_lshrrev_b32 v30, 5, v1
    v_lshlrev_b32 v30, 4, v30
    s_lshl_b32 s32, s27, 9
    s_lshl_b32 s33, s30, 8
    s_add_u32 s32, s32, s33
    v_add_u32 v30, s32, v30
    v_and_b32 v25, 31, v1
    s_lshl_b32 s32, s31, 6
    v_add_u32 v26, s32, v25
    v_lshlrev_b32 v26, 7, v26
    v_lshrrev_b32 v25, 1, v25
    v_and_b32 v25, 7, v25
    v_lshrrev_b32 v27, 5, v1
    v_xor_b32 v25, v25, v27
    v_xor_b32 v27, 0, v25
    v_lshl_add_u32 v10, v27, 4, v26
    v_add_u32 v10, 0, v10
    v_xor_b32 v27, 2, v25
    v_lshl_add_u32 v11, v27, 4, v26
    v_add_u32 v11, 0, v11
    v_xor_b32 v27, 4, v25
    v_lshl_add_u32 v12, v27, 4, v26
    v_add_u32 v12, 0, v12
    v_xor_b32 v27, 6, v25
    v_lshl_add_u32 v13, v27, 4, v26
    v_add_u32 v13, 0, v13
    v_lshrrev_b32 v25, 5, v1
    v_lshlrev_b32 v25, 3, v25
    v_bfe_u32 v26, v1, 2, 2
    v_add_u32 v25, v25, v26
    v_lshlrev_b32 v25, 8, v25
    v_bfe_u32 v27, v1, 4, 1
    v_lshl_add_u32 v25, v27, 5, v25
    v_and_b32 v27, 3, v1
    v_lshl_add_u32 v25, v27, 3, v25
    v_add_u32 v25, 65536, v25
    s_lshl_b32 s32, s30, 1
    s_add_u32 s33, s32, 0
    v_xor_b32 v27, s33, v26
    v_lshl_add_u32 v14, v27, 6, v25
    s_add_u32 s33, s32, 1
    v_xor_b32 v27, s33, v26
    v_lshl_add_u32 v15, v27, 6, v25
    v_mov_b32 v64, 0
    v_mov_b32 v65, 0
    v_mov_b32 v66, 0
    v_mov_b32 v67, 0
    v_mov_b32 v68, 0
    v_mov_b32 v69, 0
    v_mov_b32 v70, 0
    v_mov_b32 v71, 0
    v_mov_b32 v72, 0
    v_mov_b32 v73, 0
    v_mov_b32 v74, 0
    v_mov_b32 v75, 0
    v_mov_b32 v76, 0
    v_mov_b32 v77, 0
    v_mov_b32 v78, 0
    v_mov_b32 v79, 0
    v_mov_b32 v80, 0
    v_mov_b32 v81, 0
    v_mov_b32 v82, 0
    v_mov_b32 v83, 0
    v_mov_b32 v84, 0
    v_mov_b32 v85, 0
    v_mov_b32 v86, 0
    v_mov_b32 v87, 0
    v_mov_b32 v88, 0
    v_mov_b32 v89, 0
    v_mov_b32 v90, 0
    v_mov_b32 v91, 0
    v_mov_b32 v92, 0
    v_mov_b32 v93, 0
    v_mov_b32 v94, 0
    v_mov_b32 v95, 0
    v_mov_b32 v96, 0
    v_mov_b32 v97, 0
    v_mov_b32 v98, 0
    v_mov_b32 v99, 0
    v_mov_b32 v100, 0
    v_mov_b32 v101, 0
    v_mov_b32 v102, 0
    v_mov_b32 v103, 0
    v_mov_b32 v104, 0
    v_mov_b32 v105, 0
    v_mov_b32 v106, 0
    v_mov_b32 v107, 0
    v_mov_b32 v108, 0
    v_mov_b32 v109, 0
    v_mov_b32 v110, 0
    v_mov_b32 v111, 0
    v_mov_b32 v112, 0
    v_mov_b32 v113, 0
    v_mov_b32 v114, 0
    v_mov_b32 v115, 0
    v_mov_b32 v116, 0
    v_mov_b32 v117, 0
    v_mov_b32 v118, 0
    v_mov_b32 v119, 0
    v_mov_b32 v120, 0
    v_mov_b32 v121, 0
    v_mov_b32 v122, 0
    v_mov_b32 v123, 0
    v_mov_b32 v124, 0
    v_mov_b32 v125, 0
    v_mov_b32 v126, 0
    v_mov_b32 v127, 0
    s_barrier
    buffer_load_dwordx4 v[128:131], v30, s[12:15], 0 offen offset:0 sc1
    buffer_load_dwordx4 v[132:135], v30, s[12:15], 0 offen offset:32 sc1
    buffer_load_dwordx4 v[136:139], v30, s[12:15], 0 offen offset:64 sc1
    buffer_load_dwordx4 v[140:143], v30, s[12:15], 0 offen offset:96 sc1
    buffer_load_dwordx4 v[144:147], v30, s[12:15], 0 offen offset:128 sc1
    buffer_load_dwordx4 v[148:151], v30, s[12:15], 0 offen offset:160 sc1
    buffer_load_dwordx4 v[152:155], v30, s[12:15], 0 offen offset:192 sc1
    buffer_load_dwordx4 v[156:159], v30, s[12:15], 0 offen offset:224 sc1
    buffer_load_dwordx4 v[160:163], v29, s[20:23], 0 offen offset:0 sc1
    buffer_load_dwordx4 v[164:167], v29, s[20:23], 0 offen offset:16 sc1
    buffer_load_dwordx4 v[168:171], v29, s[20:23], 0 offen offset:32 sc1
    buffer_load_dwordx4 v[172:175], v29, s[20:23], 0 offen offset:48 sc1
    buffer_load_dwordx4 v[176:179], v29, s[20:23], 0 offen offset:2048 sc1
    buffer_load_dwordx4 v[180:183], v29, s[20:23], 0 offen offset:2064 sc1
    buffer_load_dwordx4 v[184:187], v29, s[20:23], 0 offen offset:2080 sc1
    buffer_load_dwordx4 v[188:191], v29, s[20:23], 0 offen offset:2096 sc1
    s_barrier
    ds_read_b128 v[32:35], v10 offset:0
    ds_read_b128 v[36:39], v10 offset:4096
    ds_read_b64_tr_b16 v[40:41], v14 offset:0
    ds_read_b64_tr_b16 v[42:43], v14 offset:1024
    ds_read_b64_tr_b16 v[44:45], v15 offset:0
    ds_read_b64_tr_b16 v[46:47], v15 offset:1024
    s_waitcnt lgkmcnt(0)
    v_mfma_f32_32x32x16_bf16 v[64:79], v[40:43], v[32:35], v[64:79]
    ds_read_b128 v[48:51], v11 offset:0
    ds_read_b128 v[52:55], v11 offset:4096
    ds_read_b64_tr_b16 v[56:57], v14 offset:4096
    v_mfma_f32_32x32x16_bf16 v[80:95], v[40:43], v[36:39], v[80:95]
    ds_read_b64_tr_b16 v[58:59], v14 offset:5120
    ds_read_b64_tr_b16 v[60:61], v15 offset:4096
    ds_read_b64_tr_b16 v[62:63], v15 offset:5120
    v_mfma_f32_32x32x16_bf16 v[96:111], v[44:47], v[32:35], v[96:111]
    v_mfma_f32_32x32x16_bf16 v[112:127], v[44:47], v[36:39], v[112:127]
    s_waitcnt lgkmcnt(0)
    v_mfma_f32_32x32x16_bf16 v[64:79], v[56:59], v[48:51], v[64:79]
    ds_read_b128 v[32:35], v12 offset:0
    ds_read_b128 v[36:39], v12 offset:4096
    ds_read_b64_tr_b16 v[40:41], v14 offset:8192
    v_mfma_f32_32x32x16_bf16 v[80:95], v[56:59], v[52:55], v[80:95]
    ds_read_b64_tr_b16 v[42:43], v14 offset:9216
    ds_read_b64_tr_b16 v[44:45], v15 offset:8192
    ds_read_b64_tr_b16 v[46:47], v15 offset:9216
    v_mfma_f32_32x32x16_bf16 v[96:111], v[60:63], v[48:51], v[96:111]
    v_mfma_f32_32x32x16_bf16 v[112:127], v[60:63], v[52:55], v[112:127]
    s_waitcnt lgkmcnt(0)
    v_mfma_f32_32x32x16_bf16 v[64:79], v[40:43], v[32:35], v[64:79]
    ds_read_b128 v[48:51], v13 offset:0
    ds_read_b128 v[52:55], v13 offset:4096
    ds_read_b64_tr_b16 v[56:57], v14 offset:12288
    v_mfma_f32_32x32x16_bf16 v[80:95], v[40:43], v[36:39], v[80:95]
    ds_read_b64_tr_b16 v[58:59], v14 offset:13312
    ds_read_b64_tr_b16 v[60:61], v15 offset:12288
    ds_read_b64_tr_b16 v[62:63], v15 offset:13312
    v_mfma_f32_32x32x16_bf16 v[96:111], v[44:47], v[32:35], v[96:111]
    v_mfma_f32_32x32x16_bf16 v[112:127], v[44:47], v[36:39], v[112:127]
    s_waitcnt lgkmcnt(0)
    v_mfma_f32_32x32x16_bf16 v[64:79], v[56:59], v[48:51], v[64:79]
    s_barrier
    v_add_u32 v10, 0x4000, v10
    v_add_u32 v11, 0x4000, v11
    v_add_u32 v12, 0x4000, v12
    v_add_u32 v13, 0x4000, v13
    v_add_u32 v14, 0x6000, v14
    v_add_u32 v15, 0x6000, v15
    v_mfma_f32_32x32x16_bf16 v[80:95], v[56:59], v[52:55], v[80:95]
    ds_read_b128 v[32:35], v10 offset:0
    ds_read_b128 v[36:39], v10 offset:4096
    ds_read_b64_tr_b16 v[40:41], v14 offset:0
    ds_read_b64_tr_b16 v[42:43], v14 offset:1024
    ds_read_b64_tr_b16 v[44:45], v15 offset:0
    ds_read_b64_tr_b16 v[46:47], v15 offset:1024
    v_mfma_f32_32x32x16_bf16 v[96:111], v[60:63], v[48:51], v[96:111]
    v_mfma_f32_32x32x16_bf16 v[112:127], v[60:63], v[52:55], v[112:127]
    s_waitcnt lgkmcnt(0)
    v_mfma_f32_32x32x16_bf16 v[64:79], v[40:43], v[32:35], v[64:79]
    ds_read_b128 v[48:51], v11 offset:0
    ds_read_b128 v[52:55], v11 offset:4096
    ds_read_b64_tr_b16 v[56:57], v14 offset:4096
    v_mfma_f32_32x32x16_bf16 v[80:95], v[40:43], v[36:39], v[80:95]
    ds_read_b64_tr_b16 v[58:59], v14 offset:5120
    ds_read_b64_tr_b16 v[60:61], v15 offset:4096
    ds_read_b64_tr_b16 v[62:63], v15 offset:5120
    v_mfma_f32_32x32x16_bf16 v[96:111], v[44:47], v[32:35], v[96:111]
    v_mfma_f32_32x32x16_bf16 v[112:127], v[44:47], v[36:39], v[112:127]
    s_waitcnt lgkmcnt(0)
    v_mfma_f32_32x32x16_bf16 v[64:79], v[56:59], v[48:51], v[64:79]
    ds_read_b128 v[32:35], v12 offset:0
    ds_read_b128 v[36:39], v12 offset:4096
    ds_read_b64_tr_b16 v[40:41], v14 offset:8192
    v_mfma_f32_32x32x16_bf16 v[80:95], v[56:59], v[52:55], v[80:95]
    ds_read_b64_tr_b16 v[42:43], v14 offset:9216
    ds_read_b64_tr_b16 v[44:45], v15 offset:8192
    ds_read_b64_tr_b16 v[46:47], v15 offset:9216
    v_mfma_f32_32x32x16_bf16 v[96:111], v[60:63], v[48:51], v[96:111]
    v_mfma_f32_32x32x16_bf16 v[112:127], v[60:63], v[52:55], v[112:127]
    s_waitcnt lgkmcnt(0)
    v_mfma_f32_32x32x16_bf16 v[64:79], v[40:43], v[32:35], v[64:79]
    ds_read_b128 v[48:51], v13 offset:0
    ds_read_b128 v[52:55], v13 offset:4096
    ds_read_b64_tr_b16 v[56:57], v14 offset:12288
    v_mfma_f32_32x32x16_bf16 v[80:95], v[40:43], v[36:39], v[80:95]
    ds_read_b64_tr_b16 v[58:59], v14 offset:13312
    ds_read_b64_tr_b16 v[60:61], v15 offset:12288
    ds_read_b64_tr_b16 v[62:63], v15 offset:13312
    v_mfma_f32_32x32x16_bf16 v[96:111], v[44:47], v[32:35], v[96:111]
    v_mfma_f32_32x32x16_bf16 v[112:127], v[44:47], v[36:39], v[112:127]
    s_waitcnt lgkmcnt(0)
    v_mfma_f32_32x32x16_bf16 v[64:79], v[56:59], v[48:51], v[64:79]
    s_barrier
    v_add_u32 v10, 0x4000, v10
    v_add_u32 v11, 0x4000, v11
    v_add_u32 v12, 0x4000, v12
    v_add_u32 v13, 0x4000, v13
    v_add_u32 v14, 0x6000, v14
    v_add_u32 v15, 0x6000, v15
    v_mfma_f32_32x32x16_bf16 v[80:95], v[56:59], v[52:55], v[80:95]
    ds_read_b128 v[32:35], v10 offset:0
    ds_read_b128 v[36:39], v10 offset:4096
    ds_read_b64_tr_b16 v[40:41], v14 offset:0
    ds_read_b64_tr_b16 v[42:43], v14 offset:1024
    ds_read_b64_tr_b16 v[44:45], v15 offset:0
    ds_read_b64_tr_b16 v[46:47], v15 offset:1024
    v_mfma_f32_32x32x16_bf16 v[96:111], v[60:63], v[48:51], v[96:111]
    v_mfma_f32_32x32x16_bf16 v[112:127], v[60:63], v[52:55], v[112:127]
    s_waitcnt lgkmcnt(0)
    v_mfma_f32_32x32x16_bf16 v[64:79], v[40:43], v[32:35], v[64:79]
    ds_read_b128 v[48:51], v11 offset:0
    ds_read_b128 v[52:55], v11 offset:4096
    ds_read_b64_tr_b16 v[56:57], v14 offset:4096
    v_mfma_f32_32x32x16_bf16 v[80:95], v[40:43], v[36:39], v[80:95]
    ds_read_b64_tr_b16 v[58:59], v14 offset:5120
    ds_read_b64_tr_b16 v[60:61], v15 offset:4096
    ds_read_b64_tr_b16 v[62:63], v15 offset:5120
    v_mfma_f32_32x32x16_bf16 v[96:111], v[44:47], v[32:35], v[96:111]
    v_mfma_f32_32x32x16_bf16 v[112:127], v[44:47], v[36:39], v[112:127]
    s_waitcnt lgkmcnt(0)
    v_mfma_f32_32x32x16_bf16 v[64:79], v[56:59], v[48:51], v[64:79]
    ds_read_b128 v[32:35], v12 offset:0
    ds_read_b128 v[36:39], v12 offset:4096
    ds_read_b64_tr_b16 v[40:41], v14 offset:8192
    v_mfma_f32_32x32x16_bf16 v[80:95], v[56:59], v[52:55], v[80:95]
    ds_read_b64_tr_b16 v[42:43], v14 offset:9216
    ds_read_b64_tr_b16 v[44:45], v15 offset:8192
    ds_read_b64_tr_b16 v[46:47], v15 offset:9216
    v_mfma_f32_32x32x16_bf16 v[96:111], v[60:63], v[48:51], v[96:111]
    v_mfma_f32_32x32x16_bf16 v[112:127], v[60:63], v[52:55], v[112:127]
    s_waitcnt lgkmcnt(0)
    v_mfma_f32_32x32x16_bf16 v[64:79], v[40:43], v[32:35], v[64:79]
    ds_read_b128 v[48:51], v13 offset:0
    ds_read_b128 v[52:55], v13 offset:4096
    ds_read_b64_tr_b16 v[56:57], v14 offset:12288
    v_mfma_f32_32x32x16_bf16 v[80:95], v[40:43], v[36:39], v[80:95]
    ds_read_b64_tr_b16 v[58:59], v14 offset:13312
    ds_read_b64_tr_b16 v[60:61], v15 offset:12288
    ds_read_b64_tr_b16 v[62:63], v15 offset:13312
    v_mfma_f32_32x32x16_bf16 v[96:111], v[44:47], v[32:35], v[96:111]
    v_mfma_f32_32x32x16_bf16 v[112:127], v[44:47], v[36:39], v[112:127]
    s_waitcnt lgkmcnt(0)
    v_mfma_f32_32x32x16_bf16 v[64:79], v[56:59], v[48:51], v[64:79]
    s_barrier
    v_add_u32 v10, 0x4000, v10
    v_add_u32 v11, 0x4000, v11
    v_add_u32 v12, 0x4000, v12
    v_add_u32 v13, 0x4000, v13
    v_add_u32 v14, 0x6000, v14
    v_add_u32 v15, 0x6000, v15
    v_mfma_f32_32x32x16_bf16 v[80:95], v[56:59], v[52:55], v[80:95]
    ds_read_b128 v[32:35], v10 offset:0
    ds_read_b128 v[36:39], v10 offset:4096
    ds_read_b64_tr_b16 v[40:41], v14 offset:0
    ds_read_b64_tr_b16 v[42:43], v14 offset:1024
    ds_read_b64_tr_b16 v[44:45], v15 offset:0
    ds_read_b64_tr_b16 v[46:47], v15 offset:1024
    v_mfma_f32_32x32x16_bf16 v[96:111], v[60:63], v[48:51], v[96:111]
    v_mfma_f32_32x32x16_bf16 v[112:127], v[60:63], v[52:55], v[112:127]
    s_waitcnt lgkmcnt(0)
    v_mfma_f32_32x32x16_bf16 v[64:79], v[40:43], v[32:35], v[64:79]
    ds_read_b128 v[48:51], v11 offset:0
    ds_read_b128 v[52:55], v11 offset:4096
    ds_read_b64_tr_b16 v[56:57], v14 offset:4096
    v_mfma_f32_32x32x16_bf16 v[80:95], v[40:43], v[36:39], v[80:95]
    ds_read_b64_tr_b16 v[58:59], v14 offset:5120
    ds_read_b64_tr_b16 v[60:61], v15 offset:4096
    ds_read_b64_tr_b16 v[62:63], v15 offset:5120
    v_mfma_f32_32x32x16_bf16 v[96:111], v[44:47], v[32:35], v[96:111]
    v_mfma_f32_32x32x16_bf16 v[112:127], v[44:47], v[36:39], v[112:127]
    s_waitcnt lgkmcnt(0)
    v_mfma_f32_32x32x16_bf16 v[64:79], v[56:59], v[48:51], v[64:79]
    ds_read_b128 v[32:35], v12 offset:0
    ds_read_b128 v[36:39], v12 offset:4096
    ds_read_b64_tr_b16 v[40:41], v14 offset:8192
    v_mfma_f32_32x32x16_bf16 v[80:95], v[56:59], v[52:55], v[80:95]
    ds_read_b64_tr_b16 v[42:43], v14 offset:9216
    ds_read_b64_tr_b16 v[44:45], v15 offset:8192
    ds_read_b64_tr_b16 v[46:47], v15 offset:9216
    v_mfma_f32_32x32x16_bf16 v[96:111], v[60:63], v[48:51], v[96:111]
    v_mfma_f32_32x32x16_bf16 v[112:127], v[60:63], v[52:55], v[112:127]
    s_waitcnt lgkmcnt(0)
    v_mfma_f32_32x32x16_bf16 v[64:79], v[40:43], v[32:35], v[64:79]
    ds_read_b128 v[48:51], v13 offset:0
    ds_read_b128 v[52:55], v13 offset:4096
    ds_read_b64_tr_b16 v[56:57], v14 offset:12288
    v_mfma_f32_32x32x16_bf16 v[80:95], v[40:43], v[36:39], v[80:95]
    ds_read_b64_tr_b16 v[58:59], v14 offset:13312
    ds_read_b64_tr_b16 v[60:61], v15 offset:12288
    ds_read_b64_tr_b16 v[62:63], v15 offset:13312
    v_mfma_f32_32x32x16_bf16 v[96:111], v[44:47], v[32:35], v[96:111]
    v_mfma_f32_32x32x16_bf16 v[112:127], v[44:47], v[36:39], v[112:127]
    s_waitcnt lgkmcnt(0)
    v_mfma_f32_32x32x16_bf16 v[64:79], v[56:59], v[48:51], v[64:79]
    s_barrier
    v_add_u32 v10, 0xffff4000, v10
    v_add_u32 v11, 0xffff4000, v11
    v_add_u32 v12, 0xffff4000, v12
    v_add_u32 v13, 0xffff4000, v13
    v_add_u32 v14, 0xfffee000, v14
    v_add_u32 v15, 0xfffee000, v15
    v_mfma_f32_32x32x16_bf16 v[80:95], v[56:59], v[52:55], v[80:95]
    ds_read_b128 v[32:35], v10 offset:0
    ds_read_b128 v[36:39], v10 offset:4096
    ds_read_b64_tr_b16 v[40:41], v14 offset:0
    ds_read_b64_tr_b16 v[42:43], v14 offset:1024
    ds_read_b64_tr_b16 v[44:45], v15 offset:0
    ds_read_b64_tr_b16 v[46:47], v15 offset:1024
    v_mfma_f32_32x32x16_bf16 v[96:111], v[60:63], v[48:51], v[96:111]
    v_mfma_f32_32x32x16_bf16 v[112:127], v[60:63], v[52:55], v[112:127]
    s_waitcnt vmcnt(0)
    v_add_f32 v16, v160, v162
    v_add_f32 v16, v16, v164
    v_add_f32 v16, v16, v166
    v_add_f32 v16, v16, v168
    v_add_f32 v16, v16, v170
    v_add_f32 v16, v16, v172
    v_add_f32 v16, v16, v174
    v_mul_f32 v16, 0x3acccccd, v16
    v_add_f32 v17, v161, v163
    v_add_f32 v17, v17, v165
    v_add_f32 v17, v17, v167
    v_add_f32 v17, v17, v169
    v_add_f32 v17, v17, v171
    v_add_f32 v17, v17, v173
    v_add_f32 v17, v17, v175
    v_mov_b32 v18, 0
    v_mul_f32 v19, 0x3c4ccccd, v160
    v_sub_f32 v19, v19, v16
    v_fmac_f32 v18, v19, v19
    v_mul_f32 v19, 0x3c4ccccd, v162
    v_sub_f32 v19, v19, v16
    v_fmac_f32 v18, v19, v19
    v_mul_f32 v19, 0x3c4ccccd, v164
    v_sub_f32 v19, v19, v16
    v_fmac_f32 v18, v19, v19
    v_mul_f32 v19, 0x3c4ccccd, v166
    v_sub_f32 v19, v19, v16
    v_fmac_f32 v18, v19, v19
    v_mul_f32 v19, 0x3c4ccccd, v168
    v_sub_f32 v19, v19, v16
    v_fmac_f32 v18, v19, v19
    v_mul_f32 v19, 0x3c4ccccd, v170
    v_sub_f32 v19, v19, v16
    v_fmac_f32 v18, v19, v19
    v_mul_f32 v19, 0x3c4ccccd, v172
    v_sub_f32 v19, v19, v16
    v_fmac_f32 v18, v19, v19
    v_mul_f32 v19, 0x3c4ccccd, v174
    v_sub_f32 v19, v19, v16
    v_fmac_f32 v18, v19, v19
    v_mov_b32 v19, 0x42a00000
    v_fmac_f32 v17, v18, v19
    v_mul_f32 v17, 0x3acccccd, v17
    v_cvt_pk_bf16_f32 v192, v16, v16
    v_lshlrev_b32 v192, 16, v192
    v_cvt_pk_bf16_f32 v194, v17, v17
    v_lshlrev_b32 v194, 16, v194
    v_add_f32 v194, 0x3727c5ac, v194
    v_cvt_pk_bf16_f32 v194, v194, v194
    v_lshlrev_b32 v194, 16, v194
    v_sqrt_f32 v194, v194
    s_nop 0
    v_cvt_pk_bf16_f32 v194, v194, v194
    v_lshlrev_b32 v194, 16, v194
    v_rcp_f32 v194, v194
    s_nop 0
    v_mov_b32 v193, v192
    v_mov_b32 v195, v194
    v_add_f32 v16, v176, v178
    v_add_f32 v16, v16, v180
    v_add_f32 v16, v16, v182
    v_add_f32 v16, v16, v184
    v_add_f32 v16, v16, v186
    v_add_f32 v16, v16, v188
    v_add_f32 v16, v16, v190
    v_mul_f32 v16, 0x3acccccd, v16
    v_add_f32 v17, v177, v179
    v_add_f32 v17, v17, v181
    v_add_f32 v17, v17, v183
    v_add_f32 v17, v17, v185
    v_add_f32 v17, v17, v187
    v_add_f32 v17, v17, v189
    v_add_f32 v17, v17, v191
    v_mov_b32 v18, 0
    v_mul_f32 v19, 0x3c4ccccd, v176
    v_sub_f32 v19, v19, v16
    v_fmac_f32 v18, v19, v19
    v_mul_f32 v19, 0x3c4ccccd, v178
    v_sub_f32 v19, v19, v16
    v_fmac_f32 v18, v19, v19
    v_mul_f32 v19, 0x3c4ccccd, v180
    v_sub_f32 v19, v19, v16
    v_fmac_f32 v18, v19, v19
    v_mul_f32 v19, 0x3c4ccccd, v182
    v_sub_f32 v19, v19, v16
    v_fmac_f32 v18, v19, v19
    v_mul_f32 v19, 0x3c4ccccd, v184
    v_sub_f32 v19, v19, v16
    v_fmac_f32 v18, v19, v19
    v_mul_f32 v19, 0x3c4ccccd, v186
    v_sub_f32 v19, v19, v16
    v_fmac_f32 v18, v19, v19
    v_mul_f32 v19, 0x3c4ccccd, v188
    v_sub_f32 v19, v19, v16
    v_fmac_f32 v18, v19, v19
    v_mul_f32 v19, 0x3c4ccccd, v190
    v_sub_f32 v19, v19, v16
    v_fmac_f32 v18, v19, v19
    v_mov_b32 v19, 0x42a00000
    v_fmac_f32 v17, v18, v19
    v_mul_f32 v17, 0x3acccccd, v17
    v_cvt_pk_bf16_f32 v196, v16, v16
    v_lshlrev_b32 v196, 16, v196
    v_cvt_pk_bf16_f32 v198, v17, v17
    v_lshlrev_b32 v198, 16, v198
    v_add_f32 v198, 0x3727c5ac, v198
    v_cvt_pk_bf16_f32 v198, v198, v198
    v_lshlrev_b32 v198, 16, v198
    v_sqrt_f32 v198, v198
    s_nop 0
    v_cvt_pk_bf16_f32 v198, v198, v198
    v_lshlrev_b32 v198, 16, v198
    v_rcp_f32 v198, v198
    s_nop 0
    v_mov_b32 v197, v196
    v_mov_b32 v199, v198
    s_waitcnt lgkmcnt(0)
    v_mfma_f32_32x32x16_bf16 v[64:79], v[40:43], v[32:35], v[64:79]
    ds_read_b128 v[48:51], v11 offset:0
    ds_read_b128 v[52:55], v11 offset:4096
    ds_read_b64_tr_b16 v[56:57], v14 offset:4096
    v_mfma_f32_32x32x16_bf16 v[80:95], v[40:43], v[36:39], v[80:95]
    ds_read_b64_tr_b16 v[58:59], v14 offset:5120
    ds_read_b64_tr_b16 v[60:61], v15 offset:4096
    ds_read_b64_tr_b16 v[62:63], v15 offset:5120
    v_mfma_f32_32x32x16_bf16 v[96:111], v[44:47], v[32:35], v[96:111]
    v_mfma_f32_32x32x16_bf16 v[112:127], v[44:47], v[36:39], v[112:127]
    s_waitcnt lgkmcnt(0)
    v_mfma_f32_32x32x16_bf16 v[64:79], v[56:59], v[48:51], v[64:79]
    ds_read_b128 v[32:35], v12 offset:0
    ds_read_b128 v[36:39], v12 offset:4096
    ds_read_b64_tr_b16 v[40:41], v14 offset:8192
    v_mfma_f32_32x32x16_bf16 v[80:95], v[56:59], v[52:55], v[80:95]
    ds_read_b64_tr_b16 v[42:43], v14 offset:9216
    ds_read_b64_tr_b16 v[44:45], v15 offset:8192
    ds_read_b64_tr_b16 v[46:47], v15 offset:9216
    v_mfma_f32_32x32x16_bf16 v[96:111], v[60:63], v[48:51], v[96:111]
    v_mfma_f32_32x32x16_bf16 v[112:127], v[60:63], v[52:55], v[112:127]
    s_waitcnt lgkmcnt(0)
    v_mfma_f32_32x32x16_bf16 v[64:79], v[40:43], v[32:35], v[64:79]
    ds_read_b128 v[48:51], v13 offset:0
    ds_read_b128 v[52:55], v13 offset:4096
    ds_read_b64_tr_b16 v[56:57], v14 offset:12288
    v_mfma_f32_32x32x16_bf16 v[80:95], v[40:43], v[36:39], v[80:95]
    ds_read_b64_tr_b16 v[58:59], v14 offset:13312
    ds_read_b64_tr_b16 v[60:61], v15 offset:12288
    ds_read_b64_tr_b16 v[62:63], v15 offset:13312
    v_mfma_f32_32x32x16_bf16 v[96:111], v[44:47], v[32:35], v[96:111]
    v_mfma_f32_32x32x16_bf16 v[112:127], v[44:47], v[36:39], v[112:127]
    s_waitcnt lgkmcnt(0)
    v_mfma_f32_32x32x16_bf16 v[64:79], v[56:59], v[48:51], v[64:79]
    s_barrier
    v_add_u32 v10, 0x4000, v10
    v_add_u32 v11, 0x4000, v11
    v_add_u32 v12, 0x4000, v12
    v_add_u32 v13, 0x4000, v13
    v_add_u32 v14, 0x6000, v14
    v_add_u32 v15, 0x6000, v15
    v_mfma_f32_32x32x16_bf16 v[80:95], v[56:59], v[52:55], v[80:95]
    ds_read_b128 v[32:35], v10 offset:0
    ds_read_b128 v[36:39], v10 offset:4096
    ds_read_b64_tr_b16 v[40:41], v14 offset:0
    ds_read_b64_tr_b16 v[42:43], v14 offset:1024
    ds_read_b64_tr_b16 v[44:45], v15 offset:0
    ds_read_b64_tr_b16 v[46:47], v15 offset:1024
    v_mfma_f32_32x32x16_bf16 v[96:111], v[60:63], v[48:51], v[96:111]
    v_mfma_f32_32x32x16_bf16 v[112:127], v[60:63], v[52:55], v[112:127]
    s_waitcnt lgkmcnt(0)
    v_mfma_f32_32x32x16_bf16 v[64:79], v[40:43], v[32:35], v[64:79]
    ds_read_b128 v[48:51], v11 offset:0
    ds_read_b128 v[52:55], v11 offset:4096
    ds_read_b64_tr_b16 v[56:57], v14 offset:4096
    v_mfma_f32_32x32x16_bf16 v[80:95], v[40:43], v[36:39], v[80:95]
    ds_read_b64_tr_b16 v[58:59], v14 offset:5120
    ds_read_b64_tr_b16 v[60:61], v15 offset:4096
    ds_read_b64_tr_b16 v[62:63], v15 offset:5120
    v_mfma_f32_32x32x16_bf16 v[96:111], v[44:47], v[32:35], v[96:111]
    v_mfma_f32_32x32x16_bf16 v[112:127], v[44:47], v[36:39], v[112:127]
    s_waitcnt lgkmcnt(0)
    v_mfma_f32_32x32x16_bf16 v[64:79], v[56:59], v[48:51], v[64:79]
    ds_read_b128 v[32:35], v12 offset:0
    ds_read_b128 v[36:39], v12 offset:4096
    ds_read_b64_tr_b16 v[40:41], v14 offset:8192
    v_mfma_f32_32x32x16_bf16 v[80:95], v[56:59], v[52:55], v[80:95]
    ds_read_b64_tr_b16 v[42:43], v14 offset:9216
    ds_read_b64_tr_b16 v[44:45], v15 offset:8192
    ds_read_b64_tr_b16 v[46:47], v15 offset:9216
    v_mfma_f32_32x32x16_bf16 v[96:111], v[60:63], v[48:51], v[96:111]
    v_mfma_f32_32x32x16_bf16 v[112:127], v[60:63], v[52:55], v[112:127]
    s_waitcnt lgkmcnt(0)
    v_mfma_f32_32x32x16_bf16 v[64:79], v[40:43], v[32:35], v[64:79]
    ds_read_b128 v[48:51], v13 offset:0
    ds_read_b128 v[52:55], v13 offset:4096
    ds_read_b64_tr_b16 v[56:57], v14 offset:12288
    v_mfma_f32_32x32x16_bf16 v[80:95], v[40:43], v[36:39], v[80:95]
    ds_read_b64_tr_b16 v[58:59], v14 offset:13312
    ds_read_b64_tr_b16 v[60:61], v15 offset:12288
    ds_read_b64_tr_b16 v[62:63], v15 offset:13312
    v_mfma_f32_32x32x16_bf16 v[96:111], v[44:47], v[32:35], v[96:111]
    v_mfma_f32_32x32x16_bf16 v[112:127], v[44:47], v[36:39], v[112:127]
    s_waitcnt lgkmcnt(0)
    v_mfma_f32_32x32x16_bf16 v[64:79], v[56:59], v[48:51], v[64:79]
    s_barrier
    v_add_u32 v10, 0x4000, v10
    v_add_u32 v11, 0x4000, v11
    v_add_u32 v12, 0x4000, v12
    v_add_u32 v13, 0x4000, v13
    v_add_u32 v14, 0x6000, v14
    v_add_u32 v15, 0x6000, v15
    v_mfma_f32_32x32x16_bf16 v[80:95], v[56:59], v[52:55], v[80:95]
    ds_read_b128 v[32:35], v10 offset:0
    ds_read_b128 v[36:39], v10 offset:4096
    ds_read_b64_tr_b16 v[40:41], v14 offset:0
    ds_read_b64_tr_b16 v[42:43], v14 offset:1024
    ds_read_b64_tr_b16 v[44:45], v15 offset:0
    ds_read_b64_tr_b16 v[46:47], v15 offset:1024
    v_mfma_f32_32x32x16_bf16 v[96:111], v[60:63], v[48:51], v[96:111]
    v_mfma_f32_32x32x16_bf16 v[112:127], v[60:63], v[52:55], v[112:127]
    s_mul_i32 s32, s29, 12288
    v_and_b32 v25, 31, v1
    v_mul_u32_u24 v25, 40, v25
    v_add_u32 v25, s32, v25
    v_cmp_gt_u32 vcc, 32, v1
    v_mov_b32 v26, 8
    v_mov_b32 v27, 0
    s_nop 0
    v_cndmask_b32 v26, v26, v27, vcc
    v_add_u32 v200, v25, v26
    v_mov_b32 v26, 24
    v_mov_b32 v27, 16
    s_nop 0
    v_cndmask_b32 v26, v26, v27, vcc
    v_add_u32 v201, v25, v26
    v_mov_b32 v26, 2560
    v_mov_b32 v27, 32
    s_nop 0
    v_cndmask_b32 v26, v26, v27, vcc
    v_add_u32 v202, v25, v26
    v_mov_b32 v26, 2576
    v_mov_b32 v27, 2568
    s_nop 0
    v_cndmask_b32 v26, v26, v27, vcc
    v_add_u32 v203, v25, v26
    v_mov_b32 v26, 2592
    v_mov_b32 v27, 2584
    s_nop 0
    v_cndmask_b32 v26, v26, v27, vcc
    v_add_u32 v204, v25, v26
    v_mov_b32 v26, 5128
    v_mov_b32 v27, 5120
    s_nop 0
    v_cndmask_b32 v26, v26, v27, vcc
    v_add_u32 v205, v25, v26
    v_mov_b32 v26, 5144
    v_mov_b32 v27, 5136
    s_nop 0
    v_cndmask_b32 v26, v26, v27, vcc
    v_add_u32 v206, v25, v26
    v_mov_b32 v26, 7680
    v_mov_b32 v27, 5152
    s_nop 0
    v_cndmask_b32 v26, v26, v27, vcc
    v_add_u32 v207, v25, v26
    v_lshlrev_b32 v28, 4, v1
    v_add_u32 v208, s32, v28
    s_lshl_b32 s32, s27, 1
    s_add_u32 s32, s32, s30
    s_mul_i32 s32, s32, 81920
    s_lshl_b32 s33, s26, 1
    s_add_u32 s33, s33, s31
    s_mul_i32 s33, s33, 2560
    s_add_u32 s39, s32, s33
    s_waitcnt lgkmcnt(0)
    v_mfma_f32_32x32x16_bf16 v[64:79], v[40:43], v[32:35], v[64:79]
    ds_read_b128 v[48:51], v11 offset:0
    ds_read_b128 v[52:55], v11 offset:4096
    ds_read_b64_tr_b16 v[56:57], v14 offset:4096
    v_mfma_f32_32x32x16_bf16 v[80:95], v[40:43], v[36:39], v[80:95]
    ds_read_b64_tr_b16 v[58:59], v14 offset:5120
    ds_read_b64_tr_b16 v[60:61], v15 offset:4096
    ds_read_b64_tr_b16 v[62:63], v15 offset:5120
    v_mfma_f32_32x32x16_bf16 v[96:111], v[44:47], v[32:35], v[96:111]
    v_mfma_f32_32x32x16_bf16 v[112:127], v[44:47], v[36:39], v[112:127]
    s_waitcnt lgkmcnt(0)
    v_mfma_f32_32x32x16_bf16 v[64:79], v[56:59], v[48:51], v[64:79]
    ds_read_b128 v[32:35], v12 offset:0
    ds_read_b128 v[36:39], v12 offset:4096
    ds_read_b64_tr_b16 v[40:41], v14 offset:8192
    v_mfma_f32_32x32x16_bf16 v[80:95], v[56:59], v[52:55], v[80:95]
    ds_read_b64_tr_b16 v[42:43], v14 offset:9216
    ds_read_b64_tr_b16 v[44:45], v15 offset:8192
    ds_read_b64_tr_b16 v[46:47], v15 offset:9216
    v_mfma_f32_32x32x16_bf16 v[96:111], v[60:63], v[48:51], v[96:111]
    v_mfma_f32_32x32x16_bf16 v[112:127], v[60:63], v[52:55], v[112:127]
    s_waitcnt lgkmcnt(0)
    v_mfma_f32_32x32x16_bf16 v[64:79], v[40:43], v[32:35], v[64:79]
    ds_read_b128 v[48:51], v13 offset:0
    ds_read_b128 v[52:55], v13 offset:4096
    ds_read_b64_tr_b16 v[56:57], v14 offset:12288
    v_mfma_f32_32x32x16_bf16 v[80:95], v[40:43], v[36:39], v[80:95]
    ds_read_b64_tr_b16 v[58:59], v14 offset:13312
    ds_read_b64_tr_b16 v[60:61], v15 offset:12288
    ds_read_b64_tr_b16 v[62:63], v15 offset:13312
    v_mfma_f32_32x32x16_bf16 v[96:111], v[44:47], v[32:35], v[96:111]
    v_mfma_f32_32x32x16_bf16 v[112:127], v[44:47], v[36:39], v[112:127]
    s_waitcnt lgkmcnt(0)
    v_mfma_f32_32x32x16_bf16 v[64:79], v[56:59], v[48:51], v[64:79]
    s_barrier
    v_add_u32 v10, 0x4000, v10
    v_add_u32 v11, 0x4000, v11
    v_add_u32 v12, 0x4000, v12
    v_add_u32 v13, 0x4000, v13
    v_add_u32 v14, 0x6000, v14
    v_add_u32 v15, 0x6000, v15
    v_mfma_f32_32x32x16_bf16 v[80:95], v[56:59], v[52:55], v[80:95]
    ds_read_b128 v[32:35], v10 offset:0
    ds_read_b128 v[36:39], v10 offset:4096
    ds_read_b64_tr_b16 v[40:41], v14 offset:0
    ds_read_b64_tr_b16 v[42:43], v14 offset:1024
    ds_read_b64_tr_b16 v[44:45], v15 offset:0
    ds_read_b64_tr_b16 v[46:47], v15 offset:1024
    v_mfma_f32_32x32x16_bf16 v[96:111], v[60:63], v[48:51], v[96:111]
    v_mfma_f32_32x32x16_bf16 v[112:127], v[60:63], v[52:55], v[112:127]
    s_waitcnt lgkmcnt(0)
    v_mfma_f32_32x32x16_bf16 v[64:79], v[40:43], v[32:35], v[64:79]
    ds_read_b128 v[48:51], v11 offset:0
    ds_read_b128 v[52:55], v11 offset:4096
    ds_read_b64_tr_b16 v[56:57], v14 offset:4096
    v_mfma_f32_32x32x16_bf16 v[80:95], v[40:43], v[36:39], v[80:95]
    ds_read_b64_tr_b16 v[58:59], v14 offset:5120
    ds_read_b64_tr_b16 v[60:61], v15 offset:4096
    ds_read_b64_tr_b16 v[62:63], v15 offset:5120
    v_mfma_f32_32x32x16_bf16 v[96:111], v[44:47], v[32:35], v[96:111]
    v_mfma_f32_32x32x16_bf16 v[112:127], v[44:47], v[36:39], v[112:127]
    s_waitcnt lgkmcnt(0)
    v_mfma_f32_32x32x16_bf16 v[64:79], v[56:59], v[48:51], v[64:79]
    ds_read_b128 v[32:35], v12 offset:0
    ds_read_b128 v[36:39], v12 offset:4096
    ds_read_b64_tr_b16 v[40:41], v14 offset:8192
    v_mfma_f32_32x32x16_bf16 v[80:95], v[56:59], v[52:55], v[80:95]
    ds_read_b64_tr_b16 v[42:43], v14 offset:9216
    ds_read_b64_tr_b16 v[44:45], v15 offset:8192
    ds_read_b64_tr_b16 v[46:47], v15 offset:9216
    v_mfma_f32_32x32x16_bf16 v[96:111], v[60:63], v[48:51], v[96:111]
    v_mfma_f32_32x32x16_bf16 v[112:127], v[60:63], v[52:55], v[112:127]
    s_waitcnt lgkmcnt(0)
    v_mfma_f32_32x32x16_bf16 v[64:79], v[40:43], v[32:35], v[64:79]
    ds_read_b128 v[48:51], v13 offset:0
    ds_read_b128 v[52:55], v13 offset:4096
    ds_read_b64_tr_b16 v[56:57], v14 offset:12288
    v_mfma_f32_32x32x16_bf16 v[80:95], v[40:43], v[36:39], v[80:95]
    ds_read_b64_tr_b16 v[58:59], v14 offset:13312
    ds_read_b64_tr_b16 v[60:61], v15 offset:12288
    ds_read_b64_tr_b16 v[62:63], v15 offset:13312
    v_mfma_f32_32x32x16_bf16 v[96:111], v[44:47], v[32:35], v[96:111]
    v_mfma_f32_32x32x16_bf16 v[112:127], v[44:47], v[36:39], v[112:127]
    s_waitcnt lgkmcnt(0)
    v_mfma_f32_32x32x16_bf16 v[64:79], v[56:59], v[48:51], v[64:79]
    s_barrier
    v_add_u32 v10, 0xffff4000, v10
    v_add_u32 v11, 0xffff4000, v11
    v_add_u32 v12, 0xffff4000, v12
    v_add_u32 v13, 0xffff4000, v13
    v_add_u32 v14, 0xfffee000, v14
    v_add_u32 v15, 0xfffee000, v15
    v_mfma_f32_32x32x16_bf16 v[80:95], v[56:59], v[52:55], v[80:95]
    ds_read_b128 v[32:35], v10 offset:0
    ds_read_b128 v[36:39], v10 offset:4096
    ds_read_b64_tr_b16 v[40:41], v14 offset:0
    ds_read_b64_tr_b16 v[42:43], v14 offset:1024
    ds_read_b64_tr_b16 v[44:45], v15 offset:0
    ds_read_b64_tr_b16 v[46:47], v15 offset:1024
    v_mfma_f32_32x32x16_bf16 v[96:111], v[60:63], v[48:51], v[96:111]
    v_mfma_f32_32x32x16_bf16 v[112:127], v[60:63], v[52:55], v[112:127]
    s_waitcnt lgkmcnt(0)
    v_mfma_f32_32x32x16_bf16 v[64:79], v[40:43], v[32:35], v[64:79]
    ds_read_b128 v[48:51], v11 offset:0
    ds_read_b128 v[52:55], v11 offset:4096
    ds_read_b64_tr_b16 v[56:57], v14 offset:4096
    v_mfma_f32_32x32x16_bf16 v[80:95], v[40:43], v[36:39], v[80:95]
    ds_read_b64_tr_b16 v[58:59], v14 offset:5120
    ds_read_b64_tr_b16 v[60:61], v15 offset:4096
    ds_read_b64_tr_b16 v[62:63], v15 offset:5120
    v_mfma_f32_32x32x16_bf16 v[96:111], v[44:47], v[32:35], v[96:111]
    v_mfma_f32_32x32x16_bf16 v[112:127], v[44:47], v[36:39], v[112:127]
    s_waitcnt lgkmcnt(0)
    v_mfma_f32_32x32x16_bf16 v[64:79], v[56:59], v[48:51], v[64:79]
    ds_read_b128 v[32:35], v12 offset:0
    ds_read_b128 v[36:39], v12 offset:4096
    ds_read_b64_tr_b16 v[40:41], v14 offset:8192
    v_mfma_f32_32x32x16_bf16 v[80:95], v[56:59], v[52:55], v[80:95]
    ds_read_b64_tr_b16 v[42:43], v14 offset:9216
    ds_read_b64_tr_b16 v[44:45], v15 offset:8192
    ds_read_b64_tr_b16 v[46:47], v15 offset:9216
    v_mfma_f32_32x32x16_bf16 v[96:111], v[60:63], v[48:51], v[96:111]
    v_mfma_f32_32x32x16_bf16 v[112:127], v[60:63], v[52:55], v[112:127]
    s_waitcnt lgkmcnt(0)
    v_mfma_f32_32x32x16_bf16 v[64:79], v[40:43], v[32:35], v[64:79]
    ds_read_b128 v[48:51], v13 offset:0
    ds_read_b128 v[52:55], v13 offset:4096
    ds_read_b64_tr_b16 v[56:57], v14 offset:12288
    v_mfma_f32_32x32x16_bf16 v[80:95], v[40:43], v[36:39], v[80:95]
    ds_read_b64_tr_b16 v[58:59], v14 offset:13312
    ds_read_b64_tr_b16 v[60:61], v15 offset:12288
    ds_read_b64_tr_b16 v[62:63], v15 offset:13312
    v_mfma_f32_32x32x16_bf16 v[96:111], v[44:47], v[32:35], v[96:111]
    v_mfma_f32_32x32x16_bf16 v[112:127], v[44:47], v[36:39], v[112:127]
    s_waitcnt lgkmcnt(0)
    v_mfma_f32_32x32x16_bf16 v[64:79], v[56:59], v[48:51], v[64:79]
    s_barrier
    v_add_u32 v10, 0x4000, v10
    v_add_u32 v11, 0x4000, v11
    v_add_u32 v12, 0x4000, v12
    v_add_u32 v13, 0x4000, v13
    v_add_u32 v14, 0x6000, v14
    v_add_u32 v15, 0x6000, v15
    v_mfma_f32_32x32x16_bf16 v[80:95], v[56:59], v[52:55], v[80:95]
    ds_read_b128 v[32:35], v10 offset:0
    ds_read_b128 v[36:39], v10 offset:4096
    ds_read_b64_tr_b16 v[40:41], v14 offset:0
    ds_read_b64_tr_b16 v[42:43], v14 offset:1024
    ds_read_b64_tr_b16 v[44:45], v15 offset:0
    ds_read_b64_tr_b16 v[46:47], v15 offset:1024
    v_mfma_f32_32x32x16_bf16 v[96:111], v[60:63], v[48:51], v[96:111]
    v_mfma_f32_32x32x16_bf16 v[112:127], v[60:63], v[52:55], v[112:127]
    s_waitcnt lgkmcnt(0)
    v_mfma_f32_32x32x16_bf16 v[64:79], v[40:43], v[32:35], v[64:79]
    ds_read_b128 v[48:51], v11 offset:0
    ds_read_b128 v[52:55], v11 offset:4096
    ds_read_b64_tr_b16 v[56:57], v14 offset:4096
    v_mfma_f32_32x32x16_bf16 v[80:95], v[40:43], v[36:39], v[80:95]
    ds_read_b64_tr_b16 v[58:59], v14 offset:5120
    ds_read_b64_tr_b16 v[60:61], v15 offset:4096
    ds_read_b64_tr_b16 v[62:63], v15 offset:5120
    v_mfma_f32_32x32x16_bf16 v[96:111], v[44:47], v[32:35], v[96:111]
    v_mfma_f32_32x32x16_bf16 v[112:127], v[44:47], v[36:39], v[112:127]
    s_waitcnt lgkmcnt(0)
    v_mfma_f32_32x32x16_bf16 v[64:79], v[56:59], v[48:51], v[64:79]
    ds_read_b128 v[32:35], v12 offset:0
    ds_read_b128 v[36:39], v12 offset:4096
    ds_read_b64_tr_b16 v[40:41], v14 offset:8192
    v_mfma_f32_32x32x16_bf16 v[80:95], v[56:59], v[52:55], v[80:95]
    ds_read_b64_tr_b16 v[42:43], v14 offset:9216
    ds_read_b64_tr_b16 v[44:45], v15 offset:8192
    ds_read_b64_tr_b16 v[46:47], v15 offset:9216
    v_mfma_f32_32x32x16_bf16 v[96:111], v[60:63], v[48:51], v[96:111]
    v_mfma_f32_32x32x16_bf16 v[112:127], v[60:63], v[52:55], v[112:127]
    s_waitcnt lgkmcnt(0)
    v_mfma_f32_32x32x16_bf16 v[64:79], v[40:43], v[32:35], v[64:79]
    ds_read_b128 v[48:51], v13 offset:0
    ds_read_b128 v[52:55], v13 offset:4096
    ds_read_b64_tr_b16 v[56:57], v14 offset:12288
    v_mfma_f32_32x32x16_bf16 v[80:95], v[40:43], v[36:39], v[80:95]
    ds_read_b64_tr_b16 v[58:59], v14 offset:13312
    ds_read_b64_tr_b16 v[60:61], v15 offset:12288
    ds_read_b64_tr_b16 v[62:63], v15 offset:13312
    v_mfma_f32_32x32x16_bf16 v[96:111], v[44:47], v[32:35], v[96:111]
    v_mfma_f32_32x32x16_bf16 v[112:127], v[44:47], v[36:39], v[112:127]
    s_waitcnt lgkmcnt(0)
    v_mfma_f32_32x32x16_bf16 v[64:79], v[56:59], v[48:51], v[64:79]
    v_mfma_f32_32x32x16_bf16 v[80:95], v[56:59], v[52:55], v[80:95]
    v_mfma_f32_32x32x16_bf16 v[96:111], v[60:63], v[48:51], v[96:111]
    v_mfma_f32_32x32x16_bf16 v[112:127], v[60:63], v[52:55], v[112:127]
    s_barrier
    s_nop 4
    v_pk_fma_f32 v[64:65], v[192:193], v[128:129], v[64:65] neg_lo:[1,0,0] neg_hi:[1,0,0]
    v_pk_mul_f32 v[64:65], v[64:65], v[194:195]
    v_pk_fma_f32 v[66:67], v[192:193], v[130:131], v[66:67] neg_lo:[1,0,0] neg_hi:[1,0,0]
    v_pk_mul_f32 v[66:67], v[66:67], v[194:195]
    v_pk_fma_f32 v[68:69], v[192:193], v[132:133], v[68:69] neg_lo:[1,0,0] neg_hi:[1,0,0]
    v_pk_mul_f32 v[68:69], v[68:69], v[194:195]
    v_pk_fma_f32 v[70:71], v[192:193], v[134:135], v[70:71] neg_lo:[1,0,0] neg_hi:[1,0,0]
    v_pk_mul_f32 v[70:71], v[70:71], v[194:195]
    v_pk_fma_f32 v[72:73], v[192:193], v[136:137], v[72:73] neg_lo:[1,0,0] neg_hi:[1,0,0]
    v_pk_mul_f32 v[72:73], v[72:73], v[194:195]
    v_pk_fma_f32 v[74:75], v[192:193], v[138:139], v[74:75] neg_lo:[1,0,0] neg_hi:[1,0,0]
    v_pk_mul_f32 v[74:75], v[74:75], v[194:195]
    v_pk_fma_f32 v[76:77], v[192:193], v[140:141], v[76:77] neg_lo:[1,0,0] neg_hi:[1,0,0]
    v_pk_mul_f32 v[76:77], v[76:77], v[194:195]
    v_pk_fma_f32 v[78:79], v[192:193], v[142:143], v[78:79] neg_lo:[1,0,0] neg_hi:[1,0,0]
    v_pk_mul_f32 v[78:79], v[78:79], v[194:195]
    v_cvt_pk_bf16_f32 v32, v64, v65
    v_cvt_pk_bf16_f32 v33, v66, v67
    ds_write_b64 v200, v[32:33] offset:0
    v_cvt_pk_bf16_f32 v34, v68, v69
    v_cvt_pk_bf16_f32 v35, v70, v71
    ds_write_b64 v201, v[34:35] offset:0
    v_cvt_pk_bf16_f32 v36, v72, v73
    v_cvt_pk_bf16_f32 v37, v74, v75
    ds_write_b64 v202, v[36:37] offset:0
    v_cvt_pk_bf16_f32 v38, v76, v77
    v_cvt_pk_bf16_f32 v39, v78, v79
    ds_write_b64 v203, v[38:39] offset:0
    v_pk_fma_f32 v[96:97], v[192:193], v[144:145], v[96:97] neg_lo:[1,0,0] neg_hi:[1,0,0]
    v_pk_mul_f32 v[96:97], v[96:97], v[194:195]
    v_pk_fma_f32 v[98:99], v[192:193], v[146:147], v[98:99] neg_lo:[1,0,0] neg_hi:[1,0,0]
    v_pk_mul_f32 v[98:99], v[98:99], v[194:195]
    v_pk_fma_f32 v[100:101], v[192:193], v[148:149], v[100:101] neg_lo:[1,0,0] neg_hi:[1,0,0]
    v_pk_mul_f32 v[100:101], v[100:101], v[194:195]
    v_pk_fma_f32 v[102:103], v[192:193], v[150:151], v[102:103] neg_lo:[1,0,0] neg_hi:[1,0,0]
    v_pk_mul_f32 v[102:103], v[102:103], v[194:195]
    v_pk_fma_f32 v[104:105], v[192:193], v[152:153], v[104:105] neg_lo:[1,0,0] neg_hi:[1,0,0]
    v_pk_mul_f32 v[104:105], v[104:105], v[194:195]
    v_pk_fma_f32 v[106:107], v[192:193], v[154:155], v[106:107] neg_lo:[1,0,0] neg_hi:[1,0,0]
    v_pk_mul_f32 v[106:107], v[106:107], v[194:195]
    v_pk_fma_f32 v[108:109], v[192:193], v[156:157], v[108:109] neg_lo:[1,0,0] neg_hi:[1,0,0]
    v_pk_mul_f32 v[108:109], v[108:109], v[194:195]
    v_pk_fma_f32 v[110:111], v[192:193], v[158:159], v[110:111] neg_lo:[1,0,0] neg_hi:[1,0,0]
    v_pk_mul_f32 v[110:111], v[110:111], v[194:195]
    v_cvt_pk_bf16_f32 v40, v96, v97
    v_cvt_pk_bf16_f32 v41, v98, v99
    ds_write_b64 v204, v[40:41] offset:0
    v_cvt_pk_bf16_f32 v42, v100, v101
    v_cvt_pk_bf16_f32 v43, v102, v103
    ds_write_b64 v205, v[42:43] offset:0
    v_cvt_pk_bf16_f32 v44, v104, v105
    v_cvt_pk_bf16_f32 v45, v106, v107
    ds_write_b64 v206, v[44:45] offset:0
    v_cvt_pk_bf16_f32 v46, v108, v109
    v_cvt_pk_bf16_f32 v47, v110, v111
    ds_write_b64 v207, v[46:47] offset:0
    v_pk_fma_f32 v[80:81], v[196:197], v[128:129], v[80:81] neg_lo:[1,0,0] neg_hi:[1,0,0]
    v_pk_mul_f32 v[80:81], v[80:81], v[198:199]
    v_pk_fma_f32 v[82:83], v[196:197], v[130:131], v[82:83] neg_lo:[1,0,0] neg_hi:[1,0,0]
    v_pk_mul_f32 v[82:83], v[82:83], v[198:199]
    v_pk_fma_f32 v[84:85], v[196:197], v[132:133], v[84:85] neg_lo:[1,0,0] neg_hi:[1,0,0]
    v_pk_mul_f32 v[84:85], v[84:85], v[198:199]
    v_pk_fma_f32 v[86:87], v[196:197], v[134:135], v[86:87] neg_lo:[1,0,0] neg_hi:[1,0,0]
    v_pk_mul_f32 v[86:87], v[86:87], v[198:199]
    v_pk_fma_f32 v[88:89], v[196:197], v[136:137], v[88:89] neg_lo:[1,0,0] neg_hi:[1,0,0]
    v_pk_mul_f32 v[88:89], v[88:89], v[198:199]
    v_pk_fma_f32 v[90:91], v[196:197], v[138:139], v[90:91] neg_lo:[1,0,0] neg_hi:[1,0,0]
    v_pk_mul_f32 v[90:91], v[90:91], v[198:199]
    v_pk_fma_f32 v[92:93], v[196:197], v[140:141], v[92:93] neg_lo:[1,0,0] neg_hi:[1,0,0]
    v_pk_mul_f32 v[92:93], v[92:93], v[198:199]
    v_pk_fma_f32 v[94:95], v[196:197], v[142:143], v[94:95] neg_lo:[1,0,0] neg_hi:[1,0,0]
    v_pk_mul_f32 v[94:95], v[94:95], v[198:199]
    v_cvt_pk_bf16_f32 v32, v80, v81
    v_cvt_pk_bf16_f32 v33, v82, v83
    ds_write_b64 v200, v[32:33] offset:1280
    v_cvt_pk_bf16_f32 v34, v84, v85
    v_cvt_pk_bf16_f32 v35, v86, v87
    ds_write_b64 v201, v[34:35] offset:1280
    v_cvt_pk_bf16_f32 v36, v88, v89
    v_cvt_pk_bf16_f32 v37, v90, v91
    ds_write_b64 v202, v[36:37] offset:1280
    v_cvt_pk_bf16_f32 v38, v92, v93
    v_cvt_pk_bf16_f32 v39, v94, v95
    ds_write_b64 v203, v[38:39] offset:1280
    v_pk_fma_f32 v[112:113], v[196:197], v[144:145], v[112:113] neg_lo:[1,0,0] neg_hi:[1,0,0]
    v_pk_mul_f32 v[112:113], v[112:113], v[198:199]
    v_pk_fma_f32 v[114:115], v[196:197], v[146:147], v[114:115] neg_lo:[1,0,0] neg_hi:[1,0,0]
    v_pk_mul_f32 v[114:115], v[114:115], v[198:199]
    v_pk_fma_f32 v[116:117], v[196:197], v[148:149], v[116:117] neg_lo:[1,0,0] neg_hi:[1,0,0]
    v_pk_mul_f32 v[116:117], v[116:117], v[198:199]
    v_pk_fma_f32 v[118:119], v[196:197], v[150:151], v[118:119] neg_lo:[1,0,0] neg_hi:[1,0,0]
    v_pk_mul_f32 v[118:119], v[118:119], v[198:199]
    v_pk_fma_f32 v[120:121], v[196:197], v[152:153], v[120:121] neg_lo:[1,0,0] neg_hi:[1,0,0]
    v_pk_mul_f32 v[120:121], v[120:121], v[198:199]
    v_pk_fma_f32 v[122:123], v[196:197], v[154:155], v[122:123] neg_lo:[1,0,0] neg_hi:[1,0,0]
    v_pk_mul_f32 v[122:123], v[122:123], v[198:199]
    v_pk_fma_f32 v[124:125], v[196:197], v[156:157], v[124:125] neg_lo:[1,0,0] neg_hi:[1,0,0]
    v_pk_mul_f32 v[124:125], v[124:125], v[198:199]
    v_pk_fma_f32 v[126:127], v[196:197], v[158:159], v[126:127] neg_lo:[1,0,0] neg_hi:[1,0,0]
    v_pk_mul_f32 v[126:127], v[126:127], v[198:199]
    v_cvt_pk_bf16_f32 v40, v112, v113
    v_cvt_pk_bf16_f32 v41, v114, v115
    ds_write_b64 v204, v[40:41] offset:1280
    v_cvt_pk_bf16_f32 v42, v116, v117
    v_cvt_pk_bf16_f32 v43, v118, v119
    ds_write_b64 v205, v[42:43] offset:1280
    v_cvt_pk_bf16_f32 v44, v120, v121
    v_cvt_pk_bf16_f32 v45, v122, v123
    ds_write_b64 v206, v[44:45] offset:1280
    v_cvt_pk_bf16_f32 v46, v124, v125
    v_cvt_pk_bf16_f32 v47, v126, v127
    ds_write_b64 v207, v[46:47] offset:1280
    s_waitcnt lgkmcnt(0)
    ds_read_b128 v[64:67], v208 offset:0
    ds_read_b128 v[68:71], v208 offset:1024
    ds_read_b128 v[72:75], v208 offset:2048
    ds_read_b128 v[76:79], v208 offset:2560
    ds_read_b128 v[80:83], v208 offset:3584
    ds_read_b128 v[84:87], v208 offset:4608
    ds_read_b128 v[88:91], v208 offset:5120
    ds_read_b128 v[92:95], v208 offset:6144
    ds_read_b128 v[96:99], v208 offset:7168
    v_cmp_gt_u32 vcc, 32, v1
    s_add_u32 s33, s39, 0
    s_waitcnt lgkmcnt(0)
    buffer_store_dwordx4 v[64:67], v28, s[16:19], s33 offen offset:0 sc1
    s_add_u32 s33, s39, 2621440
    s_waitcnt lgkmcnt(0)
    buffer_store_dwordx4 v[76:79], v28, s[16:19], s33 offen offset:0 sc1
    s_add_u32 s33, s39, 5242880
    s_waitcnt lgkmcnt(0)
    buffer_store_dwordx4 v[88:91], v28, s[16:19], s33 offen offset:0 sc1
    s_add_u32 s33, s39, 0
    s_waitcnt lgkmcnt(0)
    buffer_store_dwordx4 v[68:71], v28, s[16:19], s33 offen offset:1024 sc1
    s_add_u32 s33, s39, 2621440
    s_waitcnt lgkmcnt(0)
    buffer_store_dwordx4 v[80:83], v28, s[16:19], s33 offen offset:1024 sc1
    s_add_u32 s33, s39, 5242880
    s_waitcnt lgkmcnt(0)
    buffer_store_dwordx4 v[92:95], v28, s[16:19], s33 offen offset:1024 sc1
    s_and_saveexec_b64 s[36:37], vcc
    s_add_u32 s33, s39, 0
    buffer_store_dwordx4 v[72:75], v28, s[16:19], s33 offen offset:2048 sc1
    s_add_u32 s33, s39, 2621440
    buffer_store_dwordx4 v[84:87], v28, s[16:19], s33 offen offset:2048 sc1
    s_add_u32 s33, s39, 5242880
    buffer_store_dwordx4 v[96:99], v28, s[16:19], s33 offen offset:2048 sc1
    s_mov_b64 exec, s[36:37]
    s_waitcnt vmcnt(0)
    s_barrier
    s_lshl_b32 s32, s26, 4
    s_add_u32 s32, s32, s27
    s_add_u32 s32, s32, 0
    s_cmp_lg_u32 s29, 0
    s_cbranch_scc1 nosig_mega_kernel_7
    s_lshl_b32 s38, s32, 7
    v_mov_b32 v24, s38
    v_mov_b32 v23, 1
    v_cmp_eq_u32 vcc, 0, v1
    s_and_saveexec_b64 s[36:37], vcc
    s_cbranch_execz nosig2_mega_kernel_8
    buffer_atomic_add v23, v24, s[92:95], 0 offen sc1
nosig2_mega_kernel_8:
    s_mov_b64 exec, s[36:37]
nosig_mega_kernel_7:
    s_branch end_mega_kernel_6
loader_mega_kernel_5:
    s_lshl_b32 s32, s26, 7
    s_lshl_b32 s33, s28, 5
    s_add_u32 s32, s32, s33
    v_lshrrev_b32 v25, 3, v1
    v_add_u32 v25, s32, v25
    v_mul_u32_u24 v25, 1280, v25
    v_and_b32 v26, 7, v1
    v_lshrrev_b32 v27, 4, v1
    v_xor_b32 v26, v26, v27
    v_lshlrev_b32 v26, 4, v26
    v_xor_b32 v27, 64, v26
    v_add_u32 v2, v25, v26
    v_add_u32 v3, v25, v27
    v_add_u32 v3, 9216, v3
    v_add_u32 v4, v25, v26
    v_add_u32 v4, 18432, v4
    v_add_u32 v5, v25, v27
    v_add_u32 v5, 27648, v5
    s_lshl_b32 s34, s28, 12
    s_add_u32 s76, s84, 0x1ad9000
    s_addc_u32 s77, s85, 0
    s_mov_b32 s78, 2621440
    s_and_b32 s77, s77, 0xffff
    s_mov_b32 s79, 0x00020000
    s_lshr_b32 s82, s2, 4
    s_mul_i32 s82, s82, 163840
    s_mul_i32 s80, s28, 4096
    s_add_u32 s82, s82, s80
    v_lshlrev_b32 v8, 4, v1
    v_add_u32 v8, s82, v8
    v_add_u32 v9, 4096, v8
    s_barrier
    s_add_u32 m0, s34, 0
    s_mov_b32 s35, 0
    buffer_load_dwordx4 v2, s[4:7], s35 offen offset:0 sc1 lds
    buffer_load_dwordx4 v3, s[4:7], s35 offen offset:1024 sc1 lds
    buffer_load_dwordx4 v4, s[4:7], s35 offen offset:2048 sc1 lds
    buffer_load_dwordx4 v5, s[4:7], s35 offen offset:3072 sc1 lds
    s_add_u32 m0, s34, 16384
    s_mov_b32 s35, 128
    buffer_load_dwordx4 v2, s[4:7], s35 offen offset:0 sc1 lds
    buffer_load_dwordx4 v3, s[4:7], s35 offen offset:1024 sc1 lds
    buffer_load_dwordx4 v4, s[4:7], s35 offen offset:2048 sc1 lds
    buffer_load_dwordx4 v5, s[4:7], s35 offen offset:3072 sc1 lds
    s_waitcnt vmcnt(4)
    s_barrier
    s_add_u32 m0, s34, 32768
    s_mov_b32 s35, 256
    buffer_load_dwordx4 v2, s[4:7], s35 offen offset:0 sc1 lds
    buffer_load_dwordx4 v3, s[4:7], s35 offen offset:1024 sc1 lds
    buffer_load_dwordx4 v4, s[4:7], s35 offen offset:2048 sc1 lds
    buffer_load_dwordx4 v5, s[4:7], s35 offen offset:3072 sc1 lds
    s_add_u32 m0, s34, 49152
    s_mov_b32 s35, 384
    buffer_load_dwordx4 v2, s[4:7], s35 offen offset:0 sc1 lds
    buffer_load_dwordx4 v3, s[4:7], s35 offen offset:1024 sc1 lds
    buffer_load_dwordx4 v4, s[4:7], s35 offen offset:2048 sc1 lds
    buffer_load_dwordx4 v5, s[4:7], s35 offen offset:3072 sc1 lds
    s_waitcnt vmcnt(8)
    s_barrier
    s_add_u32 m0, s34, 0
    s_mov_b32 s35, 512
    buffer_load_dwordx4 v2, s[4:7], s35 offen offset:0 sc1 lds
    buffer_load_dwordx4 v3, s[4:7], s35 offen offset:1024 sc1 lds
    buffer_load_dwordx4 v4, s[4:7], s35 offen offset:2048 sc1 lds
    buffer_load_dwordx4 v5, s[4:7], s35 offen offset:3072 sc1 lds
    s_add_u32 m0, s80, 65536
    s_mov_b32 s81, 65536
    buffer_load_dwordx4 v8, s[76:79], s81 offen offset:0 sc1 lds
    buffer_load_dwordx4 v8, s[76:79], s81 offen offset:1024 sc1 lds
    buffer_load_dwordx4 v8, s[76:79], s81 offen offset:2048 sc1 lds
    buffer_load_dwordx4 v8, s[76:79], s81 offen offset:3072 sc1 lds
    s_waitcnt vmcnt(12)
    s_barrier
    s_add_u32 m0, s34, 16384
    s_mov_b32 s35, 640
    buffer_load_dwordx4 v2, s[4:7], s35 offen offset:0 sc1 lds
    buffer_load_dwordx4 v3, s[4:7], s35 offen offset:1024 sc1 lds
    buffer_load_dwordx4 v4, s[4:7], s35 offen offset:2048 sc1 lds
    buffer_load_dwordx4 v5, s[4:7], s35 offen offset:3072 sc1 lds
    s_add_u32 m0, s80, 90112
    s_mov_b32 s81, 81920
    buffer_load_dwordx4 v8, s[76:79], s81 offen offset:0 sc1 lds
    buffer_load_dwordx4 v8, s[76:79], s81 offen offset:1024 sc1 lds
    buffer_load_dwordx4 v8, s[76:79], s81 offen offset:2048 sc1 lds
    buffer_load_dwordx4 v8, s[76:79], s81 offen offset:3072 sc1 lds
    s_waitcnt vmcnt(16)
    s_barrier
    s_add_u32 m0, s34, 32768
    s_mov_b32 s35, 768
    buffer_load_dwordx4 v2, s[4:7], s35 offen offset:0 sc1 lds
    buffer_load_dwordx4 v3, s[4:7], s35 offen offset:1024 sc1 lds
    buffer_load_dwordx4 v4, s[4:7], s35 offen offset:2048 sc1 lds
    buffer_load_dwordx4 v5, s[4:7], s35 offen offset:3072 sc1 lds
    s_add_u32 m0, s80, 114688
    s_mov_b32 s81, 98304
    buffer_load_dwordx4 v8, s[76:79], s81 offen offset:0 sc1 lds
    buffer_load_dwordx4 v8, s[76:79], s81 offen offset:1024 sc1 lds
    buffer_load_dwordx4 v8, s[76:79], s81 offen offset:2048 sc1 lds
    buffer_load_dwordx4 v8, s[76:79], s81 offen offset:3072 sc1 lds
    s_waitcnt vmcnt(16)
    s_barrier
    s_add_u32 m0, s34, 49152
    s_mov_b32 s35, 896
    buffer_load_dwordx4 v2, s[4:7], s35 offen offset:0 sc1 lds
    buffer_load_dwordx4 v3, s[4:7], s35 offen offset:1024 sc1 lds
    buffer_load_dwordx4 v4, s[4:7], s35 offen offset:2048 sc1 lds
    buffer_load_dwordx4 v5, s[4:7], s35 offen offset:3072 sc1 lds
    s_add_u32 m0, s80, 139264
    s_mov_b32 s81, 114688
    buffer_load_dwordx4 v8, s[76:79], s81 offen offset:0 sc1 lds
    buffer_load_dwordx4 v8, s[76:79], s81 offen offset:1024 sc1 lds
    buffer_load_dwordx4 v8, s[76:79], s81 offen offset:2048 sc1 lds
    buffer_load_dwordx4 v8, s[76:79], s81 offen offset:3072 sc1 lds
    s_waitcnt vmcnt(16)
    s_barrier
    s_add_u32 m0, s34, 0
    s_mov_b32 s35, 1024
    buffer_load_dwordx4 v2, s[4:7], s35 offen offset:0 sc1 lds
    buffer_load_dwordx4 v3, s[4:7], s35 offen offset:1024 sc1 lds
    buffer_load_dwordx4 v4, s[4:7], s35 offen offset:2048 sc1 lds
    buffer_load_dwordx4 v5, s[4:7], s35 offen offset:3072 sc1 lds
    s_add_u32 m0, s80, 65536
    s_mov_b32 s81, 131072
    buffer_load_dwordx4 v8, s[76:79], s81 offen offset:0 sc1 lds
    buffer_load_dwordx4 v8, s[76:79], s81 offen offset:1024 sc1 lds
    buffer_load_dwordx4 v8, s[76:79], s81 offen offset:2048 sc1 lds
    buffer_load_dwordx4 v8, s[76:79], s81 offen offset:3072 sc1 lds
    s_waitcnt vmcnt(16)
    s_barrier
    s_add_u32 m0, s34, 16384
    s_mov_b32 s35, 1152
    buffer_load_dwordx4 v2, s[4:7], s35 offen offset:0 sc1 lds
    buffer_load_dwordx4 v3, s[4:7], s35 offen offset:1024 sc1 lds
    buffer_load_dwordx4 v4, s[4:7], s35 offen offset:2048 sc1 lds
    buffer_load_dwordx4 v5, s[4:7], s35 offen offset:3072 sc1 lds
    s_add_u32 m0, s80, 90112
    s_mov_b32 s81, 147456
    buffer_load_dwordx4 v8, s[76:79], s81 offen offset:0 sc1 lds
    buffer_load_dwordx4 v8, s[76:79], s81 offen offset:1024 sc1 lds
    buffer_load_dwordx4 v8, s[76:79], s81 offen offset:2048 sc1 lds
    buffer_load_dwordx4 v8, s[76:79], s81 offen offset:3072 sc1 lds
    s_waitcnt vmcnt(16)
    s_barrier
    s_waitcnt vmcnt(8)
    s_barrier
    s_waitcnt vmcnt(0)
    s_barrier
    s_add_u32 s76, s84, 0x2119000
    s_addc_u32 s77, s85, 0
    s_mov_b32 s78, 983040
    s_and_b32 s77, s77, 0xffff
    s_mov_b32 s79, 0x00020000
    s_lshr_b32 s82, s2, 5
    s_mul_i32 s82, s82, 122880
    s_mul_i32 s80, s28, 5120
    s_add_u32 s82, s82, s80
    v_lshlrev_b32 v8, 4, v1
    v_add_u32 v8, s82, v8
    v_add_u32 v9, 4096, v8
    s_add_u32 m0, s80, 114688
    s_mov_b32 s81, 0
    buffer_load_dwordx4 v8, s[76:79], s81 offen offset:0 sc1 lds
    buffer_load_dwordx4 v8, s[76:79], s81 offen offset:1024 sc1 lds
    buffer_load_dwordx4 v8, s[76:79], s81 offen offset:2048 sc1 lds
    buffer_load_dwordx4 v8, s[76:79], s81 offen offset:3072 sc1 lds
    s_add_u32 m0, s80, 118784
    s_nop 0
    buffer_load_dwordx4 v9, s[76:79], s81 offen offset:0 sc1 lds
    s_add_u32 m0, s80, 139264
    s_mov_b32 s81, 20480
    buffer_load_dwordx4 v8, s[76:79], s81 offen offset:0 sc1 lds
    buffer_load_dwordx4 v8, s[76:79], s81 offen offset:1024 sc1 lds
    buffer_load_dwordx4 v8, s[76:79], s81 offen offset:2048 sc1 lds
    buffer_load_dwordx4 v8, s[76:79], s81 offen offset:3072 sc1 lds
    s_add_u32 m0, s80, 143360
    s_nop 0
    buffer_load_dwordx4 v9, s[76:79], s81 offen offset:0 sc1 lds
    s_add_u32 m0, s80, 65536
    s_mov_b32 s81, 40960
    buffer_load_dwordx4 v8, s[76:79], s81 offen offset:0 sc1 lds
    buffer_load_dwordx4 v8, s[76:79], s81 offen offset:1024 sc1 lds
    buffer_load_dwordx4 v8, s[76:79], s81 offen offset:2048 sc1 lds
    buffer_load_dwordx4 v8, s[76:79], s81 offen offset:3072 sc1 lds
    s_add_u32 m0, s80, 69632
    s_nop 0
    buffer_load_dwordx4 v9, s[76:79], s81 offen offset:0 sc1 lds
    s_barrier
    s_add_u32 m0, s80, 90112
    s_mov_b32 s81, 61440
    buffer_load_dwordx4 v8, s[76:79], s81 offen offset:0 sc1 lds
    buffer_load_dwordx4 v8, s[76:79], s81 offen offset:1024 sc1 lds
    buffer_load_dwordx4 v8, s[76:79], s81 offen offset:2048 sc1 lds
    buffer_load_dwordx4 v8, s[76:79], s81 offen offset:3072 sc1 lds
    s_add_u32 m0, s80, 94208
    s_nop 0
    buffer_load_dwordx4 v9, s[76:79], s81 offen offset:0 sc1 lds
    s_barrier
end_mega_kernel_6:
    s_add_u32 s4, s84, 0xbd9000
    s_addc_u32 s5, s85, 0
    s_mov_b32 s6, 15728640
    s_and_b32 s5, s5, 0xffff
    s_mov_b32 s7, 0x00020000
    s_add_u32 s16, s84, 0x2d9000
    s_addc_u32 s17, s85, 0
    s_mov_b32 s18, 3145728
    s_and_b32 s17, s17, 0xffff
    s_mov_b32 s19, 0x00020000
    s_and_b32 s26, s2, 7
    s_lshr_b32 s27, s2, 3
    s_lshr_b32 s32, s29, 2
    s_add_u32 s32, s32, 1
    s_lshl_b32 s32, s32, 5
    s_add_u32 s32, s32, s27
    s_mul_i32 s32, s32, 81920
    s_mul_i32 s33, s26, 10240
    s_add_u32 s32, s32, s33
    s_sub_u32 s32, s32, 10240
    s_mul_i32 s33, s28, 5120
    s_add_u32 s32, s32, s33
    s_cmp_lg_u32 s26, 0
    s_cbranch_scc1 neg_mega_kernel_9
    s_cmp_ge_u32 s28, 2
    s_cbranch_scc1 neg_mega_kernel_9
    s_mov_b32 s32, 0x7ff00000
neg_mega_kernel_9:
    v_lshlrev_b32 v2, 4, v1
    v_add_u32 v2, s32, v2
    v_add_u32 v3, 4096, v2
    s_mul_i32 s34, s29, 5120
    v_and_b32 v20, 31, v1
    s_lshl_b32 s32, s26, 8
    s_lshl_b32 s35, s29, 5
    s_add_u32 s32, s32, s35
    v_add_u32 v4, s32, v20
    v_lshrrev_b32 v6, 5, v1
    s_add_u32 s33, s27, 0
    s_mul_i32 s33, s33, 81920
    s_mul_i32 s32, s26, 10240
    s_add_u32 s33, s33, s32
    s_lshl_b32 s32, s29, 11
    s_add_u32 s33, s33, s32
    v_lshlrev_b32 v7, 4, v1
    v_add_u32 v7, s33, v7
    s_add_u32 s39, s32, 40960
    v_add_u32 v5, s35, v20
    v_mul_u32_u24 v5, 40, v5
    v_lshl_add_u32 v5, v6, 4, v5
    v_add_u32 v5, 40960, v5
    v_mov_b32 v14, 0
    v_mov_b32 v15, 0
    v_add_u32 v16, s35, v20
    v_mul_u32_u24 v16, 40, v16
    v_lshl_add_u32 v16, v6, 4, v16
    v_lshlrev_b32 v17, 2, v6
    v_bfe_u32 v18, v1, 2, 2
    v_add_u32 v17, v17, v18
    v_add_u32 v17, s35, v17
    v_mul_u32_u24 v17, 40, v17
    v_bfe_u32 v18, v1, 4, 1
    v_lshl_add_u32 v17, v18, 5, v17
    v_and_b32 v18, 3, v1
    v_lshl_add_u32 v17, v18, 3, v17
    v_add_u32 v17, 20480, v17
    v_lshlrev_b32 v18, 2, v6
    v_sub_u32 v18, v20, v18
    s_cmp_lg_u32 s29, 3
    s_cbranch_scc1 pok_mega_kernel_11
    v_and_b32 v24, 3, v1
    s_lshl_b32 s38, s26, 1
    s_sub_u32 s38, s38, 2
    v_add_u32 v24, s38, v24
    v_max_i32 v24, 0, v24
    s_lshr_b32 s38, s27, 1
    s_add_u32 s38, s38, 0
    v_lshl_add_u32 v24, v24, 4, s38
    v_lshlrev_b32 v24, 7, v24
    s_mov_b32 s38, 0
    buffer_load_dword v21, v24, s[92:95], 0 offen sc1
    s_sleep 3
    buffer_load_dword v22, v24, s[92:95], 0 offen sc1
    s_sleep 3
poll_mega_kernel_10:
    buffer_load_dword v23, v24, s[92:95], 0 offen sc1
    s_waitcnt vmcnt(2)
    v_cmp_gt_u32 vcc, 1, v21
    s_nop 4
    s_cbranch_vccz pok_mega_kernel_11
    s_sleep 2
    buffer_load_dword v21, v24, s[92:95], 0 offen sc1
    s_waitcnt vmcnt(2)
    v_cmp_gt_u32 vcc, 1, v22
    s_nop 4
    s_cbranch_vccz pok_mega_kernel_11
    s_sleep 2
    buffer_load_dword v22, v24, s[92:95], 0 offen sc1
    s_waitcnt vmcnt(2)
    v_cmp_gt_u32 vcc, 1, v23
    s_nop 4
    s_cbranch_vccz pok_mega_kernel_11
    s_sleep 2
    s_add_u32 s38, s38, 1
    s_cmp_gt_u32 s38, 4000
    s_cbranch_scc0 poll_mega_kernel_10
pok_mega_kernel_11:
    s_barrier
    s_mov_b32 m0, s34
    s_nop 0
    buffer_load_dwordx4 v2, s[4:7], 0 offen offset:0 sc1 lds
    buffer_load_dwordx4 v2, s[4:7], 0 offen offset:1024 sc1 lds
    buffer_load_dwordx4 v2, s[4:7], 0 offen offset:2048 sc1 lds
    buffer_load_dwordx4 v2, s[4:7], 0 offen offset:3072 sc1 lds
    s_add_u32 m0, s34, 4096
    s_nop 0
    buffer_load_dwordx4 v3, s[4:7], 0 offen sc1 lds
    s_cmp_ge_u32 s29, 5
    s_cbranch_scc1 noq_mega_kernel_12
    s_mov_b32 m0, s39
    s_nop 0
    buffer_load_dwordx4 v7, s[4:7], 0 offen sc1 lds
    buffer_load_dwordx4 v7, s[4:7], 0 offen offset:1024 sc1 lds
noq_mega_kernel_12:
    v_cmp_gt_u32 vcc, 32, v1
    s_waitcnt vmcnt(0)
    s_barrier
    ds_read_b64 v[8:9], v5
    ds_read_b64 v[10:11], v5 offset:8
    ds_read_b64 v[12:13], v5 offset:32
    ds_read_b64 v[24:25], v16 offset:0
    ds_read_b64 v[26:27], v16 offset:8
    ds_read_b64 v[28:29], v16 offset:32
    ds_read_b64 v[30:31], v16 offset:40
    ds_read_b64 v[32:33], v16 offset:1280
    ds_read_b64 v[34:35], v16 offset:1288
    ds_read_b64 v[36:37], v16 offset:1312
    ds_read_b64 v[38:39], v16 offset:1320
    s_waitcnt lgkmcnt(4)
    v_cndmask_b32 v12, 0, v12, vcc
    v_cndmask_b32 v13, 0, v13, vcc
    s_nop 1
    v_mfma_f32_32x32x16_bf16 v[64:79], v[24:27], v[8:11], 0
    v_mfma_f32_32x32x16_bf16 v[64:79], v[28:31], v[12:15], v[64:79]
    ds_read_b64 v[24:25], v16 offset:2560
    ds_read_b64 v[26:27], v16 offset:2568
    ds_read_b64 v[28:29], v16 offset:2592
    ds_read_b64 v[30:31], v16 offset:2600
    s_waitcnt lgkmcnt(4)
    v_mfma_f32_32x32x16_bf16 v[80:95], v[32:35], v[8:11], 0
    v_mfma_f32_32x32x16_bf16 v[80:95], v[36:39], v[12:15], v[80:95]
    ds_read_b64 v[32:33], v16 offset:3840
    ds_read_b64 v[34:35], v16 offset:3848
    ds_read_b64 v[36:37], v16 offset:3872
    ds_read_b64 v[38:39], v16 offset:3880
    s_waitcnt lgkmcnt(4)
    v_mfma_f32_32x32x16_bf16 v[96:111], v[24:27], v[8:11], 0
    v_mfma_f32_32x32x16_bf16 v[96:111], v[28:31], v[12:15], v[96:111]
    ds_read_b64 v[24:25], v16 offset:5120
    ds_read_b64 v[26:27], v16 offset:5128
    ds_read_b64 v[28:29], v16 offset:5152
    ds_read_b64 v[30:31], v16 offset:5160
    s_waitcnt lgkmcnt(4)
    v_mfma_f32_32x32x16_bf16 v[112:127], v[32:35], v[8:11], 0
    v_mfma_f32_32x32x16_bf16 v[112:127], v[36:39], v[12:15], v[112:127]
    ds_read_b64 v[32:33], v16 offset:6400
    ds_read_b64 v[34:35], v16 offset:6408
    ds_read_b64 v[36:37], v16 offset:6432
    ds_read_b64 v[38:39], v16 offset:6440
    s_waitcnt lgkmcnt(4)
    v_mfma_f32_32x32x16_bf16 v[128:143], v[24:27], v[8:11], 0
    v_mfma_f32_32x32x16_bf16 v[128:143], v[28:31], v[12:15], v[128:143]
    ds_read_b64 v[24:25], v16 offset:7680
    ds_read_b64 v[26:27], v16 offset:7688
    ds_read_b64 v[28:29], v16 offset:7712
    ds_read_b64 v[30:31], v16 offset:7720
    s_waitcnt lgkmcnt(4)
    v_mfma_f32_32x32x16_bf16 v[144:159], v[32:35], v[8:11], 0
    v_mfma_f32_32x32x16_bf16 v[144:159], v[36:39], v[12:15], v[144:159]
    ds_read_b64 v[32:33], v16 offset:8960
    ds_read_b64 v[34:35], v16 offset:8968
    ds_read_b64 v[36:37], v16 offset:8992
    ds_read_b64 v[38:39], v16 offset:9000
    s_waitcnt lgkmcnt(4)
    v_mfma_f32_32x32x16_bf16 v[160:175], v[24:27], v[8:11], 0
    v_mfma_f32_32x32x16_bf16 v[160:175], v[28:31], v[12:15], v[160:175]
    ds_read_b64 v[24:25], v16 offset:10240
    ds_read_b64 v[26:27], v16 offset:10248
    ds_read_b64 v[28:29], v16 offset:10272
    ds_read_b64 v[30:31], v16 offset:10280
    s_waitcnt lgkmcnt(4)
    v_mfma_f32_32x32x16_bf16 v[176:191], v[32:35], v[8:11], 0
    v_mfma_f32_32x32x16_bf16 v[176:191], v[36:39], v[12:15], v[176:191]
    s_waitcnt lgkmcnt(0)
    v_mfma_f32_32x32x16_bf16 v[192:207], v[24:27], v[8:11], 0
    v_mfma_f32_32x32x16_bf16 v[192:207], v[28:31], v[12:15], v[192:207]
    s_nop 7
    s_nop 7
    v_mov_b32 v43, 0xce6e6b28
    v_cmp_le_i32 vcc, 0, v18
    s_nop 1
    v_cndmask_b32 v192, v43, v192, vcc
    v_cndmask_b32 v64, v64, v43, vcc
    v_cmp_le_i32 vcc, 1, v18
    s_nop 1
    v_cndmask_b32 v193, v43, v193, vcc
    v_cndmask_b32 v65, v65, v43, vcc
    v_cmp_le_i32 vcc, 2, v18
    s_nop 1
    v_cndmask_b32 v194, v43, v194, vcc
    v_cndmask_b32 v66, v66, v43, vcc
    v_cmp_le_i32 vcc, 3, v18
    s_nop 1
    v_cndmask_b32 v195, v43, v195, vcc
    v_cndmask_b32 v67, v67, v43, vcc
    v_cmp_le_i32 vcc, 8, v18
    s_nop 1
    v_cndmask_b32 v196, v43, v196, vcc
    v_cndmask_b32 v68, v68, v43, vcc
    v_cmp_le_i32 vcc, 9, v18
    s_nop 1
    v_cndmask_b32 v197, v43, v197, vcc
    v_cndmask_b32 v69, v69, v43, vcc
    v_cmp_le_i32 vcc, 10, v18
    s_nop 1
    v_cndmask_b32 v198, v43, v198, vcc
    v_cndmask_b32 v70, v70, v43, vcc
    v_cmp_le_i32 vcc, 11, v18
    s_nop 1
    v_cndmask_b32 v199, v43, v199, vcc
    v_cndmask_b32 v71, v71, v43, vcc
    v_cmp_le_i32 vcc, 16, v18
    s_nop 1
    v_cndmask_b32 v200, v43, v200, vcc
    v_cndmask_b32 v72, v72, v43, vcc
    v_cmp_le_i32 vcc, 17, v18
    s_nop 1
    v_cndmask_b32 v201, v43, v201, vcc
    v_cndmask_b32 v73, v73, v43, vcc
    v_cmp_le_i32 vcc, 18, v18
    s_nop 1
    v_cndmask_b32 v202, v43, v202, vcc
    v_cndmask_b32 v74, v74, v43, vcc
    v_cmp_le_i32 vcc, 19, v18
    s_nop 1
    v_cndmask_b32 v203, v43, v203, vcc
    v_cndmask_b32 v75, v75, v43, vcc
    v_cmp_le_i32 vcc, 24, v18
    s_nop 1
    v_cndmask_b32 v204, v43, v204, vcc
    v_cndmask_b32 v76, v76, v43, vcc
    v_cmp_le_i32 vcc, 25, v18
    s_nop 1
    v_cndmask_b32 v205, v43, v205, vcc
    v_cndmask_b32 v77, v77, v43, vcc
    v_cmp_le_i32 vcc, 26, v18
    s_nop 1
    v_cndmask_b32 v206, v43, v206, vcc
    v_cndmask_b32 v78, v78, v43, vcc
    v_cmp_le_i32 vcc, 27, v18
    s_nop 1
    v_cndmask_b32 v207, v43, v207, vcc
    v_cndmask_b32 v79, v79, v43, vcc
    s_cmp_lg_u32 s26, 0
    s_cbranch_scc1 q0_mega_kernel_13
    s_add_u32 s32, s29, 0
    s_cmp_ge_u32 s32, 8
    s_cbranch_scc1 sk_mega_kernel_14
    v_mov_b32 v64, v43
    v_mov_b32 v65, v43
    v_mov_b32 v66, v43
    v_mov_b32 v67, v43
    v_mov_b32 v68, v43
    v_mov_b32 v69, v43
    v_mov_b32 v70, v43
    v_mov_b32 v71, v43
    v_mov_b32 v72, v43
    v_mov_b32 v73, v43
    v_mov_b32 v74, v43
    v_mov_b32 v75, v43
    v_mov_b32 v76, v43
    v_mov_b32 v77, v43
    v_mov_b32 v78, v43
    v_mov_b32 v79, v43
sk_mega_kernel_14:
    s_add_u32 s32, s29, 1
    s_cmp_ge_u32 s32, 8
    s_cbranch_scc1 sk_mega_kernel_15
    v_mov_b32 v80, v43
    v_mov_b32 v81, v43
    v_mov_b32 v82, v43
    v_mov_b32 v83, v43
    v_mov_b32 v84, v43
    v_mov_b32 v85, v43
    v_mov_b32 v86, v43
    v_mov_b32 v87, v43
    v_mov_b32 v88, v43
    v_mov_b32 v89, v43
    v_mov_b32 v90, v43
    v_mov_b32 v91, v43
    v_mov_b32 v92, v43
    v_mov_b32 v93, v43
    v_mov_b32 v94, v43
    v_mov_b32 v95, v43
sk_mega_kernel_15:
    s_add_u32 s32, s29, 2
    s_cmp_ge_u32 s32, 8
    s_cbranch_scc1 sk_mega_kernel_16
    v_mov_b32 v96, v43
    v_mov_b32 v97, v43
    v_mov_b32 v98, v43
    v_mov_b32 v99, v43
    v_mov_b32 v100, v43
    v_mov_b32 v101, v43
    v_mov_b32 v102, v43
    v_mov_b32 v103, v43
    v_mov_b32 v104, v43
    v_mov_b32 v105, v43
    v_mov_b32 v106, v43
    v_mov_b32 v107, v43
    v_mov_b32 v108, v43
    v_mov_b32 v109, v43
    v_mov_b32 v110, v43
    v_mov_b32 v111, v43
sk_mega_kernel_16:
    s_add_u32 s32, s29, 3
    s_cmp_ge_u32 s32, 8
    s_cbranch_scc1 sk_mega_kernel_17
    v_mov_b32 v112, v43
    v_mov_b32 v113, v43
    v_mov_b32 v114, v43
    v_mov_b32 v115, v43
    v_mov_b32 v116, v43
    v_mov_b32 v117, v43
    v_mov_b32 v118, v43
    v_mov_b32 v119, v43
    v_mov_b32 v120, v43
    v_mov_b32 v121, v43
    v_mov_b32 v122, v43
    v_mov_b32 v123, v43
    v_mov_b32 v124, v43
    v_mov_b32 v125, v43
    v_mov_b32 v126, v43
    v_mov_b32 v127, v43
sk_mega_kernel_17:
    s_add_u32 s32, s29, 4
    s_cmp_ge_u32 s32, 8
    s_cbranch_scc1 sk_mega_kernel_18
    v_mov_b32 v128, v43
    v_mov_b32 v129, v43
    v_mov_b32 v130, v43
    v_mov_b32 v131, v43
    v_mov_b32 v132, v43
    v_mov_b32 v133, v43
    v_mov_b32 v134, v43
    v_mov_b32 v135, v43
    v_mov_b32 v136, v43
    v_mov_b32 v137, v43
    v_mov_b32 v138, v43
    v_mov_b32 v139, v43
    v_mov_b32 v140, v43
    v_mov_b32 v141, v43
    v_mov_b32 v142, v43
    v_mov_b32 v143, v43
sk_mega_kernel_18:
    s_add_u32 s32, s29, 5
    s_cmp_ge_u32 s32, 8
    s_cbranch_scc1 sk_mega_kernel_19
    v_mov_b32 v144, v43
    v_mov_b32 v145, v43
    v_mov_b32 v146, v43
    v_mov_b32 v147, v43
    v_mov_b32 v148, v43
    v_mov_b32 v149, v43
    v_mov_b32 v150, v43
    v_mov_b32 v151, v43
    v_mov_b32 v152, v43
    v_mov_b32 v153, v43
    v_mov_b32 v154, v43
    v_mov_b32 v155, v43
    v_mov_b32 v156, v43
    v_mov_b32 v157, v43
    v_mov_b32 v158, v43
    v_mov_b32 v159, v43
sk_mega_kernel_19:
    s_add_u32 s32, s29, 6
    s_cmp_ge_u32 s32, 8
    s_cbranch_scc1 sk_mega_kernel_20
    v_mov_b32 v160, v43
    v_mov_b32 v161, v43
    v_mov_b32 v162, v43
    v_mov_b32 v163, v43
    v_mov_b32 v164, v43
    v_mov_b32 v165, v43
    v_mov_b32 v166, v43
    v_mov_b32 v167, v43
    v_mov_b32 v168, v43
    v_mov_b32 v169, v43
    v_mov_b32 v170, v43
    v_mov_b32 v171, v43
    v_mov_b32 v172, v43
    v_mov_b32 v173, v43
    v_mov_b32 v174, v43
    v_mov_b32 v175, v43
sk_mega_kernel_20:
    s_add_u32 s32, s29, 7
    s_cmp_ge_u32 s32, 8
    s_cbranch_scc1 sk_mega_kernel_21
    v_mov_b32 v176, v43
    v_mov_b32 v177, v43
    v_mov_b32 v178, v43
    v_mov_b32 v179, v43
    v_mov_b32 v180, v43
    v_mov_b32 v181, v43
    v_mov_b32 v182, v43
    v_mov_b32 v183, v43
    v_mov_b32 v184, v43
    v_mov_b32 v185, v43
    v_mov_b32 v186, v43
    v_mov_b32 v187, v43
    v_mov_b32 v188, v43
    v_mov_b32 v189, v43
    v_mov_b32 v190, v43
    v_mov_b32 v191, v43
sk_mega_kernel_21:
q0_mega_kernel_13:
    v_max3_f32 v44, v64, v65, v66
    v_max3_f32 v45, v67, v68, v69
    v_max3_f32 v44, v44, v70, v71
    v_max3_f32 v45, v45, v72, v73
    v_max3_f32 v44, v44, v74, v75
    v_max3_f32 v45, v45, v76, v77
    v_max3_f32 v44, v44, v78, v79
    v_max3_f32 v45, v45, v80, v81
    v_max3_f32 v44, v44, v82, v83
    v_max3_f32 v45, v45, v84, v85
    v_max3_f32 v44, v44, v86, v87
    v_max3_f32 v45, v45, v88, v89
    v_max3_f32 v44, v44, v90, v91
    v_max3_f32 v45, v45, v92, v93
    v_max3_f32 v44, v44, v94, v95
    v_max3_f32 v45, v45, v96, v97
    v_max3_f32 v44, v44, v98, v99
    v_max3_f32 v45, v45, v100, v101
    v_max3_f32 v44, v44, v102, v103
    v_max3_f32 v45, v45, v104, v105
    v_max3_f32 v44, v44, v106, v107
    v_max3_f32 v45, v45, v108, v109
    v_max3_f32 v44, v44, v110, v111
    v_max3_f32 v45, v45, v112, v113
    v_max3_f32 v44, v44, v114, v115
    v_max3_f32 v45, v45, v116, v117
    v_max3_f32 v44, v44, v118, v119
    v_max3_f32 v45, v45, v120, v121
    v_max3_f32 v44, v44, v122, v123
    v_max3_f32 v45, v45, v124, v125
    v_max3_f32 v44, v44, v126, v127
    v_max3_f32 v45, v45, v128, v129
    v_max3_f32 v44, v44, v130, v131
    v_max3_f32 v45, v45, v132, v133
    v_max3_f32 v44, v44, v134, v135
    v_max3_f32 v45, v45, v136, v137
    v_max3_f32 v44, v44, v138, v139
    v_max3_f32 v45, v45, v140, v141
    v_max3_f32 v44, v44, v142, v143
    v_max3_f32 v45, v45, v144, v145
    v_max3_f32 v44, v44, v146, v147
    v_max3_f32 v45, v45, v148, v149
    v_max3_f32 v44, v44, v150, v151
    v_max3_f32 v45, v45, v152, v153
    v_max3_f32 v44, v44, v154, v155
    v_max3_f32 v45, v45, v156, v157
    v_max3_f32 v44, v44, v158, v159
    v_max3_f32 v45, v45, v160, v161
    v_max3_f32 v44, v44, v162, v163
    v_max3_f32 v45, v45, v164, v165
    v_max3_f32 v44, v44, v166, v167
    v_max3_f32 v45, v45, v168, v169
    v_max3_f32 v44, v44, v170, v171
    v_max3_f32 v45, v45, v172, v173
    v_max3_f32 v44, v44, v174, v175
    v_max3_f32 v45, v45, v176, v177
    v_max3_f32 v44, v44, v178, v179
    v_max3_f32 v45, v45, v180, v181
    v_max3_f32 v44, v44, v182, v183
    v_max3_f32 v45, v45, v184, v185
    v_max3_f32 v44, v44, v186, v187
    v_max3_f32 v45, v45, v188, v189
    v_max3_f32 v44, v44, v190, v191
    v_max3_f32 v45, v45, v192, v193
    v_max3_f32 v44, v44, v194, v195
    v_max3_f32 v45, v45, v196, v197
    v_max3_f32 v44, v44, v198, v199
    v_max3_f32 v45, v45, v200, v201
    v_max3_f32 v44, v44, v202, v203
    v_max3_f32 v45, v45, v204, v205
    v_max3_f32 v44, v44, v206, v207
    v_max_f32 v44, v44, v45
    v_mov_b32 v45, v44
    s_nop 1
    v_permlane32_swap_b32 v44, v45
    v_max_f32 v44, v44, v45
    v_mov_b32 v40, 0x3ea52b5b
    v_mov_b32 v41, 0x3ea52b5b
    v_mul_f32 v44, v44, v40
    v_sub_f32 v44, 0, v44
    v_mov_b32 v45, v44
    v_mov_b32 v46, 0
    v_mov_b32 v47, 0
    v_pk_fma_f32 v[64:65], v[64:65], v[40:41], v[44:45]
    v_exp_f32 v64, v64
    v_exp_f32 v65, v65
    v_pk_fma_f32 v[66:67], v[66:67], v[40:41], v[44:45]
    v_exp_f32 v66, v66
    v_exp_f32 v67, v67
    v_pk_add_f32 v[46:47], v[46:47], v[64:65]
    v_cvt_pk_bf16_f32 v64, v64, v65
    v_pk_fma_f32 v[68:69], v[68:69], v[40:41], v[44:45]
    v_exp_f32 v68, v68
    v_exp_f32 v69, v69
    v_pk_add_f32 v[46:47], v[46:47], v[66:67]
    v_cvt_pk_bf16_f32 v65, v66, v67
    v_pk_fma_f32 v[70:71], v[70:71], v[40:41], v[44:45]
    v_exp_f32 v70, v70
    v_exp_f32 v71, v71
    v_pk_add_f32 v[46:47], v[46:47], v[68:69]
    v_cvt_pk_bf16_f32 v66, v68, v69
    v_pk_fma_f32 v[72:73], v[72:73], v[40:41], v[44:45]
    v_exp_f32 v72, v72
    v_exp_f32 v73, v73
    v_pk_add_f32 v[46:47], v[46:47], v[70:71]
    v_cvt_pk_bf16_f32 v67, v70, v71
    v_pk_fma_f32 v[74:75], v[74:75], v[40:41], v[44:45]
    v_exp_f32 v74, v74
    v_exp_f32 v75, v75
    v_pk_add_f32 v[46:47], v[46:47], v[72:73]
    v_cvt_pk_bf16_f32 v68, v72, v73
    v_pk_fma_f32 v[76:77], v[76:77], v[40:41], v[44:45]
    v_exp_f32 v76, v76
    v_exp_f32 v77, v77
    v_pk_add_f32 v[46:47], v[46:47], v[74:75]
    v_cvt_pk_bf16_f32 v69, v74, v75
    v_pk_fma_f32 v[78:79], v[78:79], v[40:41], v[44:45]
    v_exp_f32 v78, v78
    v_exp_f32 v79, v79
    v_pk_add_f32 v[46:47], v[46:47], v[76:77]
    v_cvt_pk_bf16_f32 v70, v76, v77
    v_pk_fma_f32 v[80:81], v[80:81], v[40:41], v[44:45]
    v_exp_f32 v80, v80
    v_exp_f32 v81, v81
    v_pk_add_f32 v[46:47], v[46:47], v[78:79]
    v_cvt_pk_bf16_f32 v71, v78, v79
    v_pk_fma_f32 v[82:83], v[82:83], v[40:41], v[44:45]
    v_exp_f32 v82, v82
    v_exp_f32 v83, v83
    v_pk_add_f32 v[46:47], v[46:47], v[80:81]
    v_cvt_pk_bf16_f32 v80, v80, v81
    v_pk_fma_f32 v[84:85], v[84:85], v[40:41], v[44:45]
    v_exp_f32 v84, v84
    v_exp_f32 v85, v85
    v_pk_add_f32 v[46:47], v[46:47], v[82:83]
    v_cvt_pk_bf16_f32 v81, v82, v83
    v_pk_fma_f32 v[86:87], v[86:87], v[40:41], v[44:45]
    v_exp_f32 v86, v86
    v_exp_f32 v87, v87
    v_pk_add_f32 v[46:47], v[46:47], v[84:85]
    v_cvt_pk_bf16_f32 v82, v84, v85
    v_pk_fma_f32 v[88:89], v[88:89], v[40:41], v[44:45]
    v_exp_f32 v88, v88
    v_exp_f32 v89, v89
    v_pk_add_f32 v[46:47], v[46:47], v[86:87]
    v_cvt_pk_bf16_f32 v83, v86, v87
    v_pk_fma_f32 v[90:91], v[90:91], v[40:41], v[44:45]
    v_exp_f32 v90, v90
    v_exp_f32 v91, v91
    v_pk_add_f32 v[46:47], v[46:47], v[88:89]
    v_cvt_pk_bf16_f32 v84, v88, v89
    v_pk_fma_f32 v[92:93], v[92:93], v[40:41], v[44:45]
    v_exp_f32 v92, v92
    v_exp_f32 v93, v93
    v_pk_add_f32 v[46:47], v[46:47], v[90:91]
    v_cvt_pk_bf16_f32 v85, v90, v91
    v_pk_fma_f32 v[94:95], v[94:95], v[40:41], v[44:45]
    v_exp_f32 v94, v94
    v_exp_f32 v95, v95
    v_pk_add_f32 v[46:47], v[46:47], v[92:93]
    v_cvt_pk_bf16_f32 v86, v92, v93
    v_pk_fma_f32 v[96:97], v[96:97], v[40:41], v[44:45]
    v_exp_f32 v96, v96
    v_exp_f32 v97, v97
    v_pk_add_f32 v[46:47], v[46:47], v[94:95]
    v_cvt_pk_bf16_f32 v87, v94, v95
    v_pk_fma_f32 v[98:99], v[98:99], v[40:41], v[44:45]
    v_exp_f32 v98, v98
    v_exp_f32 v99, v99
    v_pk_add_f32 v[46:47], v[46:47], v[96:97]
    v_cvt_pk_bf16_f32 v96, v96, v97
    v_pk_fma_f32 v[100:101], v[100:101], v[40:41], v[44:45]
    v_exp_f32 v100, v100
    v_exp_f32 v101, v101
    v_pk_add_f32 v[46:47], v[46:47], v[98:99]
    v_cvt_pk_bf16_f32 v97, v98, v99
    v_pk_fma_f32 v[102:103], v[102:103], v[40:41], v[44:45]
    v_exp_f32 v102, v102
    v_exp_f32 v103, v103
    v_pk_add_f32 v[46:47], v[46:47], v[100:101]
    v_cvt_pk_bf16_f32 v98, v100, v101
    v_pk_fma_f32 v[104:105], v[104:105], v[40:41], v[44:45]
    v_exp_f32 v104, v104
    v_exp_f32 v105, v105
    v_pk_add_f32 v[46:47], v[46:47], v[102:103]
    v_cvt_pk_bf16_f32 v99, v102, v103
    v_pk_fma_f32 v[106:107], v[106:107], v[40:41], v[44:45]
    v_exp_f32 v106, v106
    v_exp_f32 v107, v107
    v_pk_add_f32 v[46:47], v[46:47], v[104:105]
    v_cvt_pk_bf16_f32 v100, v104, v105
    v_pk_fma_f32 v[108:109], v[108:109], v[40:41], v[44:45]
    v_exp_f32 v108, v108
    v_exp_f32 v109, v109
    v_pk_add_f32 v[46:47], v[46:47], v[106:107]
    v_cvt_pk_bf16_f32 v101, v106, v107
    v_pk_fma_f32 v[110:111], v[110:111], v[40:41], v[44:45]
    v_exp_f32 v110, v110
    v_exp_f32 v111, v111
    v_pk_add_f32 v[46:47], v[46:47], v[108:109]
    v_cvt_pk_bf16_f32 v102, v108, v109
    v_pk_fma_f32 v[112:113], v[112:113], v[40:41], v[44:45]
    v_exp_f32 v112, v112
    v_exp_f32 v113, v113
    v_pk_add_f32 v[46:47], v[46:47], v[110:111]
    v_cvt_pk_bf16_f32 v103, v110, v111
    v_pk_fma_f32 v[114:115], v[114:115], v[40:41], v[44:45]
    v_exp_f32 v114, v114
    v_exp_f32 v115, v115
    v_pk_add_f32 v[46:47], v[46:47], v[112:113]
    v_cvt_pk_bf16_f32 v112, v112, v113
    v_pk_fma_f32 v[116:117], v[116:117], v[40:41], v[44:45]
    v_exp_f32 v116, v116
    v_exp_f32 v117, v117
    v_pk_add_f32 v[46:47], v[46:47], v[114:115]
    v_cvt_pk_bf16_f32 v113, v114, v115
    v_pk_fma_f32 v[118:119], v[118:119], v[40:41], v[44:45]
    v_exp_f32 v118, v118
    v_exp_f32 v119, v119
    v_pk_add_f32 v[46:47], v[46:47], v[116:117]
    v_cvt_pk_bf16_f32 v114, v116, v117
    v_pk_fma_f32 v[120:121], v[120:121], v[40:41], v[44:45]
    v_exp_f32 v120, v120
    v_exp_f32 v121, v121
    v_pk_add_f32 v[46:47], v[46:47], v[118:119]
    v_cvt_pk_bf16_f32 v115, v118, v119
    v_pk_fma_f32 v[122:123], v[122:123], v[40:41], v[44:45]
    v_exp_f32 v122, v122
    v_exp_f32 v123, v123
    v_pk_add_f32 v[46:47], v[46:47], v[120:121]
    v_cvt_pk_bf16_f32 v116, v120, v121
    v_pk_fma_f32 v[124:125], v[124:125], v[40:41], v[44:45]
    v_exp_f32 v124, v124
    v_exp_f32 v125, v125
    v_pk_add_f32 v[46:47], v[46:47], v[122:123]
    v_cvt_pk_bf16_f32 v117, v122, v123
    v_pk_fma_f32 v[126:127], v[126:127], v[40:41], v[44:45]
    v_exp_f32 v126, v126
    v_exp_f32 v127, v127
    v_pk_add_f32 v[46:47], v[46:47], v[124:125]
    v_cvt_pk_bf16_f32 v118, v124, v125
    v_pk_fma_f32 v[128:129], v[128:129], v[40:41], v[44:45]
    v_exp_f32 v128, v128
    v_exp_f32 v129, v129
    v_pk_add_f32 v[46:47], v[46:47], v[126:127]
    v_cvt_pk_bf16_f32 v119, v126, v127
    v_pk_fma_f32 v[130:131], v[130:131], v[40:41], v[44:45]
    v_exp_f32 v130, v130
    v_exp_f32 v131, v131
    v_pk_add_f32 v[46:47], v[46:47], v[128:129]
    v_cvt_pk_bf16_f32 v128, v128, v129
    v_pk_fma_f32 v[132:133], v[132:133], v[40:41], v[44:45]
    v_exp_f32 v132, v132
    v_exp_f32 v133, v133
    v_pk_add_f32 v[46:47], v[46:47], v[130:131]
    v_cvt_pk_bf16_f32 v129, v130, v131
    v_pk_fma_f32 v[134:135], v[134:135], v[40:41], v[44:45]
    v_exp_f32 v134, v134
    v_exp_f32 v135, v135
    v_pk_add_f32 v[46:47], v[46:47], v[132:133]
    v_cvt_pk_bf16_f32 v130, v132, v133
    v_pk_fma_f32 v[136:137], v[136:137], v[40:41], v[44:45]
    v_exp_f32 v136, v136
    v_exp_f32 v137, v137
    v_pk_add_f32 v[46:47], v[46:47], v[134:135]
    v_cvt_pk_bf16_f32 v131, v134, v135
    v_pk_fma_f32 v[138:139], v[138:139], v[40:41], v[44:45]
    v_exp_f32 v138, v138
    v_exp_f32 v139, v139
    v_pk_add_f32 v[46:47], v[46:47], v[136:137]
    v_cvt_pk_bf16_f32 v132, v136, v137
    v_pk_fma_f32 v[140:141], v[140:141], v[40:41], v[44:45]
    v_exp_f32 v140, v140
    v_exp_f32 v141, v141
    v_pk_add_f32 v[46:47], v[46:47], v[138:139]
    v_cvt_pk_bf16_f32 v133, v138, v139
    v_pk_fma_f32 v[142:143], v[142:143], v[40:41], v[44:45]
    v_exp_f32 v142, v142
    v_exp_f32 v143, v143
    v_pk_add_f32 v[46:47], v[46:47], v[140:141]
    v_cvt_pk_bf16_f32 v134, v140, v141
    v_pk_fma_f32 v[144:145], v[144:145], v[40:41], v[44:45]
    v_exp_f32 v144, v144
    v_exp_f32 v145, v145
    v_pk_add_f32 v[46:47], v[46:47], v[142:143]
    v_cvt_pk_bf16_f32 v135, v142, v143
    v_pk_fma_f32 v[146:147], v[146:147], v[40:41], v[44:45]
    v_exp_f32 v146, v146
    v_exp_f32 v147, v147
    v_pk_add_f32 v[46:47], v[46:47], v[144:145]
    v_cvt_pk_bf16_f32 v144, v144, v145
    v_pk_fma_f32 v[148:149], v[148:149], v[40:41], v[44:45]
    v_exp_f32 v148, v148
    v_exp_f32 v149, v149
    v_pk_add_f32 v[46:47], v[46:47], v[146:147]
    v_cvt_pk_bf16_f32 v145, v146, v147
    v_pk_fma_f32 v[150:151], v[150:151], v[40:41], v[44:45]
    v_exp_f32 v150, v150
    v_exp_f32 v151, v151
    v_pk_add_f32 v[46:47], v[46:47], v[148:149]
    v_cvt_pk_bf16_f32 v146, v148, v149
    v_pk_fma_f32 v[152:153], v[152:153], v[40:41], v[44:45]
    v_exp_f32 v152, v152
    v_exp_f32 v153, v153
    v_pk_add_f32 v[46:47], v[46:47], v[150:151]
    v_cvt_pk_bf16_f32 v147, v150, v151
    v_pk_fma_f32 v[154:155], v[154:155], v[40:41], v[44:45]
    v_exp_f32 v154, v154
    v_exp_f32 v155, v155
    v_pk_add_f32 v[46:47], v[46:47], v[152:153]
    v_cvt_pk_bf16_f32 v148, v152, v153
    v_pk_fma_f32 v[156:157], v[156:157], v[40:41], v[44:45]
    v_exp_f32 v156, v156
    v_exp_f32 v157, v157
    v_pk_add_f32 v[46:47], v[46:47], v[154:155]
    v_cvt_pk_bf16_f32 v149, v154, v155
    v_pk_fma_f32 v[158:159], v[158:159], v[40:41], v[44:45]
    v_exp_f32 v158, v158
    v_exp_f32 v159, v159
    v_pk_add_f32 v[46:47], v[46:47], v[156:157]
    v_cvt_pk_bf16_f32 v150, v156, v157
    v_pk_fma_f32 v[160:161], v[160:161], v[40:41], v[44:45]
    v_exp_f32 v160, v160
    v_exp_f32 v161, v161
    v_pk_add_f32 v[46:47], v[46:47], v[158:159]
    v_cvt_pk_bf16_f32 v151, v158, v159
    v_pk_fma_f32 v[162:163], v[162:163], v[40:41], v[44:45]
    v_exp_f32 v162, v162
    v_exp_f32 v163, v163
    v_pk_add_f32 v[46:47], v[46:47], v[160:161]
    v_cvt_pk_bf16_f32 v160, v160, v161
    v_pk_fma_f32 v[164:165], v[164:165], v[40:41], v[44:45]
    v_exp_f32 v164, v164
    v_exp_f32 v165, v165
    v_pk_add_f32 v[46:47], v[46:47], v[162:163]
    v_cvt_pk_bf16_f32 v161, v162, v163
    v_pk_fma_f32 v[166:167], v[166:167], v[40:41], v[44:45]
    v_exp_f32 v166, v166
    v_exp_f32 v167, v167
    v_pk_add_f32 v[46:47], v[46:47], v[164:165]
    v_cvt_pk_bf16_f32 v162, v164, v165
    v_pk_fma_f32 v[168:169], v[168:169], v[40:41], v[44:45]
    v_exp_f32 v168, v168
    v_exp_f32 v169, v169
    v_pk_add_f32 v[46:47], v[46:47], v[166:167]
    v_cvt_pk_bf16_f32 v163, v166, v167
    v_pk_fma_f32 v[170:171], v[170:171], v[40:41], v[44:45]
    v_exp_f32 v170, v170
    v_exp_f32 v171, v171
    v_pk_add_f32 v[46:47], v[46:47], v[168:169]
    v_cvt_pk_bf16_f32 v164, v168, v169
    v_pk_fma_f32 v[172:173], v[172:173], v[40:41], v[44:45]
    v_exp_f32 v172, v172
    v_exp_f32 v173, v173
    v_pk_add_f32 v[46:47], v[46:47], v[170:171]
    v_cvt_pk_bf16_f32 v165, v170, v171
    v_pk_fma_f32 v[174:175], v[174:175], v[40:41], v[44:45]
    v_exp_f32 v174, v174
    v_exp_f32 v175, v175
    v_pk_add_f32 v[46:47], v[46:47], v[172:173]
    v_cvt_pk_bf16_f32 v166, v172, v173
    v_pk_fma_f32 v[176:177], v[176:177], v[40:41], v[44:45]
    v_exp_f32 v176, v176
    v_exp_f32 v177, v177
    v_pk_add_f32 v[46:47], v[46:47], v[174:175]
    v_cvt_pk_bf16_f32 v167, v174, v175
    v_pk_fma_f32 v[178:179], v[178:179], v[40:41], v[44:45]
    v_exp_f32 v178, v178
    v_exp_f32 v179, v179
    v_pk_add_f32 v[46:47], v[46:47], v[176:177]
    v_cvt_pk_bf16_f32 v176, v176, v177
    v_pk_fma_f32 v[180:181], v[180:181], v[40:41], v[44:45]
    v_exp_f32 v180, v180
    v_exp_f32 v181, v181
    v_pk_add_f32 v[46:47], v[46:47], v[178:179]
    v_cvt_pk_bf16_f32 v177, v178, v179
    v_pk_fma_f32 v[182:183], v[182:183], v[40:41], v[44:45]
    v_exp_f32 v182, v182
    v_exp_f32 v183, v183
    v_pk_add_f32 v[46:47], v[46:47], v[180:181]
    v_cvt_pk_bf16_f32 v178, v180, v181
    v_pk_fma_f32 v[184:185], v[184:185], v[40:41], v[44:45]
    v_exp_f32 v184, v184
    v_exp_f32 v185, v185
    v_pk_add_f32 v[46:47], v[46:47], v[182:183]
    v_cvt_pk_bf16_f32 v179, v182, v183
    v_pk_fma_f32 v[186:187], v[186:187], v[40:41], v[44:45]
    v_exp_f32 v186, v186
    v_exp_f32 v187, v187
    v_pk_add_f32 v[46:47], v[46:47], v[184:185]
    v_cvt_pk_bf16_f32 v180, v184, v185
    v_pk_fma_f32 v[188:189], v[188:189], v[40:41], v[44:45]
    v_exp_f32 v188, v188
    v_exp_f32 v189, v189
    v_pk_add_f32 v[46:47], v[46:47], v[186:187]
    v_cvt_pk_bf16_f32 v181, v186, v187
    v_pk_fma_f32 v[190:191], v[190:191], v[40:41], v[44:45]
    v_exp_f32 v190, v190
    v_exp_f32 v191, v191
    v_pk_add_f32 v[46:47], v[46:47], v[188:189]
    v_cvt_pk_bf16_f32 v182, v188, v189
    v_pk_fma_f32 v[192:193], v[192:193], v[40:41], v[44:45]
    v_exp_f32 v192, v192
    v_exp_f32 v193, v193
    v_pk_add_f32 v[46:47], v[46:47], v[190:191]
    v_cvt_pk_bf16_f32 v183, v190, v191
    v_pk_fma_f32 v[194:195], v[194:195], v[40:41], v[44:45]
    v_exp_f32 v194, v194
    v_exp_f32 v195, v195
    v_pk_add_f32 v[46:47], v[46:47], v[192:193]
    v_cvt_pk_bf16_f32 v192, v192, v193
    v_pk_fma_f32 v[196:197], v[196:197], v[40:41], v[44:45]
    v_exp_f32 v196, v196
    v_exp_f32 v197, v197
    v_pk_add_f32 v[46:47], v[46:47], v[194:195]
    v_cvt_pk_bf16_f32 v193, v194, v195
    v_pk_fma_f32 v[198:199], v[198:199], v[40:41], v[44:45]
    v_exp_f32 v198, v198
    v_exp_f32 v199, v199
    v_pk_add_f32 v[46:47], v[46:47], v[196:197]
    v_cvt_pk_bf16_f32 v194, v196, v197
    v_pk_fma_f32 v[200:201], v[200:201], v[40:41], v[44:45]
    v_exp_f32 v200, v200
    v_exp_f32 v201, v201
    v_pk_add_f32 v[46:47], v[46:47], v[198:199]
    v_cvt_pk_bf16_f32 v195, v198, v199
    v_pk_fma_f32 v[202:203], v[202:203], v[40:41], v[44:45]
    v_exp_f32 v202, v202
    v_exp_f32 v203, v203
    v_pk_add_f32 v[46:47], v[46:47], v[200:201]
    v_cvt_pk_bf16_f32 v196, v200, v201
    v_pk_fma_f32 v[204:205], v[204:205], v[40:41], v[44:45]
    v_exp_f32 v204, v204
    v_exp_f32 v205, v205
    v_pk_add_f32 v[46:47], v[46:47], v[202:203]
    v_cvt_pk_bf16_f32 v197, v202, v203
    v_pk_fma_f32 v[206:207], v[206:207], v[40:41], v[44:45]
    v_exp_f32 v206, v206
    v_exp_f32 v207, v207
    v_pk_add_f32 v[46:47], v[46:47], v[204:205]
    v_cvt_pk_bf16_f32 v198, v204, v205
    s_nop 0
    v_pk_add_f32 v[46:47], v[46:47], v[206:207]
    v_cvt_pk_bf16_f32 v199, v206, v207
    v_add_f32 v46, v46, v47
    v_mov_b32 v47, v46
    s_nop 1
    v_permlane32_swap_b32 v46, v47
    v_add_f32 v46, v46, v47
    v_rcp_f32 v46, v46
    s_nop 0
    v_mov_b32 v47, v46
    ds_read_b64_tr_b16 v[24:25], v17 offset:0
    ds_read_b64_tr_b16 v[26:27], v17 offset:320
    ds_read_b64_tr_b16 v[28:29], v17 offset:640
    ds_read_b64_tr_b16 v[30:31], v17 offset:960
    ds_read_b64_tr_b16 v[32:33], v17 offset:1280
    ds_read_b64_tr_b16 v[34:35], v17 offset:1600
    ds_read_b64_tr_b16 v[36:37], v17 offset:1920
    ds_read_b64_tr_b16 v[38:39], v17 offset:2240
    s_waitcnt lgkmcnt(4)
    v_mfma_f32_32x32x16_bf16 v[208:223], v[24:27], v[64:67], 0
    v_mfma_f32_32x32x16_bf16 v[208:223], v[28:31], v[68:71], v[208:223]
    ds_read_b64_tr_b16 v[24:25], v17 offset:2560
    ds_read_b64_tr_b16 v[26:27], v17 offset:2880
    ds_read_b64_tr_b16 v[28:29], v17 offset:3200
    ds_read_b64_tr_b16 v[30:31], v17 offset:3520
    s_waitcnt lgkmcnt(4)
    v_mfma_f32_32x32x16_bf16 v[208:223], v[32:35], v[80:83], v[208:223]
    v_mfma_f32_32x32x16_bf16 v[208:223], v[36:39], v[84:87], v[208:223]
    ds_read_b64_tr_b16 v[32:33], v17 offset:3840
    ds_read_b64_tr_b16 v[34:35], v17 offset:4160
    ds_read_b64_tr_b16 v[36:37], v17 offset:4480
    ds_read_b64_tr_b16 v[38:39], v17 offset:4800
    s_waitcnt lgkmcnt(4)
    v_mfma_f32_32x32x16_bf16 v[208:223], v[24:27], v[96:99], v[208:223]
    v_mfma_f32_32x32x16_bf16 v[208:223], v[28:31], v[100:103], v[208:223]
    ds_read_b64_tr_b16 v[24:25], v17 offset:5120
    ds_read_b64_tr_b16 v[26:27], v17 offset:5440
    ds_read_b64_tr_b16 v[28:29], v17 offset:5760
    ds_read_b64_tr_b16 v[30:31], v17 offset:6080
    s_waitcnt lgkmcnt(4)
    v_mfma_f32_32x32x16_bf16 v[208:223], v[32:35], v[112:115], v[208:223]
    v_mfma_f32_32x32x16_bf16 v[208:223], v[36:39], v[116:119], v[208:223]
    ds_read_b64_tr_b16 v[32:33], v17 offset:6400
    ds_read_b64_tr_b16 v[34:35], v17 offset:6720
    ds_read_b64_tr_b16 v[36:37], v17 offset:7040
    ds_read_b64_tr_b16 v[38:39], v17 offset:7360
    s_waitcnt lgkmcnt(4)
    v_mfma_f32_32x32x16_bf16 v[208:223], v[24:27], v[128:131], v[208:223]
    v_mfma_f32_32x32x16_bf16 v[208:223], v[28:31], v[132:135], v[208:223]
    ds_read_b64_tr_b16 v[24:25], v17 offset:7680
    ds_read_b64_tr_b16 v[26:27], v17 offset:8000
    ds_read_b64_tr_b16 v[28:29], v17 offset:8320
    ds_read_b64_tr_b16 v[30:31], v17 offset:8640
    s_waitcnt lgkmcnt(4)
    v_mfma_f32_32x32x16_bf16 v[208:223], v[32:35], v[144:147], v[208:223]
    v_mfma_f32_32x32x16_bf16 v[208:223], v[36:39], v[148:151], v[208:223]
    ds_read_b64_tr_b16 v[32:33], v17 offset:8960
    ds_read_b64_tr_b16 v[34:35], v17 offset:9280
    ds_read_b64_tr_b16 v[36:37], v17 offset:9600
    ds_read_b64_tr_b16 v[38:39], v17 offset:9920
    s_waitcnt lgkmcnt(4)
    v_mfma_f32_32x32x16_bf16 v[208:223], v[24:27], v[160:163], v[208:223]
    v_mfma_f32_32x32x16_bf16 v[208:223], v[28:31], v[164:167], v[208:223]
    ds_read_b64_tr_b16 v[24:25], v17 offset:10240
    ds_read_b64_tr_b16 v[26:27], v17 offset:10560
    ds_read_b64_tr_b16 v[28:29], v17 offset:10880
    ds_read_b64_tr_b16 v[30:31], v17 offset:11200
    s_waitcnt lgkmcnt(4)
    v_mfma_f32_32x32x16_bf16 v[208:223], v[32:35], v[176:179], v[208:223]
    v_mfma_f32_32x32x16_bf16 v[208:223], v[36:39], v[180:183], v[208:223]
    s_waitcnt lgkmcnt(0)
    v_mfma_f32_32x32x16_bf16 v[208:223], v[24:27], v[192:195], v[208:223]
    v_mfma_f32_32x32x16_bf16 v[208:223], v[28:31], v[196:199], v[208:223]
    s_mul_i32 s32, s29, 1536
    s_add_u32 s32, s32, 51328
    v_mul_u32_u24 v5, 48, v20
    v_lshl_add_u32 v5, v6, 3, v5
    v_add_u32 v5, s32, v5
    v_lshlrev_b32 v7, 4, v1
    v_add_u32 v2, s32, v7
    s_mul_i32 s33, s27, 98304
    s_lshl_b32 s32, s26, 8
    s_add_u32 s32, s32, s35
    s_mul_i32 s32, s32, 48
    s_add_u32 s33, s33, s32
    v_cmp_gt_u32 vcc, 32, v1
    s_nop 7
    s_nop 4
    v_pk_mul_f32 v[208:209], v[208:209], v[46:47]
    v_pk_mul_f32 v[210:211], v[210:211], v[46:47]
    v_cvt_pk_bf16_f32 v40, v208, v209
    v_cvt_pk_bf16_f32 v41, v210, v211
    v_pk_mul_f32 v[212:213], v[212:213], v[46:47]
    v_pk_mul_f32 v[214:215], v[214:215], v[46:47]
    v_cvt_pk_bf16_f32 v42, v212, v213
    v_cvt_pk_bf16_f32 v43, v214, v215
    v_pk_mul_f32 v[216:217], v[216:217], v[46:47]
    v_pk_mul_f32 v[218:219], v[218:219], v[46:47]
    v_cvt_pk_bf16_f32 v44, v216, v217
    v_cvt_pk_bf16_f32 v45, v218, v219
    v_cndmask_b32 v44, 0, v44, vcc
    v_cndmask_b32 v45, 0, v45, vcc
    ds_write_b64 v5, v[40:41] offset:0
    ds_write_b64 v5, v[42:43] offset:16
    ds_write_b64 v5, v[44:45] offset:32
    s_waitcnt lgkmcnt(0)
    ds_read_b128 v[48:51], v2
    ds_read_b128 v[52:55], v2 offset:1024
    s_waitcnt lgkmcnt(1)
    buffer_store_dwordx4 v[48:51], v7, s[16:19], s33 offen
    s_and_saveexec_b64 s[36:37], vcc
    s_waitcnt lgkmcnt(0)
    buffer_store_dwordx4 v[52:55], v7, s[16:19], s33 offen offset:1024
    s_mov_b64 exec, s[36:37]
    s_waitcnt vmcnt(0)
    s_barrier
    s_add_u32 s32, s26, 256
    s_cmp_lg_u32 s29, 0
    s_cbranch_scc1 nosig_mega_kernel_22
    s_lshl_b32 s38, s32, 7
    s_lshl_b32 s39, s27, 2
    s_add_u32 s38, s38, s39
    v_mov_b32 v24, s38
    v_mov_b32 v23, 1
    v_cmp_eq_u32 vcc, 0, v1
    s_and_saveexec_b64 s[36:37], vcc
    s_cbranch_execz nosig2_mega_kernel_23
    buffer_store_dword v23, v24, s[92:95], 0 offen
nosig2_mega_kernel_23:
    s_mov_b64 exec, s[36:37]
nosig_mega_kernel_22:
    s_and_b32 s24, s2, 7
    s_lshr_b32 s25, s2, 3
    s_lshl_b32 s26, s24, 2
    s_and_b32 s27, s25, 3
    s_add_u32 s26, s26, s27
    s_lshr_b32 s27, s25, 2
    s_add_u32 s4, s84, 0x2d9000
    s_addc_u32 s5, s85, 0
    s_mov_b32 s6, 3145728
    s_and_b32 s5, s5, 0xffff
    s_mov_b32 s7, 0x00020000
    s_mov_b32 s12, s86
    s_mov_b32 s13, s87
    s_mov_b32 s14, 2621440
    s_and_b32 s13, s13, 0xffff
    s_mov_b32 s15, 0x00020000
    s_add_u32 s16, s84, 0x59000
    s_addc_u32 s17, s85, 0
    s_mov_b32 s18, 2621440
    s_and_b32 s17, s17, 0xffff
    s_mov_b32 s19, 0x00020000
    s_add_u32 s20, s84, 0x39000
    s_addc_u32 s21, s85, 0
    s_mov_b32 s22, 131072
    s_and_b32 s21, s21, 0xffff
    s_mov_b32 s23, 0x00020000
    s_cmp_ge_u32 s29, 4
    s_cbranch_scc1 loader_mega_kernel_24
    v_and_b32 v25, 15, v1
    v_lshrrev_b32 v26, 4, v1
    s_lshl_b32 s32, s29, 2
    v_add_u32 v26, s32, v26
    v_xor_b32 v26, v26, v25
    v_lshlrev_b32 v26, 4, v26
    v_lshl_add_u32 v10, v25, 8, v26
    v_add_u32 v10, 32768, v10
    v_lshrrev_b32 v26, 4, v1
    v_lshlrev_b32 v26, 3, v26
    v_bfe_u32 v27, v1, 2, 2
    v_add_u32 v26, v26, v27
    s_lshl_b32 s32, s29, 5
    v_add_u32 v26, s32, v26
    v_mul_u32_u24 v26, 160, v26
    v_and_b32 v27, 3, v1
    v_lshl_add_u32 v26, v27, 3, v26
    v_add_u32 v11, 114688, v26
    s_lshl_b32 s32, s26, 6
    s_lshl_b32 s33, s29, 4
    s_add_u32 s32, s32, s33
    v_add_u32 v28, s32, v25
    v_mul_u32_u24 v29, 1280, v28
    v_lshrrev_b32 v26, 4, v1
    v_lshl_add_u32 v29, v26, 3, v29
    s_mul_i32 s32, s27, 160
    v_add_u32 v29, s32, v29
    v_mov_b32 v104, 0
    v_mov_b32 v105, 0
    v_mov_b32 v106, 0
    v_mov_b32 v107, 0
    v_mov_b32 v108, 0
    v_mov_b32 v109, 0
    v_mov_b32 v110, 0
    v_mov_b32 v111, 0
    v_mov_b32 v112, 0
    v_mov_b32 v113, 0
    v_mov_b32 v114, 0
    v_mov_b32 v115, 0
    v_mov_b32 v116, 0
    v_mov_b32 v117, 0
    v_mov_b32 v118, 0
    v_mov_b32 v119, 0
    v_mov_b32 v120, 0
    v_mov_b32 v121, 0
    v_mov_b32 v122, 0
    v_mov_b32 v123, 0
    v_mov_b32 v124, 0
    v_mov_b32 v125, 0
    v_mov_b32 v126, 0
    v_mov_b32 v127, 0
    v_mov_b32 v128, 0
    v_mov_b32 v129, 0
    v_mov_b32 v130, 0
    v_mov_b32 v131, 0
    v_mov_b32 v132, 0
    v_mov_b32 v133, 0
    v_mov_b32 v134, 0
    v_mov_b32 v135, 0
    v_mov_b32 v136, 0
    v_mov_b32 v137, 0
    v_mov_b32 v138, 0
    v_mov_b32 v139, 0
    v_mov_b32 v140, 0
    v_mov_b32 v141, 0
    v_mov_b32 v142, 0
    v_mov_b32 v143, 0
    v_mov_b32 v144, 0
    v_mov_b32 v145, 0
    v_mov_b32 v146, 0
    v_mov_b32 v147, 0
    v_mov_b32 v148, 0
    v_mov_b32 v149, 0
    v_mov_b32 v150, 0
    v_mov_b32 v151, 0
    v_mov_b32 v152, 0
    v_mov_b32 v153, 0
    v_mov_b32 v154, 0
    v_mov_b32 v155, 0
    v_mov_b32 v156, 0
    v_mov_b32 v157, 0
    v_mov_b32 v158, 0
    v_mov_b32 v159, 0
    v_mov_b32 v160, 0
    v_mov_b32 v161, 0
    v_mov_b32 v162, 0
    v_mov_b32 v163, 0
    v_mov_b32 v164, 0
    v_mov_b32 v165, 0
    v_mov_b32 v166, 0
    v_mov_b32 v167, 0
    v_mov_b32 v168, 0
    v_mov_b32 v169, 0
    v_mov_b32 v170, 0
    v_mov_b32 v171, 0
    v_mov_b32 v172, 0
    v_mov_b32 v173, 0
    v_mov_b32 v174, 0
    v_mov_b32 v175, 0
    v_mov_b32 v176, 0
    v_mov_b32 v177, 0
    v_mov_b32 v178, 0
    v_mov_b32 v179, 0
    v_mov_b32 v180, 0
    v_mov_b32 v181, 0
    v_mov_b32 v182, 0
    v_mov_b32 v183, 0
    s_mul_i32 s32, s29, 15360
    s_nop 0
    v_mul_u32_u24 v30, 160, v25
    v_lshrrev_b32 v26, 4, v1
    v_lshl_add_u32 v30, v26, 3, v30
    v_add_u32 v30, s32, v30
    v_lshlrev_b32 v31, 4, v1
    v_add_u32 v31, s32, v31
    s_lshl_b32 s32, s26, 6
    s_lshl_b32 s33, s29, 4
    s_add_u32 s32, s32, s33
    s_mul_i32 s33, s27, 160
    s_mov_b32 s38, 52429
    v_add_u32 v26, 0, v1
    v_mul_lo_u32 v27, v26, s38
    v_lshrrev_b32 v27, 19, v27
    v_mul_u32_u24 v24, 10, v27
    v_sub_u32 v24, v26, v24
    v_add_u32 v27, s32, v27
    v_mul_u32_u24 v27, 1280, v27
    v_lshl_add_u32 v27, v24, 4, v27
    v_add_u32 v12, s33, v27
    v_add_u32 v26, 64, v1
    v_mul_lo_u32 v27, v26, s38
    v_lshrrev_b32 v27, 19, v27
    v_mul_u32_u24 v24, 10, v27
    v_sub_u32 v24, v26, v24
    v_add_u32 v27, s32, v27
    v_mul_u32_u24 v27, 1280, v27
    v_lshl_add_u32 v27, v24, 4, v27
    v_add_u32 v13, s33, v27
    v_add_u32 v26, 128, v1
    v_mul_lo_u32 v27, v26, s38
    v_lshrrev_b32 v27, 19, v27
    v_mul_u32_u24 v24, 10, v27
    v_sub_u32 v24, v26, v24
    v_add_u32 v27, s32, v27
    v_mul_u32_u24 v27, 1280, v27
    v_lshl_add_u32 v27, v24, 4, v27
    v_add_u32 v14, s33, v27
    buffer_load_dword v200, v12, s[16:19], 0 offen
    buffer_load_dword v201, v13, s[16:19], 0 offen
    buffer_load_dword v202, v14, s[16:19], 0 offen
    s_cmp_lg_u32 s29, 3
    s_cbranch_scc1 pok_mega_kernel_27
    s_lshr_b32 s38, s26, 2
    s_add_u32 s38, s38, 256
    s_lshl_b32 s38, s38, 7
    v_and_b32 v24, 31, v1
    v_lshlrev_b32 v24, 2, v24
    v_add_u32 v24, s38, v24
    s_mov_b32 s38, 0
    buffer_load_dword v21, v24, s[92:95], 0 offen sc1
    s_sleep 3
    buffer_load_dword v22, v24, s[92:95], 0 offen sc1
    s_sleep 3
poll_mega_kernel_26:
    buffer_load_dword v23, v24, s[92:95], 0 offen sc1
    s_waitcnt vmcnt(2)
    v_cmp_gt_u32 vcc, 1, v21
    s_nop 4
    s_cbranch_vccz pok_mega_kernel_27
    s_sleep 2
    buffer_load_dword v21, v24, s[92:95], 0 offen sc1
    s_waitcnt vmcnt(2)
    v_cmp_gt_u32 vcc, 1, v22
    s_nop 4
    s_cbranch_vccz pok_mega_kernel_27
    s_sleep 2
    buffer_load_dword v22, v24, s[92:95], 0 offen sc1
    s_waitcnt vmcnt(2)
    v_cmp_gt_u32 vcc, 1, v23
    s_nop 4
    s_cbranch_vccz pok_mega_kernel_27
    s_sleep 2
    s_add_u32 s38, s38, 1
    s_cmp_gt_u32 s38, 4000
    s_cbranch_scc0 poll_mega_kernel_26
pok_mega_kernel_27:
    s_barrier
    buffer_load_dwordx2 v[184:185], v29, s[12:15], 0 offen offset:0 sc1
    buffer_load_dwordx2 v[186:187], v29, s[12:15], 0 offen offset:32 sc1
    buffer_load_dwordx2 v[188:189], v29, s[12:15], 0 offen offset:64 sc1
    buffer_load_dwordx2 v[190:191], v29, s[12:15], 0 offen offset:96 sc1
    buffer_load_dwordx2 v[192:193], v29, s[12:15], 0 offen offset:128 sc1
    s_barrier
    ds_read_b128 v[32:35], v10 offset:0
    ds_read_b128 v[36:39], v10 offset:4096
    ds_read_b128 v[40:43], v10 offset:8192
    ds_read_b128 v[44:47], v10 offset:12288
    ds_read_b64_tr_b16 v[48:49], v11 offset:0
    ds_read_b64_tr_b16 v[50:51], v11 offset:640
    ds_read_b64_tr_b16 v[52:53], v11 offset:32
    ds_read_b64_tr_b16 v[54:55], v11 offset:672
    ds_read_b64_tr_b16 v[56:57], v11 offset:64
    ds_read_b64_tr_b16 v[58:59], v11 offset:704
    ds_read_b64_tr_b16 v[60:61], v11 offset:96
    ds_read_b64_tr_b16 v[62:63], v11 offset:736
    ds_read_b64_tr_b16 v[64:65], v11 offset:128
    ds_read_b64_tr_b16 v[66:67], v11 offset:768
    s_waitcnt lgkmcnt(0)
    v_mfma_f32_16x16x32_bf16 v[104:107], v[48:51], v[32:35], v[104:107]
    s_barrier
    v_add_u32 v10, 0x4000, v10
    v_add_u32 v11, 0x6000, v11
    v_mfma_f32_16x16x32_bf16 v[108:111], v[48:51], v[36:39], v[108:111]
    ds_read_b128 v[68:71], v10 offset:0
    v_mfma_f32_16x16x32_bf16 v[112:115], v[48:51], v[40:43], v[112:115]
    ds_read_b128 v[72:75], v10 offset:4096
    v_mfma_f32_16x16x32_bf16 v[116:119], v[48:51], v[44:47], v[116:119]
    ds_read_b128 v[76:79], v10 offset:8192
    v_mfma_f32_16x16x32_bf16 v[120:123], v[52:55], v[32:35], v[120:123]
    ds_read_b128 v[80:83], v10 offset:12288
    v_mfma_f32_16x16x32_bf16 v[124:127], v[52:55], v[36:39], v[124:127]
    ds_read_b64_tr_b16 v[84:85], v11 offset:0
    v_mfma_f32_16x16x32_bf16 v[128:131], v[52:55], v[40:43], v[128:131]
    ds_read_b64_tr_b16 v[86:87], v11 offset:640
    v_mfma_f32_16x16x32_bf16 v[132:135], v[52:55], v[44:47], v[132:135]
    ds_read_b64_tr_b16 v[88:89], v11 offset:32
    v_mfma_f32_16x16x32_bf16 v[136:139], v[56:59], v[32:35], v[136:139]
    ds_read_b64_tr_b16 v[90:91], v11 offset:672
    v_mfma_f32_16x16x32_bf16 v[140:143], v[56:59], v[36:39], v[140:143]
    ds_read_b64_tr_b16 v[92:93], v11 offset:64
    v_mfma_f32_16x16x32_bf16 v[144:147], v[56:59], v[40:43], v[144:147]
    ds_read_b64_tr_b16 v[94:95], v11 offset:704
    v_mfma_f32_16x16x32_bf16 v[148:151], v[56:59], v[44:47], v[148:151]
    ds_read_b64_tr_b16 v[96:97], v11 offset:96
    v_mfma_f32_16x16x32_bf16 v[152:155], v[60:63], v[32:35], v[152:155]
    ds_read_b64_tr_b16 v[98:99], v11 offset:736
    v_mfma_f32_16x16x32_bf16 v[156:159], v[60:63], v[36:39], v[156:159]
    ds_read_b64_tr_b16 v[100:101], v11 offset:128
    v_mfma_f32_16x16x32_bf16 v[160:163], v[60:63], v[40:43], v[160:163]
    ds_read_b64_tr_b16 v[102:103], v11 offset:768
    v_mfma_f32_16x16x32_bf16 v[164:167], v[60:63], v[44:47], v[164:167]
    v_mfma_f32_16x16x32_bf16 v[168:171], v[64:67], v[32:35], v[168:171]
    v_mfma_f32_16x16x32_bf16 v[172:175], v[64:67], v[36:39], v[172:175]
    v_mfma_f32_16x16x32_bf16 v[176:179], v[64:67], v[40:43], v[176:179]
    v_mfma_f32_16x16x32_bf16 v[180:183], v[64:67], v[44:47], v[180:183]
    s_waitcnt lgkmcnt(0)
    v_mfma_f32_16x16x32_bf16 v[104:107], v[84:87], v[68:71], v[104:107]
    s_barrier
    v_add_u32 v10, 0xffff4000, v10
    v_add_u32 v11, 0xfffee000, v11
    v_mfma_f32_16x16x32_bf16 v[108:111], v[84:87], v[72:75], v[108:111]
    ds_read_b128 v[32:35], v10 offset:0
    v_mfma_f32_16x16x32_bf16 v[112:115], v[84:87], v[76:79], v[112:115]
    ds_read_b128 v[36:39], v10 offset:4096
    v_mfma_f32_16x16x32_bf16 v[116:119], v[84:87], v[80:83], v[116:119]
    ds_read_b128 v[40:43], v10 offset:8192
    v_mfma_f32_16x16x32_bf16 v[120:123], v[88:91], v[68:71], v[120:123]
    ds_read_b128 v[44:47], v10 offset:12288
    v_mfma_f32_16x16x32_bf16 v[124:127], v[88:91], v[72:75], v[124:127]
    ds_read_b64_tr_b16 v[48:49], v11 offset:0
    v_mfma_f32_16x16x32_bf16 v[128:131], v[88:91], v[76:79], v[128:131]
    ds_read_b64_tr_b16 v[50:51], v11 offset:640
    v_mfma_f32_16x16x32_bf16 v[132:135], v[88:91], v[80:83], v[132:135]
    ds_read_b64_tr_b16 v[52:53], v11 offset:32
    v_mfma_f32_16x16x32_bf16 v[136:139], v[92:95], v[68:71], v[136:139]
    ds_read_b64_tr_b16 v[54:55], v11 offset:672
    v_mfma_f32_16x16x32_bf16 v[140:143], v[92:95], v[72:75], v[140:143]
    ds_read_b64_tr_b16 v[56:57], v11 offset:64
    v_mfma_f32_16x16x32_bf16 v[144:147], v[92:95], v[76:79], v[144:147]
    ds_read_b64_tr_b16 v[58:59], v11 offset:704
    v_mfma_f32_16x16x32_bf16 v[148:151], v[92:95], v[80:83], v[148:151]
    ds_read_b64_tr_b16 v[60:61], v11 offset:96
    v_mfma_f32_16x16x32_bf16 v[152:155], v[96:99], v[68:71], v[152:155]
    ds_read_b64_tr_b16 v[62:63], v11 offset:736
    v_mfma_f32_16x16x32_bf16 v[156:159], v[96:99], v[72:75], v[156:159]
    ds_read_b64_tr_b16 v[64:65], v11 offset:128
    v_mfma_f32_16x16x32_bf16 v[160:163], v[96:99], v[76:79], v[160:163]
    ds_read_b64_tr_b16 v[66:67], v11 offset:768
    v_mfma_f32_16x16x32_bf16 v[164:167], v[96:99], v[80:83], v[164:167]
    v_mfma_f32_16x16x32_bf16 v[168:171], v[100:103], v[68:71], v[168:171]
    v_mfma_f32_16x16x32_bf16 v[172:175], v[100:103], v[72:75], v[172:175]
    v_mfma_f32_16x16x32_bf16 v[176:179], v[100:103], v[76:79], v[176:179]
    v_mfma_f32_16x16x32_bf16 v[180:183], v[100:103], v[80:83], v[180:183]
    s_waitcnt lgkmcnt(0)
    v_mfma_f32_16x16x32_bf16 v[104:107], v[48:51], v[32:35], v[104:107]
    s_barrier
    v_add_u32 v10, 0x4000, v10
    v_add_u32 v11, 0x6000, v11
    v_mfma_f32_16x16x32_bf16 v[108:111], v[48:51], v[36:39], v[108:111]
    ds_read_b128 v[68:71], v10 offset:0
    v_mfma_f32_16x16x32_bf16 v[112:115], v[48:51], v[40:43], v[112:115]
    ds_read_b128 v[72:75], v10 offset:4096
    v_mfma_f32_16x16x32_bf16 v[116:119], v[48:51], v[44:47], v[116:119]
    ds_read_b128 v[76:79], v10 offset:8192
    v_mfma_f32_16x16x32_bf16 v[120:123], v[52:55], v[32:35], v[120:123]
    ds_read_b128 v[80:83], v10 offset:12288
    v_mfma_f32_16x16x32_bf16 v[124:127], v[52:55], v[36:39], v[124:127]
    ds_read_b64_tr_b16 v[84:85], v11 offset:0
    v_mfma_f32_16x16x32_bf16 v[128:131], v[52:55], v[40:43], v[128:131]
    ds_read_b64_tr_b16 v[86:87], v11 offset:640
    v_mfma_f32_16x16x32_bf16 v[132:135], v[52:55], v[44:47], v[132:135]
    ds_read_b64_tr_b16 v[88:89], v11 offset:32
    v_mfma_f32_16x16x32_bf16 v[136:139], v[56:59], v[32:35], v[136:139]
    ds_read_b64_tr_b16 v[90:91], v11 offset:672
    v_mfma_f32_16x16x32_bf16 v[140:143], v[56:59], v[36:39], v[140:143]
    ds_read_b64_tr_b16 v[92:93], v11 offset:64
    v_mfma_f32_16x16x32_bf16 v[144:147], v[56:59], v[40:43], v[144:147]
    ds_read_b64_tr_b16 v[94:95], v11 offset:704
    v_mfma_f32_16x16x32_bf16 v[148:151], v[56:59], v[44:47], v[148:151]
    ds_read_b64_tr_b16 v[96:97], v11 offset:96
    v_mfma_f32_16x16x32_bf16 v[152:155], v[60:63], v[32:35], v[152:155]
    ds_read_b64_tr_b16 v[98:99], v11 offset:736
    v_mfma_f32_16x16x32_bf16 v[156:159], v[60:63], v[36:39], v[156:159]
    ds_read_b64_tr_b16 v[100:101], v11 offset:128
    v_mfma_f32_16x16x32_bf16 v[160:163], v[60:63], v[40:43], v[160:163]
    ds_read_b64_tr_b16 v[102:103], v11 offset:768
    v_mfma_f32_16x16x32_bf16 v[164:167], v[60:63], v[44:47], v[164:167]
    v_mfma_f32_16x16x32_bf16 v[168:171], v[64:67], v[32:35], v[168:171]
    v_mfma_f32_16x16x32_bf16 v[172:175], v[64:67], v[36:39], v[172:175]
    v_mfma_f32_16x16x32_bf16 v[176:179], v[64:67], v[40:43], v[176:179]
    v_mfma_f32_16x16x32_bf16 v[180:183], v[64:67], v[44:47], v[180:183]
    s_waitcnt lgkmcnt(0)
    v_mfma_f32_16x16x32_bf16 v[104:107], v[84:87], v[68:71], v[104:107]
    s_barrier
    v_add_u32 v10, 0x4000, v10
    v_add_u32 v11, 0x6000, v11
    v_mfma_f32_16x16x32_bf16 v[108:111], v[84:87], v[72:75], v[108:111]
    ds_read_b128 v[32:35], v10 offset:0
    v_mfma_f32_16x16x32_bf16 v[112:115], v[84:87], v[76:79], v[112:115]
    ds_read_b128 v[36:39], v10 offset:4096
    v_mfma_f32_16x16x32_bf16 v[116:119], v[84:87], v[80:83], v[116:119]
    ds_read_b128 v[40:43], v10 offset:8192
    v_mfma_f32_16x16x32_bf16 v[120:123], v[88:91], v[68:71], v[120:123]
    ds_read_b128 v[44:47], v10 offset:12288
    v_mfma_f32_16x16x32_bf16 v[124:127], v[88:91], v[72:75], v[124:127]
    ds_read_b64_tr_b16 v[48:49], v11 offset:0
    v_mfma_f32_16x16x32_bf16 v[128:131], v[88:91], v[76:79], v[128:131]
    ds_read_b64_tr_b16 v[50:51], v11 offset:640
    v_mfma_f32_16x16x32_bf16 v[132:135], v[88:91], v[80:83], v[132:135]
    ds_read_b64_tr_b16 v[52:53], v11 offset:32
    v_mfma_f32_16x16x32_bf16 v[136:139], v[92:95], v[68:71], v[136:139]
    ds_read_b64_tr_b16 v[54:55], v11 offset:672
    v_mfma_f32_16x16x32_bf16 v[140:143], v[92:95], v[72:75], v[140:143]
    ds_read_b64_tr_b16 v[56:57], v11 offset:64
    v_mfma_f32_16x16x32_bf16 v[144:147], v[92:95], v[76:79], v[144:147]
    ds_read_b64_tr_b16 v[58:59], v11 offset:704
    v_mfma_f32_16x16x32_bf16 v[148:151], v[92:95], v[80:83], v[148:151]
    ds_read_b64_tr_b16 v[60:61], v11 offset:96
    v_mfma_f32_16x16x32_bf16 v[152:155], v[96:99], v[68:71], v[152:155]
    ds_read_b64_tr_b16 v[62:63], v11 offset:736
    v_mfma_f32_16x16x32_bf16 v[156:159], v[96:99], v[72:75], v[156:159]
    ds_read_b64_tr_b16 v[64:65], v11 offset:128
    v_mfma_f32_16x16x32_bf16 v[160:163], v[96:99], v[76:79], v[160:163]
    ds_read_b64_tr_b16 v[66:67], v11 offset:768
    v_mfma_f32_16x16x32_bf16 v[164:167], v[96:99], v[80:83], v[164:167]
    v_mfma_f32_16x16x32_bf16 v[168:171], v[100:103], v[68:71], v[168:171]
    v_mfma_f32_16x16x32_bf16 v[172:175], v[100:103], v[72:75], v[172:175]
    v_mfma_f32_16x16x32_bf16 v[176:179], v[100:103], v[76:79], v[176:179]
    v_mfma_f32_16x16x32_bf16 v[180:183], v[100:103], v[80:83], v[180:183]
    s_waitcnt lgkmcnt(0)
    v_mfma_f32_16x16x32_bf16 v[104:107], v[48:51], v[32:35], v[104:107]
    s_barrier
    v_add_u32 v10, 0x4000, v10
    v_add_u32 v11, 0x6000, v11
    v_mfma_f32_16x16x32_bf16 v[108:111], v[48:51], v[36:39], v[108:111]
    ds_read_b128 v[68:71], v10 offset:0
    v_mfma_f32_16x16x32_bf16 v[112:115], v[48:51], v[40:43], v[112:115]
    ds_read_b128 v[72:75], v10 offset:4096
    v_mfma_f32_16x16x32_bf16 v[116:119], v[48:51], v[44:47], v[116:119]
    ds_read_b128 v[76:79], v10 offset:8192
    v_mfma_f32_16x16x32_bf16 v[120:123], v[52:55], v[32:35], v[120:123]
    ds_read_b128 v[80:83], v10 offset:12288
    v_mfma_f32_16x16x32_bf16 v[124:127], v[52:55], v[36:39], v[124:127]
    ds_read_b64_tr_b16 v[84:85], v11 offset:0
    v_mfma_f32_16x16x32_bf16 v[128:131], v[52:55], v[40:43], v[128:131]
    ds_read_b64_tr_b16 v[86:87], v11 offset:640
    v_mfma_f32_16x16x32_bf16 v[132:135], v[52:55], v[44:47], v[132:135]
    ds_read_b64_tr_b16 v[88:89], v11 offset:32
    v_mfma_f32_16x16x32_bf16 v[136:139], v[56:59], v[32:35], v[136:139]
    ds_read_b64_tr_b16 v[90:91], v11 offset:672
    v_mfma_f32_16x16x32_bf16 v[140:143], v[56:59], v[36:39], v[140:143]
    ds_read_b64_tr_b16 v[92:93], v11 offset:64
    v_mfma_f32_16x16x32_bf16 v[144:147], v[56:59], v[40:43], v[144:147]
    ds_read_b64_tr_b16 v[94:95], v11 offset:704
    v_mfma_f32_16x16x32_bf16 v[148:151], v[56:59], v[44:47], v[148:151]
    ds_read_b64_tr_b16 v[96:97], v11 offset:96
    v_mfma_f32_16x16x32_bf16 v[152:155], v[60:63], v[32:35], v[152:155]
    ds_read_b64_tr_b16 v[98:99], v11 offset:736
    v_mfma_f32_16x16x32_bf16 v[156:159], v[60:63], v[36:39], v[156:159]
    ds_read_b64_tr_b16 v[100:101], v11 offset:128
    v_mfma_f32_16x16x32_bf16 v[160:163], v[60:63], v[40:43], v[160:163]
    ds_read_b64_tr_b16 v[102:103], v11 offset:768
    v_mfma_f32_16x16x32_bf16 v[164:167], v[60:63], v[44:47], v[164:167]
    v_mfma_f32_16x16x32_bf16 v[168:171], v[64:67], v[32:35], v[168:171]
    v_mfma_f32_16x16x32_bf16 v[172:175], v[64:67], v[36:39], v[172:175]
    v_mfma_f32_16x16x32_bf16 v[176:179], v[64:67], v[40:43], v[176:179]
    v_mfma_f32_16x16x32_bf16 v[180:183], v[64:67], v[44:47], v[180:183]
    s_waitcnt lgkmcnt(0)
    v_mfma_f32_16x16x32_bf16 v[104:107], v[84:87], v[68:71], v[104:107]
    v_mfma_f32_16x16x32_bf16 v[108:111], v[84:87], v[72:75], v[108:111]
    v_mfma_f32_16x16x32_bf16 v[112:115], v[84:87], v[76:79], v[112:115]
    v_mfma_f32_16x16x32_bf16 v[116:119], v[84:87], v[80:83], v[116:119]
    v_mfma_f32_16x16x32_bf16 v[120:123], v[88:91], v[68:71], v[120:123]
    v_mfma_f32_16x16x32_bf16 v[124:127], v[88:91], v[72:75], v[124:127]
    v_mfma_f32_16x16x32_bf16 v[128:131], v[88:91], v[76:79], v[128:131]
    v_mfma_f32_16x16x32_bf16 v[132:135], v[88:91], v[80:83], v[132:135]
    v_mfma_f32_16x16x32_bf16 v[136:139], v[92:95], v[68:71], v[136:139]
    v_mfma_f32_16x16x32_bf16 v[140:143], v[92:95], v[72:75], v[140:143]
    v_mfma_f32_16x16x32_bf16 v[144:147], v[92:95], v[76:79], v[144:147]
    v_mfma_f32_16x16x32_bf16 v[148:151], v[92:95], v[80:83], v[148:151]
    v_mfma_f32_16x16x32_bf16 v[152:155], v[96:99], v[68:71], v[152:155]
    v_mfma_f32_16x16x32_bf16 v[156:159], v[96:99], v[72:75], v[156:159]
    v_mfma_f32_16x16x32_bf16 v[160:163], v[96:99], v[76:79], v[160:163]
    v_mfma_f32_16x16x32_bf16 v[164:167], v[96:99], v[80:83], v[164:167]
    v_mfma_f32_16x16x32_bf16 v[168:171], v[100:103], v[68:71], v[168:171]
    v_mfma_f32_16x16x32_bf16 v[172:175], v[100:103], v[72:75], v[172:175]
    v_mfma_f32_16x16x32_bf16 v[176:179], v[100:103], v[76:79], v[176:179]
    v_mfma_f32_16x16x32_bf16 v[180:183], v[100:103], v[80:83], v[180:183]
    s_barrier
    v_lshlrev_b32 v25, 4, v1
    s_mul_i32 s32, s29, 15360
    v_add_u32 v27, s32, v25
    s_nop 7
    s_cmp_eq_u32 s29, 0
    s_cbranch_scc1 rw_mega_kernel_28
    s_sub_u32 s32, s29, 1
    s_and_b32 s32, s32, 3
    s_mul_i32 s32, s32, 5120
    s_add_u32 s32, s32, 0
    v_add_u32 v26, s32, v25
    ds_write_b128 v26, v[104:107] offset:0
    ds_write_b128 v26, v[120:123] offset:1024
    ds_write_b128 v26, v[136:139] offset:2048
    ds_write_b128 v26, v[152:155] offset:3072
    ds_write_b128 v26, v[168:171] offset:4096
rw_mega_kernel_28:
    s_cmp_eq_u32 s29, 1
    s_cbranch_scc1 rw_mega_kernel_29
    s_sub_u32 s32, s29, 2
    s_and_b32 s32, s32, 3
    s_mul_i32 s32, s32, 5120
    s_add_u32 s32, s32, 15360
    v_add_u32 v26, s32, v25
    ds_write_b128 v26, v[108:111] offset:0
    ds_write_b128 v26, v[124:127] offset:1024
    ds_write_b128 v26, v[140:143] offset:2048
    ds_write_b128 v26, v[156:159] offset:3072
    ds_write_b128 v26, v[172:175] offset:4096
rw_mega_kernel_29:
    s_cmp_eq_u32 s29, 2
    s_cbranch_scc1 rw_mega_kernel_30
    s_sub_u32 s32, s29, 3
    s_and_b32 s32, s32, 3
    s_mul_i32 s32, s32, 5120
    s_add_u32 s32, s32, 30720
    v_add_u32 v26, s32, v25
    ds_write_b128 v26, v[112:115] offset:0
    ds_write_b128 v26, v[128:131] offset:1024
    ds_write_b128 v26, v[144:147] offset:2048
    ds_write_b128 v26, v[160:163] offset:3072
    ds_write_b128 v26, v[176:179] offset:4096
rw_mega_kernel_30:
    s_cmp_eq_u32 s29, 3
    s_cbranch_scc1 rw_mega_kernel_31
    s_sub_u32 s32, s29, 4
    s_and_b32 s32, s32, 3
    s_mul_i32 s32, s32, 5120
    s_add_u32 s32, s32, 46080
    v_add_u32 v26, s32, v25
    ds_write_b128 v26, v[116:119] offset:0
    ds_write_b128 v26, v[132:135] offset:1024
    ds_write_b128 v26, v[148:151] offset:2048
    ds_write_b128 v26, v[164:167] offset:3072
    ds_write_b128 v26, v[180:183] offset:4096
rw_mega_kernel_31:
    s_waitcnt lgkmcnt(0)
    s_barrier
    s_cmp_eq_u32 s29, 0
    s_cbranch_scc1 own_mega_kernel_33
    s_cmp_eq_u32 s29, 1
    s_cbranch_scc1 own_mega_kernel_34
    s_cmp_eq_u32 s29, 2
    s_cbranch_scc1 own_mega_kernel_35
    s_cmp_eq_u32 s29, 3
    s_cbranch_scc1 own_mega_kernel_36
own_mega_kernel_33:
    v_mov_b32 v32, v104
    v_mov_b32 v33, v105
    v_mov_b32 v34, v106
    v_mov_b32 v35, v107
    v_mov_b32 v36, v120
    v_mov_b32 v37, v121
    v_mov_b32 v38, v122
    v_mov_b32 v39, v123
    v_mov_b32 v40, v136
    v_mov_b32 v41, v137
    v_mov_b32 v42, v138
    v_mov_b32 v43, v139
    v_mov_b32 v44, v152
    v_mov_b32 v45, v153
    v_mov_b32 v46, v154
    v_mov_b32 v47, v155
    v_mov_b32 v48, v168
    v_mov_b32 v49, v169
    v_mov_b32 v50, v170
    v_mov_b32 v51, v171
    s_branch e_mega_kernel_32
own_mega_kernel_34:
    v_mov_b32 v32, v108
    v_mov_b32 v33, v109
    v_mov_b32 v34, v110
    v_mov_b32 v35, v111
    v_mov_b32 v36, v124
    v_mov_b32 v37, v125
    v_mov_b32 v38, v126
    v_mov_b32 v39, v127
    v_mov_b32 v40, v140
    v_mov_b32 v41, v141
    v_mov_b32 v42, v142
    v_mov_b32 v43, v143
    v_mov_b32 v44, v156
    v_mov_b32 v45, v157
    v_mov_b32 v46, v158
    v_mov_b32 v47, v159
    v_mov_b32 v48, v172
    v_mov_b32 v49, v173
    v_mov_b32 v50, v174
    v_mov_b32 v51, v175
    s_branch e_mega_kernel_32
own_mega_kernel_35:
    v_mov_b32 v32, v112
    v_mov_b32 v33, v113
    v_mov_b32 v34, v114
    v_mov_b32 v35, v115
    v_mov_b32 v36, v128
    v_mov_b32 v37, v129
    v_mov_b32 v38, v130
    v_mov_b32 v39, v131
    v_mov_b32 v40, v144
    v_mov_b32 v41, v145
    v_mov_b32 v42, v146
    v_mov_b32 v43, v147
    v_mov_b32 v44, v160
    v_mov_b32 v45, v161
    v_mov_b32 v46, v162
    v_mov_b32 v47, v163
    v_mov_b32 v48, v176
    v_mov_b32 v49, v177
    v_mov_b32 v50, v178
    v_mov_b32 v51, v179
    s_branch e_mega_kernel_32
own_mega_kernel_36:
    v_mov_b32 v32, v116
    v_mov_b32 v33, v117
    v_mov_b32 v34, v118
    v_mov_b32 v35, v119
    v_mov_b32 v36, v132
    v_mov_b32 v37, v133
    v_mov_b32 v38, v134
    v_mov_b32 v39, v135
    v_mov_b32 v40, v148
    v_mov_b32 v41, v149
    v_mov_b32 v42, v150
    v_mov_b32 v43, v151
    v_mov_b32 v44, v164
    v_mov_b32 v45, v165
    v_mov_b32 v46, v166
    v_mov_b32 v47, v167
    v_mov_b32 v48, v180
    v_mov_b32 v49, v181
    v_mov_b32 v50, v182
    v_mov_b32 v51, v183
    s_branch e_mega_kernel_32
e_mega_kernel_32:
    ds_read_b128 v[104:107], v27 offset:0
    ds_read_b128 v[108:111], v27 offset:1024
    ds_read_b128 v[112:115], v27 offset:2048
    ds_read_b128 v[116:119], v27 offset:3072
    ds_read_b128 v[120:123], v27 offset:4096
    ds_read_b128 v[124:127], v27 offset:5120
    ds_read_b128 v[128:131], v27 offset:6144
    ds_read_b128 v[132:135], v27 offset:7168
    ds_read_b128 v[136:139], v27 offset:8192
    ds_read_b128 v[140:143], v27 offset:9216
    ds_read_b128 v[144:147], v27 offset:10240
    ds_read_b128 v[148:151], v27 offset:11264
    ds_read_b128 v[152:155], v27 offset:12288
    ds_read_b128 v[156:159], v27 offset:13312
    ds_read_b128 v[160:163], v27 offset:14336
    s_waitcnt lgkmcnt(0) vmcnt(0)
    v_pk_add_f32 v[32:33], v[32:33], v[104:105]
    v_pk_add_f32 v[34:35], v[34:35], v[106:107]
    v_pk_add_f32 v[36:37], v[36:37], v[108:109]
    v_pk_add_f32 v[38:39], v[38:39], v[110:111]
    v_pk_add_f32 v[40:41], v[40:41], v[112:113]
    v_pk_add_f32 v[42:43], v[42:43], v[114:115]
    v_pk_add_f32 v[44:45], v[44:45], v[116:117]
    v_pk_add_f32 v[46:47], v[46:47], v[118:119]
    v_pk_add_f32 v[48:49], v[48:49], v[120:121]
    v_pk_add_f32 v[50:51], v[50:51], v[122:123]
    v_pk_add_f32 v[32:33], v[32:33], v[124:125]
    v_pk_add_f32 v[34:35], v[34:35], v[126:127]
    v_pk_add_f32 v[36:37], v[36:37], v[128:129]
    v_pk_add_f32 v[38:39], v[38:39], v[130:131]
    v_pk_add_f32 v[40:41], v[40:41], v[132:133]
    v_pk_add_f32 v[42:43], v[42:43], v[134:135]
    v_pk_add_f32 v[44:45], v[44:45], v[136:137]
    v_pk_add_f32 v[46:47], v[46:47], v[138:139]
    v_pk_add_f32 v[48:49], v[48:49], v[140:141]
    v_pk_add_f32 v[50:51], v[50:51], v[142:143]
    v_pk_add_f32 v[32:33], v[32:33], v[144:145]
    v_pk_add_f32 v[34:35], v[34:35], v[146:147]
    v_pk_add_f32 v[36:37], v[36:37], v[148:149]
    v_pk_add_f32 v[38:39], v[38:39], v[150:151]
    v_pk_add_f32 v[40:41], v[40:41], v[152:153]
    v_pk_add_f32 v[42:43], v[42:43], v[154:155]
    v_pk_add_f32 v[44:45], v[44:45], v[156:157]
    v_pk_add_f32 v[46:47], v[46:47], v[158:159]
    v_pk_add_f32 v[48:49], v[48:49], v[160:161]
    v_pk_add_f32 v[50:51], v[50:51], v[162:163]
    v_cvt_pk_bf16_f32 v20, v32, v33
    v_lshlrev_b32 v32, 16, v20
    v_and_b32 v33, 0xffff0000, v20
    v_lshlrev_b32 v21, 16, v184
    v_and_b32 v22, 0xffff0000, v184
    v_add_f32 v32, v32, v21
    v_add_f32 v33, v33, v22
    v_cvt_pk_bf16_f32 v184, v32, v33
    v_lshlrev_b32 v32, 16, v184
    v_and_b32 v33, 0xffff0000, v184
    v_cvt_pk_bf16_f32 v20, v34, v35
    v_lshlrev_b32 v34, 16, v20
    v_and_b32 v35, 0xffff0000, v20
    v_lshlrev_b32 v21, 16, v185
    v_and_b32 v22, 0xffff0000, v185
    v_add_f32 v34, v34, v21
    v_add_f32 v35, v35, v22
    v_cvt_pk_bf16_f32 v185, v34, v35
    v_lshlrev_b32 v34, 16, v185
    v_and_b32 v35, 0xffff0000, v185
    ds_write_b64 v30, v[184:185] offset:0
    v_cvt_pk_bf16_f32 v20, v36, v37
    v_lshlrev_b32 v36, 16, v20
    v_and_b32 v37, 0xffff0000, v20
    v_lshlrev_b32 v21, 16, v186
    v_and_b32 v22, 0xffff0000, v186
    v_add_f32 v36, v36, v21
    v_add_f32 v37, v37, v22
    v_cvt_pk_bf16_f32 v186, v36, v37
    v_lshlrev_b32 v36, 16, v186
    v_and_b32 v37, 0xffff0000, v186
    v_cvt_pk_bf16_f32 v20, v38, v39
    v_lshlrev_b32 v38, 16, v20
    v_and_b32 v39, 0xffff0000, v20
    v_lshlrev_b32 v21, 16, v187
    v_and_b32 v22, 0xffff0000, v187
    v_add_f32 v38, v38, v21
    v_add_f32 v39, v39, v22
    v_cvt_pk_bf16_f32 v187, v38, v39
    v_lshlrev_b32 v38, 16, v187
    v_and_b32 v39, 0xffff0000, v187
    ds_write_b64 v30, v[186:187] offset:32
    v_cvt_pk_bf16_f32 v20, v40, v41
    v_lshlrev_b32 v40, 16, v20
    v_and_b32 v41, 0xffff0000, v20
    v_lshlrev_b32 v21, 16, v188
    v_and_b32 v22, 0xffff0000, v188
    v_add_f32 v40, v40, v21
    v_add_f32 v41, v41, v22
    v_cvt_pk_bf16_f32 v188, v40, v41
    v_lshlrev_b32 v40, 16, v188
    v_and_b32 v41, 0xffff0000, v188
    v_cvt_pk_bf16_f32 v20, v42, v43
    v_lshlrev_b32 v42, 16, v20
    v_and_b32 v43, 0xffff0000, v20
    v_lshlrev_b32 v21, 16, v189
    v_and_b32 v22, 0xffff0000, v189
    v_add_f32 v42, v42, v21
    v_add_f32 v43, v43, v22
    v_cvt_pk_bf16_f32 v189, v42, v43
    v_lshlrev_b32 v42, 16, v189
    v_and_b32 v43, 0xffff0000, v189
    ds_write_b64 v30, v[188:189] offset:64
    v_cvt_pk_bf16_f32 v20, v44, v45
    v_lshlrev_b32 v44, 16, v20
    v_and_b32 v45, 0xffff0000, v20
    v_lshlrev_b32 v21, 16, v190
    v_and_b32 v22, 0xffff0000, v190
    v_add_f32 v44, v44, v21
    v_add_f32 v45, v45, v22
    v_cvt_pk_bf16_f32 v190, v44, v45
    v_lshlrev_b32 v44, 16, v190
    v_and_b32 v45, 0xffff0000, v190
    v_cvt_pk_bf16_f32 v20, v46, v47
    v_lshlrev_b32 v46, 16, v20
    v_and_b32 v47, 0xffff0000, v20
    v_lshlrev_b32 v21, 16, v191
    v_and_b32 v22, 0xffff0000, v191
    v_add_f32 v46, v46, v21
    v_add_f32 v47, v47, v22
    v_cvt_pk_bf16_f32 v191, v46, v47
    v_lshlrev_b32 v46, 16, v191
    v_and_b32 v47, 0xffff0000, v191
    ds_write_b64 v30, v[190:191] offset:96
    v_cvt_pk_bf16_f32 v20, v48, v49
    v_lshlrev_b32 v48, 16, v20
    v_and_b32 v49, 0xffff0000, v20
    v_lshlrev_b32 v21, 16, v192
    v_and_b32 v22, 0xffff0000, v192
    v_add_f32 v48, v48, v21
    v_add_f32 v49, v49, v22
    v_cvt_pk_bf16_f32 v192, v48, v49
    v_lshlrev_b32 v48, 16, v192
    v_and_b32 v49, 0xffff0000, v192
    v_cvt_pk_bf16_f32 v20, v50, v51
    v_lshlrev_b32 v50, 16, v20
    v_and_b32 v51, 0xffff0000, v20
    v_lshlrev_b32 v21, 16, v193
    v_and_b32 v22, 0xffff0000, v193
    v_add_f32 v50, v50, v21
    v_add_f32 v51, v51, v22
    v_cvt_pk_bf16_f32 v193, v50, v51
    v_lshlrev_b32 v50, 16, v193
    v_and_b32 v51, 0xffff0000, v193
    ds_write_b64 v30, v[192:193] offset:128
    s_waitcnt lgkmcnt(0)
    ds_read_b128 v[104:107], v31 offset:0
    ds_read_b128 v[108:111], v31 offset:1024
    ds_read_b128 v[112:115], v31 offset:2048
    v_cmp_gt_u32 vcc, 32, v1
    s_waitcnt lgkmcnt(2)
    buffer_store_dwordx4 v[104:107], v12, s[16:19], 0 offen
    s_waitcnt lgkmcnt(1)
    buffer_store_dwordx4 v[108:111], v13, s[16:19], 0 offen
    s_and_saveexec_b64 s[36:37], vcc
    s_waitcnt lgkmcnt(0)
    buffer_store_dwordx4 v[112:115], v14, s[16:19], 0 offen
    s_mov_b64 exec, s[36:37]
    v_add_f32 v20, v32, v33
    v_add_f32 v20, v20, v34
    v_add_f32 v20, v20, v35
    v_add_f32 v20, v20, v36
    v_add_f32 v20, v20, v37
    v_add_f32 v20, v20, v38
    v_add_f32 v20, v20, v39
    v_add_f32 v20, v20, v40
    v_add_f32 v20, v20, v41
    v_add_f32 v20, v20, v42
    v_add_f32 v20, v20, v43
    v_add_f32 v20, v20, v44
    v_add_f32 v20, v20, v45
    v_add_f32 v20, v20, v46
    v_add_f32 v20, v20, v47
    v_add_f32 v20, v20, v48
    v_add_f32 v20, v20, v49
    v_add_f32 v20, v20, v50
    v_add_f32 v20, v20, v51
    v_mov_b32 v22, v20
    s_nop 1
    v_permlane16_swap_b32 v20, v22
    v_add_f32 v20, v20, v22
    v_mov_b32 v22, v20
    s_nop 1
    v_permlane32_swap_b32 v20, v22
    v_add_f32 v20, v20, v22
    v_mul_f32 v23, 0x3c4ccccd, v20
    v_mov_b32 v21, 0
    v_sub_f32 v22, v32, v23
    v_fmac_f32 v21, v22, v22
    v_sub_f32 v22, v33, v23
    v_fmac_f32 v21, v22, v22
    v_sub_f32 v22, v34, v23
    v_fmac_f32 v21, v22, v22
    v_sub_f32 v22, v35, v23
    v_fmac_f32 v21, v22, v22
    v_sub_f32 v22, v36, v23
    v_fmac_f32 v21, v22, v22
    v_sub_f32 v22, v37, v23
    v_fmac_f32 v21, v22, v22
    v_sub_f32 v22, v38, v23
    v_fmac_f32 v21, v22, v22
    v_sub_f32 v22, v39, v23
    v_fmac_f32 v21, v22, v22
    v_sub_f32 v22, v40, v23
    v_fmac_f32 v21, v22, v22
    v_sub_f32 v22, v41, v23
    v_fmac_f32 v21, v22, v22
    v_sub_f32 v22, v42, v23
    v_fmac_f32 v21, v22, v22
    v_sub_f32 v22, v43, v23
    v_fmac_f32 v21, v22, v22
    v_sub_f32 v22, v44, v23
    v_fmac_f32 v21, v22, v22
    v_sub_f32 v22, v45, v23
    v_fmac_f32 v21, v22, v22
    v_sub_f32 v22, v46, v23
    v_fmac_f32 v21, v22, v22
    v_sub_f32 v22, v47, v23
    v_fmac_f32 v21, v22, v22
    v_sub_f32 v22, v48, v23
    v_fmac_f32 v21, v22, v22
    v_sub_f32 v22, v49, v23
    v_fmac_f32 v21, v22, v22
    v_sub_f32 v22, v50, v23
    v_fmac_f32 v21, v22, v22
    v_sub_f32 v22, v51, v23
    v_fmac_f32 v21, v22, v22
    v_mov_b32 v22, v21
    s_nop 1
    v_permlane16_swap_b32 v21, v22
    v_add_f32 v21, v21, v22
    v_mov_b32 v22, v21
    s_nop 1
    v_permlane32_swap_b32 v21, v22
    v_add_f32 v21, v21, v22
    v_lshlrev_b32 v28, 6, v28
    s_lshl_b32 s32, s27, 3
    v_add_u32 v28, s32, v28
    v_cmp_gt_u32 vcc, 16, v1
    s_and_saveexec_b64 s[36:37], vcc
    buffer_store_dwordx2 v[20:21], v28, s[20:23], 0 offen
    s_mov_b64 exec, s[36:37]
    s_waitcnt vmcnt(0)
    s_barrier
    s_lshr_b32 s32, s26, 1
    s_add_u32 s32, s32, 264
    s_and_b32 s33, s26, 1
    s_lshl_b32 s33, s33, 3
    s_add_u32 s33, s33, s27
    s_cmp_lg_u32 s29, 0
    s_cbranch_scc1 nosig_mega_kernel_37
    s_lshl_b32 s38, s32, 7
    s_lshl_b32 s39, s33, 2
    s_add_u32 s38, s38, s39
    v_mov_b32 v24, s38
    v_mov_b32 v23, 1
    v_cmp_eq_u32 vcc, 0, v1
    s_and_saveexec_b64 s[36:37], vcc
    s_cbranch_execz nosig2_mega_kernel_38
    buffer_store_dword v23, v24, s[92:95], 0 offen
nosig2_mega_kernel_38:
    s_mov_b64 exec, s[36:37]
nosig_mega_kernel_37:
    s_branch end_mega_kernel_25
loader_mega_kernel_24:
    s_lshl_b32 s32, s26, 6
    s_lshl_b32 s33, s28, 4
    s_add_u32 s32, s32, s33
    v_lshrrev_b32 v25, 4, v1
    v_and_b32 v26, 15, v1
    s_mov_b32 s33, 1536
    v_add_u32 v27, 0, v25
    v_xor_b32 v12, v26, v27
    v_add_u32 v27, s32, v27
    v_mul_u32_u24 v16, 48, v27
    v_add_u32 v27, 4, v25
    v_xor_b32 v13, v26, v27
    v_add_u32 v27, s32, v27
    v_mul_u32_u24 v17, 48, v27
    v_add_u32 v27, 8, v25
    v_xor_b32 v14, v26, v27
    v_add_u32 v27, s32, v27
    v_mul_u32_u24 v18, 48, v27
    v_add_u32 v27, 12, v25
    v_xor_b32 v15, v26, v27
    v_add_u32 v27, s32, v27
    v_mul_u32_u24 v19, 48, v27
    s_mov_b32 s39, 98304
    s_lshl_b32 s34, s28, 12
    s_add_u32 s76, s84, 0x2119000
    s_addc_u32 s77, s85, 0
    s_mov_b32 s78, 983040
    s_and_b32 s77, s77, 0xffff
    s_mov_b32 s79, 0x00020000
    s_lshr_b32 s82, s2, 5
    s_mul_i32 s82, s82, 122880
    s_mul_i32 s80, s28, 5120
    s_add_u32 s82, s82, s80
    v_lshlrev_b32 v8, 4, v1
    v_add_u32 v8, s82, v8
    v_add_u32 v9, 4096, v8
    s_barrier
    s_add_u32 m0, s34, 32768
    v_add_u32 v25, 0, v12
    v_mul_u32_u24 v26, 171, v25
    v_lshrrev_b32 v26, 9, v26
    v_mul_u32_u24 v27, 3, v26
    v_sub_u32 v27, v25, v27
    v_mul_lo_u32 v26, v26, s39
    v_lshl_add_u32 v26, v27, 4, v26
    v_add_u32 v2, v26, v16
    buffer_load_dwordx4 v2, s[4:7], 0 offen sc1 lds
    s_add_u32 m0, s34, 33792
    v_add_u32 v25, 0, v13
    v_mul_u32_u24 v26, 171, v25
    v_lshrrev_b32 v26, 9, v26
    v_mul_u32_u24 v27, 3, v26
    v_sub_u32 v27, v25, v27
    v_mul_lo_u32 v26, v26, s39
    v_lshl_add_u32 v26, v27, 4, v26
    v_add_u32 v3, v26, v17
    buffer_load_dwordx4 v3, s[4:7], 0 offen sc1 lds
    s_add_u32 m0, s34, 34816
    v_add_u32 v25, 0, v14
    v_mul_u32_u24 v26, 171, v25
    v_lshrrev_b32 v26, 9, v26
    v_mul_u32_u24 v27, 3, v26
    v_sub_u32 v27, v25, v27
    v_mul_lo_u32 v26, v26, s39
    v_lshl_add_u32 v26, v27, 4, v26
    v_add_u32 v4, v26, v18
    buffer_load_dwordx4 v4, s[4:7], 0 offen sc1 lds
    s_add_u32 m0, s34, 35840
    v_add_u32 v25, 0, v15
    v_mul_u32_u24 v26, 171, v25
    v_lshrrev_b32 v26, 9, v26
    v_mul_u32_u24 v27, 3, v26
    v_sub_u32 v27, v25, v27
    v_mul_lo_u32 v26, v26, s39
    v_lshl_add_u32 v26, v27, 4, v26
    v_add_u32 v5, v26, v19
    buffer_load_dwordx4 v5, s[4:7], 0 offen sc1 lds
    s_add_u32 m0, s34, 49152
    v_add_u32 v25, 16, v12
    v_mul_u32_u24 v26, 171, v25
    v_lshrrev_b32 v26, 9, v26
    v_mul_u32_u24 v27, 3, v26
    v_sub_u32 v27, v25, v27
    v_mul_lo_u32 v26, v26, s39
    v_lshl_add_u32 v26, v27, 4, v26
    v_add_u32 v2, v26, v16
    buffer_load_dwordx4 v2, s[4:7], 0 offen sc1 lds
    s_add_u32 m0, s34, 50176
    v_add_u32 v25, 16, v13
    v_mul_u32_u24 v26, 171, v25
    v_lshrrev_b32 v26, 9, v26
    v_mul_u32_u24 v27, 3, v26
    v_sub_u32 v27, v25, v27
    v_mul_lo_u32 v26, v26, s39
    v_lshl_add_u32 v26, v27, 4, v26
    v_add_u32 v3, v26, v17
    buffer_load_dwordx4 v3, s[4:7], 0 offen sc1 lds
    s_add_u32 m0, s34, 51200
    v_add_u32 v25, 16, v14
    v_mul_u32_u24 v26, 171, v25
    v_lshrrev_b32 v26, 9, v26
    v_mul_u32_u24 v27, 3, v26
    v_sub_u32 v27, v25, v27
    v_mul_lo_u32 v26, v26, s39
    v_lshl_add_u32 v26, v27, 4, v26
    v_add_u32 v4, v26, v18
    buffer_load_dwordx4 v4, s[4:7], 0 offen sc1 lds
    s_add_u32 m0, s34, 52224
    v_add_u32 v25, 16, v15
    v_mul_u32_u24 v26, 171, v25
    v_lshrrev_b32 v26, 9, v26
    v_mul_u32_u24 v27, 3, v26
    v_sub_u32 v27, v25, v27
    v_mul_lo_u32 v26, v26, s39
    v_lshl_add_u32 v26, v27, 4, v26
    v_add_u32 v5, v26, v19
    buffer_load_dwordx4 v5, s[4:7], 0 offen sc1 lds
    s_waitcnt vmcnt(4)
    s_barrier
    s_add_u32 m0, s34, 0
    v_add_u32 v25, 32, v12
    v_mul_u32_u24 v26, 171, v25
    v_lshrrev_b32 v26, 9, v26
    v_mul_u32_u24 v27, 3, v26
    v_sub_u32 v27, v25, v27
    v_mul_lo_u32 v26, v26, s39
    v_lshl_add_u32 v26, v27, 4, v26
    v_add_u32 v2, v26, v16
    buffer_load_dwordx4 v2, s[4:7], 0 offen sc1 lds
    s_add_u32 m0, s34, 1024
    v_add_u32 v25, 32, v13
    v_mul_u32_u24 v26, 171, v25
    v_lshrrev_b32 v26, 9, v26
    v_mul_u32_u24 v27, 3, v26
    v_sub_u32 v27, v25, v27
    v_mul_lo_u32 v26, v26, s39
    v_lshl_add_u32 v26, v27, 4, v26
    v_add_u32 v3, v26, v17
    buffer_load_dwordx4 v3, s[4:7], 0 offen sc1 lds
    s_add_u32 m0, s34, 2048
    v_add_u32 v25, 32, v14
    v_mul_u32_u24 v26, 171, v25
    v_lshrrev_b32 v26, 9, v26
    v_mul_u32_u24 v27, 3, v26
    v_sub_u32 v27, v25, v27
    v_mul_lo_u32 v26, v26, s39
    v_lshl_add_u32 v26, v27, 4, v26
    v_add_u32 v4, v26, v18
    buffer_load_dwordx4 v4, s[4:7], 0 offen sc1 lds
    s_add_u32 m0, s34, 3072
    v_add_u32 v25, 32, v15
    v_mul_u32_u24 v26, 171, v25
    v_lshrrev_b32 v26, 9, v26
    v_mul_u32_u24 v27, 3, v26
    v_sub_u32 v27, v25, v27
    v_mul_lo_u32 v26, v26, s39
    v_lshl_add_u32 v26, v27, 4, v26
    v_add_u32 v5, v26, v19
    buffer_load_dwordx4 v5, s[4:7], 0 offen sc1 lds
    s_add_u32 m0, s34, 16384
    v_add_u32 v25, 48, v12
    v_mul_u32_u24 v26, 171, v25
    v_lshrrev_b32 v26, 9, v26
    v_mul_u32_u24 v27, 3, v26
    v_sub_u32 v27, v25, v27
    v_mul_lo_u32 v26, v26, s39
    v_lshl_add_u32 v26, v27, 4, v26
    v_add_u32 v2, v26, v16
    buffer_load_dwordx4 v2, s[4:7], 0 offen sc1 lds
    s_add_u32 m0, s34, 17408
    v_add_u32 v25, 48, v13
    v_mul_u32_u24 v26, 171, v25
    v_lshrrev_b32 v26, 9, v26
    v_mul_u32_u24 v27, 3, v26
    v_sub_u32 v27, v25, v27
    v_mul_lo_u32 v26, v26, s39
    v_lshl_add_u32 v26, v27, 4, v26
    v_add_u32 v3, v26, v17
    buffer_load_dwordx4 v3, s[4:7], 0 offen sc1 lds
    s_add_u32 m0, s34, 18432
    v_add_u32 v25, 48, v14
    v_mul_u32_u24 v26, 171, v25
    v_lshrrev_b32 v26, 9, v26
    v_mul_u32_u24 v27, 3, v26
    v_sub_u32 v27, v25, v27
    v_mul_lo_u32 v26, v26, s39
    v_lshl_add_u32 v26, v27, 4, v26
    v_add_u32 v4, v26, v18
    buffer_load_dwordx4 v4, s[4:7], 0 offen sc1 lds
    s_add_u32 m0, s34, 19456
    v_add_u32 v25, 48, v15
    v_mul_u32_u24 v26, 171, v25
    v_lshrrev_b32 v26, 9, v26
    v_mul_u32_u24 v27, 3, v26
    v_sub_u32 v27, v25, v27
    v_mul_lo_u32 v26, v26, s39
    v_lshl_add_u32 v26, v27, 4, v26
    v_add_u32 v5, v26, v19
    buffer_load_dwordx4 v5, s[4:7], 0 offen sc1 lds
    s_waitcnt vmcnt(8)
    s_barrier
    s_add_u32 m0, s34, 32768
    v_add_u32 v25, 64, v12
    v_mul_u32_u24 v26, 171, v25
    v_lshrrev_b32 v26, 9, v26
    v_mul_u32_u24 v27, 3, v26
    v_sub_u32 v27, v25, v27
    v_mul_lo_u32 v26, v26, s39
    v_lshl_add_u32 v26, v27, 4, v26
    v_add_u32 v2, v26, v16
    buffer_load_dwordx4 v2, s[4:7], 0 offen sc1 lds
    s_add_u32 m0, s34, 33792
    v_add_u32 v25, 64, v13
    v_mul_u32_u24 v26, 171, v25
    v_lshrrev_b32 v26, 9, v26
    v_mul_u32_u24 v27, 3, v26
    v_sub_u32 v27, v25, v27
    v_mul_lo_u32 v26, v26, s39
    v_lshl_add_u32 v26, v27, 4, v26
    v_add_u32 v3, v26, v17
    buffer_load_dwordx4 v3, s[4:7], 0 offen sc1 lds
    s_add_u32 m0, s34, 34816
    v_add_u32 v25, 64, v14
    v_mul_u32_u24 v26, 171, v25
    v_lshrrev_b32 v26, 9, v26
    v_mul_u32_u24 v27, 3, v26
    v_sub_u32 v27, v25, v27
    v_mul_lo_u32 v26, v26, s39
    v_lshl_add_u32 v26, v27, 4, v26
    v_add_u32 v4, v26, v18
    buffer_load_dwordx4 v4, s[4:7], 0 offen sc1 lds
    s_add_u32 m0, s34, 35840
    v_add_u32 v25, 64, v15
    v_mul_u32_u24 v26, 171, v25
    v_lshrrev_b32 v26, 9, v26
    v_mul_u32_u24 v27, 3, v26
    v_sub_u32 v27, v25, v27
    v_mul_lo_u32 v26, v26, s39
    v_lshl_add_u32 v26, v27, 4, v26
    v_add_u32 v5, v26, v19
    buffer_load_dwordx4 v5, s[4:7], 0 offen sc1 lds
    s_add_u32 m0, s80, 114688
    s_mov_b32 s81, 81920
    buffer_load_dwordx4 v8, s[76:79], s81 offen offset:0 sc1 lds
    buffer_load_dwordx4 v8, s[76:79], s81 offen offset:1024 sc1 lds
    buffer_load_dwordx4 v8, s[76:79], s81 offen offset:2048 sc1 lds
    buffer_load_dwordx4 v8, s[76:79], s81 offen offset:3072 sc1 lds
    s_add_u32 m0, s80, 118784
    s_nop 0
    buffer_load_dwordx4 v9, s[76:79], s81 offen offset:0 sc1 lds
    s_waitcnt vmcnt(13)
    s_barrier
    s_add_u32 m0, s34, 49152
    v_add_u32 v25, 80, v12
    v_mul_u32_u24 v26, 171, v25
    v_lshrrev_b32 v26, 9, v26
    v_mul_u32_u24 v27, 3, v26
    v_sub_u32 v27, v25, v27
    v_mul_lo_u32 v26, v26, s39
    v_lshl_add_u32 v26, v27, 4, v26
    v_add_u32 v2, v26, v16
    buffer_load_dwordx4 v2, s[4:7], 0 offen sc1 lds
    s_add_u32 m0, s34, 50176
    v_add_u32 v25, 80, v13
    v_mul_u32_u24 v26, 171, v25
    v_lshrrev_b32 v26, 9, v26
    v_mul_u32_u24 v27, 3, v26
    v_sub_u32 v27, v25, v27
    v_mul_lo_u32 v26, v26, s39
    v_lshl_add_u32 v26, v27, 4, v26
    v_add_u32 v3, v26, v17
    buffer_load_dwordx4 v3, s[4:7], 0 offen sc1 lds
    s_add_u32 m0, s34, 51200
    v_add_u32 v25, 80, v14
    v_mul_u32_u24 v26, 171, v25
    v_lshrrev_b32 v26, 9, v26
    v_mul_u32_u24 v27, 3, v26
    v_sub_u32 v27, v25, v27
    v_mul_lo_u32 v26, v26, s39
    v_lshl_add_u32 v26, v27, 4, v26
    v_add_u32 v4, v26, v18
    buffer_load_dwordx4 v4, s[4:7], 0 offen sc1 lds
    s_add_u32 m0, s34, 52224
    v_add_u32 v25, 80, v15
    v_mul_u32_u24 v26, 171, v25
    v_lshrrev_b32 v26, 9, v26
    v_mul_u32_u24 v27, 3, v26
    v_sub_u32 v27, v25, v27
    v_mul_lo_u32 v26, v26, s39
    v_lshl_add_u32 v26, v27, 4, v26
    v_add_u32 v5, v26, v19
    buffer_load_dwordx4 v5, s[4:7], 0 offen sc1 lds
    s_add_u32 m0, s80, 139264
    s_mov_b32 s81, 102400
    buffer_load_dwordx4 v8, s[76:79], s81 offen offset:0 sc1 lds
    buffer_load_dwordx4 v8, s[76:79], s81 offen offset:1024 sc1 lds
    buffer_load_dwordx4 v8, s[76:79], s81 offen offset:2048 sc1 lds
    buffer_load_dwordx4 v8, s[76:79], s81 offen offset:3072 sc1 lds
    s_add_u32 m0, s80, 143360
    s_nop 0
    buffer_load_dwordx4 v9, s[76:79], s81 offen offset:0 sc1 lds
    s_waitcnt vmcnt(18)
    s_barrier
    s_waitcnt vmcnt(9)
    s_barrier
    s_waitcnt vmcnt(0)
    s_barrier
    s_add_u32 s76, s84, 0x1d59000
    s_addc_u32 s77, s85, 0
    s_mov_b32 s78, 3932160
    s_and_b32 s77, s77, 0xffff
    s_mov_b32 s79, 0x00020000
    s_lshr_b32 s82, s2, 4
    s_mul_i32 s82, s82, 245760
    s_mul_i32 s80, s28, 6144
    s_add_u32 s82, s82, s80
    v_lshlrev_b32 v8, 4, v1
    v_add_u32 v8, s82, v8
    v_add_u32 v9, 4096, v8
    s_add_u32 m0, s80, 65536
    s_mov_b32 s81, 0
    buffer_load_dwordx4 v8, s[76:79], s81 offen offset:0 sc1 lds
    buffer_load_dwordx4 v8, s[76:79], s81 offen offset:1024 sc1 lds
    buffer_load_dwordx4 v8, s[76:79], s81 offen offset:2048 sc1 lds
    buffer_load_dwordx4 v8, s[76:79], s81 offen offset:3072 sc1 lds
    s_add_u32 m0, s80, 69632
    s_nop 0
    buffer_load_dwordx4 v9, s[76:79], s81 offen offset:0 sc1 lds
    buffer_load_dwordx4 v9, s[76:79], s81 offen offset:1024 sc1 lds
    s_add_u32 m0, s80, 90112
    s_mov_b32 s81, 24576
    buffer_load_dwordx4 v8, s[76:79], s81 offen offset:0 sc1 lds
    buffer_load_dwordx4 v8, s[76:79], s81 offen offset:1024 sc1 lds
    buffer_load_dwordx4 v8, s[76:79], s81 offen offset:2048 sc1 lds
    buffer_load_dwordx4 v8, s[76:79], s81 offen offset:3072 sc1 lds
    s_add_u32 m0, s80, 94208
    s_nop 0
    buffer_load_dwordx4 v9, s[76:79], s81 offen offset:0 sc1 lds
    buffer_load_dwordx4 v9, s[76:79], s81 offen offset:1024 sc1 lds
    s_add_u32 m0, s80, 114688
    s_mov_b32 s81, 49152
    buffer_load_dwordx4 v8, s[76:79], s81 offen offset:0 sc1 lds
    buffer_load_dwordx4 v8, s[76:79], s81 offen offset:1024 sc1 lds
    buffer_load_dwordx4 v8, s[76:79], s81 offen offset:2048 sc1 lds
    buffer_load_dwordx4 v8, s[76:79], s81 offen offset:3072 sc1 lds
    s_add_u32 m0, s80, 118784
    s_nop 0
    buffer_load_dwordx4 v9, s[76:79], s81 offen offset:0 sc1 lds
    buffer_load_dwordx4 v9, s[76:79], s81 offen offset:1024 sc1 lds
    s_barrier
    s_add_u32 m0, s80, 139264
    s_mov_b32 s81, 73728
    buffer_load_dwordx4 v8, s[76:79], s81 offen offset:0 sc1 lds
    buffer_load_dwordx4 v8, s[76:79], s81 offen offset:1024 sc1 lds
    buffer_load_dwordx4 v8, s[76:79], s81 offen offset:2048 sc1 lds
    buffer_load_dwordx4 v8, s[76:79], s81 offen offset:3072 sc1 lds
    s_add_u32 m0, s80, 143360
    s_nop 0
    buffer_load_dwordx4 v9, s[76:79], s81 offen offset:0 sc1 lds
    buffer_load_dwordx4 v9, s[76:79], s81 offen offset:1024 sc1 lds
    s_barrier
    s_barrier
end_mega_kernel_25:
    s_and_b32 s24, s2, 7
    s_lshr_b32 s25, s2, 3
    s_lshl_b32 s26, s24, 1
    s_and_b32 s27, s25, 1
    s_add_u32 s26, s26, s27
    s_lshr_b32 s27, s25, 1
    s_add_u32 s4, s84, 0x59000
    s_addc_u32 s5, s85, 0
    s_mov_b32 s6, 2621440
    s_and_b32 s5, s5, 0xffff
    s_mov_b32 s7, 0x00020000
    s_add_u32 s16, s84, 0x5d9000
    s_addc_u32 s17, s85, 0
    s_mov_b32 s18, 6291456
    s_and_b32 s17, s17, 0xffff
    s_mov_b32 s19, 0x00020000
    s_add_u32 s20, s84, 0x39000
    s_addc_u32 s21, s85, 0
    s_mov_b32 s22, 131072
    s_and_b32 s21, s21, 0xffff
    s_mov_b32 s23, 0x00020000
    s_add_u32 s68, s84, 0x14000
    s_addc_u32 s69, s85, 0
    s_mov_b32 s70, 20480
    s_and_b32 s69, s69, 0xffff
    s_mov_b32 s71, 0x00020000
    s_cmp_ge_u32 s29, 4
    s_cbranch_scc1 loader_mega_kernel_39
    v_and_b32 v25, 31, v1
    s_lshl_b32 s32, s26, 7
    s_lshl_b32 s33, s29, 5
    s_add_u32 s32, s32, s33
    v_add_u32 v28, s32, v25
    v_lshlrev_b32 v29, 6, v28
    v_lshrrev_b32 v30, 5, v1
    v_lshlrev_b32 v30, 4, v30
    s_mul_i32 s32, s27, 384
    s_add_u32 s32, s32, 8192
    v_add_u32 v30, s32, v30
    s_lshl_b32 s32, s29, 5
    v_add_u32 v26, s32, v25
    v_lshlrev_b32 v26, 7, v26
    v_lshrrev_b32 v25, 1, v25
    v_and_b32 v25, 7, v25
    v_lshrrev_b32 v27, 5, v1
    v_xor_b32 v25, v25, v27
    v_xor_b32 v27, 0, v25
    v_lshl_add_u32 v10, v27, 4, v26
    v_add_u32 v10, 0, v10
    v_xor_b32 v27, 2, v25
    v_lshl_add_u32 v11, v27, 4, v26
    v_add_u32 v11, 0, v11
    v_xor_b32 v27, 4, v25
    v_lshl_add_u32 v12, v27, 4, v26
    v_add_u32 v12, 0, v12
    v_xor_b32 v27, 6, v25
    v_lshl_add_u32 v13, v27, 4, v26
    v_add_u32 v13, 0, v13
    v_lshrrev_b32 v25, 5, v1
    v_lshlrev_b32 v25, 3, v25
    v_bfe_u32 v26, v1, 2, 2
    v_add_u32 v25, v25, v26
    v_mul_u32_u24 v25, 192, v25
    v_bfe_u32 v27, v1, 4, 1
    v_lshl_add_u32 v25, v27, 5, v25
    v_and_b32 v27, 3, v1
    v_lshl_add_u32 v25, v27, 3, v25
    v_add_u32 v14, 65536, v25
    v_mov_b32 v88, 0
    v_mov_b32 v89, 0
    v_mov_b32 v90, 0
    v_mov_b32 v91, 0
    v_mov_b32 v92, 0
    v_mov_b32 v93, 0
    v_mov_b32 v94, 0
    v_mov_b32 v95, 0
    v_mov_b32 v96, 0
    v_mov_b32 v97, 0
    v_mov_b32 v98, 0
    v_mov_b32 v99, 0
    v_mov_b32 v100, 0
    v_mov_b32 v101, 0
    v_mov_b32 v102, 0
    v_mov_b32 v103, 0
    v_mov_b32 v104, 0
    v_mov_b32 v105, 0
    v_mov_b32 v106, 0
    v_mov_b32 v107, 0
    v_mov_b32 v108, 0
    v_mov_b32 v109, 0
    v_mov_b32 v110, 0
    v_mov_b32 v111, 0
    v_mov_b32 v112, 0
    v_mov_b32 v113, 0
    v_mov_b32 v114, 0
    v_mov_b32 v115, 0
    v_mov_b32 v116, 0
    v_mov_b32 v117, 0
    v_mov_b32 v118, 0
    v_mov_b32 v119, 0
    v_mov_b32 v120, 0
    v_mov_b32 v121, 0
    v_mov_b32 v122, 0
    v_mov_b32 v123, 0
    v_mov_b32 v124, 0
    v_mov_b32 v125, 0
    v_mov_b32 v126, 0
    v_mov_b32 v127, 0
    v_mov_b32 v128, 0
    v_mov_b32 v129, 0
    v_mov_b32 v130, 0
    v_mov_b32 v131, 0
    v_mov_b32 v132, 0
    v_mov_b32 v133, 0
    v_mov_b32 v134, 0
    v_mov_b32 v135, 0
    v_mov_b32 v136, 0
    v_mov_b32 v137, 0
    v_mov_b32 v138, 0
    v_mov_b32 v139, 0
    v_mov_b32 v140, 0
    v_mov_b32 v141, 0
    v_mov_b32 v142, 0
    v_mov_b32 v143, 0
    v_mov_b32 v144, 0
    v_mov_b32 v145, 0
    v_mov_b32 v146, 0
    v_mov_b32 v147, 0
    v_mov_b32 v148, 0
    v_mov_b32 v149, 0
    v_mov_b32 v150, 0
    v_mov_b32 v151, 0
    v_mov_b32 v152, 0
    v_mov_b32 v153, 0
    v_mov_b32 v154, 0
    v_mov_b32 v155, 0
    v_mov_b32 v156, 0
    v_mov_b32 v157, 0
    v_mov_b32 v158, 0
    v_mov_b32 v159, 0
    v_mov_b32 v160, 0
    v_mov_b32 v161, 0
    v_mov_b32 v162, 0
    v_mov_b32 v163, 0
    v_mov_b32 v164, 0
    v_mov_b32 v165, 0
    v_mov_b32 v166, 0
    v_mov_b32 v167, 0
    v_mov_b32 v168, 0
    v_mov_b32 v169, 0
    v_mov_b32 v170, 0
    v_mov_b32 v171, 0
    v_mov_b32 v172, 0
    v_mov_b32 v173, 0
    v_mov_b32 v174, 0
    v_mov_b32 v175, 0
    v_mov_b32 v176, 0
    v_mov_b32 v177, 0
    v_mov_b32 v178, 0
    v_mov_b32 v179, 0
    v_mov_b32 v180, 0
    v_mov_b32 v181, 0
    v_mov_b32 v182, 0
    v_mov_b32 v183, 0
    v_add_u32 v31, 6144, v30
    v_mul_u32_u24 v26, 3072, v28
    s_mul_i32 s32, s27, 192
    v_add_u32 v26, s32, v26
    v_lshrrev_b32 v27, 5, v1
    v_lshl_add_u32 v26, v27, 7, v26
    buffer_load_dword v252, v26, s[16:19], 0 offen
    buffer_load_dword v253, v26, s[16:19], 0 offen offset:60
    s_cmp_lg_u32 s29, 3
    s_cbranch_scc1 pok_mega_kernel_42
    s_add_u32 s38, s26, 264
    s_lshl_b32 s38, s38, 7
    v_and_b32 v24, 15, v1
    v_lshlrev_b32 v24, 2, v24
    v_add_u32 v24, s38, v24
    s_mov_b32 s38, 0
    buffer_load_dword v21, v24, s[92:95], 0 offen sc1
    s_sleep 3
    buffer_load_dword v22, v24, s[92:95], 0 offen sc1
    s_sleep 3
poll_mega_kernel_41:
    buffer_load_dword v23, v24, s[92:95], 0 offen sc1
    s_waitcnt vmcnt(2)
    v_cmp_gt_u32 vcc, 1, v21
    s_nop 4
    s_cbranch_vccz pok_mega_kernel_42
    s_sleep 2
    buffer_load_dword v21, v24, s[92:95], 0 offen sc1
    s_waitcnt vmcnt(2)
    v_cmp_gt_u32 vcc, 1, v22
    s_nop 4
    s_cbranch_vccz pok_mega_kernel_42
    s_sleep 2
    buffer_load_dword v22, v24, s[92:95], 0 offen sc1
    s_waitcnt vmcnt(2)
    v_cmp_gt_u32 vcc, 1, v23
    s_nop 4
    s_cbranch_vccz pok_mega_kernel_42
    s_sleep 2
    s_add_u32 s38, s38, 1
    s_cmp_gt_u32 s38, 4000
    s_cbranch_scc0 poll_mega_kernel_41
pok_mega_kernel_42:
    s_barrier
    buffer_load_dwordx4 v[188:191], v30, s[68:71], 0 offen offset:0 sc1
    buffer_load_dwordx4 v[192:195], v30, s[68:71], 0 offen offset:32 sc1
    buffer_load_dwordx4 v[196:199], v30, s[68:71], 0 offen offset:64 sc1
    buffer_load_dwordx4 v[200:203], v30, s[68:71], 0 offen offset:96 sc1
    buffer_load_dwordx4 v[204:207], v31, s[68:71], 0 offen offset:0 sc1
    buffer_load_dwordx4 v[208:211], v31, s[68:71], 0 offen offset:32 sc1
    buffer_load_dwordx4 v[212:215], v31, s[68:71], 0 offen offset:64 sc1
    buffer_load_dwordx4 v[216:219], v31, s[68:71], 0 offen offset:96 sc1
    buffer_load_dwordx4 v[220:223], v30, s[68:71], 0 offen offset:128 sc1
    buffer_load_dwordx4 v[224:227], v30, s[68:71], 0 offen offset:160 sc1
    buffer_load_dwordx4 v[228:231], v30, s[68:71], 0 offen offset:192 sc1
    buffer_load_dwordx4 v[232:235], v30, s[68:71], 0 offen offset:224 sc1
    buffer_load_dwordx4 v[236:239], v29, s[20:23], 0 offen offset:0 sc1
    buffer_load_dwordx4 v[240:243], v29, s[20:23], 0 offen offset:16 sc1
    buffer_load_dwordx4 v[244:247], v29, s[20:23], 0 offen offset:32 sc1
    buffer_load_dwordx4 v[248:251], v29, s[20:23], 0 offen offset:48 sc1
    s_barrier
    ds_read_b128 v[32:35], v10
    ds_read_b64_tr_b16 v[36:37], v14 offset:0
    ds_read_b64_tr_b16 v[38:39], v14 offset:768
    ds_read_b64_tr_b16 v[40:41], v14 offset:64
    ds_read_b64_tr_b16 v[42:43], v14 offset:832
    ds_read_b64_tr_b16 v[44:45], v14 offset:128
    ds_read_b64_tr_b16 v[46:47], v14 offset:896
    ds_read_b64_tr_b16 v[48:49], v14 offset:12288
    ds_read_b64_tr_b16 v[50:51], v14 offset:13056
    ds_read_b64_tr_b16 v[52:53], v14 offset:12352
    ds_read_b64_tr_b16 v[54:55], v14 offset:13120
    ds_read_b64_tr_b16 v[56:57], v14 offset:12416
    ds_read_b64_tr_b16 v[58:59], v14 offset:13184
    s_waitcnt lgkmcnt(0)
    v_mfma_f32_32x32x16_bf16 v[88:103], v[36:39], v[32:35], v[88:103]
    ds_read_b128 v[60:63], v11
    ds_read_b64_tr_b16 v[64:65], v14 offset:3072
    ds_read_b64_tr_b16 v[66:67], v14 offset:3840
    ds_read_b64_tr_b16 v[68:69], v14 offset:3136
    ds_read_b64_tr_b16 v[70:71], v14 offset:3904
    v_mfma_f32_32x32x16_bf16 v[104:119], v[40:43], v[32:35], v[104:119]
    ds_read_b64_tr_b16 v[72:73], v14 offset:3200
    ds_read_b64_tr_b16 v[74:75], v14 offset:3968
    ds_read_b64_tr_b16 v[76:77], v14 offset:15360
    ds_read_b64_tr_b16 v[78:79], v14 offset:16128
    v_mfma_f32_32x32x16_bf16 v[120:135], v[44:47], v[32:35], v[120:135]
    ds_read_b64_tr_b16 v[80:81], v14 offset:15424
    ds_read_b64_tr_b16 v[82:83], v14 offset:16192
    ds_read_b64_tr_b16 v[84:85], v14 offset:15488
    ds_read_b64_tr_b16 v[86:87], v14 offset:16256
    v_mfma_f32_32x32x16_bf16 v[136:151], v[48:51], v[32:35], v[136:151]
    v_mfma_f32_32x32x16_bf16 v[152:167], v[52:55], v[32:35], v[152:167]
    v_mfma_f32_32x32x16_bf16 v[168:183], v[56:59], v[32:35], v[168:183]
    s_waitcnt lgkmcnt(0)
    v_mfma_f32_32x32x16_bf16 v[88:103], v[64:67], v[60:63], v[88:103]
    ds_read_b128 v[32:35], v12
    ds_read_b64_tr_b16 v[36:37], v14 offset:6144
    ds_read_b64_tr_b16 v[38:39], v14 offset:6912
    ds_read_b64_tr_b16 v[40:41], v14 offset:6208
    ds_read_b64_tr_b16 v[42:43], v14 offset:6976
    v_mfma_f32_32x32x16_bf16 v[104:119], v[68:71], v[60:63], v[104:119]
    ds_read_b64_tr_b16 v[44:45], v14 offset:6272
    ds_read_b64_tr_b16 v[46:47], v14 offset:7040
    ds_read_b64_tr_b16 v[48:49], v14 offset:18432
    ds_read_b64_tr_b16 v[50:51], v14 offset:19200
    v_mfma_f32_32x32x16_bf16 v[120:135], v[72:75], v[60:63], v[120:135]
    ds_read_b64_tr_b16 v[52:53], v14 offset:18496
    ds_read_b64_tr_b16 v[54:55], v14 offset:19264
    ds_read_b64_tr_b16 v[56:57], v14 offset:18560
    ds_read_b64_tr_b16 v[58:59], v14 offset:19328
    v_mfma_f32_32x32x16_bf16 v[136:151], v[76:79], v[60:63], v[136:151]
    v_mfma_f32_32x32x16_bf16 v[152:167], v[80:83], v[60:63], v[152:167]
    v_mfma_f32_32x32x16_bf16 v[168:183], v[84:87], v[60:63], v[168:183]
    s_waitcnt lgkmcnt(0)
    v_mfma_f32_32x32x16_bf16 v[88:103], v[36:39], v[32:35], v[88:103]
    ds_read_b128 v[60:63], v13
    ds_read_b64_tr_b16 v[64:65], v14 offset:9216
    ds_read_b64_tr_b16 v[66:67], v14 offset:9984
    ds_read_b64_tr_b16 v[68:69], v14 offset:9280
    ds_read_b64_tr_b16 v[70:71], v14 offset:10048
    v_mfma_f32_32x32x16_bf16 v[104:119], v[40:43], v[32:35], v[104:119]
    ds_read_b64_tr_b16 v[72:73], v14 offset:9344
    ds_read_b64_tr_b16 v[74:75], v14 offset:10112
    ds_read_b64_tr_b16 v[76:77], v14 offset:21504
    ds_read_b64_tr_b16 v[78:79], v14 offset:22272
    v_mfma_f32_32x32x16_bf16 v[120:135], v[44:47], v[32:35], v[120:135]
    ds_read_b64_tr_b16 v[80:81], v14 offset:21568
    ds_read_b64_tr_b16 v[82:83], v14 offset:22336
    ds_read_b64_tr_b16 v[84:85], v14 offset:21632
    ds_read_b64_tr_b16 v[86:87], v14 offset:22400
    v_mfma_f32_32x32x16_bf16 v[136:151], v[48:51], v[32:35], v[136:151]
    v_mfma_f32_32x32x16_bf16 v[152:167], v[52:55], v[32:35], v[152:167]
    v_mfma_f32_32x32x16_bf16 v[168:183], v[56:59], v[32:35], v[168:183]
    s_waitcnt lgkmcnt(0)
    v_mfma_f32_32x32x16_bf16 v[88:103], v[64:67], v[60:63], v[88:103]
    s_barrier
    v_add_u32 v10, 0x4000, v10
    v_add_u32 v11, 0x4000, v11
    v_add_u32 v12, 0x4000, v12
    v_add_u32 v13, 0x4000, v13
    v_add_u32 v14, 0x6000, v14
    v_mfma_f32_32x32x16_bf16 v[104:119], v[68:71], v[60:63], v[104:119]
    ds_read_b128 v[32:35], v10
    ds_read_b64_tr_b16 v[36:37], v14 offset:0
    ds_read_b64_tr_b16 v[38:39], v14 offset:768
    ds_read_b64_tr_b16 v[40:41], v14 offset:64
    ds_read_b64_tr_b16 v[42:43], v14 offset:832
    v_mfma_f32_32x32x16_bf16 v[120:135], v[72:75], v[60:63], v[120:135]
    ds_read_b64_tr_b16 v[44:45], v14 offset:128
    ds_read_b64_tr_b16 v[46:47], v14 offset:896
    ds_read_b64_tr_b16 v[48:49], v14 offset:12288
    ds_read_b64_tr_b16 v[50:51], v14 offset:13056
    v_mfma_f32_32x32x16_bf16 v[136:151], v[76:79], v[60:63], v[136:151]
    ds_read_b64_tr_b16 v[52:53], v14 offset:12352
    ds_read_b64_tr_b16 v[54:55], v14 offset:13120
    ds_read_b64_tr_b16 v[56:57], v14 offset:12416
    ds_read_b64_tr_b16 v[58:59], v14 offset:13184
    v_mfma_f32_32x32x16_bf16 v[152:167], v[80:83], v[60:63], v[152:167]
    v_mfma_f32_32x32x16_bf16 v[168:183], v[84:87], v[60:63], v[168:183]
    s_waitcnt lgkmcnt(0)
    v_mfma_f32_32x32x16_bf16 v[88:103], v[36:39], v[32:35], v[88:103]
    ds_read_b128 v[60:63], v11
    ds_read_b64_tr_b16 v[64:65], v14 offset:3072
    ds_read_b64_tr_b16 v[66:67], v14 offset:3840
    ds_read_b64_tr_b16 v[68:69], v14 offset:3136
    ds_read_b64_tr_b16 v[70:71], v14 offset:3904
    v_mfma_f32_32x32x16_bf16 v[104:119], v[40:43], v[32:35], v[104:119]
    ds_read_b64_tr_b16 v[72:73], v14 offset:3200
    ds_read_b64_tr_b16 v[74:75], v14 offset:3968
    ds_read_b64_tr_b16 v[76:77], v14 offset:15360
    ds_read_b64_tr_b16 v[78:79], v14 offset:16128
    v_mfma_f32_32x32x16_bf16 v[120:135], v[44:47], v[32:35], v[120:135]
    ds_read_b64_tr_b16 v[80:81], v14 offset:15424
    ds_read_b64_tr_b16 v[82:83], v14 offset:16192
    ds_read_b64_tr_b16 v[84:85], v14 offset:15488
    ds_read_b64_tr_b16 v[86:87], v14 offset:16256
    v_mfma_f32_32x32x16_bf16 v[136:151], v[48:51], v[32:35], v[136:151]
    v_mfma_f32_32x32x16_bf16 v[152:167], v[52:55], v[32:35], v[152:167]
    v_mfma_f32_32x32x16_bf16 v[168:183], v[56:59], v[32:35], v[168:183]
    s_waitcnt lgkmcnt(0)
    v_mfma_f32_32x32x16_bf16 v[88:103], v[64:67], v[60:63], v[88:103]
    ds_read_b128 v[32:35], v12
    ds_read_b64_tr_b16 v[36:37], v14 offset:6144
    ds_read_b64_tr_b16 v[38:39], v14 offset:6912
    ds_read_b64_tr_b16 v[40:41], v14 offset:6208
    ds_read_b64_tr_b16 v[42:43], v14 offset:6976
    v_mfma_f32_32x32x16_bf16 v[104:119], v[68:71], v[60:63], v[104:119]
    ds_read_b64_tr_b16 v[44:45], v14 offset:6272
    ds_read_b64_tr_b16 v[46:47], v14 offset:7040
    ds_read_b64_tr_b16 v[48:49], v14 offset:18432
    ds_read_b64_tr_b16 v[50:51], v14 offset:19200
    v_mfma_f32_32x32x16_bf16 v[120:135], v[72:75], v[60:63], v[120:135]
    ds_read_b64_tr_b16 v[52:53], v14 offset:18496
    ds_read_b64_tr_b16 v[54:55], v14 offset:19264
    ds_read_b64_tr_b16 v[56:57], v14 offset:18560
    ds_read_b64_tr_b16 v[58:59], v14 offset:19328
    v_mfma_f32_32x32x16_bf16 v[136:151], v[76:79], v[60:63], v[136:151]
    v_mfma_f32_32x32x16_bf16 v[152:167], v[80:83], v[60:63], v[152:167]
    v_mfma_f32_32x32x16_bf16 v[168:183], v[84:87], v[60:63], v[168:183]
    s_waitcnt lgkmcnt(0)
    v_mfma_f32_32x32x16_bf16 v[88:103], v[36:39], v[32:35], v[88:103]
    ds_read_b128 v[60:63], v13
    ds_read_b64_tr_b16 v[64:65], v14 offset:9216
    ds_read_b64_tr_b16 v[66:67], v14 offset:9984
    ds_read_b64_tr_b16 v[68:69], v14 offset:9280
    ds_read_b64_tr_b16 v[70:71], v14 offset:10048
    v_mfma_f32_32x32x16_bf16 v[104:119], v[40:43], v[32:35], v[104:119]
    ds_read_b64_tr_b16 v[72:73], v14 offset:9344
    ds_read_b64_tr_b16 v[74:75], v14 offset:10112
    ds_read_b64_tr_b16 v[76:77], v14 offset:21504
    ds_read_b64_tr_b16 v[78:79], v14 offset:22272
    v_mfma_f32_32x32x16_bf16 v[120:135], v[44:47], v[32:35], v[120:135]
    ds_read_b64_tr_b16 v[80:81], v14 offset:21568
    ds_read_b64_tr_b16 v[82:83], v14 offset:22336
    ds_read_b64_tr_b16 v[84:85], v14 offset:21632
    ds_read_b64_tr_b16 v[86:87], v14 offset:22400
    v_mfma_f32_32x32x16_bf16 v[136:151], v[48:51], v[32:35], v[136:151]
    v_mfma_f32_32x32x16_bf16 v[152:167], v[52:55], v[32:35], v[152:167]
    v_mfma_f32_32x32x16_bf16 v[168:183], v[56:59], v[32:35], v[168:183]
    s_waitcnt lgkmcnt(0)
    v_mfma_f32_32x32x16_bf16 v[88:103], v[64:67], v[60:63], v[88:103]
    s_barrier
    v_add_u32 v10, 0x4000, v10
    v_add_u32 v11, 0x4000, v11
    v_add_u32 v12, 0x4000, v12
    v_add_u32 v13, 0x4000, v13
    v_add_u32 v14, 0x6000, v14
    v_mfma_f32_32x32x16_bf16 v[104:119], v[68:71], v[60:63], v[104:119]
    ds_read_b128 v[32:35], v10
    ds_read_b64_tr_b16 v[36:37], v14 offset:0
    ds_read_b64_tr_b16 v[38:39], v14 offset:768
    ds_read_b64_tr_b16 v[40:41], v14 offset:64
    ds_read_b64_tr_b16 v[42:43], v14 offset:832
    v_mfma_f32_32x32x16_bf16 v[120:135], v[72:75], v[60:63], v[120:135]
    ds_read_b64_tr_b16 v[44:45], v14 offset:128
    ds_read_b64_tr_b16 v[46:47], v14 offset:896
    ds_read_b64_tr_b16 v[48:49], v14 offset:12288
    ds_read_b64_tr_b16 v[50:51], v14 offset:13056
    v_mfma_f32_32x32x16_bf16 v[136:151], v[76:79], v[60:63], v[136:151]
    ds_read_b64_tr_b16 v[52:53], v14 offset:12352
    ds_read_b64_tr_b16 v[54:55], v14 offset:13120
    ds_read_b64_tr_b16 v[56:57], v14 offset:12416
    ds_read_b64_tr_b16 v[58:59], v14 offset:13184
    v_mfma_f32_32x32x16_bf16 v[152:167], v[80:83], v[60:63], v[152:167]
    v_mfma_f32_32x32x16_bf16 v[168:183], v[84:87], v[60:63], v[168:183]
    s_waitcnt lgkmcnt(0)
    v_mfma_f32_32x32x16_bf16 v[88:103], v[36:39], v[32:35], v[88:103]
    ds_read_b128 v[60:63], v11
    ds_read_b64_tr_b16 v[64:65], v14 offset:3072
    ds_read_b64_tr_b16 v[66:67], v14 offset:3840
    ds_read_b64_tr_b16 v[68:69], v14 offset:3136
    ds_read_b64_tr_b16 v[70:71], v14 offset:3904
    v_mfma_f32_32x32x16_bf16 v[104:119], v[40:43], v[32:35], v[104:119]
    ds_read_b64_tr_b16 v[72:73], v14 offset:3200
    ds_read_b64_tr_b16 v[74:75], v14 offset:3968
    ds_read_b64_tr_b16 v[76:77], v14 offset:15360
    ds_read_b64_tr_b16 v[78:79], v14 offset:16128
    v_mfma_f32_32x32x16_bf16 v[120:135], v[44:47], v[32:35], v[120:135]
    ds_read_b64_tr_b16 v[80:81], v14 offset:15424
    ds_read_b64_tr_b16 v[82:83], v14 offset:16192
    ds_read_b64_tr_b16 v[84:85], v14 offset:15488
    ds_read_b64_tr_b16 v[86:87], v14 offset:16256
    v_mfma_f32_32x32x16_bf16 v[136:151], v[48:51], v[32:35], v[136:151]
    v_mfma_f32_32x32x16_bf16 v[152:167], v[52:55], v[32:35], v[152:167]
    v_mfma_f32_32x32x16_bf16 v[168:183], v[56:59], v[32:35], v[168:183]
    s_waitcnt lgkmcnt(0)
    v_mfma_f32_32x32x16_bf16 v[88:103], v[64:67], v[60:63], v[88:103]
    ds_read_b128 v[32:35], v12
    ds_read_b64_tr_b16 v[36:37], v14 offset:6144
    ds_read_b64_tr_b16 v[38:39], v14 offset:6912
    ds_read_b64_tr_b16 v[40:41], v14 offset:6208
    ds_read_b64_tr_b16 v[42:43], v14 offset:6976
    v_mfma_f32_32x32x16_bf16 v[104:119], v[68:71], v[60:63], v[104:119]
    ds_read_b64_tr_b16 v[44:45], v14 offset:6272
    ds_read_b64_tr_b16 v[46:47], v14 offset:7040
    ds_read_b64_tr_b16 v[48:49], v14 offset:18432
    ds_read_b64_tr_b16 v[50:51], v14 offset:19200
    v_mfma_f32_32x32x16_bf16 v[120:135], v[72:75], v[60:63], v[120:135]
    ds_read_b64_tr_b16 v[52:53], v14 offset:18496
    ds_read_b64_tr_b16 v[54:55], v14 offset:19264
    ds_read_b64_tr_b16 v[56:57], v14 offset:18560
    ds_read_b64_tr_b16 v[58:59], v14 offset:19328
    v_mfma_f32_32x32x16_bf16 v[136:151], v[76:79], v[60:63], v[136:151]
    v_mfma_f32_32x32x16_bf16 v[152:167], v[80:83], v[60:63], v[152:167]
    v_mfma_f32_32x32x16_bf16 v[168:183], v[84:87], v[60:63], v[168:183]
    s_waitcnt lgkmcnt(0)
    v_mfma_f32_32x32x16_bf16 v[88:103], v[36:39], v[32:35], v[88:103]
    ds_read_b128 v[60:63], v13
    ds_read_b64_tr_b16 v[64:65], v14 offset:9216
    ds_read_b64_tr_b16 v[66:67], v14 offset:9984
    ds_read_b64_tr_b16 v[68:69], v14 offset:9280
    ds_read_b64_tr_b16 v[70:71], v14 offset:10048
    v_mfma_f32_32x32x16_bf16 v[104:119], v[40:43], v[32:35], v[104:119]
    ds_read_b64_tr_b16 v[72:73], v14 offset:9344
    ds_read_b64_tr_b16 v[74:75], v14 offset:10112
    ds_read_b64_tr_b16 v[76:77], v14 offset:21504
    ds_read_b64_tr_b16 v[78:79], v14 offset:22272
    v_mfma_f32_32x32x16_bf16 v[120:135], v[44:47], v[32:35], v[120:135]
    ds_read_b64_tr_b16 v[80:81], v14 offset:21568
    ds_read_b64_tr_b16 v[82:83], v14 offset:22336
    ds_read_b64_tr_b16 v[84:85], v14 offset:21632
    ds_read_b64_tr_b16 v[86:87], v14 offset:22400
    v_mfma_f32_32x32x16_bf16 v[136:151], v[48:51], v[32:35], v[136:151]
    v_mfma_f32_32x32x16_bf16 v[152:167], v[52:55], v[32:35], v[152:167]
    v_mfma_f32_32x32x16_bf16 v[168:183], v[56:59], v[32:35], v[168:183]
    s_waitcnt lgkmcnt(0)
    v_mfma_f32_32x32x16_bf16 v[88:103], v[64:67], v[60:63], v[88:103]
    s_barrier
    v_add_u32 v10, 0x4000, v10
    v_add_u32 v11, 0x4000, v11
    v_add_u32 v12, 0x4000, v12
    v_add_u32 v13, 0x4000, v13
    v_add_u32 v14, 0x6000, v14
    v_mfma_f32_32x32x16_bf16 v[104:119], v[68:71], v[60:63], v[104:119]
    ds_read_b128 v[32:35], v10
    ds_read_b64_tr_b16 v[36:37], v14 offset:0
    ds_read_b64_tr_b16 v[38:39], v14 offset:768
    ds_read_b64_tr_b16 v[40:41], v14 offset:64
    ds_read_b64_tr_b16 v[42:43], v14 offset:832
    v_mfma_f32_32x32x16_bf16 v[120:135], v[72:75], v[60:63], v[120:135]
    ds_read_b64_tr_b16 v[44:45], v14 offset:128
    ds_read_b64_tr_b16 v[46:47], v14 offset:896
    ds_read_b64_tr_b16 v[48:49], v14 offset:12288
    ds_read_b64_tr_b16 v[50:51], v14 offset:13056
    v_mfma_f32_32x32x16_bf16 v[136:151], v[76:79], v[60:63], v[136:151]
    ds_read_b64_tr_b16 v[52:53], v14 offset:12352
    ds_read_b64_tr_b16 v[54:55], v14 offset:13120
    ds_read_b64_tr_b16 v[56:57], v14 offset:12416
    ds_read_b64_tr_b16 v[58:59], v14 offset:13184
    v_mfma_f32_32x32x16_bf16 v[152:167], v[80:83], v[60:63], v[152:167]
    v_mfma_f32_32x32x16_bf16 v[168:183], v[84:87], v[60:63], v[168:183]
    s_waitcnt lgkmcnt(0)
    v_mfma_f32_32x32x16_bf16 v[88:103], v[36:39], v[32:35], v[88:103]
    ds_read_b128 v[60:63], v11
    ds_read_b64_tr_b16 v[64:65], v14 offset:3072
    ds_read_b64_tr_b16 v[66:67], v14 offset:3840
    ds_read_b64_tr_b16 v[68:69], v14 offset:3136
    ds_read_b64_tr_b16 v[70:71], v14 offset:3904
    v_mfma_f32_32x32x16_bf16 v[104:119], v[40:43], v[32:35], v[104:119]
    ds_read_b64_tr_b16 v[72:73], v14 offset:3200
    ds_read_b64_tr_b16 v[74:75], v14 offset:3968
    ds_read_b64_tr_b16 v[76:77], v14 offset:15360
    ds_read_b64_tr_b16 v[78:79], v14 offset:16128
    v_mfma_f32_32x32x16_bf16 v[120:135], v[44:47], v[32:35], v[120:135]
    ds_read_b64_tr_b16 v[80:81], v14 offset:15424
    ds_read_b64_tr_b16 v[82:83], v14 offset:16192
    ds_read_b64_tr_b16 v[84:85], v14 offset:15488
    ds_read_b64_tr_b16 v[86:87], v14 offset:16256
    v_mfma_f32_32x32x16_bf16 v[136:151], v[48:51], v[32:35], v[136:151]
    v_mfma_f32_32x32x16_bf16 v[152:167], v[52:55], v[32:35], v[152:167]
    v_mfma_f32_32x32x16_bf16 v[168:183], v[56:59], v[32:35], v[168:183]
    s_waitcnt lgkmcnt(0)
    v_mfma_f32_32x32x16_bf16 v[88:103], v[64:67], v[60:63], v[88:103]
    ds_read_b128 v[32:35], v12
    ds_read_b64_tr_b16 v[36:37], v14 offset:6144
    ds_read_b64_tr_b16 v[38:39], v14 offset:6912
    ds_read_b64_tr_b16 v[40:41], v14 offset:6208
    ds_read_b64_tr_b16 v[42:43], v14 offset:6976
    v_mfma_f32_32x32x16_bf16 v[104:119], v[68:71], v[60:63], v[104:119]
    ds_read_b64_tr_b16 v[44:45], v14 offset:6272
    ds_read_b64_tr_b16 v[46:47], v14 offset:7040
    ds_read_b64_tr_b16 v[48:49], v14 offset:18432
    ds_read_b64_tr_b16 v[50:51], v14 offset:19200
    v_mfma_f32_32x32x16_bf16 v[120:135], v[72:75], v[60:63], v[120:135]
    ds_read_b64_tr_b16 v[52:53], v14 offset:18496
    ds_read_b64_tr_b16 v[54:55], v14 offset:19264
    ds_read_b64_tr_b16 v[56:57], v14 offset:18560
    ds_read_b64_tr_b16 v[58:59], v14 offset:19328
    v_mfma_f32_32x32x16_bf16 v[136:151], v[76:79], v[60:63], v[136:151]
    v_mfma_f32_32x32x16_bf16 v[152:167], v[80:83], v[60:63], v[152:167]
    v_mfma_f32_32x32x16_bf16 v[168:183], v[84:87], v[60:63], v[168:183]
    s_waitcnt lgkmcnt(0)
    v_mfma_f32_32x32x16_bf16 v[88:103], v[36:39], v[32:35], v[88:103]
    ds_read_b128 v[60:63], v13
    ds_read_b64_tr_b16 v[64:65], v14 offset:9216
    ds_read_b64_tr_b16 v[66:67], v14 offset:9984
    ds_read_b64_tr_b16 v[68:69], v14 offset:9280
    ds_read_b64_tr_b16 v[70:71], v14 offset:10048
    v_mfma_f32_32x32x16_bf16 v[104:119], v[40:43], v[32:35], v[104:119]
    ds_read_b64_tr_b16 v[72:73], v14 offset:9344
    ds_read_b64_tr_b16 v[74:75], v14 offset:10112
    ds_read_b64_tr_b16 v[76:77], v14 offset:21504
    ds_read_b64_tr_b16 v[78:79], v14 offset:22272
    v_mfma_f32_32x32x16_bf16 v[120:135], v[44:47], v[32:35], v[120:135]
    ds_read_b64_tr_b16 v[80:81], v14 offset:21568
    ds_read_b64_tr_b16 v[82:83], v14 offset:22336
    ds_read_b64_tr_b16 v[84:85], v14 offset:21632
    ds_read_b64_tr_b16 v[86:87], v14 offset:22400
    v_mfma_f32_32x32x16_bf16 v[136:151], v[48:51], v[32:35], v[136:151]
    v_mfma_f32_32x32x16_bf16 v[152:167], v[52:55], v[32:35], v[152:167]
    v_mfma_f32_32x32x16_bf16 v[168:183], v[56:59], v[32:35], v[168:183]
    s_waitcnt lgkmcnt(0)
    v_mfma_f32_32x32x16_bf16 v[88:103], v[64:67], v[60:63], v[88:103]
    s_barrier
    v_add_u32 v10, 0xffff4000, v10
    v_add_u32 v11, 0xffff4000, v11
    v_add_u32 v12, 0xffff4000, v12
    v_add_u32 v13, 0xffff4000, v13
    v_add_u32 v14, 0xfffee000, v14
    v_mfma_f32_32x32x16_bf16 v[104:119], v[68:71], v[60:63], v[104:119]
    ds_read_b128 v[32:35], v10
    ds_read_b64_tr_b16 v[36:37], v14 offset:0
    ds_read_b64_tr_b16 v[38:39], v14 offset:768
    ds_read_b64_tr_b16 v[40:41], v14 offset:64
    ds_read_b64_tr_b16 v[42:43], v14 offset:832
    v_mfma_f32_32x32x16_bf16 v[120:135], v[72:75], v[60:63], v[120:135]
    ds_read_b64_tr_b16 v[44:45], v14 offset:128
    ds_read_b64_tr_b16 v[46:47], v14 offset:896
    ds_read_b64_tr_b16 v[48:49], v14 offset:12288
    ds_read_b64_tr_b16 v[50:51], v14 offset:13056
    v_mfma_f32_32x32x16_bf16 v[136:151], v[76:79], v[60:63], v[136:151]
    ds_read_b64_tr_b16 v[52:53], v14 offset:12352
    ds_read_b64_tr_b16 v[54:55], v14 offset:13120
    ds_read_b64_tr_b16 v[56:57], v14 offset:12416
    ds_read_b64_tr_b16 v[58:59], v14 offset:13184
    v_mfma_f32_32x32x16_bf16 v[152:167], v[80:83], v[60:63], v[152:167]
    v_mfma_f32_32x32x16_bf16 v[168:183], v[84:87], v[60:63], v[168:183]
    s_waitcnt vmcnt(0)
    v_add_f32 v16, v236, v238
    v_add_f32 v16, v16, v240
    v_add_f32 v16, v16, v242
    v_add_f32 v16, v16, v244
    v_add_f32 v16, v16, v246
    v_add_f32 v16, v16, v248
    v_add_f32 v16, v16, v250
    v_mul_f32 v16, 0x3acccccd, v16
    v_add_f32 v17, v237, v239
    v_add_f32 v17, v17, v241
    v_add_f32 v17, v17, v243
    v_add_f32 v17, v17, v245
    v_add_f32 v17, v17, v247
    v_add_f32 v17, v17, v249
    v_add_f32 v17, v17, v251
    v_mov_b32 v18, 0
    v_mul_f32 v19, 0x3c4ccccd, v236
    v_sub_f32 v19, v19, v16
    v_fmac_f32 v18, v19, v19
    v_mul_f32 v19, 0x3c4ccccd, v238
    v_sub_f32 v19, v19, v16
    v_fmac_f32 v18, v19, v19
    v_mul_f32 v19, 0x3c4ccccd, v240
    v_sub_f32 v19, v19, v16
    v_fmac_f32 v18, v19, v19
    v_mul_f32 v19, 0x3c4ccccd, v242
    v_sub_f32 v19, v19, v16
    v_fmac_f32 v18, v19, v19
    v_mul_f32 v19, 0x3c4ccccd, v244
    v_sub_f32 v19, v19, v16
    v_fmac_f32 v18, v19, v19
    v_mul_f32 v19, 0x3c4ccccd, v246
    v_sub_f32 v19, v19, v16
    v_fmac_f32 v18, v19, v19
    v_mul_f32 v19, 0x3c4ccccd, v248
    v_sub_f32 v19, v19, v16
    v_fmac_f32 v18, v19, v19
    v_mul_f32 v19, 0x3c4ccccd, v250
    v_sub_f32 v19, v19, v16
    v_fmac_f32 v18, v19, v19
    v_mov_b32 v19, 0x42a00000
    v_fmac_f32 v17, v18, v19
    v_mul_f32 v17, 0x3acccccd, v17
    v_cvt_pk_bf16_f32 v184, v16, v16
    v_lshlrev_b32 v184, 16, v184
    v_cvt_pk_bf16_f32 v186, v17, v17
    v_lshlrev_b32 v186, 16, v186
    v_add_f32 v186, 0x3727c5ac, v186
    v_cvt_pk_bf16_f32 v186, v186, v186
    v_lshlrev_b32 v186, 16, v186
    v_sqrt_f32 v186, v186
    s_nop 0
    v_cvt_pk_bf16_f32 v186, v186, v186
    v_lshlrev_b32 v186, 16, v186
    v_rcp_f32 v186, v186
    s_nop 0
    v_mov_b32 v185, v184
    v_mov_b32 v187, v186
    buffer_load_dwordx4 v[236:239], v31, s[68:71], 0 offen offset:128 sc1
    buffer_load_dwordx4 v[240:243], v31, s[68:71], 0 offen offset:160 sc1
    buffer_load_dwordx4 v[244:247], v31, s[68:71], 0 offen offset:192 sc1
    buffer_load_dwordx4 v[248:251], v31, s[68:71], 0 offen offset:224 sc1
    s_waitcnt lgkmcnt(0)
    v_mfma_f32_32x32x16_bf16 v[88:103], v[36:39], v[32:35], v[88:103]
    ds_read_b128 v[60:63], v11
    ds_read_b64_tr_b16 v[64:65], v14 offset:3072
    ds_read_b64_tr_b16 v[66:67], v14 offset:3840
    ds_read_b64_tr_b16 v[68:69], v14 offset:3136
    ds_read_b64_tr_b16 v[70:71], v14 offset:3904
    v_mfma_f32_32x32x16_bf16 v[104:119], v[40:43], v[32:35], v[104:119]
    ds_read_b64_tr_b16 v[72:73], v14 offset:3200
    ds_read_b64_tr_b16 v[74:75], v14 offset:3968
    ds_read_b64_tr_b16 v[76:77], v14 offset:15360
    ds_read_b64_tr_b16 v[78:79], v14 offset:16128
    v_mfma_f32_32x32x16_bf16 v[120:135], v[44:47], v[32:35], v[120:135]
    ds_read_b64_tr_b16 v[80:81], v14 offset:15424
    ds_read_b64_tr_b16 v[82:83], v14 offset:16192
    ds_read_b64_tr_b16 v[84:85], v14 offset:15488
    ds_read_b64_tr_b16 v[86:87], v14 offset:16256
    v_mfma_f32_32x32x16_bf16 v[136:151], v[48:51], v[32:35], v[136:151]
    v_mfma_f32_32x32x16_bf16 v[152:167], v[52:55], v[32:35], v[152:167]
    v_mfma_f32_32x32x16_bf16 v[168:183], v[56:59], v[32:35], v[168:183]
    s_waitcnt lgkmcnt(0)
    v_mfma_f32_32x32x16_bf16 v[88:103], v[64:67], v[60:63], v[88:103]
    ds_read_b128 v[32:35], v12
    ds_read_b64_tr_b16 v[36:37], v14 offset:6144
    ds_read_b64_tr_b16 v[38:39], v14 offset:6912
    ds_read_b64_tr_b16 v[40:41], v14 offset:6208
    ds_read_b64_tr_b16 v[42:43], v14 offset:6976
    v_mfma_f32_32x32x16_bf16 v[104:119], v[68:71], v[60:63], v[104:119]
    ds_read_b64_tr_b16 v[44:45], v14 offset:6272
    ds_read_b64_tr_b16 v[46:47], v14 offset:7040
    ds_read_b64_tr_b16 v[48:49], v14 offset:18432
    ds_read_b64_tr_b16 v[50:51], v14 offset:19200
    v_mfma_f32_32x32x16_bf16 v[120:135], v[72:75], v[60:63], v[120:135]
    ds_read_b64_tr_b16 v[52:53], v14 offset:18496
    ds_read_b64_tr_b16 v[54:55], v14 offset:19264
    ds_read_b64_tr_b16 v[56:57], v14 offset:18560
    ds_read_b64_tr_b16 v[58:59], v14 offset:19328
    v_mfma_f32_32x32x16_bf16 v[136:151], v[76:79], v[60:63], v[136:151]
    v_mfma_f32_32x32x16_bf16 v[152:167], v[80:83], v[60:63], v[152:167]
    v_mfma_f32_32x32x16_bf16 v[168:183], v[84:87], v[60:63], v[168:183]
    s_waitcnt lgkmcnt(0)
    v_mfma_f32_32x32x16_bf16 v[88:103], v[36:39], v[32:35], v[88:103]
    ds_read_b128 v[60:63], v13
    ds_read_b64_tr_b16 v[64:65], v14 offset:9216
    ds_read_b64_tr_b16 v[66:67], v14 offset:9984
    ds_read_b64_tr_b16 v[68:69], v14 offset:9280
    ds_read_b64_tr_b16 v[70:71], v14 offset:10048
    v_mfma_f32_32x32x16_bf16 v[104:119], v[40:43], v[32:35], v[104:119]
    ds_read_b64_tr_b16 v[72:73], v14 offset:9344
    ds_read_b64_tr_b16 v[74:75], v14 offset:10112
    ds_read_b64_tr_b16 v[76:77], v14 offset:21504
    ds_read_b64_tr_b16 v[78:79], v14 offset:22272
    v_mfma_f32_32x32x16_bf16 v[120:135], v[44:47], v[32:35], v[120:135]
    ds_read_b64_tr_b16 v[80:81], v14 offset:21568
    ds_read_b64_tr_b16 v[82:83], v14 offset:22336
    ds_read_b64_tr_b16 v[84:85], v14 offset:21632
    ds_read_b64_tr_b16 v[86:87], v14 offset:22400
    v_mfma_f32_32x32x16_bf16 v[136:151], v[48:51], v[32:35], v[136:151]
    v_mfma_f32_32x32x16_bf16 v[152:167], v[52:55], v[32:35], v[152:167]
    v_mfma_f32_32x32x16_bf16 v[168:183], v[56:59], v[32:35], v[168:183]
    s_waitcnt lgkmcnt(0)
    v_mfma_f32_32x32x16_bf16 v[88:103], v[64:67], v[60:63], v[88:103]
    s_barrier
    v_add_u32 v10, 0x4000, v10
    v_add_u32 v11, 0x4000, v11
    v_add_u32 v12, 0x4000, v12
    v_add_u32 v13, 0x4000, v13
    v_add_u32 v14, 0x6000, v14
    v_mfma_f32_32x32x16_bf16 v[104:119], v[68:71], v[60:63], v[104:119]
    ds_read_b128 v[32:35], v10
    ds_read_b64_tr_b16 v[36:37], v14 offset:0
    ds_read_b64_tr_b16 v[38:39], v14 offset:768
    ds_read_b64_tr_b16 v[40:41], v14 offset:64
    ds_read_b64_tr_b16 v[42:43], v14 offset:832
    v_mfma_f32_32x32x16_bf16 v[120:135], v[72:75], v[60:63], v[120:135]
    ds_read_b64_tr_b16 v[44:45], v14 offset:128
    ds_read_b64_tr_b16 v[46:47], v14 offset:896
    ds_read_b64_tr_b16 v[48:49], v14 offset:12288
    ds_read_b64_tr_b16 v[50:51], v14 offset:13056
    v_mfma_f32_32x32x16_bf16 v[136:151], v[76:79], v[60:63], v[136:151]
    ds_read_b64_tr_b16 v[52:53], v14 offset:12352
    ds_read_b64_tr_b16 v[54:55], v14 offset:13120
    ds_read_b64_tr_b16 v[56:57], v14 offset:12416
    ds_read_b64_tr_b16 v[58:59], v14 offset:13184
    v_mfma_f32_32x32x16_bf16 v[152:167], v[80:83], v[60:63], v[152:167]
    v_mfma_f32_32x32x16_bf16 v[168:183], v[84:87], v[60:63], v[168:183]
    s_waitcnt lgkmcnt(0)
    v_mfma_f32_32x32x16_bf16 v[88:103], v[36:39], v[32:35], v[88:103]
    ds_read_b128 v[60:63], v11
    ds_read_b64_tr_b16 v[64:65], v14 offset:3072
    ds_read_b64_tr_b16 v[66:67], v14 offset:3840
    ds_read_b64_tr_b16 v[68:69], v14 offset:3136
    ds_read_b64_tr_b16 v[70:71], v14 offset:3904
    v_mfma_f32_32x32x16_bf16 v[104:119], v[40:43], v[32:35], v[104:119]
    ds_read_b64_tr_b16 v[72:73], v14 offset:3200
    ds_read_b64_tr_b16 v[74:75], v14 offset:3968
    ds_read_b64_tr_b16 v[76:77], v14 offset:15360
    ds_read_b64_tr_b16 v[78:79], v14 offset:16128
    v_mfma_f32_32x32x16_bf16 v[120:135], v[44:47], v[32:35], v[120:135]
    ds_read_b64_tr_b16 v[80:81], v14 offset:15424
    ds_read_b64_tr_b16 v[82:83], v14 offset:16192
    ds_read_b64_tr_b16 v[84:85], v14 offset:15488
    ds_read_b64_tr_b16 v[86:87], v14 offset:16256
    v_mfma_f32_32x32x16_bf16 v[136:151], v[48:51], v[32:35], v[136:151]
    v_mfma_f32_32x32x16_bf16 v[152:167], v[52:55], v[32:35], v[152:167]
    v_mfma_f32_32x32x16_bf16 v[168:183], v[56:59], v[32:35], v[168:183]
    s_waitcnt lgkmcnt(0)
    v_mfma_f32_32x32x16_bf16 v[88:103], v[64:67], v[60:63], v[88:103]
    ds_read_b128 v[32:35], v12
    ds_read_b64_tr_b16 v[36:37], v14 offset:6144
    ds_read_b64_tr_b16 v[38:39], v14 offset:6912
    ds_read_b64_tr_b16 v[40:41], v14 offset:6208
    ds_read_b64_tr_b16 v[42:43], v14 offset:6976
    v_mfma_f32_32x32x16_bf16 v[104:119], v[68:71], v[60:63], v[104:119]
    ds_read_b64_tr_b16 v[44:45], v14 offset:6272
    ds_read_b64_tr_b16 v[46:47], v14 offset:7040
    ds_read_b64_tr_b16 v[48:49], v14 offset:18432
    ds_read_b64_tr_b16 v[50:51], v14 offset:19200
    v_mfma_f32_32x32x16_bf16 v[120:135], v[72:75], v[60:63], v[120:135]
    ds_read_b64_tr_b16 v[52:53], v14 offset:18496
    ds_read_b64_tr_b16 v[54:55], v14 offset:19264
    ds_read_b64_tr_b16 v[56:57], v14 offset:18560
    ds_read_b64_tr_b16 v[58:59], v14 offset:19328
    v_mfma_f32_32x32x16_bf16 v[136:151], v[76:79], v[60:63], v[136:151]
    v_mfma_f32_32x32x16_bf16 v[152:167], v[80:83], v[60:63], v[152:167]
    v_mfma_f32_32x32x16_bf16 v[168:183], v[84:87], v[60:63], v[168:183]
    s_waitcnt lgkmcnt(0)
    v_mfma_f32_32x32x16_bf16 v[88:103], v[36:39], v[32:35], v[88:103]
    ds_read_b128 v[60:63], v13
    ds_read_b64_tr_b16 v[64:65], v14 offset:9216
    ds_read_b64_tr_b16 v[66:67], v14 offset:9984
    ds_read_b64_tr_b16 v[68:69], v14 offset:9280
    ds_read_b64_tr_b16 v[70:71], v14 offset:10048
    v_mfma_f32_32x32x16_bf16 v[104:119], v[40:43], v[32:35], v[104:119]
    ds_read_b64_tr_b16 v[72:73], v14 offset:9344
    ds_read_b64_tr_b16 v[74:75], v14 offset:10112
    ds_read_b64_tr_b16 v[76:77], v14 offset:21504
    ds_read_b64_tr_b16 v[78:79], v14 offset:22272
    v_mfma_f32_32x32x16_bf16 v[120:135], v[44:47], v[32:35], v[120:135]
    ds_read_b64_tr_b16 v[80:81], v14 offset:21568
    ds_read_b64_tr_b16 v[82:83], v14 offset:22336
    ds_read_b64_tr_b16 v[84:85], v14 offset:21632
    ds_read_b64_tr_b16 v[86:87], v14 offset:22400
    v_mfma_f32_32x32x16_bf16 v[136:151], v[48:51], v[32:35], v[136:151]
    v_mfma_f32_32x32x16_bf16 v[152:167], v[52:55], v[32:35], v[152:167]
    v_mfma_f32_32x32x16_bf16 v[168:183], v[56:59], v[32:35], v[168:183]
    s_waitcnt lgkmcnt(0)
    v_mfma_f32_32x32x16_bf16 v[88:103], v[64:67], v[60:63], v[88:103]
    s_barrier
    v_add_u32 v10, 0x4000, v10
    v_add_u32 v11, 0x4000, v11
    v_add_u32 v12, 0x4000, v12
    v_add_u32 v13, 0x4000, v13
    v_add_u32 v14, 0x6000, v14
    v_mfma_f32_32x32x16_bf16 v[104:119], v[68:71], v[60:63], v[104:119]
    ds_read_b128 v[32:35], v10
    ds_read_b64_tr_b16 v[36:37], v14 offset:0
    ds_read_b64_tr_b16 v[38:39], v14 offset:768
    ds_read_b64_tr_b16 v[40:41], v14 offset:64
    ds_read_b64_tr_b16 v[42:43], v14 offset:832
    v_mfma_f32_32x32x16_bf16 v[120:135], v[72:75], v[60:63], v[120:135]
    ds_read_b64_tr_b16 v[44:45], v14 offset:128
    ds_read_b64_tr_b16 v[46:47], v14 offset:896
    ds_read_b64_tr_b16 v[48:49], v14 offset:12288
    ds_read_b64_tr_b16 v[50:51], v14 offset:13056
    v_mfma_f32_32x32x16_bf16 v[136:151], v[76:79], v[60:63], v[136:151]
    ds_read_b64_tr_b16 v[52:53], v14 offset:12352
    ds_read_b64_tr_b16 v[54:55], v14 offset:13120
    ds_read_b64_tr_b16 v[56:57], v14 offset:12416
    ds_read_b64_tr_b16 v[58:59], v14 offset:13184
    v_mfma_f32_32x32x16_bf16 v[152:167], v[80:83], v[60:63], v[152:167]
    v_mfma_f32_32x32x16_bf16 v[168:183], v[84:87], v[60:63], v[168:183]
    s_waitcnt lgkmcnt(0)
    v_mfma_f32_32x32x16_bf16 v[88:103], v[36:39], v[32:35], v[88:103]
    ds_read_b128 v[60:63], v11
    ds_read_b64_tr_b16 v[64:65], v14 offset:3072
    ds_read_b64_tr_b16 v[66:67], v14 offset:3840
    ds_read_b64_tr_b16 v[68:69], v14 offset:3136
    ds_read_b64_tr_b16 v[70:71], v14 offset:3904
    v_mfma_f32_32x32x16_bf16 v[104:119], v[40:43], v[32:35], v[104:119]
    ds_read_b64_tr_b16 v[72:73], v14 offset:3200
    ds_read_b64_tr_b16 v[74:75], v14 offset:3968
    ds_read_b64_tr_b16 v[76:77], v14 offset:15360
    ds_read_b64_tr_b16 v[78:79], v14 offset:16128
    v_mfma_f32_32x32x16_bf16 v[120:135], v[44:47], v[32:35], v[120:135]
    ds_read_b64_tr_b16 v[80:81], v14 offset:15424
    ds_read_b64_tr_b16 v[82:83], v14 offset:16192
    ds_read_b64_tr_b16 v[84:85], v14 offset:15488
    ds_read_b64_tr_b16 v[86:87], v14 offset:16256
    v_mfma_f32_32x32x16_bf16 v[136:151], v[48:51], v[32:35], v[136:151]
    v_mfma_f32_32x32x16_bf16 v[152:167], v[52:55], v[32:35], v[152:167]
    v_mfma_f32_32x32x16_bf16 v[168:183], v[56:59], v[32:35], v[168:183]
    s_waitcnt lgkmcnt(0)
    v_mfma_f32_32x32x16_bf16 v[88:103], v[64:67], v[60:63], v[88:103]
    ds_read_b128 v[32:35], v12
    ds_read_b64_tr_b16 v[36:37], v14 offset:6144
    ds_read_b64_tr_b16 v[38:39], v14 offset:6912
    ds_read_b64_tr_b16 v[40:41], v14 offset:6208
    ds_read_b64_tr_b16 v[42:43], v14 offset:6976
    v_mfma_f32_32x32x16_bf16 v[104:119], v[68:71], v[60:63], v[104:119]
    ds_read_b64_tr_b16 v[44:45], v14 offset:6272
    ds_read_b64_tr_b16 v[46:47], v14 offset:7040
    ds_read_b64_tr_b16 v[48:49], v14 offset:18432
    ds_read_b64_tr_b16 v[50:51], v14 offset:19200
    v_mfma_f32_32x32x16_bf16 v[120:135], v[72:75], v[60:63], v[120:135]
    ds_read_b64_tr_b16 v[52:53], v14 offset:18496
    ds_read_b64_tr_b16 v[54:55], v14 offset:19264
    ds_read_b64_tr_b16 v[56:57], v14 offset:18560
    ds_read_b64_tr_b16 v[58:59], v14 offset:19328
    v_mfma_f32_32x32x16_bf16 v[136:151], v[76:79], v[60:63], v[136:151]
    v_mfma_f32_32x32x16_bf16 v[152:167], v[80:83], v[60:63], v[152:167]
    v_mfma_f32_32x32x16_bf16 v[168:183], v[84:87], v[60:63], v[168:183]
    s_waitcnt lgkmcnt(0)
    v_mfma_f32_32x32x16_bf16 v[88:103], v[36:39], v[32:35], v[88:103]
    ds_read_b128 v[60:63], v13
    ds_read_b64_tr_b16 v[64:65], v14 offset:9216
    ds_read_b64_tr_b16 v[66:67], v14 offset:9984
    ds_read_b64_tr_b16 v[68:69], v14 offset:9280
    ds_read_b64_tr_b16 v[70:71], v14 offset:10048
    v_mfma_f32_32x32x16_bf16 v[104:119], v[40:43], v[32:35], v[104:119]
    ds_read_b64_tr_b16 v[72:73], v14 offset:9344
    ds_read_b64_tr_b16 v[74:75], v14 offset:10112
    ds_read_b64_tr_b16 v[76:77], v14 offset:21504
    ds_read_b64_tr_b16 v[78:79], v14 offset:22272
    v_mfma_f32_32x32x16_bf16 v[120:135], v[44:47], v[32:35], v[120:135]
    ds_read_b64_tr_b16 v[80:81], v14 offset:21568
    ds_read_b64_tr_b16 v[82:83], v14 offset:22336
    ds_read_b64_tr_b16 v[84:85], v14 offset:21632
    ds_read_b64_tr_b16 v[86:87], v14 offset:22400
    v_mfma_f32_32x32x16_bf16 v[136:151], v[48:51], v[32:35], v[136:151]
    v_mfma_f32_32x32x16_bf16 v[152:167], v[52:55], v[32:35], v[152:167]
    v_mfma_f32_32x32x16_bf16 v[168:183], v[56:59], v[32:35], v[168:183]
    s_waitcnt lgkmcnt(0)
    v_mfma_f32_32x32x16_bf16 v[88:103], v[64:67], v[60:63], v[88:103]
    s_barrier
    v_add_u32 v10, 0x4000, v10
    v_add_u32 v11, 0x4000, v11
    v_add_u32 v12, 0x4000, v12
    v_add_u32 v13, 0x4000, v13
    v_add_u32 v14, 0x6000, v14
    v_mfma_f32_32x32x16_bf16 v[104:119], v[68:71], v[60:63], v[104:119]
    ds_read_b128 v[32:35], v10
    ds_read_b64_tr_b16 v[36:37], v14 offset:0
    ds_read_b64_tr_b16 v[38:39], v14 offset:768
    ds_read_b64_tr_b16 v[40:41], v14 offset:64
    ds_read_b64_tr_b16 v[42:43], v14 offset:832
    v_mfma_f32_32x32x16_bf16 v[120:135], v[72:75], v[60:63], v[120:135]
    ds_read_b64_tr_b16 v[44:45], v14 offset:128
    ds_read_b64_tr_b16 v[46:47], v14 offset:896
    ds_read_b64_tr_b16 v[48:49], v14 offset:12288
    ds_read_b64_tr_b16 v[50:51], v14 offset:13056
    v_mfma_f32_32x32x16_bf16 v[136:151], v[76:79], v[60:63], v[136:151]
    ds_read_b64_tr_b16 v[52:53], v14 offset:12352
    ds_read_b64_tr_b16 v[54:55], v14 offset:13120
    ds_read_b64_tr_b16 v[56:57], v14 offset:12416
    ds_read_b64_tr_b16 v[58:59], v14 offset:13184
    v_mfma_f32_32x32x16_bf16 v[152:167], v[80:83], v[60:63], v[152:167]
    v_mfma_f32_32x32x16_bf16 v[168:183], v[84:87], v[60:63], v[168:183]
    s_waitcnt lgkmcnt(0)
    v_mfma_f32_32x32x16_bf16 v[88:103], v[36:39], v[32:35], v[88:103]
    ds_read_b128 v[60:63], v11
    ds_read_b64_tr_b16 v[64:65], v14 offset:3072
    ds_read_b64_tr_b16 v[66:67], v14 offset:3840
    ds_read_b64_tr_b16 v[68:69], v14 offset:3136
    ds_read_b64_tr_b16 v[70:71], v14 offset:3904
    v_mfma_f32_32x32x16_bf16 v[104:119], v[40:43], v[32:35], v[104:119]
    ds_read_b64_tr_b16 v[72:73], v14 offset:3200
    ds_read_b64_tr_b16 v[74:75], v14 offset:3968
    ds_read_b64_tr_b16 v[76:77], v14 offset:15360
    ds_read_b64_tr_b16 v[78:79], v14 offset:16128
    v_mfma_f32_32x32x16_bf16 v[120:135], v[44:47], v[32:35], v[120:135]
    ds_read_b64_tr_b16 v[80:81], v14 offset:15424
    ds_read_b64_tr_b16 v[82:83], v14 offset:16192
    ds_read_b64_tr_b16 v[84:85], v14 offset:15488
    ds_read_b64_tr_b16 v[86:87], v14 offset:16256
    v_mfma_f32_32x32x16_bf16 v[136:151], v[48:51], v[32:35], v[136:151]
    v_mfma_f32_32x32x16_bf16 v[152:167], v[52:55], v[32:35], v[152:167]
    v_mfma_f32_32x32x16_bf16 v[168:183], v[56:59], v[32:35], v[168:183]
    s_waitcnt lgkmcnt(0)
    v_mfma_f32_32x32x16_bf16 v[88:103], v[64:67], v[60:63], v[88:103]
    ds_read_b128 v[32:35], v12
    ds_read_b64_tr_b16 v[36:37], v14 offset:6144
    ds_read_b64_tr_b16 v[38:39], v14 offset:6912
    ds_read_b64_tr_b16 v[40:41], v14 offset:6208
    ds_read_b64_tr_b16 v[42:43], v14 offset:6976
    v_mfma_f32_32x32x16_bf16 v[104:119], v[68:71], v[60:63], v[104:119]
    ds_read_b64_tr_b16 v[44:45], v14 offset:6272
    ds_read_b64_tr_b16 v[46:47], v14 offset:7040
    ds_read_b64_tr_b16 v[48:49], v14 offset:18432
    ds_read_b64_tr_b16 v[50:51], v14 offset:19200
    v_mfma_f32_32x32x16_bf16 v[120:135], v[72:75], v[60:63], v[120:135]
    ds_read_b64_tr_b16 v[52:53], v14 offset:18496
    ds_read_b64_tr_b16 v[54:55], v14 offset:19264
    ds_read_b64_tr_b16 v[56:57], v14 offset:18560
    ds_read_b64_tr_b16 v[58:59], v14 offset:19328
    v_mfma_f32_32x32x16_bf16 v[136:151], v[76:79], v[60:63], v[136:151]
    v_mfma_f32_32x32x16_bf16 v[152:167], v[80:83], v[60:63], v[152:167]
    v_mfma_f32_32x32x16_bf16 v[168:183], v[84:87], v[60:63], v[168:183]
    s_waitcnt lgkmcnt(0)
    v_mfma_f32_32x32x16_bf16 v[88:103], v[36:39], v[32:35], v[88:103]
    ds_read_b128 v[60:63], v13
    ds_read_b64_tr_b16 v[64:65], v14 offset:9216
    ds_read_b64_tr_b16 v[66:67], v14 offset:9984
    ds_read_b64_tr_b16 v[68:69], v14 offset:9280
    ds_read_b64_tr_b16 v[70:71], v14 offset:10048
    v_mfma_f32_32x32x16_bf16 v[104:119], v[40:43], v[32:35], v[104:119]
    ds_read_b64_tr_b16 v[72:73], v14 offset:9344
    ds_read_b64_tr_b16 v[74:75], v14 offset:10112
    ds_read_b64_tr_b16 v[76:77], v14 offset:21504
    ds_read_b64_tr_b16 v[78:79], v14 offset:22272
    v_mfma_f32_32x32x16_bf16 v[120:135], v[44:47], v[32:35], v[120:135]
    ds_read_b64_tr_b16 v[80:81], v14 offset:21568
    ds_read_b64_tr_b16 v[82:83], v14 offset:22336
    ds_read_b64_tr_b16 v[84:85], v14 offset:21632
    ds_read_b64_tr_b16 v[86:87], v14 offset:22400
    v_mfma_f32_32x32x16_bf16 v[136:151], v[48:51], v[32:35], v[136:151]
    v_mfma_f32_32x32x16_bf16 v[152:167], v[52:55], v[32:35], v[152:167]
    v_mfma_f32_32x32x16_bf16 v[168:183], v[56:59], v[32:35], v[168:183]
    s_waitcnt lgkmcnt(0)
    v_mfma_f32_32x32x16_bf16 v[88:103], v[64:67], v[60:63], v[88:103]
    s_barrier
    v_add_u32 v10, 0xffff4000, v10
    v_add_u32 v11, 0xffff4000, v11
    v_add_u32 v12, 0xffff4000, v12
    v_add_u32 v13, 0xffff4000, v13
    v_add_u32 v14, 0xfffee000, v14
    v_mfma_f32_32x32x16_bf16 v[104:119], v[68:71], v[60:63], v[104:119]
    ds_read_b128 v[32:35], v10
    ds_read_b64_tr_b16 v[36:37], v14 offset:0
    ds_read_b64_tr_b16 v[38:39], v14 offset:768
    ds_read_b64_tr_b16 v[40:41], v14 offset:64
    ds_read_b64_tr_b16 v[42:43], v14 offset:832
    v_mfma_f32_32x32x16_bf16 v[120:135], v[72:75], v[60:63], v[120:135]
    ds_read_b64_tr_b16 v[44:45], v14 offset:128
    ds_read_b64_tr_b16 v[46:47], v14 offset:896
    ds_read_b64_tr_b16 v[48:49], v14 offset:12288
    ds_read_b64_tr_b16 v[50:51], v14 offset:13056
    v_mfma_f32_32x32x16_bf16 v[136:151], v[76:79], v[60:63], v[136:151]
    ds_read_b64_tr_b16 v[52:53], v14 offset:12352
    ds_read_b64_tr_b16 v[54:55], v14 offset:13120
    ds_read_b64_tr_b16 v[56:57], v14 offset:12416
    ds_read_b64_tr_b16 v[58:59], v14 offset:13184
    v_mfma_f32_32x32x16_bf16 v[152:167], v[80:83], v[60:63], v[152:167]
    v_mfma_f32_32x32x16_bf16 v[168:183], v[84:87], v[60:63], v[168:183]
    s_waitcnt lgkmcnt(0)
    v_mfma_f32_32x32x16_bf16 v[88:103], v[36:39], v[32:35], v[88:103]
    ds_read_b128 v[60:63], v11
    ds_read_b64_tr_b16 v[64:65], v14 offset:3072
    ds_read_b64_tr_b16 v[66:67], v14 offset:3840
    ds_read_b64_tr_b16 v[68:69], v14 offset:3136
    ds_read_b64_tr_b16 v[70:71], v14 offset:3904
    v_mfma_f32_32x32x16_bf16 v[104:119], v[40:43], v[32:35], v[104:119]
    ds_read_b64_tr_b16 v[72:73], v14 offset:3200
    ds_read_b64_tr_b16 v[74:75], v14 offset:3968
    ds_read_b64_tr_b16 v[76:77], v14 offset:15360
    ds_read_b64_tr_b16 v[78:79], v14 offset:16128
    v_mfma_f32_32x32x16_bf16 v[120:135], v[44:47], v[32:35], v[120:135]
    ds_read_b64_tr_b16 v[80:81], v14 offset:15424
    ds_read_b64_tr_b16 v[82:83], v14 offset:16192
    ds_read_b64_tr_b16 v[84:85], v14 offset:15488
    ds_read_b64_tr_b16 v[86:87], v14 offset:16256
    v_mfma_f32_32x32x16_bf16 v[136:151], v[48:51], v[32:35], v[136:151]
    v_mfma_f32_32x32x16_bf16 v[152:167], v[52:55], v[32:35], v[152:167]
    v_mfma_f32_32x32x16_bf16 v[168:183], v[56:59], v[32:35], v[168:183]
    s_waitcnt lgkmcnt(0)
    v_mfma_f32_32x32x16_bf16 v[88:103], v[64:67], v[60:63], v[88:103]
    ds_read_b128 v[32:35], v12
    ds_read_b64_tr_b16 v[36:37], v14 offset:6144
    ds_read_b64_tr_b16 v[38:39], v14 offset:6912
    ds_read_b64_tr_b16 v[40:41], v14 offset:6208
    ds_read_b64_tr_b16 v[42:43], v14 offset:6976
    v_mfma_f32_32x32x16_bf16 v[104:119], v[68:71], v[60:63], v[104:119]
    ds_read_b64_tr_b16 v[44:45], v14 offset:6272
    ds_read_b64_tr_b16 v[46:47], v14 offset:7040
    ds_read_b64_tr_b16 v[48:49], v14 offset:18432
    ds_read_b64_tr_b16 v[50:51], v14 offset:19200
    v_mfma_f32_32x32x16_bf16 v[120:135], v[72:75], v[60:63], v[120:135]
    ds_read_b64_tr_b16 v[52:53], v14 offset:18496
    ds_read_b64_tr_b16 v[54:55], v14 offset:19264
    ds_read_b64_tr_b16 v[56:57], v14 offset:18560
    ds_read_b64_tr_b16 v[58:59], v14 offset:19328
    v_mfma_f32_32x32x16_bf16 v[136:151], v[76:79], v[60:63], v[136:151]
    v_mfma_f32_32x32x16_bf16 v[152:167], v[80:83], v[60:63], v[152:167]
    v_mfma_f32_32x32x16_bf16 v[168:183], v[84:87], v[60:63], v[168:183]
    s_waitcnt lgkmcnt(0)
    v_mfma_f32_32x32x16_bf16 v[88:103], v[36:39], v[32:35], v[88:103]
    ds_read_b128 v[60:63], v13
    ds_read_b64_tr_b16 v[64:65], v14 offset:9216
    ds_read_b64_tr_b16 v[66:67], v14 offset:9984
    ds_read_b64_tr_b16 v[68:69], v14 offset:9280
    ds_read_b64_tr_b16 v[70:71], v14 offset:10048
    v_mfma_f32_32x32x16_bf16 v[104:119], v[40:43], v[32:35], v[104:119]
    ds_read_b64_tr_b16 v[72:73], v14 offset:9344
    ds_read_b64_tr_b16 v[74:75], v14 offset:10112
    ds_read_b64_tr_b16 v[76:77], v14 offset:21504
    ds_read_b64_tr_b16 v[78:79], v14 offset:22272
    v_mfma_f32_32x32x16_bf16 v[120:135], v[44:47], v[32:35], v[120:135]
    ds_read_b64_tr_b16 v[80:81], v14 offset:21568
    ds_read_b64_tr_b16 v[82:83], v14 offset:22336
    ds_read_b64_tr_b16 v[84:85], v14 offset:21632
    ds_read_b64_tr_b16 v[86:87], v14 offset:22400
    v_mfma_f32_32x32x16_bf16 v[136:151], v[48:51], v[32:35], v[136:151]
    v_mfma_f32_32x32x16_bf16 v[152:167], v[52:55], v[32:35], v[152:167]
    v_mfma_f32_32x32x16_bf16 v[168:183], v[56:59], v[32:35], v[168:183]
    s_waitcnt lgkmcnt(0)
    v_mfma_f32_32x32x16_bf16 v[88:103], v[64:67], v[60:63], v[88:103]
    s_barrier
    v_add_u32 v10, 0x4000, v10
    v_add_u32 v11, 0x4000, v11
    v_add_u32 v12, 0x4000, v12
    v_add_u32 v13, 0x4000, v13
    v_add_u32 v14, 0x6000, v14
    v_mfma_f32_32x32x16_bf16 v[104:119], v[68:71], v[60:63], v[104:119]
    ds_read_b128 v[32:35], v10
    ds_read_b64_tr_b16 v[36:37], v14 offset:0
    ds_read_b64_tr_b16 v[38:39], v14 offset:768
    ds_read_b64_tr_b16 v[40:41], v14 offset:64
    ds_read_b64_tr_b16 v[42:43], v14 offset:832
    v_mfma_f32_32x32x16_bf16 v[120:135], v[72:75], v[60:63], v[120:135]
    ds_read_b64_tr_b16 v[44:45], v14 offset:128
    ds_read_b64_tr_b16 v[46:47], v14 offset:896
    ds_read_b64_tr_b16 v[48:49], v14 offset:12288
    ds_read_b64_tr_b16 v[50:51], v14 offset:13056
    v_mfma_f32_32x32x16_bf16 v[136:151], v[76:79], v[60:63], v[136:151]
    ds_read_b64_tr_b16 v[52:53], v14 offset:12352
    ds_read_b64_tr_b16 v[54:55], v14 offset:13120
    ds_read_b64_tr_b16 v[56:57], v14 offset:12416
    ds_read_b64_tr_b16 v[58:59], v14 offset:13184
    v_mfma_f32_32x32x16_bf16 v[152:167], v[80:83], v[60:63], v[152:167]
    v_mfma_f32_32x32x16_bf16 v[168:183], v[84:87], v[60:63], v[168:183]
    s_waitcnt lgkmcnt(0)
    v_mfma_f32_32x32x16_bf16 v[88:103], v[36:39], v[32:35], v[88:103]
    ds_read_b128 v[60:63], v11
    ds_read_b64_tr_b16 v[64:65], v14 offset:3072
    ds_read_b64_tr_b16 v[66:67], v14 offset:3840
    ds_read_b64_tr_b16 v[68:69], v14 offset:3136
    ds_read_b64_tr_b16 v[70:71], v14 offset:3904
    v_mfma_f32_32x32x16_bf16 v[104:119], v[40:43], v[32:35], v[104:119]
    ds_read_b64_tr_b16 v[72:73], v14 offset:3200
    ds_read_b64_tr_b16 v[74:75], v14 offset:3968
    ds_read_b64_tr_b16 v[76:77], v14 offset:15360
    ds_read_b64_tr_b16 v[78:79], v14 offset:16128
    v_mfma_f32_32x32x16_bf16 v[120:135], v[44:47], v[32:35], v[120:135]
    ds_read_b64_tr_b16 v[80:81], v14 offset:15424
    ds_read_b64_tr_b16 v[82:83], v14 offset:16192
    ds_read_b64_tr_b16 v[84:85], v14 offset:15488
    ds_read_b64_tr_b16 v[86:87], v14 offset:16256
    v_mfma_f32_32x32x16_bf16 v[136:151], v[48:51], v[32:35], v[136:151]
    v_mfma_f32_32x32x16_bf16 v[152:167], v[52:55], v[32:35], v[152:167]
    v_mfma_f32_32x32x16_bf16 v[168:183], v[56:59], v[32:35], v[168:183]
    s_waitcnt lgkmcnt(0)
    v_mfma_f32_32x32x16_bf16 v[88:103], v[64:67], v[60:63], v[88:103]
    ds_read_b128 v[32:35], v12
    ds_read_b64_tr_b16 v[36:37], v14 offset:6144
    ds_read_b64_tr_b16 v[38:39], v14 offset:6912
    ds_read_b64_tr_b16 v[40:41], v14 offset:6208
    ds_read_b64_tr_b16 v[42:43], v14 offset:6976
    v_mfma_f32_32x32x16_bf16 v[104:119], v[68:71], v[60:63], v[104:119]
    ds_read_b64_tr_b16 v[44:45], v14 offset:6272
    ds_read_b64_tr_b16 v[46:47], v14 offset:7040
    ds_read_b64_tr_b16 v[48:49], v14 offset:18432
    ds_read_b64_tr_b16 v[50:51], v14 offset:19200
    v_mfma_f32_32x32x16_bf16 v[120:135], v[72:75], v[60:63], v[120:135]
    ds_read_b64_tr_b16 v[52:53], v14 offset:18496
    ds_read_b64_tr_b16 v[54:55], v14 offset:19264
    ds_read_b64_tr_b16 v[56:57], v14 offset:18560
    ds_read_b64_tr_b16 v[58:59], v14 offset:19328
    v_mfma_f32_32x32x16_bf16 v[136:151], v[76:79], v[60:63], v[136:151]
    v_mfma_f32_32x32x16_bf16 v[152:167], v[80:83], v[60:63], v[152:167]
    v_mfma_f32_32x32x16_bf16 v[168:183], v[84:87], v[60:63], v[168:183]
    s_waitcnt lgkmcnt(0)
    v_mfma_f32_32x32x16_bf16 v[88:103], v[36:39], v[32:35], v[88:103]
    ds_read_b128 v[60:63], v13
    ds_read_b64_tr_b16 v[64:65], v14 offset:9216
    ds_read_b64_tr_b16 v[66:67], v14 offset:9984
    ds_read_b64_tr_b16 v[68:69], v14 offset:9280
    ds_read_b64_tr_b16 v[70:71], v14 offset:10048
    v_mfma_f32_32x32x16_bf16 v[104:119], v[40:43], v[32:35], v[104:119]
    ds_read_b64_tr_b16 v[72:73], v14 offset:9344
    ds_read_b64_tr_b16 v[74:75], v14 offset:10112
    ds_read_b64_tr_b16 v[76:77], v14 offset:21504
    ds_read_b64_tr_b16 v[78:79], v14 offset:22272
    v_mfma_f32_32x32x16_bf16 v[120:135], v[44:47], v[32:35], v[120:135]
    ds_read_b64_tr_b16 v[80:81], v14 offset:21568
    ds_read_b64_tr_b16 v[82:83], v14 offset:22336
    ds_read_b64_tr_b16 v[84:85], v14 offset:21632
    ds_read_b64_tr_b16 v[86:87], v14 offset:22400
    v_mfma_f32_32x32x16_bf16 v[136:151], v[48:51], v[32:35], v[136:151]
    v_mfma_f32_32x32x16_bf16 v[152:167], v[52:55], v[32:35], v[152:167]
    v_mfma_f32_32x32x16_bf16 v[168:183], v[56:59], v[32:35], v[168:183]
    s_waitcnt lgkmcnt(0)
    v_mfma_f32_32x32x16_bf16 v[88:103], v[64:67], v[60:63], v[88:103]
    v_mfma_f32_32x32x16_bf16 v[104:119], v[68:71], v[60:63], v[104:119]
    v_mfma_f32_32x32x16_bf16 v[120:135], v[72:75], v[60:63], v[120:135]
    v_mfma_f32_32x32x16_bf16 v[136:151], v[76:79], v[60:63], v[136:151]
    v_mfma_f32_32x32x16_bf16 v[152:167], v[80:83], v[60:63], v[152:167]
    v_mfma_f32_32x32x16_bf16 v[168:183], v[84:87], v[60:63], v[168:183]
    buffer_load_dwordx4 v[32:35], v30, s[68:71], 0 offen offset:256 sc1
    buffer_load_dwordx4 v[36:39], v30, s[68:71], 0 offen offset:288 sc1
    buffer_load_dwordx4 v[40:43], v30, s[68:71], 0 offen offset:320 sc1
    buffer_load_dwordx4 v[44:47], v30, s[68:71], 0 offen offset:352 sc1
    s_barrier
    buffer_load_dwordx4 v[60:63], v31, s[68:71], 0 offen offset:256 sc1
    buffer_load_dwordx4 v[64:67], v31, s[68:71], 0 offen offset:288 sc1
    buffer_load_dwordx4 v[68:71], v31, s[68:71], 0 offen offset:320 sc1
    buffer_load_dwordx4 v[72:75], v31, s[68:71], 0 offen offset:352 sc1
    s_mul_i32 s32, s29, 6656
    v_and_b32 v25, 31, v1
    v_mul_u32_u24 v25, 208, v25
    v_lshrrev_b32 v26, 5, v1
    v_lshl_add_u32 v25, v26, 3, v25
    v_add_u32 v25, s32, v25
    s_lshl_b32 s33, s26, 7
    s_lshl_b32 s38, s29, 5
    s_add_u32 s33, s33, s38
    s_mul_i32 s38, s27, 192
    s_mov_b32 s39, 43691
    v_mov_b32 v16, 0xbfb8aa3b
    v_mov_b32 v17, 0xbfb8aa3b
    v_mov_b32 v18, 1.0
    v_mov_b32 v19, 1.0
    s_waitcnt vmcnt(8)
    v_pk_fma_f32 v[88:89], v[184:185], v[188:189], v[88:89] neg_lo:[1,0,0] neg_hi:[1,0,0]
    v_pk_fma_f32 v[136:137], v[184:185], v[204:205], v[136:137] neg_lo:[1,0,0] neg_hi:[1,0,0]
    v_pk_mul_f32 v[88:89], v[88:89], v[186:187]
    v_pk_mul_f32 v[136:137], v[136:137], v[186:187]
    v_cvt_pk_bf16_f32 v20, v88, v89
    v_cvt_pk_bf16_f32 v21, v136, v137
    v_lshlrev_b32 v88, 16, v20
    v_and_b32 v89, 0xffff0000, v20
    v_lshlrev_b32 v136, 16, v21
    v_and_b32 v137, 0xffff0000, v21
    v_pk_mul_f32 v[88:89], v[88:89], v[16:17]
    v_exp_f32 v88, v88
    v_exp_f32 v89, v89
    s_nop 0
    v_pk_add_f32 v[88:89], v[88:89], v[18:19]
    v_rcp_f32 v88, v88
    v_rcp_f32 v89, v89
    s_nop 0
    v_cvt_pk_bf16_f32 v20, v88, v89
    v_lshlrev_b32 v88, 16, v20
    v_and_b32 v89, 0xffff0000, v20
    v_pk_mul_f32 v[88:89], v[88:89], v[136:137]
    v_pk_fma_f32 v[90:91], v[184:185], v[190:191], v[90:91] neg_lo:[1,0,0] neg_hi:[1,0,0]
    v_pk_fma_f32 v[138:139], v[184:185], v[206:207], v[138:139] neg_lo:[1,0,0] neg_hi:[1,0,0]
    v_pk_mul_f32 v[90:91], v[90:91], v[186:187]
    v_pk_mul_f32 v[138:139], v[138:139], v[186:187]
    v_cvt_pk_bf16_f32 v20, v90, v91
    v_cvt_pk_bf16_f32 v21, v138, v139
    v_lshlrev_b32 v90, 16, v20
    v_and_b32 v91, 0xffff0000, v20
    v_lshlrev_b32 v138, 16, v21
    v_and_b32 v139, 0xffff0000, v21
    v_pk_mul_f32 v[90:91], v[90:91], v[16:17]
    v_exp_f32 v90, v90
    v_exp_f32 v91, v91
    s_nop 0
    v_pk_add_f32 v[90:91], v[90:91], v[18:19]
    v_rcp_f32 v90, v90
    v_rcp_f32 v91, v91
    s_nop 0
    v_cvt_pk_bf16_f32 v20, v90, v91
    v_lshlrev_b32 v90, 16, v20
    v_and_b32 v91, 0xffff0000, v20
    v_pk_mul_f32 v[90:91], v[90:91], v[138:139]
    v_pk_fma_f32 v[92:93], v[184:185], v[192:193], v[92:93] neg_lo:[1,0,0] neg_hi:[1,0,0]
    v_pk_fma_f32 v[140:141], v[184:185], v[208:209], v[140:141] neg_lo:[1,0,0] neg_hi:[1,0,0]
    v_pk_mul_f32 v[92:93], v[92:93], v[186:187]
    v_pk_mul_f32 v[140:141], v[140:141], v[186:187]
    v_cvt_pk_bf16_f32 v20, v92, v93
    v_cvt_pk_bf16_f32 v21, v140, v141
    v_lshlrev_b32 v92, 16, v20
    v_and_b32 v93, 0xffff0000, v20
    v_lshlrev_b32 v140, 16, v21
    v_and_b32 v141, 0xffff0000, v21
    v_pk_mul_f32 v[92:93], v[92:93], v[16:17]
    v_exp_f32 v92, v92
    v_exp_f32 v93, v93
    s_nop 0
    v_pk_add_f32 v[92:93], v[92:93], v[18:19]
    v_rcp_f32 v92, v92
    v_rcp_f32 v93, v93
    s_nop 0
    v_cvt_pk_bf16_f32 v20, v92, v93
    v_lshlrev_b32 v92, 16, v20
    v_and_b32 v93, 0xffff0000, v20
    v_pk_mul_f32 v[92:93], v[92:93], v[140:141]
    v_pk_fma_f32 v[94:95], v[184:185], v[194:195], v[94:95] neg_lo:[1,0,0] neg_hi:[1,0,0]
    v_pk_fma_f32 v[142:143], v[184:185], v[210:211], v[142:143] neg_lo:[1,0,0] neg_hi:[1,0,0]
    v_pk_mul_f32 v[94:95], v[94:95], v[186:187]
    v_pk_mul_f32 v[142:143], v[142:143], v[186:187]
    v_cvt_pk_bf16_f32 v20, v94, v95
    v_cvt_pk_bf16_f32 v21, v142, v143
    v_lshlrev_b32 v94, 16, v20
    v_and_b32 v95, 0xffff0000, v20
    v_lshlrev_b32 v142, 16, v21
    v_and_b32 v143, 0xffff0000, v21
    v_pk_mul_f32 v[94:95], v[94:95], v[16:17]
    v_exp_f32 v94, v94
    v_exp_f32 v95, v95
    s_nop 0
    v_pk_add_f32 v[94:95], v[94:95], v[18:19]
    v_rcp_f32 v94, v94
    v_rcp_f32 v95, v95
    s_nop 0
    v_cvt_pk_bf16_f32 v20, v94, v95
    v_lshlrev_b32 v94, 16, v20
    v_and_b32 v95, 0xffff0000, v20
    v_pk_mul_f32 v[94:95], v[94:95], v[142:143]
    v_pk_fma_f32 v[96:97], v[184:185], v[196:197], v[96:97] neg_lo:[1,0,0] neg_hi:[1,0,0]
    v_pk_fma_f32 v[144:145], v[184:185], v[212:213], v[144:145] neg_lo:[1,0,0] neg_hi:[1,0,0]
    v_pk_mul_f32 v[96:97], v[96:97], v[186:187]
    v_pk_mul_f32 v[144:145], v[144:145], v[186:187]
    v_cvt_pk_bf16_f32 v20, v96, v97
    v_cvt_pk_bf16_f32 v21, v144, v145
    v_lshlrev_b32 v96, 16, v20
    v_and_b32 v97, 0xffff0000, v20
    v_lshlrev_b32 v144, 16, v21
    v_and_b32 v145, 0xffff0000, v21
    v_pk_mul_f32 v[96:97], v[96:97], v[16:17]
    v_exp_f32 v96, v96
    v_exp_f32 v97, v97
    s_nop 0
    v_pk_add_f32 v[96:97], v[96:97], v[18:19]
    v_rcp_f32 v96, v96
    v_rcp_f32 v97, v97
    s_nop 0
    v_cvt_pk_bf16_f32 v20, v96, v97
    v_lshlrev_b32 v96, 16, v20
    v_and_b32 v97, 0xffff0000, v20
    v_pk_mul_f32 v[96:97], v[96:97], v[144:145]
    v_pk_fma_f32 v[98:99], v[184:185], v[198:199], v[98:99] neg_lo:[1,0,0] neg_hi:[1,0,0]
    v_pk_fma_f32 v[146:147], v[184:185], v[214:215], v[146:147] neg_lo:[1,0,0] neg_hi:[1,0,0]
    v_pk_mul_f32 v[98:99], v[98:99], v[186:187]
    v_pk_mul_f32 v[146:147], v[146:147], v[186:187]
    v_cvt_pk_bf16_f32 v20, v98, v99
    v_cvt_pk_bf16_f32 v21, v146, v147
    v_lshlrev_b32 v98, 16, v20
    v_and_b32 v99, 0xffff0000, v20
    v_lshlrev_b32 v146, 16, v21
    v_and_b32 v147, 0xffff0000, v21
    v_pk_mul_f32 v[98:99], v[98:99], v[16:17]
    v_exp_f32 v98, v98
    v_exp_f32 v99, v99
    s_nop 0
    v_pk_add_f32 v[98:99], v[98:99], v[18:19]
    v_rcp_f32 v98, v98
    v_rcp_f32 v99, v99
    s_nop 0
    v_cvt_pk_bf16_f32 v20, v98, v99
    v_lshlrev_b32 v98, 16, v20
    v_and_b32 v99, 0xffff0000, v20
    v_pk_mul_f32 v[98:99], v[98:99], v[146:147]
    v_pk_fma_f32 v[100:101], v[184:185], v[200:201], v[100:101] neg_lo:[1,0,0] neg_hi:[1,0,0]
    v_pk_fma_f32 v[148:149], v[184:185], v[216:217], v[148:149] neg_lo:[1,0,0] neg_hi:[1,0,0]
    v_pk_mul_f32 v[100:101], v[100:101], v[186:187]
    v_pk_mul_f32 v[148:149], v[148:149], v[186:187]
    v_cvt_pk_bf16_f32 v20, v100, v101
    v_cvt_pk_bf16_f32 v21, v148, v149
    v_lshlrev_b32 v100, 16, v20
    v_and_b32 v101, 0xffff0000, v20
    v_lshlrev_b32 v148, 16, v21
    v_and_b32 v149, 0xffff0000, v21
    v_pk_mul_f32 v[100:101], v[100:101], v[16:17]
    v_exp_f32 v100, v100
    v_exp_f32 v101, v101
    s_nop 0
    v_pk_add_f32 v[100:101], v[100:101], v[18:19]
    v_rcp_f32 v100, v100
    v_rcp_f32 v101, v101
    s_nop 0
    v_cvt_pk_bf16_f32 v20, v100, v101
    v_lshlrev_b32 v100, 16, v20
    v_and_b32 v101, 0xffff0000, v20
    v_pk_mul_f32 v[100:101], v[100:101], v[148:149]
    v_pk_fma_f32 v[102:103], v[184:185], v[202:203], v[102:103] neg_lo:[1,0,0] neg_hi:[1,0,0]
    v_pk_fma_f32 v[150:151], v[184:185], v[218:219], v[150:151] neg_lo:[1,0,0] neg_hi:[1,0,0]
    v_pk_mul_f32 v[102:103], v[102:103], v[186:187]
    v_pk_mul_f32 v[150:151], v[150:151], v[186:187]
    v_cvt_pk_bf16_f32 v20, v102, v103
    v_cvt_pk_bf16_f32 v21, v150, v151
    v_lshlrev_b32 v102, 16, v20
    v_and_b32 v103, 0xffff0000, v20
    v_lshlrev_b32 v150, 16, v21
    v_and_b32 v151, 0xffff0000, v21
    v_pk_mul_f32 v[102:103], v[102:103], v[16:17]
    v_exp_f32 v102, v102
    v_exp_f32 v103, v103
    s_nop 0
    v_pk_add_f32 v[102:103], v[102:103], v[18:19]
    v_rcp_f32 v102, v102
    v_rcp_f32 v103, v103
    s_nop 0
    v_cvt_pk_bf16_f32 v20, v102, v103
    v_lshlrev_b32 v102, 16, v20
    v_and_b32 v103, 0xffff0000, v20
    v_pk_mul_f32 v[102:103], v[102:103], v[150:151]
    v_cvt_pk_bf16_f32 v2, v88, v89
    v_cvt_pk_bf16_f32 v3, v90, v91
    ds_write_b64 v25, v[2:3] offset:0
    v_cvt_pk_bf16_f32 v4, v92, v93
    v_cvt_pk_bf16_f32 v5, v94, v95
    ds_write_b64 v25, v[4:5] offset:16
    v_cvt_pk_bf16_f32 v6, v96, v97
    v_cvt_pk_bf16_f32 v7, v98, v99
    ds_write_b64 v25, v[6:7] offset:32
    v_cvt_pk_bf16_f32 v8, v100, v101
    v_cvt_pk_bf16_f32 v9, v102, v103
    ds_write_b64 v25, v[8:9] offset:48
    v_pk_fma_f32 v[104:105], v[184:185], v[220:221], v[104:105] neg_lo:[1,0,0] neg_hi:[1,0,0]
    v_pk_fma_f32 v[152:153], v[184:185], v[236:237], v[152:153] neg_lo:[1,0,0] neg_hi:[1,0,0]
    v_pk_mul_f32 v[104:105], v[104:105], v[186:187]
    v_pk_mul_f32 v[152:153], v[152:153], v[186:187]
    v_cvt_pk_bf16_f32 v20, v104, v105
    v_cvt_pk_bf16_f32 v21, v152, v153
    v_lshlrev_b32 v104, 16, v20
    v_and_b32 v105, 0xffff0000, v20
    v_lshlrev_b32 v152, 16, v21
    v_and_b32 v153, 0xffff0000, v21
    v_pk_mul_f32 v[104:105], v[104:105], v[16:17]
    v_exp_f32 v104, v104
    v_exp_f32 v105, v105
    s_nop 0
    v_pk_add_f32 v[104:105], v[104:105], v[18:19]
    v_rcp_f32 v104, v104
    v_rcp_f32 v105, v105
    s_nop 0
    v_cvt_pk_bf16_f32 v20, v104, v105
    v_lshlrev_b32 v104, 16, v20
    v_and_b32 v105, 0xffff0000, v20
    v_pk_mul_f32 v[104:105], v[104:105], v[152:153]
    v_pk_fma_f32 v[106:107], v[184:185], v[222:223], v[106:107] neg_lo:[1,0,0] neg_hi:[1,0,0]
    v_pk_fma_f32 v[154:155], v[184:185], v[238:239], v[154:155] neg_lo:[1,0,0] neg_hi:[1,0,0]
    v_pk_mul_f32 v[106:107], v[106:107], v[186:187]
    v_pk_mul_f32 v[154:155], v[154:155], v[186:187]
    v_cvt_pk_bf16_f32 v20, v106, v107
    v_cvt_pk_bf16_f32 v21, v154, v155
    v_lshlrev_b32 v106, 16, v20
    v_and_b32 v107, 0xffff0000, v20
    v_lshlrev_b32 v154, 16, v21
    v_and_b32 v155, 0xffff0000, v21
    v_pk_mul_f32 v[106:107], v[106:107], v[16:17]
    v_exp_f32 v106, v106
    v_exp_f32 v107, v107
    s_nop 0
    v_pk_add_f32 v[106:107], v[106:107], v[18:19]
    v_rcp_f32 v106, v106
    v_rcp_f32 v107, v107
    s_nop 0
    v_cvt_pk_bf16_f32 v20, v106, v107
    v_lshlrev_b32 v106, 16, v20
    v_and_b32 v107, 0xffff0000, v20
    v_pk_mul_f32 v[106:107], v[106:107], v[154:155]
    v_pk_fma_f32 v[108:109], v[184:185], v[224:225], v[108:109] neg_lo:[1,0,0] neg_hi:[1,0,0]
    v_pk_fma_f32 v[156:157], v[184:185], v[240:241], v[156:157] neg_lo:[1,0,0] neg_hi:[1,0,0]
    v_pk_mul_f32 v[108:109], v[108:109], v[186:187]
    v_pk_mul_f32 v[156:157], v[156:157], v[186:187]
    v_cvt_pk_bf16_f32 v20, v108, v109
    v_cvt_pk_bf16_f32 v21, v156, v157
    v_lshlrev_b32 v108, 16, v20
    v_and_b32 v109, 0xffff0000, v20
    v_lshlrev_b32 v156, 16, v21
    v_and_b32 v157, 0xffff0000, v21
    v_pk_mul_f32 v[108:109], v[108:109], v[16:17]
    v_exp_f32 v108, v108
    v_exp_f32 v109, v109
    s_nop 0
    v_pk_add_f32 v[108:109], v[108:109], v[18:19]
    v_rcp_f32 v108, v108
    v_rcp_f32 v109, v109
    s_nop 0
    v_cvt_pk_bf16_f32 v20, v108, v109
    v_lshlrev_b32 v108, 16, v20
    v_and_b32 v109, 0xffff0000, v20
    v_pk_mul_f32 v[108:109], v[108:109], v[156:157]
    v_pk_fma_f32 v[110:111], v[184:185], v[226:227], v[110:111] neg_lo:[1,0,0] neg_hi:[1,0,0]
    v_pk_fma_f32 v[158:159], v[184:185], v[242:243], v[158:159] neg_lo:[1,0,0] neg_hi:[1,0,0]
    v_pk_mul_f32 v[110:111], v[110:111], v[186:187]
    v_pk_mul_f32 v[158:159], v[158:159], v[186:187]
    v_cvt_pk_bf16_f32 v20, v110, v111
    v_cvt_pk_bf16_f32 v21, v158, v159
    v_lshlrev_b32 v110, 16, v20
    v_and_b32 v111, 0xffff0000, v20
    v_lshlrev_b32 v158, 16, v21
    v_and_b32 v159, 0xffff0000, v21
    v_pk_mul_f32 v[110:111], v[110:111], v[16:17]
    v_exp_f32 v110, v110
    v_exp_f32 v111, v111
    s_nop 0
    v_pk_add_f32 v[110:111], v[110:111], v[18:19]
    v_rcp_f32 v110, v110
    v_rcp_f32 v111, v111
    s_nop 0
    v_cvt_pk_bf16_f32 v20, v110, v111
    v_lshlrev_b32 v110, 16, v20
    v_and_b32 v111, 0xffff0000, v20
    v_pk_mul_f32 v[110:111], v[110:111], v[158:159]
    v_pk_fma_f32 v[112:113], v[184:185], v[228:229], v[112:113] neg_lo:[1,0,0] neg_hi:[1,0,0]
    v_pk_fma_f32 v[160:161], v[184:185], v[244:245], v[160:161] neg_lo:[1,0,0] neg_hi:[1,0,0]
    v_pk_mul_f32 v[112:113], v[112:113], v[186:187]
    v_pk_mul_f32 v[160:161], v[160:161], v[186:187]
    v_cvt_pk_bf16_f32 v20, v112, v113
    v_cvt_pk_bf16_f32 v21, v160, v161
    v_lshlrev_b32 v112, 16, v20
    v_and_b32 v113, 0xffff0000, v20
    v_lshlrev_b32 v160, 16, v21
    v_and_b32 v161, 0xffff0000, v21
    v_pk_mul_f32 v[112:113], v[112:113], v[16:17]
    v_exp_f32 v112, v112
    v_exp_f32 v113, v113
    s_nop 0
    v_pk_add_f32 v[112:113], v[112:113], v[18:19]
    v_rcp_f32 v112, v112
    v_rcp_f32 v113, v113
    s_nop 0
    v_cvt_pk_bf16_f32 v20, v112, v113
    v_lshlrev_b32 v112, 16, v20
    v_and_b32 v113, 0xffff0000, v20
    v_pk_mul_f32 v[112:113], v[112:113], v[160:161]
    v_pk_fma_f32 v[114:115], v[184:185], v[230:231], v[114:115] neg_lo:[1,0,0] neg_hi:[1,0,0]
    v_pk_fma_f32 v[162:163], v[184:185], v[246:247], v[162:163] neg_lo:[1,0,0] neg_hi:[1,0,0]
    v_pk_mul_f32 v[114:115], v[114:115], v[186:187]
    v_pk_mul_f32 v[162:163], v[162:163], v[186:187]
    v_cvt_pk_bf16_f32 v20, v114, v115
    v_cvt_pk_bf16_f32 v21, v162, v163
    v_lshlrev_b32 v114, 16, v20
    v_and_b32 v115, 0xffff0000, v20
    v_lshlrev_b32 v162, 16, v21
    v_and_b32 v163, 0xffff0000, v21
    v_pk_mul_f32 v[114:115], v[114:115], v[16:17]
    v_exp_f32 v114, v114
    v_exp_f32 v115, v115
    s_nop 0
    v_pk_add_f32 v[114:115], v[114:115], v[18:19]
    v_rcp_f32 v114, v114
    v_rcp_f32 v115, v115
    s_nop 0
    v_cvt_pk_bf16_f32 v20, v114, v115
    v_lshlrev_b32 v114, 16, v20
    v_and_b32 v115, 0xffff0000, v20
    v_pk_mul_f32 v[114:115], v[114:115], v[162:163]
    v_pk_fma_f32 v[116:117], v[184:185], v[232:233], v[116:117] neg_lo:[1,0,0] neg_hi:[1,0,0]
    v_pk_fma_f32 v[164:165], v[184:185], v[248:249], v[164:165] neg_lo:[1,0,0] neg_hi:[1,0,0]
    v_pk_mul_f32 v[116:117], v[116:117], v[186:187]
    v_pk_mul_f32 v[164:165], v[164:165], v[186:187]
    v_cvt_pk_bf16_f32 v20, v116, v117
    v_cvt_pk_bf16_f32 v21, v164, v165
    v_lshlrev_b32 v116, 16, v20
    v_and_b32 v117, 0xffff0000, v20
    v_lshlrev_b32 v164, 16, v21
    v_and_b32 v165, 0xffff0000, v21
    v_pk_mul_f32 v[116:117], v[116:117], v[16:17]
    v_exp_f32 v116, v116
    v_exp_f32 v117, v117
    s_nop 0
    v_pk_add_f32 v[116:117], v[116:117], v[18:19]
    v_rcp_f32 v116, v116
    v_rcp_f32 v117, v117
    s_nop 0
    v_cvt_pk_bf16_f32 v20, v116, v117
    v_lshlrev_b32 v116, 16, v20
    v_and_b32 v117, 0xffff0000, v20
    v_pk_mul_f32 v[116:117], v[116:117], v[164:165]
    v_pk_fma_f32 v[118:119], v[184:185], v[234:235], v[118:119] neg_lo:[1,0,0] neg_hi:[1,0,0]
    v_pk_fma_f32 v[166:167], v[184:185], v[250:251], v[166:167] neg_lo:[1,0,0] neg_hi:[1,0,0]
    v_pk_mul_f32 v[118:119], v[118:119], v[186:187]
    v_pk_mul_f32 v[166:167], v[166:167], v[186:187]
    v_cvt_pk_bf16_f32 v20, v118, v119
    v_cvt_pk_bf16_f32 v21, v166, v167
    v_lshlrev_b32 v118, 16, v20
    v_and_b32 v119, 0xffff0000, v20
    v_lshlrev_b32 v166, 16, v21
    v_and_b32 v167, 0xffff0000, v21
    v_pk_mul_f32 v[118:119], v[118:119], v[16:17]
    v_exp_f32 v118, v118
    v_exp_f32 v119, v119
    s_nop 0
    v_pk_add_f32 v[118:119], v[118:119], v[18:19]
    v_rcp_f32 v118, v118
    v_rcp_f32 v119, v119
    s_nop 0
    v_cvt_pk_bf16_f32 v20, v118, v119
    v_lshlrev_b32 v118, 16, v20
    v_and_b32 v119, 0xffff0000, v20
    v_pk_mul_f32 v[118:119], v[118:119], v[166:167]
    v_cvt_pk_bf16_f32 v2, v104, v105
    v_cvt_pk_bf16_f32 v3, v106, v107
    ds_write_b64 v25, v[2:3] offset:64
    v_cvt_pk_bf16_f32 v4, v108, v109
    v_cvt_pk_bf16_f32 v5, v110, v111
    ds_write_b64 v25, v[4:5] offset:80
    v_cvt_pk_bf16_f32 v6, v112, v113
    v_cvt_pk_bf16_f32 v7, v114, v115
    ds_write_b64 v25, v[6:7] offset:96
    v_cvt_pk_bf16_f32 v8, v116, v117
    v_cvt_pk_bf16_f32 v9, v118, v119
    ds_write_b64 v25, v[8:9] offset:112
    s_waitcnt vmcnt(0)
    v_pk_fma_f32 v[120:121], v[184:185], v[32:33], v[120:121] neg_lo:[1,0,0] neg_hi:[1,0,0]
    v_pk_fma_f32 v[168:169], v[184:185], v[60:61], v[168:169] neg_lo:[1,0,0] neg_hi:[1,0,0]
    v_pk_mul_f32 v[120:121], v[120:121], v[186:187]
    v_pk_mul_f32 v[168:169], v[168:169], v[186:187]
    v_cvt_pk_bf16_f32 v20, v120, v121
    v_cvt_pk_bf16_f32 v21, v168, v169
    v_lshlrev_b32 v120, 16, v20
    v_and_b32 v121, 0xffff0000, v20
    v_lshlrev_b32 v168, 16, v21
    v_and_b32 v169, 0xffff0000, v21
    v_pk_mul_f32 v[120:121], v[120:121], v[16:17]
    v_exp_f32 v120, v120
    v_exp_f32 v121, v121
    s_nop 0
    v_pk_add_f32 v[120:121], v[120:121], v[18:19]
    v_rcp_f32 v120, v120
    v_rcp_f32 v121, v121
    s_nop 0
    v_cvt_pk_bf16_f32 v20, v120, v121
    v_lshlrev_b32 v120, 16, v20
    v_and_b32 v121, 0xffff0000, v20
    v_pk_mul_f32 v[120:121], v[120:121], v[168:169]
    v_pk_fma_f32 v[122:123], v[184:185], v[34:35], v[122:123] neg_lo:[1,0,0] neg_hi:[1,0,0]
    v_pk_fma_f32 v[170:171], v[184:185], v[62:63], v[170:171] neg_lo:[1,0,0] neg_hi:[1,0,0]
    v_pk_mul_f32 v[122:123], v[122:123], v[186:187]
    v_pk_mul_f32 v[170:171], v[170:171], v[186:187]
    v_cvt_pk_bf16_f32 v20, v122, v123
    v_cvt_pk_bf16_f32 v21, v170, v171
    v_lshlrev_b32 v122, 16, v20
    v_and_b32 v123, 0xffff0000, v20
    v_lshlrev_b32 v170, 16, v21
    v_and_b32 v171, 0xffff0000, v21
    v_pk_mul_f32 v[122:123], v[122:123], v[16:17]
    v_exp_f32 v122, v122
    v_exp_f32 v123, v123
    s_nop 0
    v_pk_add_f32 v[122:123], v[122:123], v[18:19]
    v_rcp_f32 v122, v122
    v_rcp_f32 v123, v123
    s_nop 0
    v_cvt_pk_bf16_f32 v20, v122, v123
    v_lshlrev_b32 v122, 16, v20
    v_and_b32 v123, 0xffff0000, v20
    v_pk_mul_f32 v[122:123], v[122:123], v[170:171]
    v_pk_fma_f32 v[124:125], v[184:185], v[36:37], v[124:125] neg_lo:[1,0,0] neg_hi:[1,0,0]
    v_pk_fma_f32 v[172:173], v[184:185], v[64:65], v[172:173] neg_lo:[1,0,0] neg_hi:[1,0,0]
    v_pk_mul_f32 v[124:125], v[124:125], v[186:187]
    v_pk_mul_f32 v[172:173], v[172:173], v[186:187]
    v_cvt_pk_bf16_f32 v20, v124, v125
    v_cvt_pk_bf16_f32 v21, v172, v173
    v_lshlrev_b32 v124, 16, v20
    v_and_b32 v125, 0xffff0000, v20
    v_lshlrev_b32 v172, 16, v21
    v_and_b32 v173, 0xffff0000, v21
    v_pk_mul_f32 v[124:125], v[124:125], v[16:17]
    v_exp_f32 v124, v124
    v_exp_f32 v125, v125
    s_nop 0
    v_pk_add_f32 v[124:125], v[124:125], v[18:19]
    v_rcp_f32 v124, v124
    v_rcp_f32 v125, v125
    s_nop 0
    v_cvt_pk_bf16_f32 v20, v124, v125
    v_lshlrev_b32 v124, 16, v20
    v_and_b32 v125, 0xffff0000, v20
    v_pk_mul_f32 v[124:125], v[124:125], v[172:173]
    v_pk_fma_f32 v[126:127], v[184:185], v[38:39], v[126:127] neg_lo:[1,0,0] neg_hi:[1,0,0]
    v_pk_fma_f32 v[174:175], v[184:185], v[66:67], v[174:175] neg_lo:[1,0,0] neg_hi:[1,0,0]
    v_pk_mul_f32 v[126:127], v[126:127], v[186:187]
    v_pk_mul_f32 v[174:175], v[174:175], v[186:187]
    v_cvt_pk_bf16_f32 v20, v126, v127
    v_cvt_pk_bf16_f32 v21, v174, v175
    v_lshlrev_b32 v126, 16, v20
    v_and_b32 v127, 0xffff0000, v20
    v_lshlrev_b32 v174, 16, v21
    v_and_b32 v175, 0xffff0000, v21
    v_pk_mul_f32 v[126:127], v[126:127], v[16:17]
    v_exp_f32 v126, v126
    v_exp_f32 v127, v127
    s_nop 0
    v_pk_add_f32 v[126:127], v[126:127], v[18:19]
    v_rcp_f32 v126, v126
    v_rcp_f32 v127, v127
    s_nop 0
    v_cvt_pk_bf16_f32 v20, v126, v127
    v_lshlrev_b32 v126, 16, v20
    v_and_b32 v127, 0xffff0000, v20
    v_pk_mul_f32 v[126:127], v[126:127], v[174:175]
    v_pk_fma_f32 v[128:129], v[184:185], v[40:41], v[128:129] neg_lo:[1,0,0] neg_hi:[1,0,0]
    v_pk_fma_f32 v[176:177], v[184:185], v[68:69], v[176:177] neg_lo:[1,0,0] neg_hi:[1,0,0]
    v_pk_mul_f32 v[128:129], v[128:129], v[186:187]
    v_pk_mul_f32 v[176:177], v[176:177], v[186:187]
    v_cvt_pk_bf16_f32 v20, v128, v129
    v_cvt_pk_bf16_f32 v21, v176, v177
    v_lshlrev_b32 v128, 16, v20
    v_and_b32 v129, 0xffff0000, v20
    v_lshlrev_b32 v176, 16, v21
    v_and_b32 v177, 0xffff0000, v21
    v_pk_mul_f32 v[128:129], v[128:129], v[16:17]
    v_exp_f32 v128, v128
    v_exp_f32 v129, v129
    s_nop 0
    v_pk_add_f32 v[128:129], v[128:129], v[18:19]
    v_rcp_f32 v128, v128
    v_rcp_f32 v129, v129
    s_nop 0
    v_cvt_pk_bf16_f32 v20, v128, v129
    v_lshlrev_b32 v128, 16, v20
    v_and_b32 v129, 0xffff0000, v20
    v_pk_mul_f32 v[128:129], v[128:129], v[176:177]
    v_pk_fma_f32 v[130:131], v[184:185], v[42:43], v[130:131] neg_lo:[1,0,0] neg_hi:[1,0,0]
    v_pk_fma_f32 v[178:179], v[184:185], v[70:71], v[178:179] neg_lo:[1,0,0] neg_hi:[1,0,0]
    v_pk_mul_f32 v[130:131], v[130:131], v[186:187]
    v_pk_mul_f32 v[178:179], v[178:179], v[186:187]
    v_cvt_pk_bf16_f32 v20, v130, v131
    v_cvt_pk_bf16_f32 v21, v178, v179
    v_lshlrev_b32 v130, 16, v20
    v_and_b32 v131, 0xffff0000, v20
    v_lshlrev_b32 v178, 16, v21
    v_and_b32 v179, 0xffff0000, v21
    v_pk_mul_f32 v[130:131], v[130:131], v[16:17]
    v_exp_f32 v130, v130
    v_exp_f32 v131, v131
    s_nop 0
    v_pk_add_f32 v[130:131], v[130:131], v[18:19]
    v_rcp_f32 v130, v130
    v_rcp_f32 v131, v131
    s_nop 0
    v_cvt_pk_bf16_f32 v20, v130, v131
    v_lshlrev_b32 v130, 16, v20
    v_and_b32 v131, 0xffff0000, v20
    v_pk_mul_f32 v[130:131], v[130:131], v[178:179]
    v_pk_fma_f32 v[132:133], v[184:185], v[44:45], v[132:133] neg_lo:[1,0,0] neg_hi:[1,0,0]
    v_pk_fma_f32 v[180:181], v[184:185], v[72:73], v[180:181] neg_lo:[1,0,0] neg_hi:[1,0,0]
    v_pk_mul_f32 v[132:133], v[132:133], v[186:187]
    v_pk_mul_f32 v[180:181], v[180:181], v[186:187]
    v_cvt_pk_bf16_f32 v20, v132, v133
    v_cvt_pk_bf16_f32 v21, v180, v181
    v_lshlrev_b32 v132, 16, v20
    v_and_b32 v133, 0xffff0000, v20
    v_lshlrev_b32 v180, 16, v21
    v_and_b32 v181, 0xffff0000, v21
    v_pk_mul_f32 v[132:133], v[132:133], v[16:17]
    v_exp_f32 v132, v132
    v_exp_f32 v133, v133
    s_nop 0
    v_pk_add_f32 v[132:133], v[132:133], v[18:19]
    v_rcp_f32 v132, v132
    v_rcp_f32 v133, v133
    s_nop 0
    v_cvt_pk_bf16_f32 v20, v132, v133
    v_lshlrev_b32 v132, 16, v20
    v_and_b32 v133, 0xffff0000, v20
    v_pk_mul_f32 v[132:133], v[132:133], v[180:181]
    v_pk_fma_f32 v[134:135], v[184:185], v[46:47], v[134:135] neg_lo:[1,0,0] neg_hi:[1,0,0]
    v_pk_fma_f32 v[182:183], v[184:185], v[74:75], v[182:183] neg_lo:[1,0,0] neg_hi:[1,0,0]
    v_pk_mul_f32 v[134:135], v[134:135], v[186:187]
    v_pk_mul_f32 v[182:183], v[182:183], v[186:187]
    v_cvt_pk_bf16_f32 v20, v134, v135
    v_cvt_pk_bf16_f32 v21, v182, v183
    v_lshlrev_b32 v134, 16, v20
    v_and_b32 v135, 0xffff0000, v20
    v_lshlrev_b32 v182, 16, v21
    v_and_b32 v183, 0xffff0000, v21
    v_pk_mul_f32 v[134:135], v[134:135], v[16:17]
    v_exp_f32 v134, v134
    v_exp_f32 v135, v135
    s_nop 0
    v_pk_add_f32 v[134:135], v[134:135], v[18:19]
    v_rcp_f32 v134, v134
    v_rcp_f32 v135, v135
    s_nop 0
    v_cvt_pk_bf16_f32 v20, v134, v135
    v_lshlrev_b32 v134, 16, v20
    v_and_b32 v135, 0xffff0000, v20
    v_pk_mul_f32 v[134:135], v[134:135], v[182:183]
    v_cvt_pk_bf16_f32 v2, v120, v121
    v_cvt_pk_bf16_f32 v3, v122, v123
    ds_write_b64 v25, v[2:3] offset:128
    v_cvt_pk_bf16_f32 v4, v124, v125
    v_cvt_pk_bf16_f32 v5, v126, v127
    ds_write_b64 v25, v[4:5] offset:144
    v_cvt_pk_bf16_f32 v6, v128, v129
    v_cvt_pk_bf16_f32 v7, v130, v131
    ds_write_b64 v25, v[6:7] offset:160
    v_cvt_pk_bf16_f32 v8, v132, v133
    v_cvt_pk_bf16_f32 v9, v134, v135
    ds_write_b64 v25, v[8:9] offset:176
    v_add_u32 v26, 0, v1
    v_mul_lo_u32 v27, v26, s39
    v_lshrrev_b32 v27, 19, v27
    v_mul_u32_u24 v28, 12, v27
    v_sub_u32 v28, v26, v28
    v_mul_u32_u24 v26, 208, v27
    v_lshl_add_u32 v26, v28, 4, v26
    v_add_u32 v32, s32, v26
    v_add_u32 v27, s33, v27
    v_mul_u32_u24 v27, 3072, v27
    v_lshl_add_u32 v27, v28, 4, v27
    v_add_u32 v40, s38, v27
    v_add_u32 v26, 64, v1
    v_mul_lo_u32 v27, v26, s39
    v_lshrrev_b32 v27, 19, v27
    v_mul_u32_u24 v28, 12, v27
    v_sub_u32 v28, v26, v28
    v_mul_u32_u24 v26, 208, v27
    v_lshl_add_u32 v26, v28, 4, v26
    v_add_u32 v33, s32, v26
    v_add_u32 v27, s33, v27
    v_mul_u32_u24 v27, 3072, v27
    v_lshl_add_u32 v27, v28, 4, v27
    v_add_u32 v41, s38, v27
    v_add_u32 v26, 128, v1
    v_mul_lo_u32 v27, v26, s39
    v_lshrrev_b32 v27, 19, v27
    v_mul_u32_u24 v28, 12, v27
    v_sub_u32 v28, v26, v28
    v_mul_u32_u24 v26, 208, v27
    v_lshl_add_u32 v26, v28, 4, v26
    v_add_u32 v34, s32, v26
    v_add_u32 v27, s33, v27
    v_mul_u32_u24 v27, 3072, v27
    v_lshl_add_u32 v27, v28, 4, v27
    v_add_u32 v42, s38, v27
    v_add_u32 v26, 192, v1
    v_mul_lo_u32 v27, v26, s39
    v_lshrrev_b32 v27, 19, v27
    v_mul_u32_u24 v28, 12, v27
    v_sub_u32 v28, v26, v28
    v_mul_u32_u24 v26, 208, v27
    v_lshl_add_u32 v26, v28, 4, v26
    v_add_u32 v35, s32, v26
    v_add_u32 v27, s33, v27
    v_mul_u32_u24 v27, 3072, v27
    v_lshl_add_u32 v27, v28, 4, v27
    v_add_u32 v43, s38, v27
    v_add_u32 v26, 256, v1
    v_mul_lo_u32 v27, v26, s39
    v_lshrrev_b32 v27, 19, v27
    v_mul_u32_u24 v28, 12, v27
    v_sub_u32 v28, v26, v28
    v_mul_u32_u24 v26, 208, v27
    v_lshl_add_u32 v26, v28, 4, v26
    v_add_u32 v36, s32, v26
    v_add_u32 v27, s33, v27
    v_mul_u32_u24 v27, 3072, v27
    v_lshl_add_u32 v27, v28, 4, v27
    v_add_u32 v44, s38, v27
    v_add_u32 v26, 320, v1
    v_mul_lo_u32 v27, v26, s39
    v_lshrrev_b32 v27, 19, v27
    v_mul_u32_u24 v28, 12, v27
    v_sub_u32 v28, v26, v28
    v_mul_u32_u24 v26, 208, v27
    v_lshl_add_u32 v26, v28, 4, v26
    v_add_u32 v37, s32, v26
    v_add_u32 v27, s33, v27
    v_mul_u32_u24 v27, 3072, v27
    v_lshl_add_u32 v27, v28, 4, v27
    v_add_u32 v45, s38, v27
    s_waitcnt lgkmcnt(0)
    ds_read_b128 v[88:91], v32
    ds_read_b128 v[92:95], v33
    ds_read_b128 v[96:99], v34
    ds_read_b128 v[100:103], v35
    ds_read_b128 v[104:107], v36
    ds_read_b128 v[108:111], v37
    s_waitcnt lgkmcnt(5)
    buffer_store_dwordx4 v[88:91], v40, s[16:19], 0 offen
    s_waitcnt lgkmcnt(4)
    buffer_store_dwordx4 v[92:95], v41, s[16:19], 0 offen
    s_waitcnt lgkmcnt(3)
    buffer_store_dwordx4 v[96:99], v42, s[16:19], 0 offen
    s_waitcnt lgkmcnt(2)
    buffer_store_dwordx4 v[100:103], v43, s[16:19], 0 offen
    s_waitcnt lgkmcnt(1)
    buffer_store_dwordx4 v[104:107], v44, s[16:19], 0 offen
    s_waitcnt lgkmcnt(0)
    buffer_store_dwordx4 v[108:111], v45, s[16:19], 0 offen
    s_waitcnt vmcnt(0)
    s_barrier
    s_add_u32 s32, s26, 280
    s_cmp_lg_u32 s29, 0
    s_cbranch_scc1 nosig_mega_kernel_43
    s_lshl_b32 s38, s32, 7
    s_lshl_b32 s39, s27, 2
    s_add_u32 s38, s38, s39
    v_mov_b32 v24, s38
    v_mov_b32 v23, 1
    v_cmp_eq_u32 vcc, 0, v1
    s_and_saveexec_b64 s[36:37], vcc
    s_cbranch_execz nosig2_mega_kernel_44
    buffer_store_dword v23, v24, s[92:95], 0 offen
nosig2_mega_kernel_44:
    s_mov_b64 exec, s[36:37]
nosig_mega_kernel_43:
    s_branch end_mega_kernel_40
loader_mega_kernel_39:
    s_lshl_b32 s32, s26, 7
    s_lshl_b32 s33, s28, 5
    s_add_u32 s32, s32, s33
    v_lshrrev_b32 v25, 3, v1
    v_add_u32 v25, s32, v25
    v_mul_u32_u24 v25, 1280, v25
    v_and_b32 v26, 7, v1
    v_lshrrev_b32 v27, 4, v1
    v_xor_b32 v26, v26, v27
    v_lshlrev_b32 v26, 4, v26
    v_xor_b32 v27, 64, v26
    v_add_u32 v2, v25, v26
    v_add_u32 v3, v25, v27
    v_add_u32 v3, 9216, v3
    v_add_u32 v4, v25, v26
    v_add_u32 v4, 18432, v4
    v_add_u32 v5, v25, v27
    v_add_u32 v5, 27648, v5
    s_lshl_b32 s34, s28, 12
    s_add_u32 s76, s84, 0x1d59000
    s_addc_u32 s77, s85, 0
    s_mov_b32 s78, 3932160
    s_and_b32 s77, s77, 0xffff
    s_mov_b32 s79, 0x00020000
    s_lshr_b32 s82, s2, 4
    s_mul_i32 s82, s82, 245760
    s_mul_i32 s80, s28, 6144
    s_add_u32 s82, s82, s80
    v_lshlrev_b32 v8, 4, v1
    v_add_u32 v8, s82, v8
    v_add_u32 v9, 4096, v8
    s_barrier
    s_add_u32 m0, s34, 0
    s_mov_b32 s35, 0
    buffer_load_dwordx4 v2, s[4:7], s35 offen offset:0 sc1 lds
    buffer_load_dwordx4 v3, s[4:7], s35 offen offset:1024 sc1 lds
    buffer_load_dwordx4 v4, s[4:7], s35 offen offset:2048 sc1 lds
    buffer_load_dwordx4 v5, s[4:7], s35 offen offset:3072 sc1 lds
    s_add_u32 m0, s34, 16384
    s_mov_b32 s35, 128
    buffer_load_dwordx4 v2, s[4:7], s35 offen offset:0 sc1 lds
    buffer_load_dwordx4 v3, s[4:7], s35 offen offset:1024 sc1 lds
    buffer_load_dwordx4 v4, s[4:7], s35 offen offset:2048 sc1 lds
    buffer_load_dwordx4 v5, s[4:7], s35 offen offset:3072 sc1 lds
    s_waitcnt vmcnt(4)
    s_barrier
    s_add_u32 m0, s34, 32768
    s_mov_b32 s35, 256
    buffer_load_dwordx4 v2, s[4:7], s35 offen offset:0 sc1 lds
    buffer_load_dwordx4 v3, s[4:7], s35 offen offset:1024 sc1 lds
    buffer_load_dwordx4 v4, s[4:7], s35 offen offset:2048 sc1 lds
    buffer_load_dwordx4 v5, s[4:7], s35 offen offset:3072 sc1 lds
    s_add_u32 m0, s34, 49152
    s_mov_b32 s35, 384
    buffer_load_dwordx4 v2, s[4:7], s35 offen offset:0 sc1 lds
    buffer_load_dwordx4 v3, s[4:7], s35 offen offset:1024 sc1 lds
    buffer_load_dwordx4 v4, s[4:7], s35 offen offset:2048 sc1 lds
    buffer_load_dwordx4 v5, s[4:7], s35 offen offset:3072 sc1 lds
    s_waitcnt vmcnt(8)
    s_barrier
    s_add_u32 m0, s34, 0
    s_mov_b32 s35, 512
    buffer_load_dwordx4 v2, s[4:7], s35 offen offset:0 sc1 lds
    buffer_load_dwordx4 v3, s[4:7], s35 offen offset:1024 sc1 lds
    buffer_load_dwordx4 v4, s[4:7], s35 offen offset:2048 sc1 lds
    buffer_load_dwordx4 v5, s[4:7], s35 offen offset:3072 sc1 lds
    s_add_u32 m0, s80, 65536
    s_mov_b32 s81, 98304
    buffer_load_dwordx4 v8, s[76:79], s81 offen offset:0 sc1 lds
    buffer_load_dwordx4 v8, s[76:79], s81 offen offset:1024 sc1 lds
    buffer_load_dwordx4 v8, s[76:79], s81 offen offset:2048 sc1 lds
    buffer_load_dwordx4 v8, s[76:79], s81 offen offset:3072 sc1 lds
    s_add_u32 m0, s80, 69632
    s_nop 0
    buffer_load_dwordx4 v9, s[76:79], s81 offen offset:0 sc1 lds
    buffer_load_dwordx4 v9, s[76:79], s81 offen offset:1024 sc1 lds
    s_waitcnt vmcnt(14)
    s_barrier
    s_add_u32 m0, s34, 16384
    s_mov_b32 s35, 640
    buffer_load_dwordx4 v2, s[4:7], s35 offen offset:0 sc1 lds
    buffer_load_dwordx4 v3, s[4:7], s35 offen offset:1024 sc1 lds
    buffer_load_dwordx4 v4, s[4:7], s35 offen offset:2048 sc1 lds
    buffer_load_dwordx4 v5, s[4:7], s35 offen offset:3072 sc1 lds
    s_add_u32 m0, s80, 90112
    s_mov_b32 s81, 122880
    buffer_load_dwordx4 v8, s[76:79], s81 offen offset:0 sc1 lds
    buffer_load_dwordx4 v8, s[76:79], s81 offen offset:1024 sc1 lds
    buffer_load_dwordx4 v8, s[76:79], s81 offen offset:2048 sc1 lds
    buffer_load_dwordx4 v8, s[76:79], s81 offen offset:3072 sc1 lds
    s_add_u32 m0, s80, 94208
    s_nop 0
    buffer_load_dwordx4 v9, s[76:79], s81 offen offset:0 sc1 lds
    buffer_load_dwordx4 v9, s[76:79], s81 offen offset:1024 sc1 lds
    s_waitcnt vmcnt(20)
    s_barrier
    s_add_u32 m0, s34, 32768
    s_mov_b32 s35, 768
    buffer_load_dwordx4 v2, s[4:7], s35 offen offset:0 sc1 lds
    buffer_load_dwordx4 v3, s[4:7], s35 offen offset:1024 sc1 lds
    buffer_load_dwordx4 v4, s[4:7], s35 offen offset:2048 sc1 lds
    buffer_load_dwordx4 v5, s[4:7], s35 offen offset:3072 sc1 lds
    s_add_u32 m0, s80, 114688
    s_mov_b32 s81, 147456
    buffer_load_dwordx4 v8, s[76:79], s81 offen offset:0 sc1 lds
    buffer_load_dwordx4 v8, s[76:79], s81 offen offset:1024 sc1 lds
    buffer_load_dwordx4 v8, s[76:79], s81 offen offset:2048 sc1 lds
    buffer_load_dwordx4 v8, s[76:79], s81 offen offset:3072 sc1 lds
    s_add_u32 m0, s80, 118784
    s_nop 0
    buffer_load_dwordx4 v9, s[76:79], s81 offen offset:0 sc1 lds
    buffer_load_dwordx4 v9, s[76:79], s81 offen offset:1024 sc1 lds
    s_waitcnt vmcnt(20)
    s_barrier
    s_add_u32 m0, s34, 49152
    s_mov_b32 s35, 896
    buffer_load_dwordx4 v2, s[4:7], s35 offen offset:0 sc1 lds
    buffer_load_dwordx4 v3, s[4:7], s35 offen offset:1024 sc1 lds
    buffer_load_dwordx4 v4, s[4:7], s35 offen offset:2048 sc1 lds
    buffer_load_dwordx4 v5, s[4:7], s35 offen offset:3072 sc1 lds
    s_add_u32 m0, s80, 139264
    s_mov_b32 s81, 172032
    buffer_load_dwordx4 v8, s[76:79], s81 offen offset:0 sc1 lds
    buffer_load_dwordx4 v8, s[76:79], s81 offen offset:1024 sc1 lds
    buffer_load_dwordx4 v8, s[76:79], s81 offen offset:2048 sc1 lds
    buffer_load_dwordx4 v8, s[76:79], s81 offen offset:3072 sc1 lds
    s_add_u32 m0, s80, 143360
    s_nop 0
    buffer_load_dwordx4 v9, s[76:79], s81 offen offset:0 sc1 lds
    buffer_load_dwordx4 v9, s[76:79], s81 offen offset:1024 sc1 lds
    s_waitcnt vmcnt(20)
    s_barrier
    s_add_u32 m0, s34, 0
    s_mov_b32 s35, 1024
    buffer_load_dwordx4 v2, s[4:7], s35 offen offset:0 sc1 lds
    buffer_load_dwordx4 v3, s[4:7], s35 offen offset:1024 sc1 lds
    buffer_load_dwordx4 v4, s[4:7], s35 offen offset:2048 sc1 lds
    buffer_load_dwordx4 v5, s[4:7], s35 offen offset:3072 sc1 lds
    s_add_u32 m0, s80, 65536
    s_mov_b32 s81, 196608
    buffer_load_dwordx4 v8, s[76:79], s81 offen offset:0 sc1 lds
    buffer_load_dwordx4 v8, s[76:79], s81 offen offset:1024 sc1 lds
    buffer_load_dwordx4 v8, s[76:79], s81 offen offset:2048 sc1 lds
    buffer_load_dwordx4 v8, s[76:79], s81 offen offset:3072 sc1 lds
    s_add_u32 m0, s80, 69632
    s_nop 0
    buffer_load_dwordx4 v9, s[76:79], s81 offen offset:0 sc1 lds
    buffer_load_dwordx4 v9, s[76:79], s81 offen offset:1024 sc1 lds
    s_waitcnt vmcnt(20)
    s_barrier
    s_add_u32 m0, s34, 16384
    s_mov_b32 s35, 1152
    buffer_load_dwordx4 v2, s[4:7], s35 offen offset:0 sc1 lds
    buffer_load_dwordx4 v3, s[4:7], s35 offen offset:1024 sc1 lds
    buffer_load_dwordx4 v4, s[4:7], s35 offen offset:2048 sc1 lds
    buffer_load_dwordx4 v5, s[4:7], s35 offen offset:3072 sc1 lds
    s_add_u32 m0, s80, 90112
    s_mov_b32 s81, 221184
    buffer_load_dwordx4 v8, s[76:79], s81 offen offset:0 sc1 lds
    buffer_load_dwordx4 v8, s[76:79], s81 offen offset:1024 sc1 lds
    buffer_load_dwordx4 v8, s[76:79], s81 offen offset:2048 sc1 lds
    buffer_load_dwordx4 v8, s[76:79], s81 offen offset:3072 sc1 lds
    s_add_u32 m0, s80, 94208
    s_nop 0
    buffer_load_dwordx4 v9, s[76:79], s81 offen offset:0 sc1 lds
    buffer_load_dwordx4 v9, s[76:79], s81 offen offset:1024 sc1 lds
    s_waitcnt vmcnt(20)
    s_barrier
    s_waitcnt vmcnt(10)
    s_barrier
    s_waitcnt vmcnt(0)
    s_barrier
    s_add_u32 s76, s84, 0x2209000
    s_addc_u32 s77, s85, 0
    s_mov_b32 s78, 1966080
    s_and_b32 s77, s77, 0xffff
    s_mov_b32 s79, 0x00020000
    s_lshr_b32 s82, s2, 5
    s_mul_i32 s82, s82, 245760
    s_mul_i32 s80, s28, 5120
    s_add_u32 s82, s82, s80
    v_lshlrev_b32 v8, 4, v1
    v_add_u32 v8, s82, v8
    v_add_u32 v9, 4096, v8
    s_add_u32 m0, s80, 114688
    s_mov_b32 s81, 0
    buffer_load_dwordx4 v8, s[76:79], s81 offen offset:0 sc1 lds
    buffer_load_dwordx4 v8, s[76:79], s81 offen offset:1024 sc1 lds
    buffer_load_dwordx4 v8, s[76:79], s81 offen offset:2048 sc1 lds
    buffer_load_dwordx4 v8, s[76:79], s81 offen offset:3072 sc1 lds
    s_add_u32 m0, s80, 118784
    s_nop 0
    buffer_load_dwordx4 v9, s[76:79], s81 offen offset:0 sc1 lds
    s_add_u32 m0, s80, 139264
    s_mov_b32 s81, 20480
    buffer_load_dwordx4 v8, s[76:79], s81 offen offset:0 sc1 lds
    buffer_load_dwordx4 v8, s[76:79], s81 offen offset:1024 sc1 lds
    buffer_load_dwordx4 v8, s[76:79], s81 offen offset:2048 sc1 lds
    buffer_load_dwordx4 v8, s[76:79], s81 offen offset:3072 sc1 lds
    s_add_u32 m0, s80, 143360
    s_nop 0
    buffer_load_dwordx4 v9, s[76:79], s81 offen offset:0 sc1 lds
    s_add_u32 m0, s80, 65536
    s_mov_b32 s81, 40960
    buffer_load_dwordx4 v8, s[76:79], s81 offen offset:0 sc1 lds
    buffer_load_dwordx4 v8, s[76:79], s81 offen offset:1024 sc1 lds
    buffer_load_dwordx4 v8, s[76:79], s81 offen offset:2048 sc1 lds
    buffer_load_dwordx4 v8, s[76:79], s81 offen offset:3072 sc1 lds
    s_add_u32 m0, s80, 69632
    s_nop 0
    buffer_load_dwordx4 v9, s[76:79], s81 offen offset:0 sc1 lds
    s_barrier
    s_add_u32 m0, s80, 90112
    s_mov_b32 s81, 61440
    buffer_load_dwordx4 v8, s[76:79], s81 offen offset:0 sc1 lds
    buffer_load_dwordx4 v8, s[76:79], s81 offen offset:1024 sc1 lds
    buffer_load_dwordx4 v8, s[76:79], s81 offen offset:2048 sc1 lds
    buffer_load_dwordx4 v8, s[76:79], s81 offen offset:3072 sc1 lds
    s_add_u32 m0, s80, 94208
    s_nop 0
    buffer_load_dwordx4 v9, s[76:79], s81 offen offset:0 sc1 lds
    s_barrier
end_mega_kernel_40:
    s_and_b32 s24, s2, 7
    s_lshr_b32 s25, s2, 3
    s_lshl_b32 s26, s24, 2
    s_and_b32 s27, s25, 3
    s_add_u32 s26, s26, s27
    s_lshr_b32 s27, s25, 2
    s_add_u32 s4, s84, 0x5d9000
    s_addc_u32 s5, s85, 0
    s_mov_b32 s6, 6291456
    s_and_b32 s5, s5, 0xffff
    s_mov_b32 s7, 0x00020000
    s_add_u32 s12, s84, 0x59000
    s_addc_u32 s13, s85, 0
    s_mov_b32 s14, 2621440
    s_and_b32 s13, s13, 0xffff
    s_mov_b32 s15, 0x00020000
    s_add_u32 s16, s84, 0x59000
    s_addc_u32 s17, s85, 0
    s_mov_b32 s18, 2621440
    s_and_b32 s17, s17, 0xffff
    s_mov_b32 s19, 0x00020000
    s_add_u32 s20, s84, 0x39000
    s_addc_u32 s21, s85, 0
    s_mov_b32 s22, 131072
    s_and_b32 s21, s21, 0xffff
    s_mov_b32 s23, 0x00020000
    s_cmp_ge_u32 s29, 4
    s_cbranch_scc1 loader_mega_kernel_45
    v_and_b32 v25, 15, v1
    v_lshrrev_b32 v26, 4, v1
    s_lshl_b32 s32, s29, 2
    v_add_u32 v26, s32, v26
    v_xor_b32 v26, v26, v25
    v_lshlrev_b32 v26, 4, v26
    v_lshl_add_u32 v10, v25, 8, v26
    v_add_u32 v10, 32768, v10
    v_lshrrev_b32 v26, 4, v1
    v_lshlrev_b32 v26, 3, v26
    v_bfe_u32 v27, v1, 2, 2
    v_add_u32 v26, v26, v27
    s_lshl_b32 s32, s29, 5
    v_add_u32 v26, s32, v26
    v_mul_u32_u24 v26, 160, v26
    v_and_b32 v27, 3, v1
    v_lshl_add_u32 v26, v27, 3, v26
    v_add_u32 v11, 114688, v26
    s_lshl_b32 s32, s26, 6
    s_lshl_b32 s33, s29, 4
    s_add_u32 s32, s32, s33
    v_add_u32 v28, s32, v25
    v_mul_u32_u24 v29, 1280, v28
    v_lshrrev_b32 v26, 4, v1
    v_lshl_add_u32 v29, v26, 3, v29
    s_mul_i32 s32, s27, 160
    v_add_u32 v29, s32, v29
    v_mov_b32 v104, 0
    v_mov_b32 v105, 0
    v_mov_b32 v106, 0
    v_mov_b32 v107, 0
    v_mov_b32 v108, 0
    v_mov_b32 v109, 0
    v_mov_b32 v110, 0
    v_mov_b32 v111, 0
    v_mov_b32 v112, 0
    v_mov_b32 v113, 0
    v_mov_b32 v114, 0
    v_mov_b32 v115, 0
    v_mov_b32 v116, 0
    v_mov_b32 v117, 0
    v_mov_b32 v118, 0
    v_mov_b32 v119, 0
    v_mov_b32 v120, 0
    v_mov_b32 v121, 0
    v_mov_b32 v122, 0
    v_mov_b32 v123, 0
    v_mov_b32 v124, 0
    v_mov_b32 v125, 0
    v_mov_b32 v126, 0
    v_mov_b32 v127, 0
    v_mov_b32 v128, 0
    v_mov_b32 v129, 0
    v_mov_b32 v130, 0
    v_mov_b32 v131, 0
    v_mov_b32 v132, 0
    v_mov_b32 v133, 0
    v_mov_b32 v134, 0
    v_mov_b32 v135, 0
    v_mov_b32 v136, 0
    v_mov_b32 v137, 0
    v_mov_b32 v138, 0
    v_mov_b32 v139, 0
    v_mov_b32 v140, 0
    v_mov_b32 v141, 0
    v_mov_b32 v142, 0
    v_mov_b32 v143, 0
    v_mov_b32 v144, 0
    v_mov_b32 v145, 0
    v_mov_b32 v146, 0
    v_mov_b32 v147, 0
    v_mov_b32 v148, 0
    v_mov_b32 v149, 0
    v_mov_b32 v150, 0
    v_mov_b32 v151, 0
    v_mov_b32 v152, 0
    v_mov_b32 v153, 0
    v_mov_b32 v154, 0
    v_mov_b32 v155, 0
    v_mov_b32 v156, 0
    v_mov_b32 v157, 0
    v_mov_b32 v158, 0
    v_mov_b32 v159, 0
    v_mov_b32 v160, 0
    v_mov_b32 v161, 0
    v_mov_b32 v162, 0
    v_mov_b32 v163, 0
    v_mov_b32 v164, 0
    v_mov_b32 v165, 0
    v_mov_b32 v166, 0
    v_mov_b32 v167, 0
    v_mov_b32 v168, 0
    v_mov_b32 v169, 0
    v_mov_b32 v170, 0
    v_mov_b32 v171, 0
    v_mov_b32 v172, 0
    v_mov_b32 v173, 0
    v_mov_b32 v174, 0
    v_mov_b32 v175, 0
    v_mov_b32 v176, 0
    v_mov_b32 v177, 0
    v_mov_b32 v178, 0
    v_mov_b32 v179, 0
    v_mov_b32 v180, 0
    v_mov_b32 v181, 0
    v_mov_b32 v182, 0
    v_mov_b32 v183, 0
    s_mul_i32 s32, s29, 15360
    s_nop 0
    v_mul_u32_u24 v30, 160, v25
    v_lshrrev_b32 v26, 4, v1
    v_lshl_add_u32 v30, v26, 3, v30
    v_add_u32 v30, s32, v30
    v_lshlrev_b32 v31, 4, v1
    v_add_u32 v31, s32, v31
    s_lshl_b32 s32, s26, 6
    s_lshl_b32 s33, s29, 4
    s_add_u32 s32, s32, s33
    s_mul_i32 s33, s27, 160
    s_mov_b32 s38, 52429
    v_add_u32 v26, 0, v1
    v_mul_lo_u32 v27, v26, s38
    v_lshrrev_b32 v27, 19, v27
    v_mul_u32_u24 v24, 10, v27
    v_sub_u32 v24, v26, v24
    v_add_u32 v27, s32, v27
    v_mul_u32_u24 v27, 1280, v27
    v_lshl_add_u32 v27, v24, 4, v27
    v_add_u32 v12, s33, v27
    v_add_u32 v26, 64, v1
    v_mul_lo_u32 v27, v26, s38
    v_lshrrev_b32 v27, 19, v27
    v_mul_u32_u24 v24, 10, v27
    v_sub_u32 v24, v26, v24
    v_add_u32 v27, s32, v27
    v_mul_u32_u24 v27, 1280, v27
    v_lshl_add_u32 v27, v24, 4, v27
    v_add_u32 v13, s33, v27
    v_add_u32 v26, 128, v1
    v_mul_lo_u32 v27, v26, s38
    v_lshrrev_b32 v27, 19, v27
    v_mul_u32_u24 v24, 10, v27
    v_sub_u32 v24, v26, v24
    v_add_u32 v27, s32, v27
    v_mul_u32_u24 v27, 1280, v27
    v_lshl_add_u32 v27, v24, 4, v27
    v_add_u32 v14, s33, v27
    s_cmp_lg_u32 s29, 3
    s_cbranch_scc1 pok_mega_kernel_48
    s_lshr_b32 s38, s26, 1
    s_add_u32 s38, s38, 280
    s_lshl_b32 s38, s38, 7
    v_and_b32 v24, 15, v1
    v_lshlrev_b32 v24, 2, v24
    v_add_u32 v24, s38, v24
    s_mov_b32 s38, 0
    buffer_load_dword v21, v24, s[92:95], 0 offen sc1
    s_sleep 3
    buffer_load_dword v22, v24, s[92:95], 0 offen sc1
    s_sleep 3
poll_mega_kernel_47:
    buffer_load_dword v23, v24, s[92:95], 0 offen sc1
    s_waitcnt vmcnt(2)
    v_cmp_gt_u32 vcc, 1, v21
    s_nop 4
    s_cbranch_vccz pok_mega_kernel_48
    s_sleep 2
    buffer_load_dword v21, v24, s[92:95], 0 offen sc1
    s_waitcnt vmcnt(2)
    v_cmp_gt_u32 vcc, 1, v22
    s_nop 4
    s_cbranch_vccz pok_mega_kernel_48
    s_sleep 2
    buffer_load_dword v22, v24, s[92:95], 0 offen sc1
    s_waitcnt vmcnt(2)
    v_cmp_gt_u32 vcc, 1, v23
    s_nop 4
    s_cbranch_vccz pok_mega_kernel_48
    s_sleep 2
    s_add_u32 s38, s38, 1
    s_cmp_gt_u32 s38, 4000
    s_cbranch_scc0 poll_mega_kernel_47
pok_mega_kernel_48:
    s_barrier
    buffer_load_dwordx2 v[184:185], v29, s[12:15], 0 offen offset:0 sc1
    buffer_load_dwordx2 v[186:187], v29, s[12:15], 0 offen offset:32 sc1
    buffer_load_dwordx2 v[188:189], v29, s[12:15], 0 offen offset:64 sc1
    buffer_load_dwordx2 v[190:191], v29, s[12:15], 0 offen offset:96 sc1
    buffer_load_dwordx2 v[192:193], v29, s[12:15], 0 offen offset:128 sc1
    s_barrier
    ds_read_b128 v[32:35], v10 offset:0
    ds_read_b128 v[36:39], v10 offset:4096
    ds_read_b128 v[40:43], v10 offset:8192
    ds_read_b128 v[44:47], v10 offset:12288
    ds_read_b64_tr_b16 v[48:49], v11 offset:0
    ds_read_b64_tr_b16 v[50:51], v11 offset:640
    ds_read_b64_tr_b16 v[52:53], v11 offset:32
    ds_read_b64_tr_b16 v[54:55], v11 offset:672
    ds_read_b64_tr_b16 v[56:57], v11 offset:64
    ds_read_b64_tr_b16 v[58:59], v11 offset:704
    ds_read_b64_tr_b16 v[60:61], v11 offset:96
    ds_read_b64_tr_b16 v[62:63], v11 offset:736
    ds_read_b64_tr_b16 v[64:65], v11 offset:128
    ds_read_b64_tr_b16 v[66:67], v11 offset:768
    s_waitcnt lgkmcnt(0)
    v_mfma_f32_16x16x32_bf16 v[104:107], v[48:51], v[32:35], v[104:107]
    s_barrier
    v_add_u32 v10, 0x4000, v10
    v_add_u32 v11, 0x6000, v11
    v_mfma_f32_16x16x32_bf16 v[108:111], v[48:51], v[36:39], v[108:111]
    ds_read_b128 v[68:71], v10 offset:0
    v_mfma_f32_16x16x32_bf16 v[112:115], v[48:51], v[40:43], v[112:115]
    ds_read_b128 v[72:75], v10 offset:4096
    v_mfma_f32_16x16x32_bf16 v[116:119], v[48:51], v[44:47], v[116:119]
    ds_read_b128 v[76:79], v10 offset:8192
    v_mfma_f32_16x16x32_bf16 v[120:123], v[52:55], v[32:35], v[120:123]
    ds_read_b128 v[80:83], v10 offset:12288
    v_mfma_f32_16x16x32_bf16 v[124:127], v[52:55], v[36:39], v[124:127]
    ds_read_b64_tr_b16 v[84:85], v11 offset:0
    v_mfma_f32_16x16x32_bf16 v[128:131], v[52:55], v[40:43], v[128:131]
    ds_read_b64_tr_b16 v[86:87], v11 offset:640
    v_mfma_f32_16x16x32_bf16 v[132:135], v[52:55], v[44:47], v[132:135]
    ds_read_b64_tr_b16 v[88:89], v11 offset:32
    v_mfma_f32_16x16x32_bf16 v[136:139], v[56:59], v[32:35], v[136:139]
    ds_read_b64_tr_b16 v[90:91], v11 offset:672
    v_mfma_f32_16x16x32_bf16 v[140:143], v[56:59], v[36:39], v[140:143]
    ds_read_b64_tr_b16 v[92:93], v11 offset:64
    v_mfma_f32_16x16x32_bf16 v[144:147], v[56:59], v[40:43], v[144:147]
    ds_read_b64_tr_b16 v[94:95], v11 offset:704
    v_mfma_f32_16x16x32_bf16 v[148:151], v[56:59], v[44:47], v[148:151]
    ds_read_b64_tr_b16 v[96:97], v11 offset:96
    v_mfma_f32_16x16x32_bf16 v[152:155], v[60:63], v[32:35], v[152:155]
    ds_read_b64_tr_b16 v[98:99], v11 offset:736
    v_mfma_f32_16x16x32_bf16 v[156:159], v[60:63], v[36:39], v[156:159]
    ds_read_b64_tr_b16 v[100:101], v11 offset:128
    v_mfma_f32_16x16x32_bf16 v[160:163], v[60:63], v[40:43], v[160:163]
    ds_read_b64_tr_b16 v[102:103], v11 offset:768
    v_mfma_f32_16x16x32_bf16 v[164:167], v[60:63], v[44:47], v[164:167]
    v_mfma_f32_16x16x32_bf16 v[168:171], v[64:67], v[32:35], v[168:171]
    v_mfma_f32_16x16x32_bf16 v[172:175], v[64:67], v[36:39], v[172:175]
    v_mfma_f32_16x16x32_bf16 v[176:179], v[64:67], v[40:43], v[176:179]
    v_mfma_f32_16x16x32_bf16 v[180:183], v[64:67], v[44:47], v[180:183]
    s_waitcnt lgkmcnt(0)
    v_mfma_f32_16x16x32_bf16 v[104:107], v[84:87], v[68:71], v[104:107]
    s_barrier
    v_add_u32 v10, 0xffff4000, v10
    v_add_u32 v11, 0xfffee000, v11
    v_mfma_f32_16x16x32_bf16 v[108:111], v[84:87], v[72:75], v[108:111]
    ds_read_b128 v[32:35], v10 offset:0
    v_mfma_f32_16x16x32_bf16 v[112:115], v[84:87], v[76:79], v[112:115]
    ds_read_b128 v[36:39], v10 offset:4096
    v_mfma_f32_16x16x32_bf16 v[116:119], v[84:87], v[80:83], v[116:119]
    ds_read_b128 v[40:43], v10 offset:8192
    v_mfma_f32_16x16x32_bf16 v[120:123], v[88:91], v[68:71], v[120:123]
    ds_read_b128 v[44:47], v10 offset:12288
    v_mfma_f32_16x16x32_bf16 v[124:127], v[88:91], v[72:75], v[124:127]
    ds_read_b64_tr_b16 v[48:49], v11 offset:0
    v_mfma_f32_16x16x32_bf16 v[128:131], v[88:91], v[76:79], v[128:131]
    ds_read_b64_tr_b16 v[50:51], v11 offset:640
    v_mfma_f32_16x16x32_bf16 v[132:135], v[88:91], v[80:83], v[132:135]
    ds_read_b64_tr_b16 v[52:53], v11 offset:32
    v_mfma_f32_16x16x32_bf16 v[136:139], v[92:95], v[68:71], v[136:139]
    ds_read_b64_tr_b16 v[54:55], v11 offset:672
    v_mfma_f32_16x16x32_bf16 v[140:143], v[92:95], v[72:75], v[140:143]
    ds_read_b64_tr_b16 v[56:57], v11 offset:64
    v_mfma_f32_16x16x32_bf16 v[144:147], v[92:95], v[76:79], v[144:147]
    ds_read_b64_tr_b16 v[58:59], v11 offset:704
    v_mfma_f32_16x16x32_bf16 v[148:151], v[92:95], v[80:83], v[148:151]
    ds_read_b64_tr_b16 v[60:61], v11 offset:96
    v_mfma_f32_16x16x32_bf16 v[152:155], v[96:99], v[68:71], v[152:155]
    ds_read_b64_tr_b16 v[62:63], v11 offset:736
    v_mfma_f32_16x16x32_bf16 v[156:159], v[96:99], v[72:75], v[156:159]
    ds_read_b64_tr_b16 v[64:65], v11 offset:128
    v_mfma_f32_16x16x32_bf16 v[160:163], v[96:99], v[76:79], v[160:163]
    ds_read_b64_tr_b16 v[66:67], v11 offset:768
    v_mfma_f32_16x16x32_bf16 v[164:167], v[96:99], v[80:83], v[164:167]
    v_mfma_f32_16x16x32_bf16 v[168:171], v[100:103], v[68:71], v[168:171]
    v_mfma_f32_16x16x32_bf16 v[172:175], v[100:103], v[72:75], v[172:175]
    v_mfma_f32_16x16x32_bf16 v[176:179], v[100:103], v[76:79], v[176:179]
    v_mfma_f32_16x16x32_bf16 v[180:183], v[100:103], v[80:83], v[180:183]
    s_waitcnt lgkmcnt(0)
    v_mfma_f32_16x16x32_bf16 v[104:107], v[48:51], v[32:35], v[104:107]
    s_barrier
    v_add_u32 v10, 0x4000, v10
    v_add_u32 v11, 0x6000, v11
    v_mfma_f32_16x16x32_bf16 v[108:111], v[48:51], v[36:39], v[108:111]
    ds_read_b128 v[68:71], v10 offset:0
    v_mfma_f32_16x16x32_bf16 v[112:115], v[48:51], v[40:43], v[112:115]
    ds_read_b128 v[72:75], v10 offset:4096
    v_mfma_f32_16x16x32_bf16 v[116:119], v[48:51], v[44:47], v[116:119]
    ds_read_b128 v[76:79], v10 offset:8192
    v_mfma_f32_16x16x32_bf16 v[120:123], v[52:55], v[32:35], v[120:123]
    ds_read_b128 v[80:83], v10 offset:12288
    v_mfma_f32_16x16x32_bf16 v[124:127], v[52:55], v[36:39], v[124:127]
    ds_read_b64_tr_b16 v[84:85], v11 offset:0
    v_mfma_f32_16x16x32_bf16 v[128:131], v[52:55], v[40:43], v[128:131]
    ds_read_b64_tr_b16 v[86:87], v11 offset:640
    v_mfma_f32_16x16x32_bf16 v[132:135], v[52:55], v[44:47], v[132:135]
    ds_read_b64_tr_b16 v[88:89], v11 offset:32
    v_mfma_f32_16x16x32_bf16 v[136:139], v[56:59], v[32:35], v[136:139]
    ds_read_b64_tr_b16 v[90:91], v11 offset:672
    v_mfma_f32_16x16x32_bf16 v[140:143], v[56:59], v[36:39], v[140:143]
    ds_read_b64_tr_b16 v[92:93], v11 offset:64
    v_mfma_f32_16x16x32_bf16 v[144:147], v[56:59], v[40:43], v[144:147]
    ds_read_b64_tr_b16 v[94:95], v11 offset:704
    v_mfma_f32_16x16x32_bf16 v[148:151], v[56:59], v[44:47], v[148:151]
    ds_read_b64_tr_b16 v[96:97], v11 offset:96
    v_mfma_f32_16x16x32_bf16 v[152:155], v[60:63], v[32:35], v[152:155]
    ds_read_b64_tr_b16 v[98:99], v11 offset:736
    v_mfma_f32_16x16x32_bf16 v[156:159], v[60:63], v[36:39], v[156:159]
    ds_read_b64_tr_b16 v[100:101], v11 offset:128
    v_mfma_f32_16x16x32_bf16 v[160:163], v[60:63], v[40:43], v[160:163]
    ds_read_b64_tr_b16 v[102:103], v11 offset:768
    v_mfma_f32_16x16x32_bf16 v[164:167], v[60:63], v[44:47], v[164:167]
    v_mfma_f32_16x16x32_bf16 v[168:171], v[64:67], v[32:35], v[168:171]
    v_mfma_f32_16x16x32_bf16 v[172:175], v[64:67], v[36:39], v[172:175]
    v_mfma_f32_16x16x32_bf16 v[176:179], v[64:67], v[40:43], v[176:179]
    v_mfma_f32_16x16x32_bf16 v[180:183], v[64:67], v[44:47], v[180:183]
    s_waitcnt lgkmcnt(0)
    v_mfma_f32_16x16x32_bf16 v[104:107], v[84:87], v[68:71], v[104:107]
    s_barrier
    v_add_u32 v10, 0x4000, v10
    v_add_u32 v11, 0x6000, v11
    v_mfma_f32_16x16x32_bf16 v[108:111], v[84:87], v[72:75], v[108:111]
    ds_read_b128 v[32:35], v10 offset:0
    v_mfma_f32_16x16x32_bf16 v[112:115], v[84:87], v[76:79], v[112:115]
    ds_read_b128 v[36:39], v10 offset:4096
    v_mfma_f32_16x16x32_bf16 v[116:119], v[84:87], v[80:83], v[116:119]
    ds_read_b128 v[40:43], v10 offset:8192
    v_mfma_f32_16x16x32_bf16 v[120:123], v[88:91], v[68:71], v[120:123]
    ds_read_b128 v[44:47], v10 offset:12288
    v_mfma_f32_16x16x32_bf16 v[124:127], v[88:91], v[72:75], v[124:127]
    ds_read_b64_tr_b16 v[48:49], v11 offset:0
    v_mfma_f32_16x16x32_bf16 v[128:131], v[88:91], v[76:79], v[128:131]
    ds_read_b64_tr_b16 v[50:51], v11 offset:640
    v_mfma_f32_16x16x32_bf16 v[132:135], v[88:91], v[80:83], v[132:135]
    ds_read_b64_tr_b16 v[52:53], v11 offset:32
    v_mfma_f32_16x16x32_bf16 v[136:139], v[92:95], v[68:71], v[136:139]
    ds_read_b64_tr_b16 v[54:55], v11 offset:672
    v_mfma_f32_16x16x32_bf16 v[140:143], v[92:95], v[72:75], v[140:143]
    ds_read_b64_tr_b16 v[56:57], v11 offset:64
    v_mfma_f32_16x16x32_bf16 v[144:147], v[92:95], v[76:79], v[144:147]
    ds_read_b64_tr_b16 v[58:59], v11 offset:704
    v_mfma_f32_16x16x32_bf16 v[148:151], v[92:95], v[80:83], v[148:151]
    ds_read_b64_tr_b16 v[60:61], v11 offset:96
    v_mfma_f32_16x16x32_bf16 v[152:155], v[96:99], v[68:71], v[152:155]
    ds_read_b64_tr_b16 v[62:63], v11 offset:736
    v_mfma_f32_16x16x32_bf16 v[156:159], v[96:99], v[72:75], v[156:159]
    ds_read_b64_tr_b16 v[64:65], v11 offset:128
    v_mfma_f32_16x16x32_bf16 v[160:163], v[96:99], v[76:79], v[160:163]
    ds_read_b64_tr_b16 v[66:67], v11 offset:768
    v_mfma_f32_16x16x32_bf16 v[164:167], v[96:99], v[80:83], v[164:167]
    v_mfma_f32_16x16x32_bf16 v[168:171], v[100:103], v[68:71], v[168:171]
    v_mfma_f32_16x16x32_bf16 v[172:175], v[100:103], v[72:75], v[172:175]
    v_mfma_f32_16x16x32_bf16 v[176:179], v[100:103], v[76:79], v[176:179]
    v_mfma_f32_16x16x32_bf16 v[180:183], v[100:103], v[80:83], v[180:183]
    s_waitcnt lgkmcnt(0)
    v_mfma_f32_16x16x32_bf16 v[104:107], v[48:51], v[32:35], v[104:107]
    s_barrier
    v_add_u32 v10, 0x4000, v10
    v_add_u32 v11, 0x6000, v11
    v_mfma_f32_16x16x32_bf16 v[108:111], v[48:51], v[36:39], v[108:111]
    ds_read_b128 v[68:71], v10 offset:0
    v_mfma_f32_16x16x32_bf16 v[112:115], v[48:51], v[40:43], v[112:115]
    ds_read_b128 v[72:75], v10 offset:4096
    v_mfma_f32_16x16x32_bf16 v[116:119], v[48:51], v[44:47], v[116:119]
    ds_read_b128 v[76:79], v10 offset:8192
    v_mfma_f32_16x16x32_bf16 v[120:123], v[52:55], v[32:35], v[120:123]
    ds_read_b128 v[80:83], v10 offset:12288
    v_mfma_f32_16x16x32_bf16 v[124:127], v[52:55], v[36:39], v[124:127]
    ds_read_b64_tr_b16 v[84:85], v11 offset:0
    v_mfma_f32_16x16x32_bf16 v[128:131], v[52:55], v[40:43], v[128:131]
    ds_read_b64_tr_b16 v[86:87], v11 offset:640
    v_mfma_f32_16x16x32_bf16 v[132:135], v[52:55], v[44:47], v[132:135]
    ds_read_b64_tr_b16 v[88:89], v11 offset:32
    v_mfma_f32_16x16x32_bf16 v[136:139], v[56:59], v[32:35], v[136:139]
    ds_read_b64_tr_b16 v[90:91], v11 offset:672
    v_mfma_f32_16x16x32_bf16 v[140:143], v[56:59], v[36:39], v[140:143]
    ds_read_b64_tr_b16 v[92:93], v11 offset:64
    v_mfma_f32_16x16x32_bf16 v[144:147], v[56:59], v[40:43], v[144:147]
    ds_read_b64_tr_b16 v[94:95], v11 offset:704
    v_mfma_f32_16x16x32_bf16 v[148:151], v[56:59], v[44:47], v[148:151]
    ds_read_b64_tr_b16 v[96:97], v11 offset:96
    v_mfma_f32_16x16x32_bf16 v[152:155], v[60:63], v[32:35], v[152:155]
    ds_read_b64_tr_b16 v[98:99], v11 offset:736
    v_mfma_f32_16x16x32_bf16 v[156:159], v[60:63], v[36:39], v[156:159]
    ds_read_b64_tr_b16 v[100:101], v11 offset:128
    v_mfma_f32_16x16x32_bf16 v[160:163], v[60:63], v[40:43], v[160:163]
    ds_read_b64_tr_b16 v[102:103], v11 offset:768
    v_mfma_f32_16x16x32_bf16 v[164:167], v[60:63], v[44:47], v[164:167]
    v_mfma_f32_16x16x32_bf16 v[168:171], v[64:67], v[32:35], v[168:171]
    v_mfma_f32_16x16x32_bf16 v[172:175], v[64:67], v[36:39], v[172:175]
    v_mfma_f32_16x16x32_bf16 v[176:179], v[64:67], v[40:43], v[176:179]
    v_mfma_f32_16x16x32_bf16 v[180:183], v[64:67], v[44:47], v[180:183]
    s_waitcnt lgkmcnt(0)
    v_mfma_f32_16x16x32_bf16 v[104:107], v[84:87], v[68:71], v[104:107]
    s_barrier
    v_add_u32 v10, 0xffff4000, v10
    v_add_u32 v11, 0xfffee000, v11
    v_mfma_f32_16x16x32_bf16 v[108:111], v[84:87], v[72:75], v[108:111]
    ds_read_b128 v[32:35], v10 offset:0
    v_mfma_f32_16x16x32_bf16 v[112:115], v[84:87], v[76:79], v[112:115]
    ds_read_b128 v[36:39], v10 offset:4096
    v_mfma_f32_16x16x32_bf16 v[116:119], v[84:87], v[80:83], v[116:119]
    ds_read_b128 v[40:43], v10 offset:8192
    v_mfma_f32_16x16x32_bf16 v[120:123], v[88:91], v[68:71], v[120:123]
    ds_read_b128 v[44:47], v10 offset:12288
    v_mfma_f32_16x16x32_bf16 v[124:127], v[88:91], v[72:75], v[124:127]
    ds_read_b64_tr_b16 v[48:49], v11 offset:0
    v_mfma_f32_16x16x32_bf16 v[128:131], v[88:91], v[76:79], v[128:131]
    ds_read_b64_tr_b16 v[50:51], v11 offset:640
    v_mfma_f32_16x16x32_bf16 v[132:135], v[88:91], v[80:83], v[132:135]
    ds_read_b64_tr_b16 v[52:53], v11 offset:32
    v_mfma_f32_16x16x32_bf16 v[136:139], v[92:95], v[68:71], v[136:139]
    ds_read_b64_tr_b16 v[54:55], v11 offset:672
    v_mfma_f32_16x16x32_bf16 v[140:143], v[92:95], v[72:75], v[140:143]
    ds_read_b64_tr_b16 v[56:57], v11 offset:64
    v_mfma_f32_16x16x32_bf16 v[144:147], v[92:95], v[76:79], v[144:147]
    ds_read_b64_tr_b16 v[58:59], v11 offset:704
    v_mfma_f32_16x16x32_bf16 v[148:151], v[92:95], v[80:83], v[148:151]
    ds_read_b64_tr_b16 v[60:61], v11 offset:96
    v_mfma_f32_16x16x32_bf16 v[152:155], v[96:99], v[68:71], v[152:155]
    ds_read_b64_tr_b16 v[62:63], v11 offset:736
    v_mfma_f32_16x16x32_bf16 v[156:159], v[96:99], v[72:75], v[156:159]
    ds_read_b64_tr_b16 v[64:65], v11 offset:128
    v_mfma_f32_16x16x32_bf16 v[160:163], v[96:99], v[76:79], v[160:163]
    ds_read_b64_tr_b16 v[66:67], v11 offset:768
    v_mfma_f32_16x16x32_bf16 v[164:167], v[96:99], v[80:83], v[164:167]
    v_mfma_f32_16x16x32_bf16 v[168:171], v[100:103], v[68:71], v[168:171]
    v_mfma_f32_16x16x32_bf16 v[172:175], v[100:103], v[72:75], v[172:175]
    v_mfma_f32_16x16x32_bf16 v[176:179], v[100:103], v[76:79], v[176:179]
    v_mfma_f32_16x16x32_bf16 v[180:183], v[100:103], v[80:83], v[180:183]
    s_waitcnt lgkmcnt(0)
    v_mfma_f32_16x16x32_bf16 v[104:107], v[48:51], v[32:35], v[104:107]
    s_barrier
    v_add_u32 v10, 0x4000, v10
    v_add_u32 v11, 0x6000, v11
    v_mfma_f32_16x16x32_bf16 v[108:111], v[48:51], v[36:39], v[108:111]
    ds_read_b128 v[68:71], v10 offset:0
    v_mfma_f32_16x16x32_bf16 v[112:115], v[48:51], v[40:43], v[112:115]
    ds_read_b128 v[72:75], v10 offset:4096
    v_mfma_f32_16x16x32_bf16 v[116:119], v[48:51], v[44:47], v[116:119]
    ds_read_b128 v[76:79], v10 offset:8192
    v_mfma_f32_16x16x32_bf16 v[120:123], v[52:55], v[32:35], v[120:123]
    ds_read_b128 v[80:83], v10 offset:12288
    v_mfma_f32_16x16x32_bf16 v[124:127], v[52:55], v[36:39], v[124:127]
    ds_read_b64_tr_b16 v[84:85], v11 offset:0
    v_mfma_f32_16x16x32_bf16 v[128:131], v[52:55], v[40:43], v[128:131]
    ds_read_b64_tr_b16 v[86:87], v11 offset:640
    v_mfma_f32_16x16x32_bf16 v[132:135], v[52:55], v[44:47], v[132:135]
    ds_read_b64_tr_b16 v[88:89], v11 offset:32
    v_mfma_f32_16x16x32_bf16 v[136:139], v[56:59], v[32:35], v[136:139]
    ds_read_b64_tr_b16 v[90:91], v11 offset:672
    v_mfma_f32_16x16x32_bf16 v[140:143], v[56:59], v[36:39], v[140:143]
    ds_read_b64_tr_b16 v[92:93], v11 offset:64
    v_mfma_f32_16x16x32_bf16 v[144:147], v[56:59], v[40:43], v[144:147]
    ds_read_b64_tr_b16 v[94:95], v11 offset:704
    v_mfma_f32_16x16x32_bf16 v[148:151], v[56:59], v[44:47], v[148:151]
    ds_read_b64_tr_b16 v[96:97], v11 offset:96
    v_mfma_f32_16x16x32_bf16 v[152:155], v[60:63], v[32:35], v[152:155]
    ds_read_b64_tr_b16 v[98:99], v11 offset:736
    v_mfma_f32_16x16x32_bf16 v[156:159], v[60:63], v[36:39], v[156:159]
    ds_read_b64_tr_b16 v[100:101], v11 offset:128
    v_mfma_f32_16x16x32_bf16 v[160:163], v[60:63], v[40:43], v[160:163]
    ds_read_b64_tr_b16 v[102:103], v11 offset:768
    v_mfma_f32_16x16x32_bf16 v[164:167], v[60:63], v[44:47], v[164:167]
    v_mfma_f32_16x16x32_bf16 v[168:171], v[64:67], v[32:35], v[168:171]
    v_mfma_f32_16x16x32_bf16 v[172:175], v[64:67], v[36:39], v[172:175]
    v_mfma_f32_16x16x32_bf16 v[176:179], v[64:67], v[40:43], v[176:179]
    v_mfma_f32_16x16x32_bf16 v[180:183], v[64:67], v[44:47], v[180:183]
    s_waitcnt lgkmcnt(0)
    v_mfma_f32_16x16x32_bf16 v[104:107], v[84:87], v[68:71], v[104:107]
    s_barrier
    v_add_u32 v10, 0x4000, v10
    v_add_u32 v11, 0x6000, v11
    v_mfma_f32_16x16x32_bf16 v[108:111], v[84:87], v[72:75], v[108:111]
    ds_read_b128 v[32:35], v10 offset:0
    v_mfma_f32_16x16x32_bf16 v[112:115], v[84:87], v[76:79], v[112:115]
    ds_read_b128 v[36:39], v10 offset:4096
    v_mfma_f32_16x16x32_bf16 v[116:119], v[84:87], v[80:83], v[116:119]
    ds_read_b128 v[40:43], v10 offset:8192
    v_mfma_f32_16x16x32_bf16 v[120:123], v[88:91], v[68:71], v[120:123]
    ds_read_b128 v[44:47], v10 offset:12288
    v_mfma_f32_16x16x32_bf16 v[124:127], v[88:91], v[72:75], v[124:127]
    ds_read_b64_tr_b16 v[48:49], v11 offset:0
    v_mfma_f32_16x16x32_bf16 v[128:131], v[88:91], v[76:79], v[128:131]
    ds_read_b64_tr_b16 v[50:51], v11 offset:640
    v_mfma_f32_16x16x32_bf16 v[132:135], v[88:91], v[80:83], v[132:135]
    ds_read_b64_tr_b16 v[52:53], v11 offset:32
    v_mfma_f32_16x16x32_bf16 v[136:139], v[92:95], v[68:71], v[136:139]
    ds_read_b64_tr_b16 v[54:55], v11 offset:672
    v_mfma_f32_16x16x32_bf16 v[140:143], v[92:95], v[72:75], v[140:143]
    ds_read_b64_tr_b16 v[56:57], v11 offset:64
    v_mfma_f32_16x16x32_bf16 v[144:147], v[92:95], v[76:79], v[144:147]
    ds_read_b64_tr_b16 v[58:59], v11 offset:704
    v_mfma_f32_16x16x32_bf16 v[148:151], v[92:95], v[80:83], v[148:151]
    ds_read_b64_tr_b16 v[60:61], v11 offset:96
    v_mfma_f32_16x16x32_bf16 v[152:155], v[96:99], v[68:71], v[152:155]
    ds_read_b64_tr_b16 v[62:63], v11 offset:736
    v_mfma_f32_16x16x32_bf16 v[156:159], v[96:99], v[72:75], v[156:159]
    ds_read_b64_tr_b16 v[64:65], v11 offset:128
    v_mfma_f32_16x16x32_bf16 v[160:163], v[96:99], v[76:79], v[160:163]
    ds_read_b64_tr_b16 v[66:67], v11 offset:768
    v_mfma_f32_16x16x32_bf16 v[164:167], v[96:99], v[80:83], v[164:167]
    v_mfma_f32_16x16x32_bf16 v[168:171], v[100:103], v[68:71], v[168:171]
    v_mfma_f32_16x16x32_bf16 v[172:175], v[100:103], v[72:75], v[172:175]
    v_mfma_f32_16x16x32_bf16 v[176:179], v[100:103], v[76:79], v[176:179]
    v_mfma_f32_16x16x32_bf16 v[180:183], v[100:103], v[80:83], v[180:183]
    s_waitcnt lgkmcnt(0)
    v_mfma_f32_16x16x32_bf16 v[104:107], v[48:51], v[32:35], v[104:107]
    s_barrier
    v_add_u32 v10, 0x4000, v10
    v_add_u32 v11, 0x6000, v11
    v_mfma_f32_16x16x32_bf16 v[108:111], v[48:51], v[36:39], v[108:111]
    ds_read_b128 v[68:71], v10 offset:0
    v_mfma_f32_16x16x32_bf16 v[112:115], v[48:51], v[40:43], v[112:115]
    ds_read_b128 v[72:75], v10 offset:4096
    v_mfma_f32_16x16x32_bf16 v[116:119], v[48:51], v[44:47], v[116:119]
    ds_read_b128 v[76:79], v10 offset:8192
    v_mfma_f32_16x16x32_bf16 v[120:123], v[52:55], v[32:35], v[120:123]
    ds_read_b128 v[80:83], v10 offset:12288
    v_mfma_f32_16x16x32_bf16 v[124:127], v[52:55], v[36:39], v[124:127]
    ds_read_b64_tr_b16 v[84:85], v11 offset:0
    v_mfma_f32_16x16x32_bf16 v[128:131], v[52:55], v[40:43], v[128:131]
    ds_read_b64_tr_b16 v[86:87], v11 offset:640
    v_mfma_f32_16x16x32_bf16 v[132:135], v[52:55], v[44:47], v[132:135]
    ds_read_b64_tr_b16 v[88:89], v11 offset:32
    v_mfma_f32_16x16x32_bf16 v[136:139], v[56:59], v[32:35], v[136:139]
    ds_read_b64_tr_b16 v[90:91], v11 offset:672
    v_mfma_f32_16x16x32_bf16 v[140:143], v[56:59], v[36:39], v[140:143]
    ds_read_b64_tr_b16 v[92:93], v11 offset:64
    v_mfma_f32_16x16x32_bf16 v[144:147], v[56:59], v[40:43], v[144:147]
    ds_read_b64_tr_b16 v[94:95], v11 offset:704
    v_mfma_f32_16x16x32_bf16 v[148:151], v[56:59], v[44:47], v[148:151]
    ds_read_b64_tr_b16 v[96:97], v11 offset:96
    v_mfma_f32_16x16x32_bf16 v[152:155], v[60:63], v[32:35], v[152:155]
    ds_read_b64_tr_b16 v[98:99], v11 offset:736
    v_mfma_f32_16x16x32_bf16 v[156:159], v[60:63], v[36:39], v[156:159]
    ds_read_b64_tr_b16 v[100:101], v11 offset:128
    v_mfma_f32_16x16x32_bf16 v[160:163], v[60:63], v[40:43], v[160:163]
    ds_read_b64_tr_b16 v[102:103], v11 offset:768
    v_mfma_f32_16x16x32_bf16 v[164:167], v[60:63], v[44:47], v[164:167]
    v_mfma_f32_16x16x32_bf16 v[168:171], v[64:67], v[32:35], v[168:171]
    v_mfma_f32_16x16x32_bf16 v[172:175], v[64:67], v[36:39], v[172:175]
    v_mfma_f32_16x16x32_bf16 v[176:179], v[64:67], v[40:43], v[176:179]
    v_mfma_f32_16x16x32_bf16 v[180:183], v[64:67], v[44:47], v[180:183]
    s_waitcnt lgkmcnt(0)
    v_mfma_f32_16x16x32_bf16 v[104:107], v[84:87], v[68:71], v[104:107]
    s_barrier
    v_add_u32 v10, 0xffff4000, v10
    v_add_u32 v11, 0xfffee000, v11
    v_mfma_f32_16x16x32_bf16 v[108:111], v[84:87], v[72:75], v[108:111]
    ds_read_b128 v[32:35], v10 offset:0
    v_mfma_f32_16x16x32_bf16 v[112:115], v[84:87], v[76:79], v[112:115]
    ds_read_b128 v[36:39], v10 offset:4096
    v_mfma_f32_16x16x32_bf16 v[116:119], v[84:87], v[80:83], v[116:119]
    ds_read_b128 v[40:43], v10 offset:8192
    v_mfma_f32_16x16x32_bf16 v[120:123], v[88:91], v[68:71], v[120:123]
    ds_read_b128 v[44:47], v10 offset:12288
    v_mfma_f32_16x16x32_bf16 v[124:127], v[88:91], v[72:75], v[124:127]
    ds_read_b64_tr_b16 v[48:49], v11 offset:0
    v_mfma_f32_16x16x32_bf16 v[128:131], v[88:91], v[76:79], v[128:131]
    ds_read_b64_tr_b16 v[50:51], v11 offset:640
    v_mfma_f32_16x16x32_bf16 v[132:135], v[88:91], v[80:83], v[132:135]
    ds_read_b64_tr_b16 v[52:53], v11 offset:32
    v_mfma_f32_16x16x32_bf16 v[136:139], v[92:95], v[68:71], v[136:139]
    ds_read_b64_tr_b16 v[54:55], v11 offset:672
    v_mfma_f32_16x16x32_bf16 v[140:143], v[92:95], v[72:75], v[140:143]
    ds_read_b64_tr_b16 v[56:57], v11 offset:64
    v_mfma_f32_16x16x32_bf16 v[144:147], v[92:95], v[76:79], v[144:147]
    ds_read_b64_tr_b16 v[58:59], v11 offset:704
    v_mfma_f32_16x16x32_bf16 v[148:151], v[92:95], v[80:83], v[148:151]
    ds_read_b64_tr_b16 v[60:61], v11 offset:96
    v_mfma_f32_16x16x32_bf16 v[152:155], v[96:99], v[68:71], v[152:155]
    ds_read_b64_tr_b16 v[62:63], v11 offset:736
    v_mfma_f32_16x16x32_bf16 v[156:159], v[96:99], v[72:75], v[156:159]
    ds_read_b64_tr_b16 v[64:65], v11 offset:128
    v_mfma_f32_16x16x32_bf16 v[160:163], v[96:99], v[76:79], v[160:163]
    ds_read_b64_tr_b16 v[66:67], v11 offset:768
    v_mfma_f32_16x16x32_bf16 v[164:167], v[96:99], v[80:83], v[164:167]
    v_mfma_f32_16x16x32_bf16 v[168:171], v[100:103], v[68:71], v[168:171]
    v_mfma_f32_16x16x32_bf16 v[172:175], v[100:103], v[72:75], v[172:175]
    v_mfma_f32_16x16x32_bf16 v[176:179], v[100:103], v[76:79], v[176:179]
    v_mfma_f32_16x16x32_bf16 v[180:183], v[100:103], v[80:83], v[180:183]
    s_waitcnt lgkmcnt(0)
    v_mfma_f32_16x16x32_bf16 v[104:107], v[48:51], v[32:35], v[104:107]
    s_barrier
    v_add_u32 v10, 0x4000, v10
    v_add_u32 v11, 0x6000, v11
    v_mfma_f32_16x16x32_bf16 v[108:111], v[48:51], v[36:39], v[108:111]
    ds_read_b128 v[68:71], v10 offset:0
    v_mfma_f32_16x16x32_bf16 v[112:115], v[48:51], v[40:43], v[112:115]
    ds_read_b128 v[72:75], v10 offset:4096
    v_mfma_f32_16x16x32_bf16 v[116:119], v[48:51], v[44:47], v[116:119]
    ds_read_b128 v[76:79], v10 offset:8192
    v_mfma_f32_16x16x32_bf16 v[120:123], v[52:55], v[32:35], v[120:123]
    ds_read_b128 v[80:83], v10 offset:12288
    v_mfma_f32_16x16x32_bf16 v[124:127], v[52:55], v[36:39], v[124:127]
    ds_read_b64_tr_b16 v[84:85], v11 offset:0
    v_mfma_f32_16x16x32_bf16 v[128:131], v[52:55], v[40:43], v[128:131]
    ds_read_b64_tr_b16 v[86:87], v11 offset:640
    v_mfma_f32_16x16x32_bf16 v[132:135], v[52:55], v[44:47], v[132:135]
    ds_read_b64_tr_b16 v[88:89], v11 offset:32
    v_mfma_f32_16x16x32_bf16 v[136:139], v[56:59], v[32:35], v[136:139]
    ds_read_b64_tr_b16 v[90:91], v11 offset:672
    v_mfma_f32_16x16x32_bf16 v[140:143], v[56:59], v[36:39], v[140:143]
    ds_read_b64_tr_b16 v[92:93], v11 offset:64
    v_mfma_f32_16x16x32_bf16 v[144:147], v[56:59], v[40:43], v[144:147]
    ds_read_b64_tr_b16 v[94:95], v11 offset:704
    v_mfma_f32_16x16x32_bf16 v[148:151], v[56:59], v[44:47], v[148:151]
    ds_read_b64_tr_b16 v[96:97], v11 offset:96
    v_mfma_f32_16x16x32_bf16 v[152:155], v[60:63], v[32:35], v[152:155]
    ds_read_b64_tr_b16 v[98:99], v11 offset:736
    v_mfma_f32_16x16x32_bf16 v[156:159], v[60:63], v[36:39], v[156:159]
    ds_read_b64_tr_b16 v[100:101], v11 offset:128
    v_mfma_f32_16x16x32_bf16 v[160:163], v[60:63], v[40:43], v[160:163]
    ds_read_b64_tr_b16 v[102:103], v11 offset:768
    v_mfma_f32_16x16x32_bf16 v[164:167], v[60:63], v[44:47], v[164:167]
    v_mfma_f32_16x16x32_bf16 v[168:171], v[64:67], v[32:35], v[168:171]
    v_mfma_f32_16x16x32_bf16 v[172:175], v[64:67], v[36:39], v[172:175]
    v_mfma_f32_16x16x32_bf16 v[176:179], v[64:67], v[40:43], v[176:179]
    v_mfma_f32_16x16x32_bf16 v[180:183], v[64:67], v[44:47], v[180:183]
    s_waitcnt lgkmcnt(0)
    v_mfma_f32_16x16x32_bf16 v[104:107], v[84:87], v[68:71], v[104:107]
    v_mfma_f32_16x16x32_bf16 v[108:111], v[84:87], v[72:75], v[108:111]
    v_mfma_f32_16x16x32_bf16 v[112:115], v[84:87], v[76:79], v[112:115]
    v_mfma_f32_16x16x32_bf16 v[116:119], v[84:87], v[80:83], v[116:119]
    v_mfma_f32_16x16x32_bf16 v[120:123], v[88:91], v[68:71], v[120:123]
    v_mfma_f32_16x16x32_bf16 v[124:127], v[88:91], v[72:75], v[124:127]
    v_mfma_f32_16x16x32_bf16 v[128:131], v[88:91], v[76:79], v[128:131]
    v_mfma_f32_16x16x32_bf16 v[132:135], v[88:91], v[80:83], v[132:135]
    v_mfma_f32_16x16x32_bf16 v[136:139], v[92:95], v[68:71], v[136:139]
    v_mfma_f32_16x16x32_bf16 v[140:143], v[92:95], v[72:75], v[140:143]
    v_mfma_f32_16x16x32_bf16 v[144:147], v[92:95], v[76:79], v[144:147]
    v_mfma_f32_16x16x32_bf16 v[148:151], v[92:95], v[80:83], v[148:151]
    v_mfma_f32_16x16x32_bf16 v[152:155], v[96:99], v[68:71], v[152:155]
    v_mfma_f32_16x16x32_bf16 v[156:159], v[96:99], v[72:75], v[156:159]
    v_mfma_f32_16x16x32_bf16 v[160:163], v[96:99], v[76:79], v[160:163]
    v_mfma_f32_16x16x32_bf16 v[164:167], v[96:99], v[80:83], v[164:167]
    v_mfma_f32_16x16x32_bf16 v[168:171], v[100:103], v[68:71], v[168:171]
    v_mfma_f32_16x16x32_bf16 v[172:175], v[100:103], v[72:75], v[172:175]
    v_mfma_f32_16x16x32_bf16 v[176:179], v[100:103], v[76:79], v[176:179]
    v_mfma_f32_16x16x32_bf16 v[180:183], v[100:103], v[80:83], v[180:183]
    s_barrier
    v_lshlrev_b32 v25, 4, v1
    s_mul_i32 s32, s29, 15360
    v_add_u32 v27, s32, v25
    s_nop 7
    s_cmp_eq_u32 s29, 0
    s_cbranch_scc1 rw_mega_kernel_49
    s_sub_u32 s32, s29, 1
    s_and_b32 s32, s32, 3
    s_mul_i32 s32, s32, 5120
    s_add_u32 s32, s32, 0
    v_add_u32 v26, s32, v25
    ds_write_b128 v26, v[104:107] offset:0
    ds_write_b128 v26, v[120:123] offset:1024
    ds_write_b128 v26, v[136:139] offset:2048
    ds_write_b128 v26, v[152:155] offset:3072
    ds_write_b128 v26, v[168:171] offset:4096
rw_mega_kernel_49:
    s_cmp_eq_u32 s29, 1
    s_cbranch_scc1 rw_mega_kernel_50
    s_sub_u32 s32, s29, 2
    s_and_b32 s32, s32, 3
    s_mul_i32 s32, s32, 5120
    s_add_u32 s32, s32, 15360
    v_add_u32 v26, s32, v25
    ds_write_b128 v26, v[108:111] offset:0
    ds_write_b128 v26, v[124:127] offset:1024
    ds_write_b128 v26, v[140:143] offset:2048
    ds_write_b128 v26, v[156:159] offset:3072
    ds_write_b128 v26, v[172:175] offset:4096
rw_mega_kernel_50:
    s_cmp_eq_u32 s29, 2
    s_cbranch_scc1 rw_mega_kernel_51
    s_sub_u32 s32, s29, 3
    s_and_b32 s32, s32, 3
    s_mul_i32 s32, s32, 5120
    s_add_u32 s32, s32, 30720
    v_add_u32 v26, s32, v25
    ds_write_b128 v26, v[112:115] offset:0
    ds_write_b128 v26, v[128:131] offset:1024
    ds_write_b128 v26, v[144:147] offset:2048
    ds_write_b128 v26, v[160:163] offset:3072
    ds_write_b128 v26, v[176:179] offset:4096
rw_mega_kernel_51:
    s_cmp_eq_u32 s29, 3
    s_cbranch_scc1 rw_mega_kernel_52
    s_sub_u32 s32, s29, 4
    s_and_b32 s32, s32, 3
    s_mul_i32 s32, s32, 5120
    s_add_u32 s32, s32, 46080
    v_add_u32 v26, s32, v25
    ds_write_b128 v26, v[116:119] offset:0
    ds_write_b128 v26, v[132:135] offset:1024
    ds_write_b128 v26, v[148:151] offset:2048
    ds_write_b128 v26, v[164:167] offset:3072
    ds_write_b128 v26, v[180:183] offset:4096
rw_mega_kernel_52:
    s_waitcnt lgkmcnt(0)
    s_barrier
    s_cmp_eq_u32 s29, 0
    s_cbranch_scc1 own_mega_kernel_54
    s_cmp_eq_u32 s29, 1
    s_cbranch_scc1 own_mega_kernel_55
    s_cmp_eq_u32 s29, 2
    s_cbranch_scc1 own_mega_kernel_56
    s_cmp_eq_u32 s29, 3
    s_cbranch_scc1 own_mega_kernel_57
own_mega_kernel_54:
    v_mov_b32 v32, v104
    v_mov_b32 v33, v105
    v_mov_b32 v34, v106
    v_mov_b32 v35, v107
    v_mov_b32 v36, v120
    v_mov_b32 v37, v121
    v_mov_b32 v38, v122
    v_mov_b32 v39, v123
    v_mov_b32 v40, v136
    v_mov_b32 v41, v137
    v_mov_b32 v42, v138
    v_mov_b32 v43, v139
    v_mov_b32 v44, v152
    v_mov_b32 v45, v153
    v_mov_b32 v46, v154
    v_mov_b32 v47, v155
    v_mov_b32 v48, v168
    v_mov_b32 v49, v169
    v_mov_b32 v50, v170
    v_mov_b32 v51, v171
    s_branch e_mega_kernel_53
own_mega_kernel_55:
    v_mov_b32 v32, v108
    v_mov_b32 v33, v109
    v_mov_b32 v34, v110
    v_mov_b32 v35, v111
    v_mov_b32 v36, v124
    v_mov_b32 v37, v125
    v_mov_b32 v38, v126
    v_mov_b32 v39, v127
    v_mov_b32 v40, v140
    v_mov_b32 v41, v141
    v_mov_b32 v42, v142
    v_mov_b32 v43, v143
    v_mov_b32 v44, v156
    v_mov_b32 v45, v157
    v_mov_b32 v46, v158
    v_mov_b32 v47, v159
    v_mov_b32 v48, v172
    v_mov_b32 v49, v173
    v_mov_b32 v50, v174
    v_mov_b32 v51, v175
    s_branch e_mega_kernel_53
own_mega_kernel_56:
    v_mov_b32 v32, v112
    v_mov_b32 v33, v113
    v_mov_b32 v34, v114
    v_mov_b32 v35, v115
    v_mov_b32 v36, v128
    v_mov_b32 v37, v129
    v_mov_b32 v38, v130
    v_mov_b32 v39, v131
    v_mov_b32 v40, v144
    v_mov_b32 v41, v145
    v_mov_b32 v42, v146
    v_mov_b32 v43, v147
    v_mov_b32 v44, v160
    v_mov_b32 v45, v161
    v_mov_b32 v46, v162
    v_mov_b32 v47, v163
    v_mov_b32 v48, v176
    v_mov_b32 v49, v177
    v_mov_b32 v50, v178
    v_mov_b32 v51, v179
    s_branch e_mega_kernel_53
own_mega_kernel_57:
    v_mov_b32 v32, v116
    v_mov_b32 v33, v117
    v_mov_b32 v34, v118
    v_mov_b32 v35, v119
    v_mov_b32 v36, v132
    v_mov_b32 v37, v133
    v_mov_b32 v38, v134
    v_mov_b32 v39, v135
    v_mov_b32 v40, v148
    v_mov_b32 v41, v149
    v_mov_b32 v42, v150
    v_mov_b32 v43, v151
    v_mov_b32 v44, v164
    v_mov_b32 v45, v165
    v_mov_b32 v46, v166
    v_mov_b32 v47, v167
    v_mov_b32 v48, v180
    v_mov_b32 v49, v181
    v_mov_b32 v50, v182
    v_mov_b32 v51, v183
    s_branch e_mega_kernel_53
e_mega_kernel_53:
    ds_read_b128 v[104:107], v27 offset:0
    ds_read_b128 v[108:111], v27 offset:1024
    ds_read_b128 v[112:115], v27 offset:2048
    ds_read_b128 v[116:119], v27 offset:3072
    ds_read_b128 v[120:123], v27 offset:4096
    ds_read_b128 v[124:127], v27 offset:5120
    ds_read_b128 v[128:131], v27 offset:6144
    ds_read_b128 v[132:135], v27 offset:7168
    ds_read_b128 v[136:139], v27 offset:8192
    ds_read_b128 v[140:143], v27 offset:9216
    ds_read_b128 v[144:147], v27 offset:10240
    ds_read_b128 v[148:151], v27 offset:11264
    ds_read_b128 v[152:155], v27 offset:12288
    ds_read_b128 v[156:159], v27 offset:13312
    ds_read_b128 v[160:163], v27 offset:14336
    s_waitcnt lgkmcnt(0) vmcnt(0)
    v_pk_add_f32 v[32:33], v[32:33], v[104:105]
    v_pk_add_f32 v[34:35], v[34:35], v[106:107]
    v_pk_add_f32 v[36:37], v[36:37], v[108:109]
    v_pk_add_f32 v[38:39], v[38:39], v[110:111]
    v_pk_add_f32 v[40:41], v[40:41], v[112:113]
    v_pk_add_f32 v[42:43], v[42:43], v[114:115]
    v_pk_add_f32 v[44:45], v[44:45], v[116:117]
    v_pk_add_f32 v[46:47], v[46:47], v[118:119]
    v_pk_add_f32 v[48:49], v[48:49], v[120:121]
    v_pk_add_f32 v[50:51], v[50:51], v[122:123]
    v_pk_add_f32 v[32:33], v[32:33], v[124:125]
    v_pk_add_f32 v[34:35], v[34:35], v[126:127]
    v_pk_add_f32 v[36:37], v[36:37], v[128:129]
    v_pk_add_f32 v[38:39], v[38:39], v[130:131]
    v_pk_add_f32 v[40:41], v[40:41], v[132:133]
    v_pk_add_f32 v[42:43], v[42:43], v[134:135]
    v_pk_add_f32 v[44:45], v[44:45], v[136:137]
    v_pk_add_f32 v[46:47], v[46:47], v[138:139]
    v_pk_add_f32 v[48:49], v[48:49], v[140:141]
    v_pk_add_f32 v[50:51], v[50:51], v[142:143]
    v_pk_add_f32 v[32:33], v[32:33], v[144:145]
    v_pk_add_f32 v[34:35], v[34:35], v[146:147]
    v_pk_add_f32 v[36:37], v[36:37], v[148:149]
    v_pk_add_f32 v[38:39], v[38:39], v[150:151]
    v_pk_add_f32 v[40:41], v[40:41], v[152:153]
    v_pk_add_f32 v[42:43], v[42:43], v[154:155]
    v_pk_add_f32 v[44:45], v[44:45], v[156:157]
    v_pk_add_f32 v[46:47], v[46:47], v[158:159]
    v_pk_add_f32 v[48:49], v[48:49], v[160:161]
    v_pk_add_f32 v[50:51], v[50:51], v[162:163]
    v_cvt_pk_bf16_f32 v20, v32, v33
    v_lshlrev_b32 v32, 16, v20
    v_and_b32 v33, 0xffff0000, v20
    v_lshlrev_b32 v21, 16, v184
    v_and_b32 v22, 0xffff0000, v184
    v_add_f32 v32, v32, v21
    v_add_f32 v33, v33, v22
    v_cvt_pk_bf16_f32 v184, v32, v33
    v_lshlrev_b32 v32, 16, v184
    v_and_b32 v33, 0xffff0000, v184
    v_cvt_pk_bf16_f32 v20, v34, v35
    v_lshlrev_b32 v34, 16, v20
    v_and_b32 v35, 0xffff0000, v20
    v_lshlrev_b32 v21, 16, v185
    v_and_b32 v22, 0xffff0000, v185
    v_add_f32 v34, v34, v21
    v_add_f32 v35, v35, v22
    v_cvt_pk_bf16_f32 v185, v34, v35
    v_lshlrev_b32 v34, 16, v185
    v_and_b32 v35, 0xffff0000, v185
    ds_write_b64 v30, v[184:185] offset:0
    v_cvt_pk_bf16_f32 v20, v36, v37
    v_lshlrev_b32 v36, 16, v20
    v_and_b32 v37, 0xffff0000, v20
    v_lshlrev_b32 v21, 16, v186
    v_and_b32 v22, 0xffff0000, v186
    v_add_f32 v36, v36, v21
    v_add_f32 v37, v37, v22
    v_cvt_pk_bf16_f32 v186, v36, v37
    v_lshlrev_b32 v36, 16, v186
    v_and_b32 v37, 0xffff0000, v186
    v_cvt_pk_bf16_f32 v20, v38, v39
    v_lshlrev_b32 v38, 16, v20
    v_and_b32 v39, 0xffff0000, v20
    v_lshlrev_b32 v21, 16, v187
    v_and_b32 v22, 0xffff0000, v187
    v_add_f32 v38, v38, v21
    v_add_f32 v39, v39, v22
    v_cvt_pk_bf16_f32 v187, v38, v39
    v_lshlrev_b32 v38, 16, v187
    v_and_b32 v39, 0xffff0000, v187
    ds_write_b64 v30, v[186:187] offset:32
    v_cvt_pk_bf16_f32 v20, v40, v41
    v_lshlrev_b32 v40, 16, v20
    v_and_b32 v41, 0xffff0000, v20
    v_lshlrev_b32 v21, 16, v188
    v_and_b32 v22, 0xffff0000, v188
    v_add_f32 v40, v40, v21
    v_add_f32 v41, v41, v22
    v_cvt_pk_bf16_f32 v188, v40, v41
    v_lshlrev_b32 v40, 16, v188
    v_and_b32 v41, 0xffff0000, v188
    v_cvt_pk_bf16_f32 v20, v42, v43
    v_lshlrev_b32 v42, 16, v20
    v_and_b32 v43, 0xffff0000, v20
    v_lshlrev_b32 v21, 16, v189
    v_and_b32 v22, 0xffff0000, v189
    v_add_f32 v42, v42, v21
    v_add_f32 v43, v43, v22
    v_cvt_pk_bf16_f32 v189, v42, v43
    v_lshlrev_b32 v42, 16, v189
    v_and_b32 v43, 0xffff0000, v189
    ds_write_b64 v30, v[188:189] offset:64
    v_cvt_pk_bf16_f32 v20, v44, v45
    v_lshlrev_b32 v44, 16, v20
    v_and_b32 v45, 0xffff0000, v20
    v_lshlrev_b32 v21, 16, v190
    v_and_b32 v22, 0xffff0000, v190
    v_add_f32 v44, v44, v21
    v_add_f32 v45, v45, v22
    v_cvt_pk_bf16_f32 v190, v44, v45
    v_lshlrev_b32 v44, 16, v190
    v_and_b32 v45, 0xffff0000, v190
    v_cvt_pk_bf16_f32 v20, v46, v47
    v_lshlrev_b32 v46, 16, v20
    v_and_b32 v47, 0xffff0000, v20
    v_lshlrev_b32 v21, 16, v191
    v_and_b32 v22, 0xffff0000, v191
    v_add_f32 v46, v46, v21
    v_add_f32 v47, v47, v22
    v_cvt_pk_bf16_f32 v191, v46, v47
    v_lshlrev_b32 v46, 16, v191
    v_and_b32 v47, 0xffff0000, v191
    ds_write_b64 v30, v[190:191] offset:96
    v_cvt_pk_bf16_f32 v20, v48, v49
    v_lshlrev_b32 v48, 16, v20
    v_and_b32 v49, 0xffff0000, v20
    v_lshlrev_b32 v21, 16, v192
    v_and_b32 v22, 0xffff0000, v192
    v_add_f32 v48, v48, v21
    v_add_f32 v49, v49, v22
    v_cvt_pk_bf16_f32 v192, v48, v49
    v_lshlrev_b32 v48, 16, v192
    v_and_b32 v49, 0xffff0000, v192
    v_cvt_pk_bf16_f32 v20, v50, v51
    v_lshlrev_b32 v50, 16, v20
    v_and_b32 v51, 0xffff0000, v20
    v_lshlrev_b32 v21, 16, v193
    v_and_b32 v22, 0xffff0000, v193
    v_add_f32 v50, v50, v21
    v_add_f32 v51, v51, v22
    v_cvt_pk_bf16_f32 v193, v50, v51
    v_lshlrev_b32 v50, 16, v193
    v_and_b32 v51, 0xffff0000, v193
    ds_write_b64 v30, v[192:193] offset:128
    s_waitcnt lgkmcnt(0)
    ds_read_b128 v[104:107], v31 offset:0
    ds_read_b128 v[108:111], v31 offset:1024
    ds_read_b128 v[112:115], v31 offset:2048
    v_cmp_gt_u32 vcc, 32, v1
    s_waitcnt lgkmcnt(2)
    buffer_store_dwordx4 v[104:107], v12, s[16:19], 0 offen
    s_waitcnt lgkmcnt(1)
    buffer_store_dwordx4 v[108:111], v13, s[16:19], 0 offen
    s_and_saveexec_b64 s[36:37], vcc
    s_waitcnt lgkmcnt(0)
    buffer_store_dwordx4 v[112:115], v14, s[16:19], 0 offen
    s_mov_b64 exec, s[36:37]
    v_add_f32 v20, v32, v33
    v_add_f32 v20, v20, v34
    v_add_f32 v20, v20, v35
    v_add_f32 v20, v20, v36
    v_add_f32 v20, v20, v37
    v_add_f32 v20, v20, v38
    v_add_f32 v20, v20, v39
    v_add_f32 v20, v20, v40
    v_add_f32 v20, v20, v41
    v_add_f32 v20, v20, v42
    v_add_f32 v20, v20, v43
    v_add_f32 v20, v20, v44
    v_add_f32 v20, v20, v45
    v_add_f32 v20, v20, v46
    v_add_f32 v20, v20, v47
    v_add_f32 v20, v20, v48
    v_add_f32 v20, v20, v49
    v_add_f32 v20, v20, v50
    v_add_f32 v20, v20, v51
    v_mov_b32 v22, v20
    s_nop 1
    v_permlane16_swap_b32 v20, v22
    v_add_f32 v20, v20, v22
    v_mov_b32 v22, v20
    s_nop 1
    v_permlane32_swap_b32 v20, v22
    v_add_f32 v20, v20, v22
    v_mul_f32 v23, 0x3c4ccccd, v20
    v_mov_b32 v21, 0
    v_sub_f32 v22, v32, v23
    v_fmac_f32 v21, v22, v22
    v_sub_f32 v22, v33, v23
    v_fmac_f32 v21, v22, v22
    v_sub_f32 v22, v34, v23
    v_fmac_f32 v21, v22, v22
    v_sub_f32 v22, v35, v23
    v_fmac_f32 v21, v22, v22
    v_sub_f32 v22, v36, v23
    v_fmac_f32 v21, v22, v22
    v_sub_f32 v22, v37, v23
    v_fmac_f32 v21, v22, v22
    v_sub_f32 v22, v38, v23
    v_fmac_f32 v21, v22, v22
    v_sub_f32 v22, v39, v23
    v_fmac_f32 v21, v22, v22
    v_sub_f32 v22, v40, v23
    v_fmac_f32 v21, v22, v22
    v_sub_f32 v22, v41, v23
    v_fmac_f32 v21, v22, v22
    v_sub_f32 v22, v42, v23
    v_fmac_f32 v21, v22, v22
    v_sub_f32 v22, v43, v23
    v_fmac_f32 v21, v22, v22
    v_sub_f32 v22, v44, v23
    v_fmac_f32 v21, v22, v22
    v_sub_f32 v22, v45, v23
    v_fmac_f32 v21, v22, v22
    v_sub_f32 v22, v46, v23
    v_fmac_f32 v21, v22, v22
    v_sub_f32 v22, v47, v23
    v_fmac_f32 v21, v22, v22
    v_sub_f32 v22, v48, v23
    v_fmac_f32 v21, v22, v22
    v_sub_f32 v22, v49, v23
    v_fmac_f32 v21, v22, v22
    v_sub_f32 v22, v50, v23
    v_fmac_f32 v21, v22, v22
    v_sub_f32 v22, v51, v23
    v_fmac_f32 v21, v22, v22
    v_mov_b32 v22, v21
    s_nop 1
    v_permlane16_swap_b32 v21, v22
    v_add_f32 v21, v21, v22
    v_mov_b32 v22, v21
    s_nop 1
    v_permlane32_swap_b32 v21, v22
    v_add_f32 v21, v21, v22
    v_lshlrev_b32 v28, 6, v28
    s_lshl_b32 s32, s27, 3
    v_add_u32 v28, s32, v28
    v_cmp_gt_u32 vcc, 16, v1
    s_and_saveexec_b64 s[36:37], vcc
    buffer_store_dwordx2 v[20:21], v28, s[20:23], 0 offen
    s_mov_b64 exec, s[36:37]
    s_waitcnt vmcnt(0)
    s_barrier
    s_lshr_b32 s32, s26, 1
    s_add_u32 s32, s32, 296
    s_and_b32 s33, s26, 1
    s_lshl_b32 s33, s33, 3
    s_add_u32 s33, s33, s27
    s_cmp_lg_u32 s29, 0
    s_cbranch_scc1 nosig_mega_kernel_58
    s_lshl_b32 s38, s32, 7
    s_lshl_b32 s39, s33, 2
    s_add_u32 s38, s38, s39
    v_mov_b32 v24, s38
    v_mov_b32 v23, 1
    v_cmp_eq_u32 vcc, 0, v1
    s_and_saveexec_b64 s[36:37], vcc
    s_cbranch_execz nosig2_mega_kernel_59
    buffer_store_dword v23, v24, s[92:95], 0 offen
nosig2_mega_kernel_59:
    s_mov_b64 exec, s[36:37]
nosig_mega_kernel_58:
    s_branch end_mega_kernel_46
loader_mega_kernel_45:
    s_lshl_b32 s32, s26, 6
    s_lshl_b32 s33, s28, 4
    s_add_u32 s32, s32, s33
    v_lshrrev_b32 v25, 4, v1
    v_and_b32 v26, 15, v1
    s_mov_b32 s33, 3072
    v_add_u32 v27, 0, v25
    v_xor_b32 v28, v26, v27
    v_add_u32 v27, s32, v27
    v_mul_lo_u32 v27, v27, s33
    v_lshl_add_u32 v27, v28, 4, v27
    v_subrev_u32 v2, 0, v27
    v_add_u32 v27, 4, v25
    v_xor_b32 v28, v26, v27
    v_add_u32 v27, s32, v27
    v_mul_lo_u32 v27, v27, s33
    v_lshl_add_u32 v27, v28, 4, v27
    v_subrev_u32 v3, 1024, v27
    v_add_u32 v27, 8, v25
    v_xor_b32 v28, v26, v27
    v_add_u32 v27, s32, v27
    v_mul_lo_u32 v27, v27, s33
    v_lshl_add_u32 v27, v28, 4, v27
    v_subrev_u32 v4, 2048, v27
    v_add_u32 v27, 12, v25
    v_xor_b32 v28, v26, v27
    v_add_u32 v27, s32, v27
    v_mul_lo_u32 v27, v27, s33
    v_lshl_add_u32 v27, v28, 4, v27
    v_subrev_u32 v5, 3072, v27
    s_mov_b32 s39, 98304
    s_lshl_b32 s34, s28, 12
    s_add_u32 s76, s84, 0x2209000
    s_addc_u32 s77, s85, 0
    s_mov_b32 s78, 1966080
    s_and_b32 s77, s77, 0xffff
    s_mov_b32 s79, 0x00020000
    s_lshr_b32 s82, s2, 5
    s_mul_i32 s82, s82, 245760
    s_mul_i32 s80, s28, 5120
    s_add_u32 s82, s82, s80
    v_lshlrev_b32 v8, 4, v1
    v_add_u32 v8, s82, v8
    v_add_u32 v9, 4096, v8
    s_barrier
    s_add_u32 m0, s34, 32768
    s_mov_b32 s35, 0
    buffer_load_dwordx4 v2, s[4:7], s35 offen offset:0 sc1 lds
    buffer_load_dwordx4 v3, s[4:7], s35 offen offset:1024 sc1 lds
    buffer_load_dwordx4 v4, s[4:7], s35 offen offset:2048 sc1 lds
    buffer_load_dwordx4 v5, s[4:7], s35 offen offset:3072 sc1 lds
    s_add_u32 m0, s34, 49152
    s_mov_b32 s35, 256
    buffer_load_dwordx4 v2, s[4:7], s35 offen offset:0 sc1 lds
    buffer_load_dwordx4 v3, s[4:7], s35 offen offset:1024 sc1 lds
    buffer_load_dwordx4 v4, s[4:7], s35 offen offset:2048 sc1 lds
    buffer_load_dwordx4 v5, s[4:7], s35 offen offset:3072 sc1 lds
    s_waitcnt vmcnt(4)
    s_barrier
    s_add_u32 m0, s34, 0
    s_mov_b32 s35, 512
    buffer_load_dwordx4 v2, s[4:7], s35 offen offset:0 sc1 lds
    buffer_load_dwordx4 v3, s[4:7], s35 offen offset:1024 sc1 lds
    buffer_load_dwordx4 v4, s[4:7], s35 offen offset:2048 sc1 lds
    buffer_load_dwordx4 v5, s[4:7], s35 offen offset:3072 sc1 lds
    s_add_u32 m0, s34, 16384
    s_mov_b32 s35, 768
    buffer_load_dwordx4 v2, s[4:7], s35 offen offset:0 sc1 lds
    buffer_load_dwordx4 v3, s[4:7], s35 offen offset:1024 sc1 lds
    buffer_load_dwordx4 v4, s[4:7], s35 offen offset:2048 sc1 lds
    buffer_load_dwordx4 v5, s[4:7], s35 offen offset:3072 sc1 lds
    s_waitcnt vmcnt(8)
    s_barrier
    s_add_u32 m0, s34, 32768
    s_mov_b32 s35, 1024
    buffer_load_dwordx4 v2, s[4:7], s35 offen offset:0 sc1 lds
    buffer_load_dwordx4 v3, s[4:7], s35 offen offset:1024 sc1 lds
    buffer_load_dwordx4 v4, s[4:7], s35 offen offset:2048 sc1 lds
    buffer_load_dwordx4 v5, s[4:7], s35 offen offset:3072 sc1 lds
    s_add_u32 m0, s80, 114688
    s_mov_b32 s81, 81920
    buffer_load_dwordx4 v8, s[76:79], s81 offen offset:0 sc1 lds
    buffer_load_dwordx4 v8, s[76:79], s81 offen offset:1024 sc1 lds
    buffer_load_dwordx4 v8, s[76:79], s81 offen offset:2048 sc1 lds
    buffer_load_dwordx4 v8, s[76:79], s81 offen offset:3072 sc1 lds
    s_add_u32 m0, s80, 118784
    s_nop 0
    buffer_load_dwordx4 v9, s[76:79], s81 offen offset:0 sc1 lds
    s_waitcnt vmcnt(13)
    s_barrier
    s_add_u32 m0, s34, 49152
    s_mov_b32 s35, 1280
    buffer_load_dwordx4 v2, s[4:7], s35 offen offset:0 sc1 lds
    buffer_load_dwordx4 v3, s[4:7], s35 offen offset:1024 sc1 lds
    buffer_load_dwordx4 v4, s[4:7], s35 offen offset:2048 sc1 lds
    buffer_load_dwordx4 v5, s[4:7], s35 offen offset:3072 sc1 lds
    s_add_u32 m0, s80, 139264
    s_mov_b32 s81, 102400
    buffer_load_dwordx4 v8, s[76:79], s81 offen offset:0 sc1 lds
    buffer_load_dwordx4 v8, s[76:79], s81 offen offset:1024 sc1 lds
    buffer_load_dwordx4 v8, s[76:79], s81 offen offset:2048 sc1 lds
    buffer_load_dwordx4 v8, s[76:79], s81 offen offset:3072 sc1 lds
    s_add_u32 m0, s80, 143360
    s_nop 0
    buffer_load_dwordx4 v9, s[76:79], s81 offen offset:0 sc1 lds
    s_waitcnt vmcnt(18)
    s_barrier
    s_add_u32 m0, s34, 0
    s_mov_b32 s35, 1536
    buffer_load_dwordx4 v2, s[4:7], s35 offen offset:0 sc1 lds
    buffer_load_dwordx4 v3, s[4:7], s35 offen offset:1024 sc1 lds
    buffer_load_dwordx4 v4, s[4:7], s35 offen offset:2048 sc1 lds
    buffer_load_dwordx4 v5, s[4:7], s35 offen offset:3072 sc1 lds
    s_add_u32 m0, s80, 65536
    s_mov_b32 s81, 122880
    buffer_load_dwordx4 v8, s[76:79], s81 offen offset:0 sc1 lds
    buffer_load_dwordx4 v8, s[76:79], s81 offen offset:1024 sc1 lds
    buffer_load_dwordx4 v8, s[76:79], s81 offen offset:2048 sc1 lds
    buffer_load_dwordx4 v8, s[76:79], s81 offen offset:3072 sc1 lds
    s_add_u32 m0, s80, 69632
    s_nop 0
    buffer_load_dwordx4 v9, s[76:79], s81 offen offset:0 sc1 lds
    s_waitcnt vmcnt(18)
    s_barrier
    s_add_u32 m0, s34, 16384
    s_mov_b32 s35, 1792
    buffer_load_dwordx4 v2, s[4:7], s35 offen offset:0 sc1 lds
    buffer_load_dwordx4 v3, s[4:7], s35 offen offset:1024 sc1 lds
    buffer_load_dwordx4 v4, s[4:7], s35 offen offset:2048 sc1 lds
    buffer_load_dwordx4 v5, s[4:7], s35 offen offset:3072 sc1 lds
    s_add_u32 m0, s80, 90112
    s_mov_b32 s81, 143360
    buffer_load_dwordx4 v8, s[76:79], s81 offen offset:0 sc1 lds
    buffer_load_dwordx4 v8, s[76:79], s81 offen offset:1024 sc1 lds
    buffer_load_dwordx4 v8, s[76:79], s81 offen offset:2048 sc1 lds
    buffer_load_dwordx4 v8, s[76:79], s81 offen offset:3072 sc1 lds
    s_add_u32 m0, s80, 94208
    s_nop 0
    buffer_load_dwordx4 v9, s[76:79], s81 offen offset:0 sc1 lds
    s_waitcnt vmcnt(18)
    s_barrier
    s_add_u32 m0, s34, 32768
    s_mov_b32 s35, 2048
    buffer_load_dwordx4 v2, s[4:7], s35 offen offset:0 sc1 lds
    buffer_load_dwordx4 v3, s[4:7], s35 offen offset:1024 sc1 lds
    buffer_load_dwordx4 v4, s[4:7], s35 offen offset:2048 sc1 lds
    buffer_load_dwordx4 v5, s[4:7], s35 offen offset:3072 sc1 lds
    s_add_u32 m0, s80, 114688
    s_mov_b32 s81, 163840
    buffer_load_dwordx4 v8, s[76:79], s81 offen offset:0 sc1 lds
    buffer_load_dwordx4 v8, s[76:79], s81 offen offset:1024 sc1 lds
    buffer_load_dwordx4 v8, s[76:79], s81 offen offset:2048 sc1 lds
    buffer_load_dwordx4 v8, s[76:79], s81 offen offset:3072 sc1 lds
    s_add_u32 m0, s80, 118784
    s_nop 0
    buffer_load_dwordx4 v9, s[76:79], s81 offen offset:0 sc1 lds
    s_waitcnt vmcnt(18)
    s_barrier
    s_add_u32 m0, s34, 49152
    s_mov_b32 s35, 2304
    buffer_load_dwordx4 v2, s[4:7], s35 offen offset:0 sc1 lds
    buffer_load_dwordx4 v3, s[4:7], s35 offen offset:1024 sc1 lds
    buffer_load_dwordx4 v4, s[4:7], s35 offen offset:2048 sc1 lds
    buffer_load_dwordx4 v5, s[4:7], s35 offen offset:3072 sc1 lds
    s_add_u32 m0, s80, 139264
    s_mov_b32 s81, 184320
    buffer_load_dwordx4 v8, s[76:79], s81 offen offset:0 sc1 lds
    buffer_load_dwordx4 v8, s[76:79], s81 offen offset:1024 sc1 lds
    buffer_load_dwordx4 v8, s[76:79], s81 offen offset:2048 sc1 lds
    buffer_load_dwordx4 v8, s[76:79], s81 offen offset:3072 sc1 lds
    s_add_u32 m0, s80, 143360
    s_nop 0
    buffer_load_dwordx4 v9, s[76:79], s81 offen offset:0 sc1 lds
    s_waitcnt vmcnt(18)
    s_barrier
    s_add_u32 m0, s34, 0
    s_mov_b32 s35, 2560
    buffer_load_dwordx4 v2, s[4:7], s35 offen offset:0 sc1 lds
    buffer_load_dwordx4 v3, s[4:7], s35 offen offset:1024 sc1 lds
    buffer_load_dwordx4 v4, s[4:7], s35 offen offset:2048 sc1 lds
    buffer_load_dwordx4 v5, s[4:7], s35 offen offset:3072 sc1 lds
    s_add_u32 m0, s80, 65536
    s_mov_b32 s81, 204800
    buffer_load_dwordx4 v8, s[76:79], s81 offen offset:0 sc1 lds
    buffer_load_dwordx4 v8, s[76:79], s81 offen offset:1024 sc1 lds
    buffer_load_dwordx4 v8, s[76:79], s81 offen offset:2048 sc1 lds
    buffer_load_dwordx4 v8, s[76:79], s81 offen offset:3072 sc1 lds
    s_add_u32 m0, s80, 69632
    s_nop 0
    buffer_load_dwordx4 v9, s[76:79], s81 offen offset:0 sc1 lds
    s_waitcnt vmcnt(18)
    s_barrier
    s_add_u32 m0, s34, 16384
    s_mov_b32 s35, 2816
    buffer_load_dwordx4 v2, s[4:7], s35 offen offset:0 sc1 lds
    buffer_load_dwordx4 v3, s[4:7], s35 offen offset:1024 sc1 lds
    buffer_load_dwordx4 v4, s[4:7], s35 offen offset:2048 sc1 lds
    buffer_load_dwordx4 v5, s[4:7], s35 offen offset:3072 sc1 lds
    s_add_u32 m0, s80, 90112
    s_mov_b32 s81, 225280
    buffer_load_dwordx4 v8, s[76:79], s81 offen offset:0 sc1 lds
    buffer_load_dwordx4 v8, s[76:79], s81 offen offset:1024 sc1 lds
    buffer_load_dwordx4 v8, s[76:79], s81 offen offset:2048 sc1 lds
    buffer_load_dwordx4 v8, s[76:79], s81 offen offset:3072 sc1 lds
    s_add_u32 m0, s80, 94208
    s_nop 0
    buffer_load_dwordx4 v9, s[76:79], s81 offen offset:0 sc1 lds
    s_waitcnt vmcnt(18)
    s_barrier
    s_waitcnt vmcnt(9)
    s_barrier
    s_waitcnt vmcnt(0)
    s_barrier
    s_add_u32 s76, s84, 0x1ad9000
    s_addc_u32 s77, s85, 0
    s_mov_b32 s78, 2621440
    s_and_b32 s77, s77, 0xffff
    s_mov_b32 s79, 0x00020000
    s_lshr_b32 s82, s2, 4
    s_mul_i32 s82, s82, 163840
    s_mul_i32 s80, s28, 4096
    s_add_u32 s82, s82, s80
    v_lshlrev_b32 v8, 4, v1
    v_add_u32 v8, s82, v8
    v_add_u32 v9, 4096, v8
    s_add_u32 m0, s80, 114688
    s_mov_b32 s81, 0
    buffer_load_dwordx4 v8, s[76:79], s81 offen offset:0 sc1 lds
    buffer_load_dwordx4 v8, s[76:79], s81 offen offset:1024 sc1 lds
    buffer_load_dwordx4 v8, s[76:79], s81 offen offset:2048 sc1 lds
    buffer_load_dwordx4 v8, s[76:79], s81 offen offset:3072 sc1 lds
    s_add_u32 m0, s80, 139264
    s_mov_b32 s81, 16384
    buffer_load_dwordx4 v8, s[76:79], s81 offen offset:0 sc1 lds
    buffer_load_dwordx4 v8, s[76:79], s81 offen offset:1024 sc1 lds
    buffer_load_dwordx4 v8, s[76:79], s81 offen offset:2048 sc1 lds
    buffer_load_dwordx4 v8, s[76:79], s81 offen offset:3072 sc1 lds
    s_add_u32 m0, s80, 65536
    s_mov_b32 s81, 32768
    buffer_load_dwordx4 v8, s[76:79], s81 offen offset:0 sc1 lds
    buffer_load_dwordx4 v8, s[76:79], s81 offen offset:1024 sc1 lds
    buffer_load_dwordx4 v8, s[76:79], s81 offen offset:2048 sc1 lds
    buffer_load_dwordx4 v8, s[76:79], s81 offen offset:3072 sc1 lds
    s_barrier
    s_add_u32 m0, s80, 90112
    s_mov_b32 s81, 49152
    buffer_load_dwordx4 v8, s[76:79], s81 offen offset:0 sc1 lds
    buffer_load_dwordx4 v8, s[76:79], s81 offen offset:1024 sc1 lds
    buffer_load_dwordx4 v8, s[76:79], s81 offen offset:2048 sc1 lds
    buffer_load_dwordx4 v8, s[76:79], s81 offen offset:3072 sc1 lds
    s_barrier
    s_barrier
end_mega_kernel_46:
    s_and_b32 s24, s2, 7
    s_lshr_b32 s25, s2, 3
    s_lshl_b32 s26, s24, 1
    s_and_b32 s27, s25, 1
    s_add_u32 s26, s26, s27
    s_lshr_b32 s27, s25, 1
    s_add_u32 s4, s84, 0x59000
    s_addc_u32 s5, s85, 0
    s_mov_b32 s6, 2621440
    s_and_b32 s5, s5, 0xffff
    s_mov_b32 s7, 0x00020000
    s_add_u32 s16, s84, 0xbd9000
    s_addc_u32 s17, s85, 0
    s_mov_b32 s18, 15728640
    s_and_b32 s17, s17, 0xffff
    s_mov_b32 s19, 0x00020000
    s_add_u32 s20, s84, 0x39000
    s_addc_u32 s21, s85, 0
    s_mov_b32 s22, 131072
    s_and_b32 s21, s21, 0xffff
    s_mov_b32 s23, 0x00020000
    s_add_u32 s12, s84, 0x14000
    s_addc_u32 s13, s85, 0
    s_mov_b32 s14, 20480
    s_and_b32 s13, s13, 0xffff
    s_mov_b32 s15, 0x00020000
    s_cmp_ge_u32 s29, 4
    s_cbranch_scc1 loader_mega_kernel_60
    s_and_b32 s30, s29, 1
    s_lshr_b32 s31, s29, 1
    v_and_b32 v25, 31, v1
    s_lshl_b32 s32, s26, 7
    s_lshl_b32 s33, s31, 6
    s_add_u32 s32, s32, s33
    v_add_u32 v28, s32, v25
    v_lshlrev_b32 v29, 6, v28
    v_lshrrev_b32 v30, 5, v1
    v_lshlrev_b32 v30, 4, v30
    s_lshl_b32 s32, s27, 9
    s_lshl_b32 s33, s30, 8
    s_add_u32 s32, s32, s33
    v_add_u32 v30, s32, v30
    v_and_b32 v25, 31, v1
    s_lshl_b32 s32, s31, 6
    v_add_u32 v26, s32, v25
    v_lshlrev_b32 v26, 7, v26
    v_lshrrev_b32 v25, 1, v25
    v_and_b32 v25, 7, v25
    v_lshrrev_b32 v27, 5, v1
    v_xor_b32 v25, v25, v27
    v_xor_b32 v27, 0, v25
    v_lshl_add_u32 v10, v27, 4, v26
    v_add_u32 v10, 32768, v10
    v_xor_b32 v27, 2, v25
    v_lshl_add_u32 v11, v27, 4, v26
    v_add_u32 v11, 32768, v11
    v_xor_b32 v27, 4, v25
    v_lshl_add_u32 v12, v27, 4, v26
    v_add_u32 v12, 32768, v12
    v_xor_b32 v27, 6, v25
    v_lshl_add_u32 v13, v27, 4, v26
    v_add_u32 v13, 32768, v13
    v_lshrrev_b32 v25, 5, v1
    v_lshlrev_b32 v25, 3, v25
    v_bfe_u32 v26, v1, 2, 2
    v_add_u32 v25, v25, v26
    v_lshlrev_b32 v25, 8, v25
    v_bfe_u32 v27, v1, 4, 1
    v_lshl_add_u32 v25, v27, 5, v25
    v_and_b32 v27, 3, v1
    v_lshl_add_u32 v25, v27, 3, v25
    v_add_u32 v25, 114688, v25
    s_lshl_b32 s32, s30, 1
    s_add_u32 s33, s32, 0
    v_xor_b32 v27, s33, v26
    v_lshl_add_u32 v14, v27, 6, v25
    s_add_u32 s33, s32, 1
    v_xor_b32 v27, s33, v26
    v_lshl_add_u32 v15, v27, 6, v25
    v_mov_b32 v64, 0
    v_mov_b32 v65, 0
    v_mov_b32 v66, 0
    v_mov_b32 v67, 0
    v_mov_b32 v68, 0
    v_mov_b32 v69, 0
    v_mov_b32 v70, 0
    v_mov_b32 v71, 0
    v_mov_b32 v72, 0
    v_mov_b32 v73, 0
    v_mov_b32 v74, 0
    v_mov_b32 v75, 0
    v_mov_b32 v76, 0
    v_mov_b32 v77, 0
    v_mov_b32 v78, 0
    v_mov_b32 v79, 0
    v_mov_b32 v80, 0
    v_mov_b32 v81, 0
    v_mov_b32 v82, 0
    v_mov_b32 v83, 0
    v_mov_b32 v84, 0
    v_mov_b32 v85, 0
    v_mov_b32 v86, 0
    v_mov_b32 v87, 0
    v_mov_b32 v88, 0
    v_mov_b32 v89, 0
    v_mov_b32 v90, 0
    v_mov_b32 v91, 0
    v_mov_b32 v92, 0
    v_mov_b32 v93, 0
    v_mov_b32 v94, 0
    v_mov_b32 v95, 0
    v_mov_b32 v96, 0
    v_mov_b32 v97, 0
    v_mov_b32 v98, 0
    v_mov_b32 v99, 0
    v_mov_b32 v100, 0
    v_mov_b32 v101, 0
    v_mov_b32 v102, 0
    v_mov_b32 v103, 0
    v_mov_b32 v104, 0
    v_mov_b32 v105, 0
    v_mov_b32 v106, 0
    v_mov_b32 v107, 0
    v_mov_b32 v108, 0
    v_mov_b32 v109, 0
    v_mov_b32 v110, 0
    v_mov_b32 v111, 0
    v_mov_b32 v112, 0
    v_mov_b32 v113, 0
    v_mov_b32 v114, 0
    v_mov_b32 v115, 0
    v_mov_b32 v116, 0
    v_mov_b32 v117, 0
    v_mov_b32 v118, 0
    v_mov_b32 v119, 0
    v_mov_b32 v120, 0
    v_mov_b32 v121, 0
    v_mov_b32 v122, 0
    v_mov_b32 v123, 0
    v_mov_b32 v124, 0
    v_mov_b32 v125, 0
    v_mov_b32 v126, 0
    v_mov_b32 v127, 0
    s_cmp_lg_u32 s29, 3
    s_cbranch_scc1 pok_mega_kernel_63
    s_add_u32 s38, s26, 296
    s_lshl_b32 s38, s38, 7
    v_and_b32 v24, 15, v1
    v_lshlrev_b32 v24, 2, v24
    v_add_u32 v24, s38, v24
    s_mov_b32 s38, 0
    buffer_load_dword v21, v24, s[92:95], 0 offen sc1
    s_sleep 3
    buffer_load_dword v22, v24, s[92:95], 0 offen sc1
    s_sleep 3
poll_mega_kernel_62:
    buffer_load_dword v23, v24, s[92:95], 0 offen sc1
    s_waitcnt vmcnt(2)
    v_cmp_gt_u32 vcc, 1, v21
    s_nop 4
    s_cbranch_vccz pok_mega_kernel_63
    s_sleep 2
    buffer_load_dword v21, v24, s[92:95], 0 offen sc1
    s_waitcnt vmcnt(2)
    v_cmp_gt_u32 vcc, 1, v22
    s_nop 4
    s_cbranch_vccz pok_mega_kernel_63
    s_sleep 2
    buffer_load_dword v22, v24, s[92:95], 0 offen sc1
    s_waitcnt vmcnt(2)
    v_cmp_gt_u32 vcc, 1, v23
    s_nop 4
    s_cbranch_vccz pok_mega_kernel_63
    s_sleep 2
    s_add_u32 s38, s38, 1
    s_cmp_gt_u32 s38, 4000
    s_cbranch_scc0 poll_mega_kernel_62
pok_mega_kernel_63:
    s_barrier
    buffer_load_dwordx4 v[128:131], v30, s[12:15], 0 offen offset:0 sc1
    buffer_load_dwordx4 v[132:135], v30, s[12:15], 0 offen offset:32 sc1
    buffer_load_dwordx4 v[136:139], v30, s[12:15], 0 offen offset:64 sc1
    buffer_load_dwordx4 v[140:143], v30, s[12:15], 0 offen offset:96 sc1
    buffer_load_dwordx4 v[144:147], v30, s[12:15], 0 offen offset:128 sc1
    buffer_load_dwordx4 v[148:151], v30, s[12:15], 0 offen offset:160 sc1
    buffer_load_dwordx4 v[152:155], v30, s[12:15], 0 offen offset:192 sc1
    buffer_load_dwordx4 v[156:159], v30, s[12:15], 0 offen offset:224 sc1
    buffer_load_dwordx4 v[160:163], v29, s[20:23], 0 offen offset:0 sc1
    buffer_load_dwordx4 v[164:167], v29, s[20:23], 0 offen offset:16 sc1
    buffer_load_dwordx4 v[168:171], v29, s[20:23], 0 offen offset:32 sc1
    buffer_load_dwordx4 v[172:175], v29, s[20:23], 0 offen offset:48 sc1
    buffer_load_dwordx4 v[176:179], v29, s[20:23], 0 offen offset:2048 sc1
    buffer_load_dwordx4 v[180:183], v29, s[20:23], 0 offen offset:2064 sc1
    buffer_load_dwordx4 v[184:187], v29, s[20:23], 0 offen offset:2080 sc1
    buffer_load_dwordx4 v[188:191], v29, s[20:23], 0 offen offset:2096 sc1
    s_barrier
    ds_read_b128 v[32:35], v10 offset:0
    ds_read_b128 v[36:39], v10 offset:4096
    ds_read_b64_tr_b16 v[40:41], v14 offset:0
    ds_read_b64_tr_b16 v[42:43], v14 offset:1024
    ds_read_b64_tr_b16 v[44:45], v15 offset:0
    ds_read_b64_tr_b16 v[46:47], v15 offset:1024
    s_waitcnt lgkmcnt(0)
    v_mfma_f32_32x32x16_bf16 v[64:79], v[40:43], v[32:35], v[64:79]
    ds_read_b128 v[48:51], v11 offset:0
    ds_read_b128 v[52:55], v11 offset:4096
    ds_read_b64_tr_b16 v[56:57], v14 offset:4096
    v_mfma_f32_32x32x16_bf16 v[80:95], v[40:43], v[36:39], v[80:95]
    ds_read_b64_tr_b16 v[58:59], v14 offset:5120
    ds_read_b64_tr_b16 v[60:61], v15 offset:4096
    ds_read_b64_tr_b16 v[62:63], v15 offset:5120
    v_mfma_f32_32x32x16_bf16 v[96:111], v[44:47], v[32:35], v[96:111]
    v_mfma_f32_32x32x16_bf16 v[112:127], v[44:47], v[36:39], v[112:127]
    s_waitcnt lgkmcnt(0)
    v_mfma_f32_32x32x16_bf16 v[64:79], v[56:59], v[48:51], v[64:79]
    ds_read_b128 v[32:35], v12 offset:0
    ds_read_b128 v[36:39], v12 offset:4096
    ds_read_b64_tr_b16 v[40:41], v14 offset:8192
    v_mfma_f32_32x32x16_bf16 v[80:95], v[56:59], v[52:55], v[80:95]
    ds_read_b64_tr_b16 v[42:43], v14 offset:9216
    ds_read_b64_tr_b16 v[44:45], v15 offset:8192
    ds_read_b64_tr_b16 v[46:47], v15 offset:9216
    v_mfma_f32_32x32x16_bf16 v[96:111], v[60:63], v[48:51], v[96:111]
    v_mfma_f32_32x32x16_bf16 v[112:127], v[60:63], v[52:55], v[112:127]
    s_waitcnt lgkmcnt(0)
    v_mfma_f32_32x32x16_bf16 v[64:79], v[40:43], v[32:35], v[64:79]
    ds_read_b128 v[48:51], v13 offset:0
    ds_read_b128 v[52:55], v13 offset:4096
    ds_read_b64_tr_b16 v[56:57], v14 offset:12288
    v_mfma_f32_32x32x16_bf16 v[80:95], v[40:43], v[36:39], v[80:95]
    ds_read_b64_tr_b16 v[58:59], v14 offset:13312
    ds_read_b64_tr_b16 v[60:61], v15 offset:12288
    ds_read_b64_tr_b16 v[62:63], v15 offset:13312
    v_mfma_f32_32x32x16_bf16 v[96:111], v[44:47], v[32:35], v[96:111]
    v_mfma_f32_32x32x16_bf16 v[112:127], v[44:47], v[36:39], v[112:127]
    s_waitcnt lgkmcnt(0)
    v_mfma_f32_32x32x16_bf16 v[64:79], v[56:59], v[48:51], v[64:79]
    s_barrier
    v_add_u32 v10, 0x4000, v10
    v_add_u32 v11, 0x4000, v11
    v_add_u32 v12, 0x4000, v12
    v_add_u32 v13, 0x4000, v13
    v_add_u32 v14, 0x6000, v14
    v_add_u32 v15, 0x6000, v15
    v_mfma_f32_32x32x16_bf16 v[80:95], v[56:59], v[52:55], v[80:95]
    ds_read_b128 v[32:35], v10 offset:0
    ds_read_b128 v[36:39], v10 offset:4096
    ds_read_b64_tr_b16 v[40:41], v14 offset:0
    ds_read_b64_tr_b16 v[42:43], v14 offset:1024
    ds_read_b64_tr_b16 v[44:45], v15 offset:0
    ds_read_b64_tr_b16 v[46:47], v15 offset:1024
    v_mfma_f32_32x32x16_bf16 v[96:111], v[60:63], v[48:51], v[96:111]
    v_mfma_f32_32x32x16_bf16 v[112:127], v[60:63], v[52:55], v[112:127]
    s_waitcnt lgkmcnt(0)
    v_mfma_f32_32x32x16_bf16 v[64:79], v[40:43], v[32:35], v[64:79]
    ds_read_b128 v[48:51], v11 offset:0
    ds_read_b128 v[52:55], v11 offset:4096
    ds_read_b64_tr_b16 v[56:57], v14 offset:4096
    v_mfma_f32_32x32x16_bf16 v[80:95], v[40:43], v[36:39], v[80:95]
    ds_read_b64_tr_b16 v[58:59], v14 offset:5120
    ds_read_b64_tr_b16 v[60:61], v15 offset:4096
    ds_read_b64_tr_b16 v[62:63], v15 offset:5120
    v_mfma_f32_32x32x16_bf16 v[96:111], v[44:47], v[32:35], v[96:111]
    v_mfma_f32_32x32x16_bf16 v[112:127], v[44:47], v[36:39], v[112:127]
    s_waitcnt lgkmcnt(0)
    v_mfma_f32_32x32x16_bf16 v[64:79], v[56:59], v[48:51], v[64:79]
    ds_read_b128 v[32:35], v12 offset:0
    ds_read_b128 v[36:39], v12 offset:4096
    ds_read_b64_tr_b16 v[40:41], v14 offset:8192
    v_mfma_f32_32x32x16_bf16 v[80:95], v[56:59], v[52:55], v[80:95]
    ds_read_b64_tr_b16 v[42:43], v14 offset:9216
    ds_read_b64_tr_b16 v[44:45], v15 offset:8192
    ds_read_b64_tr_b16 v[46:47], v15 offset:9216
    v_mfma_f32_32x32x16_bf16 v[96:111], v[60:63], v[48:51], v[96:111]
    v_mfma_f32_32x32x16_bf16 v[112:127], v[60:63], v[52:55], v[112:127]
    s_waitcnt lgkmcnt(0)
    v_mfma_f32_32x32x16_bf16 v[64:79], v[40:43], v[32:35], v[64:79]
    ds_read_b128 v[48:51], v13 offset:0
    ds_read_b128 v[52:55], v13 offset:4096
    ds_read_b64_tr_b16 v[56:57], v14 offset:12288
    v_mfma_f32_32x32x16_bf16 v[80:95], v[40:43], v[36:39], v[80:95]
    ds_read_b64_tr_b16 v[58:59], v14 offset:13312
    ds_read_b64_tr_b16 v[60:61], v15 offset:12288
    ds_read_b64_tr_b16 v[62:63], v15 offset:13312
    v_mfma_f32_32x32x16_bf16 v[96:111], v[44:47], v[32:35], v[96:111]
    v_mfma_f32_32x32x16_bf16 v[112:127], v[44:47], v[36:39], v[112:127]
    s_waitcnt lgkmcnt(0)
    v_mfma_f32_32x32x16_bf16 v[64:79], v[56:59], v[48:51], v[64:79]
    s_barrier
    v_add_u32 v10, 0xffff4000, v10
    v_add_u32 v11, 0xffff4000, v11
    v_add_u32 v12, 0xffff4000, v12
    v_add_u32 v13, 0xffff4000, v13
    v_add_u32 v14, 0xfffee000, v14
    v_add_u32 v15, 0xfffee000, v15
    v_mfma_f32_32x32x16_bf16 v[80:95], v[56:59], v[52:55], v[80:95]
    ds_read_b128 v[32:35], v10 offset:0
    ds_read_b128 v[36:39], v10 offset:4096
    ds_read_b64_tr_b16 v[40:41], v14 offset:0
    ds_read_b64_tr_b16 v[42:43], v14 offset:1024
    ds_read_b64_tr_b16 v[44:45], v15 offset:0
    ds_read_b64_tr_b16 v[46:47], v15 offset:1024
    v_mfma_f32_32x32x16_bf16 v[96:111], v[60:63], v[48:51], v[96:111]
    v_mfma_f32_32x32x16_bf16 v[112:127], v[60:63], v[52:55], v[112:127]
    s_waitcnt lgkmcnt(0)
    v_mfma_f32_32x32x16_bf16 v[64:79], v[40:43], v[32:35], v[64:79]
    ds_read_b128 v[48:51], v11 offset:0
    ds_read_b128 v[52:55], v11 offset:4096
    ds_read_b64_tr_b16 v[56:57], v14 offset:4096
    v_mfma_f32_32x32x16_bf16 v[80:95], v[40:43], v[36:39], v[80:95]
    ds_read_b64_tr_b16 v[58:59], v14 offset:5120
    ds_read_b64_tr_b16 v[60:61], v15 offset:4096
    ds_read_b64_tr_b16 v[62:63], v15 offset:5120
    v_mfma_f32_32x32x16_bf16 v[96:111], v[44:47], v[32:35], v[96:111]
    v_mfma_f32_32x32x16_bf16 v[112:127], v[44:47], v[36:39], v[112:127]
    s_waitcnt lgkmcnt(0)
    v_mfma_f32_32x32x16_bf16 v[64:79], v[56:59], v[48:51], v[64:79]
    ds_read_b128 v[32:35], v12 offset:0
    ds_read_b128 v[36:39], v12 offset:4096
    ds_read_b64_tr_b16 v[40:41], v14 offset:8192
    v_mfma_f32_32x32x16_bf16 v[80:95], v[56:59], v[52:55], v[80:95]
    ds_read_b64_tr_b16 v[42:43], v14 offset:9216
    ds_read_b64_tr_b16 v[44:45], v15 offset:8192
    ds_read_b64_tr_b16 v[46:47], v15 offset:9216
    v_mfma_f32_32x32x16_bf16 v[96:111], v[60:63], v[48:51], v[96:111]
    v_mfma_f32_32x32x16_bf16 v[112:127], v[60:63], v[52:55], v[112:127]
    s_waitcnt lgkmcnt(0)
    v_mfma_f32_32x32x16_bf16 v[64:79], v[40:43], v[32:35], v[64:79]
    ds_read_b128 v[48:51], v13 offset:0
    ds_read_b128 v[52:55], v13 offset:4096
    ds_read_b64_tr_b16 v[56:57], v14 offset:12288
    v_mfma_f32_32x32x16_bf16 v[80:95], v[40:43], v[36:39], v[80:95]
    ds_read_b64_tr_b16 v[58:59], v14 offset:13312
    ds_read_b64_tr_b16 v[60:61], v15 offset:12288
    ds_read_b64_tr_b16 v[62:63], v15 offset:13312
    v_mfma_f32_32x32x16_bf16 v[96:111], v[44:47], v[32:35], v[96:111]
    v_mfma_f32_32x32x16_bf16 v[112:127], v[44:47], v[36:39], v[112:127]
    s_waitcnt lgkmcnt(0)
    v_mfma_f32_32x32x16_bf16 v[64:79], v[56:59], v[48:51], v[64:79]
    s_barrier
    v_add_u32 v10, 0x4000, v10
    v_add_u32 v11, 0x4000, v11
    v_add_u32 v12, 0x4000, v12
    v_add_u32 v13, 0x4000, v13
    v_add_u32 v14, 0x6000, v14
    v_add_u32 v15, 0x6000, v15
    v_mfma_f32_32x32x16_bf16 v[80:95], v[56:59], v[52:55], v[80:95]
    ds_read_b128 v[32:35], v10 offset:0
    ds_read_b128 v[36:39], v10 offset:4096
    ds_read_b64_tr_b16 v[40:41], v14 offset:0
    ds_read_b64_tr_b16 v[42:43], v14 offset:1024
    ds_read_b64_tr_b16 v[44:45], v15 offset:0
    ds_read_b64_tr_b16 v[46:47], v15 offset:1024
    v_mfma_f32_32x32x16_bf16 v[96:111], v[60:63], v[48:51], v[96:111]
    v_mfma_f32_32x32x16_bf16 v[112:127], v[60:63], v[52:55], v[112:127]
    s_waitcnt lgkmcnt(0)
    v_mfma_f32_32x32x16_bf16 v[64:79], v[40:43], v[32:35], v[64:79]
    ds_read_b128 v[48:51], v11 offset:0
    ds_read_b128 v[52:55], v11 offset:4096
    ds_read_b64_tr_b16 v[56:57], v14 offset:4096
    v_mfma_f32_32x32x16_bf16 v[80:95], v[40:43], v[36:39], v[80:95]
    ds_read_b64_tr_b16 v[58:59], v14 offset:5120
    ds_read_b64_tr_b16 v[60:61], v15 offset:4096
    ds_read_b64_tr_b16 v[62:63], v15 offset:5120
    v_mfma_f32_32x32x16_bf16 v[96:111], v[44:47], v[32:35], v[96:111]
    v_mfma_f32_32x32x16_bf16 v[112:127], v[44:47], v[36:39], v[112:127]
    s_waitcnt lgkmcnt(0)
    v_mfma_f32_32x32x16_bf16 v[64:79], v[56:59], v[48:51], v[64:79]
    ds_read_b128 v[32:35], v12 offset:0
    ds_read_b128 v[36:39], v12 offset:4096
    ds_read_b64_tr_b16 v[40:41], v14 offset:8192
    v_mfma_f32_32x32x16_bf16 v[80:95], v[56:59], v[52:55], v[80:95]
    ds_read_b64_tr_b16 v[42:43], v14 offset:9216
    ds_read_b64_tr_b16 v[44:45], v15 offset:8192
    ds_read_b64_tr_b16 v[46:47], v15 offset:9216
    v_mfma_f32_32x32x16_bf16 v[96:111], v[60:63], v[48:51], v[96:111]
    v_mfma_f32_32x32x16_bf16 v[112:127], v[60:63], v[52:55], v[112:127]
    s_waitcnt lgkmcnt(0)
    v_mfma_f32_32x32x16_bf16 v[64:79], v[40:43], v[32:35], v[64:79]
    ds_read_b128 v[48:51], v13 offset:0
    ds_read_b128 v[52:55], v13 offset:4096
    ds_read_b64_tr_b16 v[56:57], v14 offset:12288
    v_mfma_f32_32x32x16_bf16 v[80:95], v[40:43], v[36:39], v[80:95]
    ds_read_b64_tr_b16 v[58:59], v14 offset:13312
    ds_read_b64_tr_b16 v[60:61], v15 offset:12288
    ds_read_b64_tr_b16 v[62:63], v15 offset:13312
    v_mfma_f32_32x32x16_bf16 v[96:111], v[44:47], v[32:35], v[96:111]
    v_mfma_f32_32x32x16_bf16 v[112:127], v[44:47], v[36:39], v[112:127]
    s_waitcnt lgkmcnt(0)
    v_mfma_f32_32x32x16_bf16 v[64:79], v[56:59], v[48:51], v[64:79]
    s_barrier
    v_add_u32 v10, 0x4000, v10
    v_add_u32 v11, 0x4000, v11
    v_add_u32 v12, 0x4000, v12
    v_add_u32 v13, 0x4000, v13
    v_add_u32 v14, 0x6000, v14
    v_add_u32 v15, 0x6000, v15
    v_mfma_f32_32x32x16_bf16 v[80:95], v[56:59], v[52:55], v[80:95]
    ds_read_b128 v[32:35], v10 offset:0
    ds_read_b128 v[36:39], v10 offset:4096
    ds_read_b64_tr_b16 v[40:41], v14 offset:0
    ds_read_b64_tr_b16 v[42:43], v14 offset:1024
    ds_read_b64_tr_b16 v[44:45], v15 offset:0
    ds_read_b64_tr_b16 v[46:47], v15 offset:1024
    v_mfma_f32_32x32x16_bf16 v[96:111], v[60:63], v[48:51], v[96:111]
    v_mfma_f32_32x32x16_bf16 v[112:127], v[60:63], v[52:55], v[112:127]
    s_waitcnt vmcnt(0)
    v_add_f32 v16, v160, v162
    v_add_f32 v16, v16, v164
    v_add_f32 v16, v16, v166
    v_add_f32 v16, v16, v168
    v_add_f32 v16, v16, v170
    v_add_f32 v16, v16, v172
    v_add_f32 v16, v16, v174
    v_mul_f32 v16, 0x3acccccd, v16
    v_add_f32 v17, v161, v163
    v_add_f32 v17, v17, v165
    v_add_f32 v17, v17, v167
    v_add_f32 v17, v17, v169
    v_add_f32 v17, v17, v171
    v_add_f32 v17, v17, v173
    v_add_f32 v17, v17, v175
    v_mov_b32 v18, 0
    v_mul_f32 v19, 0x3c4ccccd, v160
    v_sub_f32 v19, v19, v16
    v_fmac_f32 v18, v19, v19
    v_mul_f32 v19, 0x3c4ccccd, v162
    v_sub_f32 v19, v19, v16
    v_fmac_f32 v18, v19, v19
    v_mul_f32 v19, 0x3c4ccccd, v164
    v_sub_f32 v19, v19, v16
    v_fmac_f32 v18, v19, v19
    v_mul_f32 v19, 0x3c4ccccd, v166
    v_sub_f32 v19, v19, v16
    v_fmac_f32 v18, v19, v19
    v_mul_f32 v19, 0x3c4ccccd, v168
    v_sub_f32 v19, v19, v16
    v_fmac_f32 v18, v19, v19
    v_mul_f32 v19, 0x3c4ccccd, v170
    v_sub_f32 v19, v19, v16
    v_fmac_f32 v18, v19, v19
    v_mul_f32 v19, 0x3c4ccccd, v172
    v_sub_f32 v19, v19, v16
    v_fmac_f32 v18, v19, v19
    v_mul_f32 v19, 0x3c4ccccd, v174
    v_sub_f32 v19, v19, v16
    v_fmac_f32 v18, v19, v19
    v_mov_b32 v19, 0x42a00000
    v_fmac_f32 v17, v18, v19
    v_mul_f32 v17, 0x3acccccd, v17
    v_cvt_pk_bf16_f32 v192, v16, v16
    v_lshlrev_b32 v192, 16, v192
    v_cvt_pk_bf16_f32 v194, v17, v17
    v_lshlrev_b32 v194, 16, v194
    v_add_f32 v194, 0x3727c5ac, v194
    v_cvt_pk_bf16_f32 v194, v194, v194
    v_lshlrev_b32 v194, 16, v194
    v_sqrt_f32 v194, v194
    s_nop 0
    v_cvt_pk_bf16_f32 v194, v194, v194
    v_lshlrev_b32 v194, 16, v194
    v_rcp_f32 v194, v194
    s_nop 0
    v_mov_b32 v193, v192
    v_mov_b32 v195, v194
    v_add_f32 v16, v176, v178
    v_add_f32 v16, v16, v180
    v_add_f32 v16, v16, v182
    v_add_f32 v16, v16, v184
    v_add_f32 v16, v16, v186
    v_add_f32 v16, v16, v188
    v_add_f32 v16, v16, v190
    v_mul_f32 v16, 0x3acccccd, v16
    v_add_f32 v17, v177, v179
    v_add_f32 v17, v17, v181
    v_add_f32 v17, v17, v183
    v_add_f32 v17, v17, v185
    v_add_f32 v17, v17, v187
    v_add_f32 v17, v17, v189
    v_add_f32 v17, v17, v191
    v_mov_b32 v18, 0
    v_mul_f32 v19, 0x3c4ccccd, v176
    v_sub_f32 v19, v19, v16
    v_fmac_f32 v18, v19, v19
    v_mul_f32 v19, 0x3c4ccccd, v178
    v_sub_f32 v19, v19, v16
    v_fmac_f32 v18, v19, v19
    v_mul_f32 v19, 0x3c4ccccd, v180
    v_sub_f32 v19, v19, v16
    v_fmac_f32 v18, v19, v19
    v_mul_f32 v19, 0x3c4ccccd, v182
    v_sub_f32 v19, v19, v16
    v_fmac_f32 v18, v19, v19
    v_mul_f32 v19, 0x3c4ccccd, v184
    v_sub_f32 v19, v19, v16
    v_fmac_f32 v18, v19, v19
    v_mul_f32 v19, 0x3c4ccccd, v186
    v_sub_f32 v19, v19, v16
    v_fmac_f32 v18, v19, v19
    v_mul_f32 v19, 0x3c4ccccd, v188
    v_sub_f32 v19, v19, v16
    v_fmac_f32 v18, v19, v19
    v_mul_f32 v19, 0x3c4ccccd, v190
    v_sub_f32 v19, v19, v16
    v_fmac_f32 v18, v19, v19
    v_mov_b32 v19, 0x42a00000
    v_fmac_f32 v17, v18, v19
    v_mul_f32 v17, 0x3acccccd, v17
    v_cvt_pk_bf16_f32 v196, v16, v16
    v_lshlrev_b32 v196, 16, v196
    v_cvt_pk_bf16_f32 v198, v17, v17
    v_lshlrev_b32 v198, 16, v198
    v_add_f32 v198, 0x3727c5ac, v198
    v_cvt_pk_bf16_f32 v198, v198, v198
    v_lshlrev_b32 v198, 16, v198
    v_sqrt_f32 v198, v198
    s_nop 0
    v_cvt_pk_bf16_f32 v198, v198, v198
    v_lshlrev_b32 v198, 16, v198
    v_rcp_f32 v198, v198
    s_nop 0
    v_mov_b32 v197, v196
    v_mov_b32 v199, v198
    s_waitcnt lgkmcnt(0)
    v_mfma_f32_32x32x16_bf16 v[64:79], v[40:43], v[32:35], v[64:79]
    ds_read_b128 v[48:51], v11 offset:0
    ds_read_b128 v[52:55], v11 offset:4096
    ds_read_b64_tr_b16 v[56:57], v14 offset:4096
    v_mfma_f32_32x32x16_bf16 v[80:95], v[40:43], v[36:39], v[80:95]
    ds_read_b64_tr_b16 v[58:59], v14 offset:5120
    ds_read_b64_tr_b16 v[60:61], v15 offset:4096
    ds_read_b64_tr_b16 v[62:63], v15 offset:5120
    v_mfma_f32_32x32x16_bf16 v[96:111], v[44:47], v[32:35], v[96:111]
    v_mfma_f32_32x32x16_bf16 v[112:127], v[44:47], v[36:39], v[112:127]
    s_waitcnt lgkmcnt(0)
    v_mfma_f32_32x32x16_bf16 v[64:79], v[56:59], v[48:51], v[64:79]
    ds_read_b128 v[32:35], v12 offset:0
    ds_read_b128 v[36:39], v12 offset:4096
    ds_read_b64_tr_b16 v[40:41], v14 offset:8192
    v_mfma_f32_32x32x16_bf16 v[80:95], v[56:59], v[52:55], v[80:95]
    ds_read_b64_tr_b16 v[42:43], v14 offset:9216
    ds_read_b64_tr_b16 v[44:45], v15 offset:8192
    ds_read_b64_tr_b16 v[46:47], v15 offset:9216
    v_mfma_f32_32x32x16_bf16 v[96:111], v[60:63], v[48:51], v[96:111]
    v_mfma_f32_32x32x16_bf16 v[112:127], v[60:63], v[52:55], v[112:127]
    s_waitcnt lgkmcnt(0)
    v_mfma_f32_32x32x16_bf16 v[64:79], v[40:43], v[32:35], v[64:79]
    ds_read_b128 v[48:51], v13 offset:0
    ds_read_b128 v[52:55], v13 offset:4096
    ds_read_b64_tr_b16 v[56:57], v14 offset:12288
    v_mfma_f32_32x32x16_bf16 v[80:95], v[40:43], v[36:39], v[80:95]
    ds_read_b64_tr_b16 v[58:59], v14 offset:13312
    ds_read_b64_tr_b16 v[60:61], v15 offset:12288
    ds_read_b64_tr_b16 v[62:63], v15 offset:13312
    v_mfma_f32_32x32x16_bf16 v[96:111], v[44:47], v[32:35], v[96:111]
    v_mfma_f32_32x32x16_bf16 v[112:127], v[44:47], v[36:39], v[112:127]
    s_waitcnt lgkmcnt(0)
    v_mfma_f32_32x32x16_bf16 v[64:79], v[56:59], v[48:51], v[64:79]
    s_barrier
    v_add_u32 v10, 0x4000, v10
    v_add_u32 v11, 0x4000, v11
    v_add_u32 v12, 0x4000, v12
    v_add_u32 v13, 0x4000, v13
    v_add_u32 v14, 0x6000, v14
    v_add_u32 v15, 0x6000, v15
    v_mfma_f32_32x32x16_bf16 v[80:95], v[56:59], v[52:55], v[80:95]
    ds_read_b128 v[32:35], v10 offset:0
    ds_read_b128 v[36:39], v10 offset:4096
    ds_read_b64_tr_b16 v[40:41], v14 offset:0
    ds_read_b64_tr_b16 v[42:43], v14 offset:1024
    ds_read_b64_tr_b16 v[44:45], v15 offset:0
    ds_read_b64_tr_b16 v[46:47], v15 offset:1024
    v_mfma_f32_32x32x16_bf16 v[96:111], v[60:63], v[48:51], v[96:111]
    v_mfma_f32_32x32x16_bf16 v[112:127], v[60:63], v[52:55], v[112:127]
    s_waitcnt lgkmcnt(0)
    v_mfma_f32_32x32x16_bf16 v[64:79], v[40:43], v[32:35], v[64:79]
    ds_read_b128 v[48:51], v11 offset:0
    ds_read_b128 v[52:55], v11 offset:4096
    ds_read_b64_tr_b16 v[56:57], v14 offset:4096
    v_mfma_f32_32x32x16_bf16 v[80:95], v[40:43], v[36:39], v[80:95]
    ds_read_b64_tr_b16 v[58:59], v14 offset:5120
    ds_read_b64_tr_b16 v[60:61], v15 offset:4096
    ds_read_b64_tr_b16 v[62:63], v15 offset:5120
    v_mfma_f32_32x32x16_bf16 v[96:111], v[44:47], v[32:35], v[96:111]
    v_mfma_f32_32x32x16_bf16 v[112:127], v[44:47], v[36:39], v[112:127]
    s_waitcnt lgkmcnt(0)
    v_mfma_f32_32x32x16_bf16 v[64:79], v[56:59], v[48:51], v[64:79]
    ds_read_b128 v[32:35], v12 offset:0
    ds_read_b128 v[36:39], v12 offset:4096
    ds_read_b64_tr_b16 v[40:41], v14 offset:8192
    v_mfma_f32_32x32x16_bf16 v[80:95], v[56:59], v[52:55], v[80:95]
    ds_read_b64_tr_b16 v[42:43], v14 offset:9216
    ds_read_b64_tr_b16 v[44:45], v15 offset:8192
    ds_read_b64_tr_b16 v[46:47], v15 offset:9216
    v_mfma_f32_32x32x16_bf16 v[96:111], v[60:63], v[48:51], v[96:111]
    v_mfma_f32_32x32x16_bf16 v[112:127], v[60:63], v[52:55], v[112:127]
    s_waitcnt lgkmcnt(0)
    v_mfma_f32_32x32x16_bf16 v[64:79], v[40:43], v[32:35], v[64:79]
    ds_read_b128 v[48:51], v13 offset:0
    ds_read_b128 v[52:55], v13 offset:4096
    ds_read_b64_tr_b16 v[56:57], v14 offset:12288
    v_mfma_f32_32x32x16_bf16 v[80:95], v[40:43], v[36:39], v[80:95]
    ds_read_b64_tr_b16 v[58:59], v14 offset:13312
    ds_read_b64_tr_b16 v[60:61], v15 offset:12288
    ds_read_b64_tr_b16 v[62:63], v15 offset:13312
    v_mfma_f32_32x32x16_bf16 v[96:111], v[44:47], v[32:35], v[96:111]
    v_mfma_f32_32x32x16_bf16 v[112:127], v[44:47], v[36:39], v[112:127]
    s_waitcnt lgkmcnt(0)
    v_mfma_f32_32x32x16_bf16 v[64:79], v[56:59], v[48:51], v[64:79]
    s_barrier
    v_add_u32 v10, 0xffff4000, v10
    v_add_u32 v11, 0xffff4000, v11
    v_add_u32 v12, 0xffff4000, v12
    v_add_u32 v13, 0xffff4000, v13
    v_add_u32 v14, 0xfffee000, v14
    v_add_u32 v15, 0xfffee000, v15
    v_mfma_f32_32x32x16_bf16 v[80:95], v[56:59], v[52:55], v[80:95]
    ds_read_b128 v[32:35], v10 offset:0
    ds_read_b128 v[36:39], v10 offset:4096
    ds_read_b64_tr_b16 v[40:41], v14 offset:0
    ds_read_b64_tr_b16 v[42:43], v14 offset:1024
    ds_read_b64_tr_b16 v[44:45], v15 offset:0
    ds_read_b64_tr_b16 v[46:47], v15 offset:1024
    v_mfma_f32_32x32x16_bf16 v[96:111], v[60:63], v[48:51], v[96:111]
    v_mfma_f32_32x32x16_bf16 v[112:127], v[60:63], v[52:55], v[112:127]
    s_mul_i32 s32, s29, 12288
    v_and_b32 v25, 31, v1
    v_mul_u32_u24 v25, 40, v25
    v_add_u32 v25, s32, v25
    v_cmp_gt_u32 vcc, 32, v1
    v_mov_b32 v26, 8
    v_mov_b32 v27, 0
    s_nop 0
    v_cndmask_b32 v26, v26, v27, vcc
    v_add_u32 v200, v25, v26
    v_mov_b32 v26, 24
    v_mov_b32 v27, 16
    s_nop 0
    v_cndmask_b32 v26, v26, v27, vcc
    v_add_u32 v201, v25, v26
    v_mov_b32 v26, 2560
    v_mov_b32 v27, 32
    s_nop 0
    v_cndmask_b32 v26, v26, v27, vcc
    v_add_u32 v202, v25, v26
    v_mov_b32 v26, 2576
    v_mov_b32 v27, 2568
    s_nop 0
    v_cndmask_b32 v26, v26, v27, vcc
    v_add_u32 v203, v25, v26
    v_mov_b32 v26, 2592
    v_mov_b32 v27, 2584
    s_nop 0
    v_cndmask_b32 v26, v26, v27, vcc
    v_add_u32 v204, v25, v26
    v_mov_b32 v26, 5128
    v_mov_b32 v27, 5120
    s_nop 0
    v_cndmask_b32 v26, v26, v27, vcc
    v_add_u32 v205, v25, v26
    v_mov_b32 v26, 5144
    v_mov_b32 v27, 5136
    s_nop 0
    v_cndmask_b32 v26, v26, v27, vcc
    v_add_u32 v206, v25, v26
    v_mov_b32 v26, 7680
    v_mov_b32 v27, 5152
    s_nop 0
    v_cndmask_b32 v26, v26, v27, vcc
    v_add_u32 v207, v25, v26
    v_lshlrev_b32 v28, 4, v1
    v_add_u32 v208, s32, v28
    s_lshl_b32 s32, s27, 1
    s_add_u32 s32, s32, s30
    s_mul_i32 s32, s32, 81920
    s_lshl_b32 s33, s26, 1
    s_add_u32 s33, s33, s31
    s_mul_i32 s33, s33, 2560
    s_add_u32 s39, s32, s33
    s_waitcnt lgkmcnt(0)
    v_mfma_f32_32x32x16_bf16 v[64:79], v[40:43], v[32:35], v[64:79]
    ds_read_b128 v[48:51], v11 offset:0
    ds_read_b128 v[52:55], v11 offset:4096
    ds_read_b64_tr_b16 v[56:57], v14 offset:4096
    v_mfma_f32_32x32x16_bf16 v[80:95], v[40:43], v[36:39], v[80:95]
    ds_read_b64_tr_b16 v[58:59], v14 offset:5120
    ds_read_b64_tr_b16 v[60:61], v15 offset:4096
    ds_read_b64_tr_b16 v[62:63], v15 offset:5120
    v_mfma_f32_32x32x16_bf16 v[96:111], v[44:47], v[32:35], v[96:111]
    v_mfma_f32_32x32x16_bf16 v[112:127], v[44:47], v[36:39], v[112:127]
    s_waitcnt lgkmcnt(0)
    v_mfma_f32_32x32x16_bf16 v[64:79], v[56:59], v[48:51], v[64:79]
    ds_read_b128 v[32:35], v12 offset:0
    ds_read_b128 v[36:39], v12 offset:4096
    ds_read_b64_tr_b16 v[40:41], v14 offset:8192
    v_mfma_f32_32x32x16_bf16 v[80:95], v[56:59], v[52:55], v[80:95]
    ds_read_b64_tr_b16 v[42:43], v14 offset:9216
    ds_read_b64_tr_b16 v[44:45], v15 offset:8192
    ds_read_b64_tr_b16 v[46:47], v15 offset:9216
    v_mfma_f32_32x32x16_bf16 v[96:111], v[60:63], v[48:51], v[96:111]
    v_mfma_f32_32x32x16_bf16 v[112:127], v[60:63], v[52:55], v[112:127]
    s_waitcnt lgkmcnt(0)
    v_mfma_f32_32x32x16_bf16 v[64:79], v[40:43], v[32:35], v[64:79]
    ds_read_b128 v[48:51], v13 offset:0
    ds_read_b128 v[52:55], v13 offset:4096
    ds_read_b64_tr_b16 v[56:57], v14 offset:12288
    v_mfma_f32_32x32x16_bf16 v[80:95], v[40:43], v[36:39], v[80:95]
    ds_read_b64_tr_b16 v[58:59], v14 offset:13312
    ds_read_b64_tr_b16 v[60:61], v15 offset:12288
    ds_read_b64_tr_b16 v[62:63], v15 offset:13312
    v_mfma_f32_32x32x16_bf16 v[96:111], v[44:47], v[32:35], v[96:111]
    v_mfma_f32_32x32x16_bf16 v[112:127], v[44:47], v[36:39], v[112:127]
    s_waitcnt lgkmcnt(0)
    v_mfma_f32_32x32x16_bf16 v[64:79], v[56:59], v[48:51], v[64:79]
    s_barrier
    v_add_u32 v10, 0x4000, v10
    v_add_u32 v11, 0x4000, v11
    v_add_u32 v12, 0x4000, v12
    v_add_u32 v13, 0x4000, v13
    v_add_u32 v14, 0x6000, v14
    v_add_u32 v15, 0x6000, v15
    v_mfma_f32_32x32x16_bf16 v[80:95], v[56:59], v[52:55], v[80:95]
    ds_read_b128 v[32:35], v10 offset:0
    ds_read_b128 v[36:39], v10 offset:4096
    ds_read_b64_tr_b16 v[40:41], v14 offset:0
    ds_read_b64_tr_b16 v[42:43], v14 offset:1024
    ds_read_b64_tr_b16 v[44:45], v15 offset:0
    ds_read_b64_tr_b16 v[46:47], v15 offset:1024
    v_mfma_f32_32x32x16_bf16 v[96:111], v[60:63], v[48:51], v[96:111]
    v_mfma_f32_32x32x16_bf16 v[112:127], v[60:63], v[52:55], v[112:127]
    s_waitcnt lgkmcnt(0)
    v_mfma_f32_32x32x16_bf16 v[64:79], v[40:43], v[32:35], v[64:79]
    ds_read_b128 v[48:51], v11 offset:0
    ds_read_b128 v[52:55], v11 offset:4096
    ds_read_b64_tr_b16 v[56:57], v14 offset:4096
    v_mfma_f32_32x32x16_bf16 v[80:95], v[40:43], v[36:39], v[80:95]
    ds_read_b64_tr_b16 v[58:59], v14 offset:5120
    ds_read_b64_tr_b16 v[60:61], v15 offset:4096
    ds_read_b64_tr_b16 v[62:63], v15 offset:5120
    v_mfma_f32_32x32x16_bf16 v[96:111], v[44:47], v[32:35], v[96:111]
    v_mfma_f32_32x32x16_bf16 v[112:127], v[44:47], v[36:39], v[112:127]
    s_waitcnt lgkmcnt(0)
    v_mfma_f32_32x32x16_bf16 v[64:79], v[56:59], v[48:51], v[64:79]
    ds_read_b128 v[32:35], v12 offset:0
    ds_read_b128 v[36:39], v12 offset:4096
    ds_read_b64_tr_b16 v[40:41], v14 offset:8192
    v_mfma_f32_32x32x16_bf16 v[80:95], v[56:59], v[52:55], v[80:95]
    ds_read_b64_tr_b16 v[42:43], v14 offset:9216
    ds_read_b64_tr_b16 v[44:45], v15 offset:8192
    ds_read_b64_tr_b16 v[46:47], v15 offset:9216
    v_mfma_f32_32x32x16_bf16 v[96:111], v[60:63], v[48:51], v[96:111]
    v_mfma_f32_32x32x16_bf16 v[112:127], v[60:63], v[52:55], v[112:127]
    s_waitcnt lgkmcnt(0)
    v_mfma_f32_32x32x16_bf16 v[64:79], v[40:43], v[32:35], v[64:79]
    ds_read_b128 v[48:51], v13 offset:0
    ds_read_b128 v[52:55], v13 offset:4096
    ds_read_b64_tr_b16 v[56:57], v14 offset:12288
    v_mfma_f32_32x32x16_bf16 v[80:95], v[40:43], v[36:39], v[80:95]
    ds_read_b64_tr_b16 v[58:59], v14 offset:13312
    ds_read_b64_tr_b16 v[60:61], v15 offset:12288
    ds_read_b64_tr_b16 v[62:63], v15 offset:13312
    v_mfma_f32_32x32x16_bf16 v[96:111], v[44:47], v[32:35], v[96:111]
    v_mfma_f32_32x32x16_bf16 v[112:127], v[44:47], v[36:39], v[112:127]
    s_waitcnt lgkmcnt(0)
    v_mfma_f32_32x32x16_bf16 v[64:79], v[56:59], v[48:51], v[64:79]
    s_barrier
    v_add_u32 v10, 0x4000, v10
    v_add_u32 v11, 0x4000, v11
    v_add_u32 v12, 0x4000, v12
    v_add_u32 v13, 0x4000, v13
    v_add_u32 v14, 0x6000, v14
    v_add_u32 v15, 0x6000, v15
    v_mfma_f32_32x32x16_bf16 v[80:95], v[56:59], v[52:55], v[80:95]
    ds_read_b128 v[32:35], v10 offset:0
    ds_read_b128 v[36:39], v10 offset:4096
    ds_read_b64_tr_b16 v[40:41], v14 offset:0
    ds_read_b64_tr_b16 v[42:43], v14 offset:1024
    ds_read_b64_tr_b16 v[44:45], v15 offset:0
    ds_read_b64_tr_b16 v[46:47], v15 offset:1024
    v_mfma_f32_32x32x16_bf16 v[96:111], v[60:63], v[48:51], v[96:111]
    v_mfma_f32_32x32x16_bf16 v[112:127], v[60:63], v[52:55], v[112:127]
    s_waitcnt lgkmcnt(0)
    v_mfma_f32_32x32x16_bf16 v[64:79], v[40:43], v[32:35], v[64:79]
    ds_read_b128 v[48:51], v11 offset:0
    ds_read_b128 v[52:55], v11 offset:4096
    ds_read_b64_tr_b16 v[56:57], v14 offset:4096
    v_mfma_f32_32x32x16_bf16 v[80:95], v[40:43], v[36:39], v[80:95]
    ds_read_b64_tr_b16 v[58:59], v14 offset:5120
    ds_read_b64_tr_b16 v[60:61], v15 offset:4096
    ds_read_b64_tr_b16 v[62:63], v15 offset:5120
    v_mfma_f32_32x32x16_bf16 v[96:111], v[44:47], v[32:35], v[96:111]
    v_mfma_f32_32x32x16_bf16 v[112:127], v[44:47], v[36:39], v[112:127]
    s_waitcnt lgkmcnt(0)
    v_mfma_f32_32x32x16_bf16 v[64:79], v[56:59], v[48:51], v[64:79]
    ds_read_b128 v[32:35], v12 offset:0
    ds_read_b128 v[36:39], v12 offset:4096
    ds_read_b64_tr_b16 v[40:41], v14 offset:8192
    v_mfma_f32_32x32x16_bf16 v[80:95], v[56:59], v[52:55], v[80:95]
    ds_read_b64_tr_b16 v[42:43], v14 offset:9216
    ds_read_b64_tr_b16 v[44:45], v15 offset:8192
    ds_read_b64_tr_b16 v[46:47], v15 offset:9216
    v_mfma_f32_32x32x16_bf16 v[96:111], v[60:63], v[48:51], v[96:111]
    v_mfma_f32_32x32x16_bf16 v[112:127], v[60:63], v[52:55], v[112:127]
    s_waitcnt lgkmcnt(0)
    v_mfma_f32_32x32x16_bf16 v[64:79], v[40:43], v[32:35], v[64:79]
    ds_read_b128 v[48:51], v13 offset:0
    ds_read_b128 v[52:55], v13 offset:4096
    ds_read_b64_tr_b16 v[56:57], v14 offset:12288
    v_mfma_f32_32x32x16_bf16 v[80:95], v[40:43], v[36:39], v[80:95]
    ds_read_b64_tr_b16 v[58:59], v14 offset:13312
    ds_read_b64_tr_b16 v[60:61], v15 offset:12288
    ds_read_b64_tr_b16 v[62:63], v15 offset:13312
    v_mfma_f32_32x32x16_bf16 v[96:111], v[44:47], v[32:35], v[96:111]
    v_mfma_f32_32x32x16_bf16 v[112:127], v[44:47], v[36:39], v[112:127]
    s_waitcnt lgkmcnt(0)
    v_mfma_f32_32x32x16_bf16 v[64:79], v[56:59], v[48:51], v[64:79]
    s_barrier
    v_add_u32 v10, 0x4000, v10
    v_add_u32 v11, 0x4000, v11
    v_add_u32 v12, 0x4000, v12
    v_add_u32 v13, 0x4000, v13
    v_add_u32 v14, 0x6000, v14
    v_add_u32 v15, 0x6000, v15
    v_mfma_f32_32x32x16_bf16 v[80:95], v[56:59], v[52:55], v[80:95]
    ds_read_b128 v[32:35], v10 offset:0
    ds_read_b128 v[36:39], v10 offset:4096
    ds_read_b64_tr_b16 v[40:41], v14 offset:0
    ds_read_b64_tr_b16 v[42:43], v14 offset:1024
    ds_read_b64_tr_b16 v[44:45], v15 offset:0
    ds_read_b64_tr_b16 v[46:47], v15 offset:1024
    v_mfma_f32_32x32x16_bf16 v[96:111], v[60:63], v[48:51], v[96:111]
    v_mfma_f32_32x32x16_bf16 v[112:127], v[60:63], v[52:55], v[112:127]
    s_waitcnt lgkmcnt(0)
    v_mfma_f32_32x32x16_bf16 v[64:79], v[40:43], v[32:35], v[64:79]
    ds_read_b128 v[48:51], v11 offset:0
    ds_read_b128 v[52:55], v11 offset:4096
    ds_read_b64_tr_b16 v[56:57], v14 offset:4096
    v_mfma_f32_32x32x16_bf16 v[80:95], v[40:43], v[36:39], v[80:95]
    ds_read_b64_tr_b16 v[58:59], v14 offset:5120
    ds_read_b64_tr_b16 v[60:61], v15 offset:4096
    ds_read_b64_tr_b16 v[62:63], v15 offset:5120
    v_mfma_f32_32x32x16_bf16 v[96:111], v[44:47], v[32:35], v[96:111]
    v_mfma_f32_32x32x16_bf16 v[112:127], v[44:47], v[36:39], v[112:127]
    s_waitcnt lgkmcnt(0)
    v_mfma_f32_32x32x16_bf16 v[64:79], v[56:59], v[48:51], v[64:79]
    ds_read_b128 v[32:35], v12 offset:0
    ds_read_b128 v[36:39], v12 offset:4096
    ds_read_b64_tr_b16 v[40:41], v14 offset:8192
    v_mfma_f32_32x32x16_bf16 v[80:95], v[56:59], v[52:55], v[80:95]
    ds_read_b64_tr_b16 v[42:43], v14 offset:9216
    ds_read_b64_tr_b16 v[44:45], v15 offset:8192
    ds_read_b64_tr_b16 v[46:47], v15 offset:9216
    v_mfma_f32_32x32x16_bf16 v[96:111], v[60:63], v[48:51], v[96:111]
    v_mfma_f32_32x32x16_bf16 v[112:127], v[60:63], v[52:55], v[112:127]
    s_waitcnt lgkmcnt(0)
    v_mfma_f32_32x32x16_bf16 v[64:79], v[40:43], v[32:35], v[64:79]
    ds_read_b128 v[48:51], v13 offset:0
    ds_read_b128 v[52:55], v13 offset:4096
    ds_read_b64_tr_b16 v[56:57], v14 offset:12288
    v_mfma_f32_32x32x16_bf16 v[80:95], v[40:43], v[36:39], v[80:95]
    ds_read_b64_tr_b16 v[58:59], v14 offset:13312
    ds_read_b64_tr_b16 v[60:61], v15 offset:12288
    ds_read_b64_tr_b16 v[62:63], v15 offset:13312
    v_mfma_f32_32x32x16_bf16 v[96:111], v[44:47], v[32:35], v[96:111]
    v_mfma_f32_32x32x16_bf16 v[112:127], v[44:47], v[36:39], v[112:127]
    s_waitcnt lgkmcnt(0)
    v_mfma_f32_32x32x16_bf16 v[64:79], v[56:59], v[48:51], v[64:79]
    v_mfma_f32_32x32x16_bf16 v[80:95], v[56:59], v[52:55], v[80:95]
    v_mfma_f32_32x32x16_bf16 v[96:111], v[60:63], v[48:51], v[96:111]
    v_mfma_f32_32x32x16_bf16 v[112:127], v[60:63], v[52:55], v[112:127]
    s_barrier
    s_nop 4
    v_pk_fma_f32 v[64:65], v[192:193], v[128:129], v[64:65] neg_lo:[1,0,0] neg_hi:[1,0,0]
    v_pk_mul_f32 v[64:65], v[64:65], v[194:195]
    v_pk_fma_f32 v[66:67], v[192:193], v[130:131], v[66:67] neg_lo:[1,0,0] neg_hi:[1,0,0]
    v_pk_mul_f32 v[66:67], v[66:67], v[194:195]
    v_pk_fma_f32 v[68:69], v[192:193], v[132:133], v[68:69] neg_lo:[1,0,0] neg_hi:[1,0,0]
    v_pk_mul_f32 v[68:69], v[68:69], v[194:195]
    v_pk_fma_f32 v[70:71], v[192:193], v[134:135], v[70:71] neg_lo:[1,0,0] neg_hi:[1,0,0]
    v_pk_mul_f32 v[70:71], v[70:71], v[194:195]
    v_pk_fma_f32 v[72:73], v[192:193], v[136:137], v[72:73] neg_lo:[1,0,0] neg_hi:[1,0,0]
    v_pk_mul_f32 v[72:73], v[72:73], v[194:195]
    v_pk_fma_f32 v[74:75], v[192:193], v[138:139], v[74:75] neg_lo:[1,0,0] neg_hi:[1,0,0]
    v_pk_mul_f32 v[74:75], v[74:75], v[194:195]
    v_pk_fma_f32 v[76:77], v[192:193], v[140:141], v[76:77] neg_lo:[1,0,0] neg_hi:[1,0,0]
    v_pk_mul_f32 v[76:77], v[76:77], v[194:195]
    v_pk_fma_f32 v[78:79], v[192:193], v[142:143], v[78:79] neg_lo:[1,0,0] neg_hi:[1,0,0]
    v_pk_mul_f32 v[78:79], v[78:79], v[194:195]
    v_cvt_pk_bf16_f32 v32, v64, v65
    v_cvt_pk_bf16_f32 v33, v66, v67
    ds_write_b64 v200, v[32:33] offset:0
    v_cvt_pk_bf16_f32 v34, v68, v69
    v_cvt_pk_bf16_f32 v35, v70, v71
    ds_write_b64 v201, v[34:35] offset:0
    v_cvt_pk_bf16_f32 v36, v72, v73
    v_cvt_pk_bf16_f32 v37, v74, v75
    ds_write_b64 v202, v[36:37] offset:0
    v_cvt_pk_bf16_f32 v38, v76, v77
    v_cvt_pk_bf16_f32 v39, v78, v79
    ds_write_b64 v203, v[38:39] offset:0
    v_pk_fma_f32 v[96:97], v[192:193], v[144:145], v[96:97] neg_lo:[1,0,0] neg_hi:[1,0,0]
    v_pk_mul_f32 v[96:97], v[96:97], v[194:195]
    v_pk_fma_f32 v[98:99], v[192:193], v[146:147], v[98:99] neg_lo:[1,0,0] neg_hi:[1,0,0]
    v_pk_mul_f32 v[98:99], v[98:99], v[194:195]
    v_pk_fma_f32 v[100:101], v[192:193], v[148:149], v[100:101] neg_lo:[1,0,0] neg_hi:[1,0,0]
    v_pk_mul_f32 v[100:101], v[100:101], v[194:195]
    v_pk_fma_f32 v[102:103], v[192:193], v[150:151], v[102:103] neg_lo:[1,0,0] neg_hi:[1,0,0]
    v_pk_mul_f32 v[102:103], v[102:103], v[194:195]
    v_pk_fma_f32 v[104:105], v[192:193], v[152:153], v[104:105] neg_lo:[1,0,0] neg_hi:[1,0,0]
    v_pk_mul_f32 v[104:105], v[104:105], v[194:195]
    v_pk_fma_f32 v[106:107], v[192:193], v[154:155], v[106:107] neg_lo:[1,0,0] neg_hi:[1,0,0]
    v_pk_mul_f32 v[106:107], v[106:107], v[194:195]
    v_pk_fma_f32 v[108:109], v[192:193], v[156:157], v[108:109] neg_lo:[1,0,0] neg_hi:[1,0,0]
    v_pk_mul_f32 v[108:109], v[108:109], v[194:195]
    v_pk_fma_f32 v[110:111], v[192:193], v[158:159], v[110:111] neg_lo:[1,0,0] neg_hi:[1,0,0]
    v_pk_mul_f32 v[110:111], v[110:111], v[194:195]
    v_cvt_pk_bf16_f32 v40, v96, v97
    v_cvt_pk_bf16_f32 v41, v98, v99
    ds_write_b64 v204, v[40:41] offset:0
    v_cvt_pk_bf16_f32 v42, v100, v101
    v_cvt_pk_bf16_f32 v43, v102, v103
    ds_write_b64 v205, v[42:43] offset:0
    v_cvt_pk_bf16_f32 v44, v104, v105
    v_cvt_pk_bf16_f32 v45, v106, v107
    ds_write_b64 v206, v[44:45] offset:0
    v_cvt_pk_bf16_f32 v46, v108, v109
    v_cvt_pk_bf16_f32 v47, v110, v111
    ds_write_b64 v207, v[46:47] offset:0
    v_pk_fma_f32 v[80:81], v[196:197], v[128:129], v[80:81] neg_lo:[1,0,0] neg_hi:[1,0,0]
    v_pk_mul_f32 v[80:81], v[80:81], v[198:199]
    v_pk_fma_f32 v[82:83], v[196:197], v[130:131], v[82:83] neg_lo:[1,0,0] neg_hi:[1,0,0]
    v_pk_mul_f32 v[82:83], v[82:83], v[198:199]
    v_pk_fma_f32 v[84:85], v[196:197], v[132:133], v[84:85] neg_lo:[1,0,0] neg_hi:[1,0,0]
    v_pk_mul_f32 v[84:85], v[84:85], v[198:199]
    v_pk_fma_f32 v[86:87], v[196:197], v[134:135], v[86:87] neg_lo:[1,0,0] neg_hi:[1,0,0]
    v_pk_mul_f32 v[86:87], v[86:87], v[198:199]
    v_pk_fma_f32 v[88:89], v[196:197], v[136:137], v[88:89] neg_lo:[1,0,0] neg_hi:[1,0,0]
    v_pk_mul_f32 v[88:89], v[88:89], v[198:199]
    v_pk_fma_f32 v[90:91], v[196:197], v[138:139], v[90:91] neg_lo:[1,0,0] neg_hi:[1,0,0]
    v_pk_mul_f32 v[90:91], v[90:91], v[198:199]
    v_pk_fma_f32 v[92:93], v[196:197], v[140:141], v[92:93] neg_lo:[1,0,0] neg_hi:[1,0,0]
    v_pk_mul_f32 v[92:93], v[92:93], v[198:199]
    v_pk_fma_f32 v[94:95], v[196:197], v[142:143], v[94:95] neg_lo:[1,0,0] neg_hi:[1,0,0]
    v_pk_mul_f32 v[94:95], v[94:95], v[198:199]
    v_cvt_pk_bf16_f32 v32, v80, v81
    v_cvt_pk_bf16_f32 v33, v82, v83
    ds_write_b64 v200, v[32:33] offset:1280
    v_cvt_pk_bf16_f32 v34, v84, v85
    v_cvt_pk_bf16_f32 v35, v86, v87
    ds_write_b64 v201, v[34:35] offset:1280
    v_cvt_pk_bf16_f32 v36, v88, v89
    v_cvt_pk_bf16_f32 v37, v90, v91
    ds_write_b64 v202, v[36:37] offset:1280
    v_cvt_pk_bf16_f32 v38, v92, v93
    v_cvt_pk_bf16_f32 v39, v94, v95
    ds_write_b64 v203, v[38:39] offset:1280
    v_pk_fma_f32 v[112:113], v[196:197], v[144:145], v[112:113] neg_lo:[1,0,0] neg_hi:[1,0,0]
    v_pk_mul_f32 v[112:113], v[112:113], v[198:199]
    v_pk_fma_f32 v[114:115], v[196:197], v[146:147], v[114:115] neg_lo:[1,0,0] neg_hi:[1,0,0]
    v_pk_mul_f32 v[114:115], v[114:115], v[198:199]
    v_pk_fma_f32 v[116:117], v[196:197], v[148:149], v[116:117] neg_lo:[1,0,0] neg_hi:[1,0,0]
    v_pk_mul_f32 v[116:117], v[116:117], v[198:199]
    v_pk_fma_f32 v[118:119], v[196:197], v[150:151], v[118:119] neg_lo:[1,0,0] neg_hi:[1,0,0]
    v_pk_mul_f32 v[118:119], v[118:119], v[198:199]
    v_pk_fma_f32 v[120:121], v[196:197], v[152:153], v[120:121] neg_lo:[1,0,0] neg_hi:[1,0,0]
    v_pk_mul_f32 v[120:121], v[120:121], v[198:199]
    v_pk_fma_f32 v[122:123], v[196:197], v[154:155], v[122:123] neg_lo:[1,0,0] neg_hi:[1,0,0]
    v_pk_mul_f32 v[122:123], v[122:123], v[198:199]
    v_pk_fma_f32 v[124:125], v[196:197], v[156:157], v[124:125] neg_lo:[1,0,0] neg_hi:[1,0,0]
    v_pk_mul_f32 v[124:125], v[124:125], v[198:199]
    v_pk_fma_f32 v[126:127], v[196:197], v[158:159], v[126:127] neg_lo:[1,0,0] neg_hi:[1,0,0]
    v_pk_mul_f32 v[126:127], v[126:127], v[198:199]
    v_cvt_pk_bf16_f32 v40, v112, v113
    v_cvt_pk_bf16_f32 v41, v114, v115
    ds_write_b64 v204, v[40:41] offset:1280
    v_cvt_pk_bf16_f32 v42, v116, v117
    v_cvt_pk_bf16_f32 v43, v118, v119
    ds_write_b64 v205, v[42:43] offset:1280
    v_cvt_pk_bf16_f32 v44, v120, v121
    v_cvt_pk_bf16_f32 v45, v122, v123
    ds_write_b64 v206, v[44:45] offset:1280
    v_cvt_pk_bf16_f32 v46, v124, v125
    v_cvt_pk_bf16_f32 v47, v126, v127
    ds_write_b64 v207, v[46:47] offset:1280
    s_waitcnt lgkmcnt(0)
    ds_read_b128 v[64:67], v208 offset:0
    ds_read_b128 v[68:71], v208 offset:1024
    ds_read_b128 v[72:75], v208 offset:2048
    ds_read_b128 v[76:79], v208 offset:2560
    ds_read_b128 v[80:83], v208 offset:3584
    ds_read_b128 v[84:87], v208 offset:4608
    ds_read_b128 v[88:91], v208 offset:5120
    ds_read_b128 v[92:95], v208 offset:6144
    ds_read_b128 v[96:99], v208 offset:7168
    v_cmp_gt_u32 vcc, 32, v1
    s_add_u32 s33, s39, 7864320
    s_waitcnt lgkmcnt(0)
    buffer_store_dwordx4 v[64:67], v28, s[16:19], s33 offen offset:0 sc1
    s_add_u32 s33, s39, 10485760
    s_waitcnt lgkmcnt(0)
    buffer_store_dwordx4 v[76:79], v28, s[16:19], s33 offen offset:0 sc1
    s_add_u32 s33, s39, 13107200
    s_waitcnt lgkmcnt(0)
    buffer_store_dwordx4 v[88:91], v28, s[16:19], s33 offen offset:0 sc1
    s_add_u32 s33, s39, 7864320
    s_waitcnt lgkmcnt(0)
    buffer_store_dwordx4 v[68:71], v28, s[16:19], s33 offen offset:1024 sc1
    s_add_u32 s33, s39, 10485760
    s_waitcnt lgkmcnt(0)
    buffer_store_dwordx4 v[80:83], v28, s[16:19], s33 offen offset:1024 sc1
    s_add_u32 s33, s39, 13107200
    s_waitcnt lgkmcnt(0)
    buffer_store_dwordx4 v[92:95], v28, s[16:19], s33 offen offset:1024 sc1
    s_and_saveexec_b64 s[36:37], vcc
    s_add_u32 s33, s39, 7864320
    buffer_store_dwordx4 v[72:75], v28, s[16:19], s33 offen offset:2048 sc1
    s_add_u32 s33, s39, 10485760
    buffer_store_dwordx4 v[84:87], v28, s[16:19], s33 offen offset:2048 sc1
    s_add_u32 s33, s39, 13107200
    buffer_store_dwordx4 v[96:99], v28, s[16:19], s33 offen offset:2048 sc1
    s_mov_b64 exec, s[36:37]
    s_waitcnt vmcnt(0)
    s_barrier
    s_lshl_b32 s32, s26, 4
    s_add_u32 s32, s32, s27
    s_add_u32 s32, s32, 320
    s_cmp_lg_u32 s29, 0
    s_cbranch_scc1 nosig_mega_kernel_64
    s_lshl_b32 s38, s32, 7
    v_mov_b32 v24, s38
    v_mov_b32 v23, 1
    v_cmp_eq_u32 vcc, 0, v1
    s_and_saveexec_b64 s[36:37], vcc
    s_cbranch_execz nosig2_mega_kernel_65
    buffer_atomic_add v23, v24, s[92:95], 0 offen sc1
nosig2_mega_kernel_65:
    s_mov_b64 exec, s[36:37]
nosig_mega_kernel_64:
    s_branch end_mega_kernel_61
loader_mega_kernel_60:
    s_lshl_b32 s32, s26, 7
    s_lshl_b32 s33, s28, 5
    s_add_u32 s32, s32, s33
    v_lshrrev_b32 v25, 3, v1
    v_add_u32 v25, s32, v25
    v_mul_u32_u24 v25, 1280, v25
    v_and_b32 v26, 7, v1
    v_lshrrev_b32 v27, 4, v1
    v_xor_b32 v26, v26, v27
    v_lshlrev_b32 v26, 4, v26
    v_xor_b32 v27, 64, v26
    v_add_u32 v2, v25, v26
    v_add_u32 v3, v25, v27
    v_add_u32 v3, 9216, v3
    v_add_u32 v4, v25, v26
    v_add_u32 v4, 18432, v4
    v_add_u32 v5, v25, v27
    v_add_u32 v5, 27648, v5
    s_lshl_b32 s34, s28, 12
    s_add_u32 s76, s84, 0x1ad9000
    s_addc_u32 s77, s85, 0
    s_mov_b32 s78, 2621440
    s_and_b32 s77, s77, 0xffff
    s_mov_b32 s79, 0x00020000
    s_lshr_b32 s82, s2, 4
    s_mul_i32 s82, s82, 163840
    s_mul_i32 s80, s28, 4096
    s_add_u32 s82, s82, s80
    v_lshlrev_b32 v8, 4, v1
    v_add_u32 v8, s82, v8
    v_add_u32 v9, 4096, v8
    s_barrier
    s_add_u32 m0, s34, 32768
    s_mov_b32 s35, 0
    buffer_load_dwordx4 v2, s[4:7], s35 offen offset:0 sc1 lds
    buffer_load_dwordx4 v3, s[4:7], s35 offen offset:1024 sc1 lds
    buffer_load_dwordx4 v4, s[4:7], s35 offen offset:2048 sc1 lds
    buffer_load_dwordx4 v5, s[4:7], s35 offen offset:3072 sc1 lds
    s_add_u32 m0, s34, 49152
    s_mov_b32 s35, 128
    buffer_load_dwordx4 v2, s[4:7], s35 offen offset:0 sc1 lds
    buffer_load_dwordx4 v3, s[4:7], s35 offen offset:1024 sc1 lds
    buffer_load_dwordx4 v4, s[4:7], s35 offen offset:2048 sc1 lds
    buffer_load_dwordx4 v5, s[4:7], s35 offen offset:3072 sc1 lds
    s_waitcnt vmcnt(4)
    s_barrier
    s_add_u32 m0, s34, 0
    s_mov_b32 s35, 256
    buffer_load_dwordx4 v2, s[4:7], s35 offen offset:0 sc1 lds
    buffer_load_dwordx4 v3, s[4:7], s35 offen offset:1024 sc1 lds
    buffer_load_dwordx4 v4, s[4:7], s35 offen offset:2048 sc1 lds
    buffer_load_dwordx4 v5, s[4:7], s35 offen offset:3072 sc1 lds
    s_add_u32 m0, s34, 16384
    s_mov_b32 s35, 384
    buffer_load_dwordx4 v2, s[4:7], s35 offen offset:0 sc1 lds
    buffer_load_dwordx4 v3, s[4:7], s35 offen offset:1024 sc1 lds
    buffer_load_dwordx4 v4, s[4:7], s35 offen offset:2048 sc1 lds
    buffer_load_dwordx4 v5, s[4:7], s35 offen offset:3072 sc1 lds
    s_waitcnt vmcnt(8)
    s_barrier
    s_add_u32 m0, s34, 32768
    s_mov_b32 s35, 512
    buffer_load_dwordx4 v2, s[4:7], s35 offen offset:0 sc1 lds
    buffer_load_dwordx4 v3, s[4:7], s35 offen offset:1024 sc1 lds
    buffer_load_dwordx4 v4, s[4:7], s35 offen offset:2048 sc1 lds
    buffer_load_dwordx4 v5, s[4:7], s35 offen offset:3072 sc1 lds
    s_add_u32 m0, s80, 114688
    s_mov_b32 s81, 65536
    buffer_load_dwordx4 v8, s[76:79], s81 offen offset:0 sc1 lds
    buffer_load_dwordx4 v8, s[76:79], s81 offen offset:1024 sc1 lds
    buffer_load_dwordx4 v8, s[76:79], s81 offen offset:2048 sc1 lds
    buffer_load_dwordx4 v8, s[76:79], s81 offen offset:3072 sc1 lds
    s_waitcnt vmcnt(12)
    s_barrier
    s_add_u32 m0, s34, 49152
    s_mov_b32 s35, 640
    buffer_load_dwordx4 v2, s[4:7], s35 offen offset:0 sc1 lds
    buffer_load_dwordx4 v3, s[4:7], s35 offen offset:1024 sc1 lds
    buffer_load_dwordx4 v4, s[4:7], s35 offen offset:2048 sc1 lds
    buffer_load_dwordx4 v5, s[4:7], s35 offen offset:3072 sc1 lds
    s_add_u32 m0, s80, 139264
    s_mov_b32 s81, 81920
    buffer_load_dwordx4 v8, s[76:79], s81 offen offset:0 sc1 lds
    buffer_load_dwordx4 v8, s[76:79], s81 offen offset:1024 sc1 lds
    buffer_load_dwordx4 v8, s[76:79], s81 offen offset:2048 sc1 lds
    buffer_load_dwordx4 v8, s[76:79], s81 offen offset:3072 sc1 lds
    s_waitcnt vmcnt(16)
    s_barrier
    s_add_u32 m0, s34, 0
    s_mov_b32 s35, 768
    buffer_load_dwordx4 v2, s[4:7], s35 offen offset:0 sc1 lds
    buffer_load_dwordx4 v3, s[4:7], s35 offen offset:1024 sc1 lds
    buffer_load_dwordx4 v4, s[4:7], s35 offen offset:2048 sc1 lds
    buffer_load_dwordx4 v5, s[4:7], s35 offen offset:3072 sc1 lds
    s_add_u32 m0, s80, 65536
    s_mov_b32 s81, 98304
    buffer_load_dwordx4 v8, s[76:79], s81 offen offset:0 sc1 lds
    buffer_load_dwordx4 v8, s[76:79], s81 offen offset:1024 sc1 lds
    buffer_load_dwordx4 v8, s[76:79], s81 offen offset:2048 sc1 lds
    buffer_load_dwordx4 v8, s[76:79], s81 offen offset:3072 sc1 lds
    s_waitcnt vmcnt(16)
    s_barrier
    s_add_u32 m0, s34, 16384
    s_mov_b32 s35, 896
    buffer_load_dwordx4 v2, s[4:7], s35 offen offset:0 sc1 lds
    buffer_load_dwordx4 v3, s[4:7], s35 offen offset:1024 sc1 lds
    buffer_load_dwordx4 v4, s[4:7], s35 offen offset:2048 sc1 lds
    buffer_load_dwordx4 v5, s[4:7], s35 offen offset:3072 sc1 lds
    s_add_u32 m0, s80, 90112
    s_mov_b32 s81, 114688
    buffer_load_dwordx4 v8, s[76:79], s81 offen offset:0 sc1 lds
    buffer_load_dwordx4 v8, s[76:79], s81 offen offset:1024 sc1 lds
    buffer_load_dwordx4 v8, s[76:79], s81 offen offset:2048 sc1 lds
    buffer_load_dwordx4 v8, s[76:79], s81 offen offset:3072 sc1 lds
    s_waitcnt vmcnt(16)
    s_barrier
    s_add_u32 m0, s34, 32768
    s_mov_b32 s35, 1024
    buffer_load_dwordx4 v2, s[4:7], s35 offen offset:0 sc1 lds
    buffer_load_dwordx4 v3, s[4:7], s35 offen offset:1024 sc1 lds
    buffer_load_dwordx4 v4, s[4:7], s35 offen offset:2048 sc1 lds
    buffer_load_dwordx4 v5, s[4:7], s35 offen offset:3072 sc1 lds
    s_add_u32 m0, s80, 114688
    s_mov_b32 s81, 131072
    buffer_load_dwordx4 v8, s[76:79], s81 offen offset:0 sc1 lds
    buffer_load_dwordx4 v8, s[76:79], s81 offen offset:1024 sc1 lds
    buffer_load_dwordx4 v8, s[76:79], s81 offen offset:2048 sc1 lds
    buffer_load_dwordx4 v8, s[76:79], s81 offen offset:3072 sc1 lds
    s_waitcnt vmcnt(16)
    s_barrier
    s_add_u32 m0, s34, 49152
    s_mov_b32 s35, 1152
    buffer_load_dwordx4 v2, s[4:7], s35 offen offset:0 sc1 lds
    buffer_load_dwordx4 v3, s[4:7], s35 offen offset:1024 sc1 lds
    buffer_load_dwordx4 v4, s[4:7], s35 offen offset:2048 sc1 lds
    buffer_load_dwordx4 v5, s[4:7], s35 offen offset:3072 sc1 lds
    s_add_u32 m0, s80, 139264
    s_mov_b32 s81, 147456
    buffer_load_dwordx4 v8, s[76:79], s81 offen offset:0 sc1 lds
    buffer_load_dwordx4 v8, s[76:79], s81 offen offset:1024 sc1 lds
    buffer_load_dwordx4 v8, s[76:79], s81 offen offset:2048 sc1 lds
    buffer_load_dwordx4 v8, s[76:79], s81 offen offset:3072 sc1 lds
    s_waitcnt vmcnt(16)
    s_barrier
    s_waitcnt vmcnt(8)
    s_barrier
    s_waitcnt vmcnt(0)
    s_barrier
    s_add_u32 s76, s84, 0x2119000
    s_addc_u32 s77, s85, 0
    s_mov_b32 s78, 983040
    s_and_b32 s77, s77, 0xffff
    s_mov_b32 s79, 0x00020000
    s_lshr_b32 s82, s2, 5
    s_mul_i32 s82, s82, 122880
    s_mul_i32 s80, s28, 5120
    s_add_u32 s82, s82, s80
    v_lshlrev_b32 v8, 4, v1
    v_add_u32 v8, s82, v8
    v_add_u32 v9, 4096, v8
    s_add_u32 m0, s80, 65536
    s_mov_b32 s81, 0
    buffer_load_dwordx4 v8, s[76:79], s81 offen offset:0 sc1 lds
    buffer_load_dwordx4 v8, s[76:79], s81 offen offset:1024 sc1 lds
    buffer_load_dwordx4 v8, s[76:79], s81 offen offset:2048 sc1 lds
    buffer_load_dwordx4 v8, s[76:79], s81 offen offset:3072 sc1 lds
    s_add_u32 m0, s80, 69632
    s_nop 0
    buffer_load_dwordx4 v9, s[76:79], s81 offen offset:0 sc1 lds
    s_add_u32 m0, s80, 90112
    s_mov_b32 s81, 20480
    buffer_load_dwordx4 v8, s[76:79], s81 offen offset:0 sc1 lds
    buffer_load_dwordx4 v8, s[76:79], s81 offen offset:1024 sc1 lds
    buffer_load_dwordx4 v8, s[76:79], s81 offen offset:2048 sc1 lds
    buffer_load_dwordx4 v8, s[76:79], s81 offen offset:3072 sc1 lds
    s_add_u32 m0, s80, 94208
    s_nop 0
    buffer_load_dwordx4 v9, s[76:79], s81 offen offset:0 sc1 lds
    s_add_u32 m0, s80, 114688
    s_mov_b32 s81, 40960
    buffer_load_dwordx4 v8, s[76:79], s81 offen offset:0 sc1 lds
    buffer_load_dwordx4 v8, s[76:79], s81 offen offset:1024 sc1 lds
    buffer_load_dwordx4 v8, s[76:79], s81 offen offset:2048 sc1 lds
    buffer_load_dwordx4 v8, s[76:79], s81 offen offset:3072 sc1 lds
    s_add_u32 m0, s80, 118784
    s_nop 0
    buffer_load_dwordx4 v9, s[76:79], s81 offen offset:0 sc1 lds
    s_barrier
    s_add_u32 m0, s80, 139264
    s_mov_b32 s81, 61440
    buffer_load_dwordx4 v8, s[76:79], s81 offen offset:0 sc1 lds
    buffer_load_dwordx4 v8, s[76:79], s81 offen offset:1024 sc1 lds
    buffer_load_dwordx4 v8, s[76:79], s81 offen offset:2048 sc1 lds
    buffer_load_dwordx4 v8, s[76:79], s81 offen offset:3072 sc1 lds
    s_add_u32 m0, s80, 143360
    s_nop 0
    buffer_load_dwordx4 v9, s[76:79], s81 offen offset:0 sc1 lds
    s_barrier
end_mega_kernel_61:
    s_add_u32 s4, s84, 0xbd9000
    s_addc_u32 s5, s85, 0
    s_mov_b32 s6, 15728640
    s_and_b32 s5, s5, 0xffff
    s_mov_b32 s7, 0x00020000
    s_add_u32 s16, s84, 0x2d9000
    s_addc_u32 s17, s85, 0
    s_mov_b32 s18, 3145728
    s_and_b32 s17, s17, 0xffff
    s_mov_b32 s19, 0x00020000
    s_and_b32 s26, s2, 7
    s_lshr_b32 s27, s2, 3
    s_lshr_b32 s32, s29, 2
    s_add_u32 s32, s32, 4
    s_lshl_b32 s32, s32, 5
    s_add_u32 s32, s32, s27
    s_mul_i32 s32, s32, 81920
    s_mul_i32 s33, s26, 10240
    s_add_u32 s32, s32, s33
    s_sub_u32 s32, s32, 10240
    s_mul_i32 s33, s28, 5120
    s_add_u32 s32, s32, s33
    s_cmp_lg_u32 s26, 0
    s_cbranch_scc1 neg_mega_kernel_66
    s_cmp_ge_u32 s28, 2
    s_cbranch_scc1 neg_mega_kernel_66
    s_mov_b32 s32, 0x7ff00000
neg_mega_kernel_66:
    v_lshlrev_b32 v2, 4, v1
    v_add_u32 v2, s32, v2
    v_add_u32 v3, 4096, v2
    s_mul_i32 s34, s29, 5120
    v_and_b32 v20, 31, v1
    s_lshl_b32 s32, s26, 8
    s_lshl_b32 s35, s29, 5
    s_add_u32 s32, s32, s35
    v_add_u32 v4, s32, v20
    v_lshrrev_b32 v6, 5, v1
    s_add_u32 s33, s27, 96
    s_mul_i32 s33, s33, 81920
    s_mul_i32 s32, s26, 10240
    s_add_u32 s33, s33, s32
    s_lshl_b32 s32, s29, 11
    s_add_u32 s33, s33, s32
    v_lshlrev_b32 v7, 4, v1
    v_add_u32 v7, s33, v7
    s_add_u32 s39, s32, 40960
    v_add_u32 v5, s35, v20
    v_mul_u32_u24 v5, 40, v5
    v_lshl_add_u32 v5, v6, 4, v5
    v_add_u32 v5, 40960, v5
    v_mov_b32 v14, 0
    v_mov_b32 v15, 0
    v_add_u32 v16, s35, v20
    v_mul_u32_u24 v16, 40, v16
    v_lshl_add_u32 v16, v6, 4, v16
    v_lshlrev_b32 v17, 2, v6
    v_bfe_u32 v18, v1, 2, 2
    v_add_u32 v17, v17, v18
    v_add_u32 v17, s35, v17
    v_mul_u32_u24 v17, 40, v17
    v_bfe_u32 v18, v1, 4, 1
    v_lshl_add_u32 v17, v18, 5, v17
    v_and_b32 v18, 3, v1
    v_lshl_add_u32 v17, v18, 3, v17
    v_add_u32 v17, 20480, v17
    v_lshlrev_b32 v18, 2, v6
    v_sub_u32 v18, v20, v18
    s_cmp_lg_u32 s29, 3
    s_cbranch_scc1 pok_mega_kernel_68
    v_and_b32 v24, 3, v1
    s_lshl_b32 s38, s26, 1
    s_sub_u32 s38, s38, 2
    v_add_u32 v24, s38, v24
    v_max_i32 v24, 0, v24
    s_lshr_b32 s38, s27, 1
    s_add_u32 s38, s38, 320
    v_lshl_add_u32 v24, v24, 4, s38
    v_lshlrev_b32 v24, 7, v24
    s_mov_b32 s38, 0
    buffer_load_dword v21, v24, s[92:95], 0 offen sc1
    s_sleep 3
    buffer_load_dword v22, v24, s[92:95], 0 offen sc1
    s_sleep 3
poll_mega_kernel_67:
    buffer_load_dword v23, v24, s[92:95], 0 offen sc1
    s_waitcnt vmcnt(2)
    v_cmp_gt_u32 vcc, 1, v21
    s_nop 4
    s_cbranch_vccz pok_mega_kernel_68
    s_sleep 2
    buffer_load_dword v21, v24, s[92:95], 0 offen sc1
    s_waitcnt vmcnt(2)
    v_cmp_gt_u32 vcc, 1, v22
    s_nop 4
    s_cbranch_vccz pok_mega_kernel_68
    s_sleep 2
    buffer_load_dword v22, v24, s[92:95], 0 offen sc1
    s_waitcnt vmcnt(2)
    v_cmp_gt_u32 vcc, 1, v23
    s_nop 4
    s_cbranch_vccz pok_mega_kernel_68
    s_sleep 2
    s_add_u32 s38, s38, 1
    s_cmp_gt_u32 s38, 4000
    s_cbranch_scc0 poll_mega_kernel_67
pok_mega_kernel_68:
    s_barrier
    s_mov_b32 m0, s34
    s_nop 0
    buffer_load_dwordx4 v2, s[4:7], 0 offen offset:0 sc1 lds
    buffer_load_dwordx4 v2, s[4:7], 0 offen offset:1024 sc1 lds
    buffer_load_dwordx4 v2, s[4:7], 0 offen offset:2048 sc1 lds
    buffer_load_dwordx4 v2, s[4:7], 0 offen offset:3072 sc1 lds
    s_add_u32 m0, s34, 4096
    s_nop 0
    buffer_load_dwordx4 v3, s[4:7], 0 offen sc1 lds
    s_cmp_ge_u32 s29, 5
    s_cbranch_scc1 noq_mega_kernel_69
    s_mov_b32 m0, s39
    s_nop 0
    buffer_load_dwordx4 v7, s[4:7], 0 offen sc1 lds
    buffer_load_dwordx4 v7, s[4:7], 0 offen offset:1024 sc1 lds
noq_mega_kernel_69:
    v_cmp_gt_u32 vcc, 32, v1
    s_waitcnt vmcnt(0)
    s_barrier
    ds_read_b64 v[8:9], v5
    ds_read_b64 v[10:11], v5 offset:8
    ds_read_b64 v[12:13], v5 offset:32
    ds_read_b64 v[24:25], v16 offset:0
    ds_read_b64 v[26:27], v16 offset:8
    ds_read_b64 v[28:29], v16 offset:32
    ds_read_b64 v[30:31], v16 offset:40
    ds_read_b64 v[32:33], v16 offset:1280
    ds_read_b64 v[34:35], v16 offset:1288
    ds_read_b64 v[36:37], v16 offset:1312
    ds_read_b64 v[38:39], v16 offset:1320
    s_waitcnt lgkmcnt(4)
    v_cndmask_b32 v12, 0, v12, vcc
    v_cndmask_b32 v13, 0, v13, vcc
    s_nop 1
    v_mfma_f32_32x32x16_bf16 v[64:79], v[24:27], v[8:11], 0
    v_mfma_f32_32x32x16_bf16 v[64:79], v[28:31], v[12:15], v[64:79]
    ds_read_b64 v[24:25], v16 offset:2560
    ds_read_b64 v[26:27], v16 offset:2568
    ds_read_b64 v[28:29], v16 offset:2592
    ds_read_b64 v[30:31], v16 offset:2600
    s_waitcnt lgkmcnt(4)
    v_mfma_f32_32x32x16_bf16 v[80:95], v[32:35], v[8:11], 0
    v_mfma_f32_32x32x16_bf16 v[80:95], v[36:39], v[12:15], v[80:95]
    ds_read_b64 v[32:33], v16 offset:3840
    ds_read_b64 v[34:35], v16 offset:3848
    ds_read_b64 v[36:37], v16 offset:3872
    ds_read_b64 v[38:39], v16 offset:3880
    s_waitcnt lgkmcnt(4)
    v_mfma_f32_32x32x16_bf16 v[96:111], v[24:27], v[8:11], 0
    v_mfma_f32_32x32x16_bf16 v[96:111], v[28:31], v[12:15], v[96:111]
    ds_read_b64 v[24:25], v16 offset:5120
    ds_read_b64 v[26:27], v16 offset:5128
    ds_read_b64 v[28:29], v16 offset:5152
    ds_read_b64 v[30:31], v16 offset:5160
    s_waitcnt lgkmcnt(4)
    v_mfma_f32_32x32x16_bf16 v[112:127], v[32:35], v[8:11], 0
    v_mfma_f32_32x32x16_bf16 v[112:127], v[36:39], v[12:15], v[112:127]
    ds_read_b64 v[32:33], v16 offset:6400
    ds_read_b64 v[34:35], v16 offset:6408
    ds_read_b64 v[36:37], v16 offset:6432
    ds_read_b64 v[38:39], v16 offset:6440
    s_waitcnt lgkmcnt(4)
    v_mfma_f32_32x32x16_bf16 v[128:143], v[24:27], v[8:11], 0
    v_mfma_f32_32x32x16_bf16 v[128:143], v[28:31], v[12:15], v[128:143]
    ds_read_b64 v[24:25], v16 offset:7680
    ds_read_b64 v[26:27], v16 offset:7688
    ds_read_b64 v[28:29], v16 offset:7712
    ds_read_b64 v[30:31], v16 offset:7720
    s_waitcnt lgkmcnt(4)
    v_mfma_f32_32x32x16_bf16 v[144:159], v[32:35], v[8:11], 0
    v_mfma_f32_32x32x16_bf16 v[144:159], v[36:39], v[12:15], v[144:159]
    ds_read_b64 v[32:33], v16 offset:8960
    ds_read_b64 v[34:35], v16 offset:8968
    ds_read_b64 v[36:37], v16 offset:8992
    ds_read_b64 v[38:39], v16 offset:9000
    s_waitcnt lgkmcnt(4)
    v_mfma_f32_32x32x16_bf16 v[160:175], v[24:27], v[8:11], 0
    v_mfma_f32_32x32x16_bf16 v[160:175], v[28:31], v[12:15], v[160:175]
    ds_read_b64 v[24:25], v16 offset:10240
    ds_read_b64 v[26:27], v16 offset:10248
    ds_read_b64 v[28:29], v16 offset:10272
    ds_read_b64 v[30:31], v16 offset:10280
    s_waitcnt lgkmcnt(4)
    v_mfma_f32_32x32x16_bf16 v[176:191], v[32:35], v[8:11], 0
    v_mfma_f32_32x32x16_bf16 v[176:191], v[36:39], v[12:15], v[176:191]
    s_waitcnt lgkmcnt(0)
    v_mfma_f32_32x32x16_bf16 v[192:207], v[24:27], v[8:11], 0
    v_mfma_f32_32x32x16_bf16 v[192:207], v[28:31], v[12:15], v[192:207]
    s_nop 7
    s_nop 7
    v_mov_b32 v43, 0xce6e6b28
    v_cmp_le_i32 vcc, 0, v18
    s_nop 1
    v_cndmask_b32 v192, v43, v192, vcc
    v_cndmask_b32 v64, v64, v43, vcc
    v_cmp_le_i32 vcc, 1, v18
    s_nop 1
    v_cndmask_b32 v193, v43, v193, vcc
    v_cndmask_b32 v65, v65, v43, vcc
    v_cmp_le_i32 vcc, 2, v18
    s_nop 1
    v_cndmask_b32 v194, v43, v194, vcc
    v_cndmask_b32 v66, v66, v43, vcc
    v_cmp_le_i32 vcc, 3, v18
    s_nop 1
    v_cndmask_b32 v195, v43, v195, vcc
    v_cndmask_b32 v67, v67, v43, vcc
    v_cmp_le_i32 vcc, 8, v18
    s_nop 1
    v_cndmask_b32 v196, v43, v196, vcc
    v_cndmask_b32 v68, v68, v43, vcc
    v_cmp_le_i32 vcc, 9, v18
    s_nop 1
    v_cndmask_b32 v197, v43, v197, vcc
    v_cndmask_b32 v69, v69, v43, vcc
    v_cmp_le_i32 vcc, 10, v18
    s_nop 1
    v_cndmask_b32 v198, v43, v198, vcc
    v_cndmask_b32 v70, v70, v43, vcc
    v_cmp_le_i32 vcc, 11, v18
    s_nop 1
    v_cndmask_b32 v199, v43, v199, vcc
    v_cndmask_b32 v71, v71, v43, vcc
    v_cmp_le_i32 vcc, 16, v18
    s_nop 1
    v_cndmask_b32 v200, v43, v200, vcc
    v_cndmask_b32 v72, v72, v43, vcc
    v_cmp_le_i32 vcc, 17, v18
    s_nop 1
    v_cndmask_b32 v201, v43, v201, vcc
    v_cndmask_b32 v73, v73, v43, vcc
    v_cmp_le_i32 vcc, 18, v18
    s_nop 1
    v_cndmask_b32 v202, v43, v202, vcc
    v_cndmask_b32 v74, v74, v43, vcc
    v_cmp_le_i32 vcc, 19, v18
    s_nop 1
    v_cndmask_b32 v203, v43, v203, vcc
    v_cndmask_b32 v75, v75, v43, vcc
    v_cmp_le_i32 vcc, 24, v18
    s_nop 1
    v_cndmask_b32 v204, v43, v204, vcc
    v_cndmask_b32 v76, v76, v43, vcc
    v_cmp_le_i32 vcc, 25, v18
    s_nop 1
    v_cndmask_b32 v205, v43, v205, vcc
    v_cndmask_b32 v77, v77, v43, vcc
    v_cmp_le_i32 vcc, 26, v18
    s_nop 1
    v_cndmask_b32 v206, v43, v206, vcc
    v_cndmask_b32 v78, v78, v43, vcc
    v_cmp_le_i32 vcc, 27, v18
    s_nop 1
    v_cndmask_b32 v207, v43, v207, vcc
    v_cndmask_b32 v79, v79, v43, vcc
    s_cmp_lg_u32 s26, 0
    s_cbranch_scc1 q0_mega_kernel_70
    s_add_u32 s32, s29, 0
    s_cmp_ge_u32 s32, 8
    s_cbranch_scc1 sk_mega_kernel_71
    v_mov_b32 v64, v43
    v_mov_b32 v65, v43
    v_mov_b32 v66, v43
    v_mov_b32 v67, v43
    v_mov_b32 v68, v43
    v_mov_b32 v69, v43
    v_mov_b32 v70, v43
    v_mov_b32 v71, v43
    v_mov_b32 v72, v43
    v_mov_b32 v73, v43
    v_mov_b32 v74, v43
    v_mov_b32 v75, v43
    v_mov_b32 v76, v43
    v_mov_b32 v77, v43
    v_mov_b32 v78, v43
    v_mov_b32 v79, v43
sk_mega_kernel_71:
    s_add_u32 s32, s29, 1
    s_cmp_ge_u32 s32, 8
    s_cbranch_scc1 sk_mega_kernel_72
    v_mov_b32 v80, v43
    v_mov_b32 v81, v43
    v_mov_b32 v82, v43
    v_mov_b32 v83, v43
    v_mov_b32 v84, v43
    v_mov_b32 v85, v43
    v_mov_b32 v86, v43
    v_mov_b32 v87, v43
    v_mov_b32 v88, v43
    v_mov_b32 v89, v43
    v_mov_b32 v90, v43
    v_mov_b32 v91, v43
    v_mov_b32 v92, v43
    v_mov_b32 v93, v43
    v_mov_b32 v94, v43
    v_mov_b32 v95, v43
sk_mega_kernel_72:
    s_add_u32 s32, s29, 2
    s_cmp_ge_u32 s32, 8
    s_cbranch_scc1 sk_mega_kernel_73
    v_mov_b32 v96, v43
    v_mov_b32 v97, v43
    v_mov_b32 v98, v43
    v_mov_b32 v99, v43
    v_mov_b32 v100, v43
    v_mov_b32 v101, v43
    v_mov_b32 v102, v43
    v_mov_b32 v103, v43
    v_mov_b32 v104, v43
    v_mov_b32 v105, v43
    v_mov_b32 v106, v43
    v_mov_b32 v107, v43
    v_mov_b32 v108, v43
    v_mov_b32 v109, v43
    v_mov_b32 v110, v43
    v_mov_b32 v111, v43
sk_mega_kernel_73:
    s_add_u32 s32, s29, 3
    s_cmp_ge_u32 s32, 8
    s_cbranch_scc1 sk_mega_kernel_74
    v_mov_b32 v112, v43
    v_mov_b32 v113, v43
    v_mov_b32 v114, v43
    v_mov_b32 v115, v43
    v_mov_b32 v116, v43
    v_mov_b32 v117, v43
    v_mov_b32 v118, v43
    v_mov_b32 v119, v43
    v_mov_b32 v120, v43
    v_mov_b32 v121, v43
    v_mov_b32 v122, v43
    v_mov_b32 v123, v43
    v_mov_b32 v124, v43
    v_mov_b32 v125, v43
    v_mov_b32 v126, v43
    v_mov_b32 v127, v43
sk_mega_kernel_74:
    s_add_u32 s32, s29, 4
    s_cmp_ge_u32 s32, 8
    s_cbranch_scc1 sk_mega_kernel_75
    v_mov_b32 v128, v43
    v_mov_b32 v129, v43
    v_mov_b32 v130, v43
    v_mov_b32 v131, v43
    v_mov_b32 v132, v43
    v_mov_b32 v133, v43
    v_mov_b32 v134, v43
    v_mov_b32 v135, v43
    v_mov_b32 v136, v43
    v_mov_b32 v137, v43
    v_mov_b32 v138, v43
    v_mov_b32 v139, v43
    v_mov_b32 v140, v43
    v_mov_b32 v141, v43
    v_mov_b32 v142, v43
    v_mov_b32 v143, v43
sk_mega_kernel_75:
    s_add_u32 s32, s29, 5
    s_cmp_ge_u32 s32, 8
    s_cbranch_scc1 sk_mega_kernel_76
    v_mov_b32 v144, v43
    v_mov_b32 v145, v43
    v_mov_b32 v146, v43
    v_mov_b32 v147, v43
    v_mov_b32 v148, v43
    v_mov_b32 v149, v43
    v_mov_b32 v150, v43
    v_mov_b32 v151, v43
    v_mov_b32 v152, v43
    v_mov_b32 v153, v43
    v_mov_b32 v154, v43
    v_mov_b32 v155, v43
    v_mov_b32 v156, v43
    v_mov_b32 v157, v43
    v_mov_b32 v158, v43
    v_mov_b32 v159, v43
sk_mega_kernel_76:
    s_add_u32 s32, s29, 6
    s_cmp_ge_u32 s32, 8
    s_cbranch_scc1 sk_mega_kernel_77
    v_mov_b32 v160, v43
    v_mov_b32 v161, v43
    v_mov_b32 v162, v43
    v_mov_b32 v163, v43
    v_mov_b32 v164, v43
    v_mov_b32 v165, v43
    v_mov_b32 v166, v43
    v_mov_b32 v167, v43
    v_mov_b32 v168, v43
    v_mov_b32 v169, v43
    v_mov_b32 v170, v43
    v_mov_b32 v171, v43
    v_mov_b32 v172, v43
    v_mov_b32 v173, v43
    v_mov_b32 v174, v43
    v_mov_b32 v175, v43
sk_mega_kernel_77:
    s_add_u32 s32, s29, 7
    s_cmp_ge_u32 s32, 8
    s_cbranch_scc1 sk_mega_kernel_78
    v_mov_b32 v176, v43
    v_mov_b32 v177, v43
    v_mov_b32 v178, v43
    v_mov_b32 v179, v43
    v_mov_b32 v180, v43
    v_mov_b32 v181, v43
    v_mov_b32 v182, v43
    v_mov_b32 v183, v43
    v_mov_b32 v184, v43
    v_mov_b32 v185, v43
    v_mov_b32 v186, v43
    v_mov_b32 v187, v43
    v_mov_b32 v188, v43
    v_mov_b32 v189, v43
    v_mov_b32 v190, v43
    v_mov_b32 v191, v43
sk_mega_kernel_78:
q0_mega_kernel_70:
    v_max3_f32 v44, v64, v65, v66
    v_max3_f32 v45, v67, v68, v69
    v_max3_f32 v44, v44, v70, v71
    v_max3_f32 v45, v45, v72, v73
    v_max3_f32 v44, v44, v74, v75
    v_max3_f32 v45, v45, v76, v77
    v_max3_f32 v44, v44, v78, v79
    v_max3_f32 v45, v45, v80, v81
    v_max3_f32 v44, v44, v82, v83
    v_max3_f32 v45, v45, v84, v85
    v_max3_f32 v44, v44, v86, v87
    v_max3_f32 v45, v45, v88, v89
    v_max3_f32 v44, v44, v90, v91
    v_max3_f32 v45, v45, v92, v93
    v_max3_f32 v44, v44, v94, v95
    v_max3_f32 v45, v45, v96, v97
    v_max3_f32 v44, v44, v98, v99
    v_max3_f32 v45, v45, v100, v101
    v_max3_f32 v44, v44, v102, v103
    v_max3_f32 v45, v45, v104, v105
    v_max3_f32 v44, v44, v106, v107
    v_max3_f32 v45, v45, v108, v109
    v_max3_f32 v44, v44, v110, v111
    v_max3_f32 v45, v45, v112, v113
    v_max3_f32 v44, v44, v114, v115
    v_max3_f32 v45, v45, v116, v117
    v_max3_f32 v44, v44, v118, v119
    v_max3_f32 v45, v45, v120, v121
    v_max3_f32 v44, v44, v122, v123
    v_max3_f32 v45, v45, v124, v125
    v_max3_f32 v44, v44, v126, v127
    v_max3_f32 v45, v45, v128, v129
    v_max3_f32 v44, v44, v130, v131
    v_max3_f32 v45, v45, v132, v133
    v_max3_f32 v44, v44, v134, v135
    v_max3_f32 v45, v45, v136, v137
    v_max3_f32 v44, v44, v138, v139
    v_max3_f32 v45, v45, v140, v141
    v_max3_f32 v44, v44, v142, v143
    v_max3_f32 v45, v45, v144, v145
    v_max3_f32 v44, v44, v146, v147
    v_max3_f32 v45, v45, v148, v149
    v_max3_f32 v44, v44, v150, v151
    v_max3_f32 v45, v45, v152, v153
    v_max3_f32 v44, v44, v154, v155
    v_max3_f32 v45, v45, v156, v157
    v_max3_f32 v44, v44, v158, v159
    v_max3_f32 v45, v45, v160, v161
    v_max3_f32 v44, v44, v162, v163
    v_max3_f32 v45, v45, v164, v165
    v_max3_f32 v44, v44, v166, v167
    v_max3_f32 v45, v45, v168, v169
    v_max3_f32 v44, v44, v170, v171
    v_max3_f32 v45, v45, v172, v173
    v_max3_f32 v44, v44, v174, v175
    v_max3_f32 v45, v45, v176, v177
    v_max3_f32 v44, v44, v178, v179
    v_max3_f32 v45, v45, v180, v181
    v_max3_f32 v44, v44, v182, v183
    v_max3_f32 v45, v45, v184, v185
    v_max3_f32 v44, v44, v186, v187
    v_max3_f32 v45, v45, v188, v189
    v_max3_f32 v44, v44, v190, v191
    v_max3_f32 v45, v45, v192, v193
    v_max3_f32 v44, v44, v194, v195
    v_max3_f32 v45, v45, v196, v197
    v_max3_f32 v44, v44, v198, v199
    v_max3_f32 v45, v45, v200, v201
    v_max3_f32 v44, v44, v202, v203
    v_max3_f32 v45, v45, v204, v205
    v_max3_f32 v44, v44, v206, v207
    v_max_f32 v44, v44, v45
    v_mov_b32 v45, v44
    s_nop 1
    v_permlane32_swap_b32 v44, v45
    v_max_f32 v44, v44, v45
    v_mov_b32 v40, 0x3ea52b5b
    v_mov_b32 v41, 0x3ea52b5b
    v_mul_f32 v44, v44, v40
    v_sub_f32 v44, 0, v44
    v_mov_b32 v45, v44
    v_mov_b32 v46, 0
    v_mov_b32 v47, 0
    v_pk_fma_f32 v[64:65], v[64:65], v[40:41], v[44:45]
    v_exp_f32 v64, v64
    v_exp_f32 v65, v65
    v_pk_fma_f32 v[66:67], v[66:67], v[40:41], v[44:45]
    v_exp_f32 v66, v66
    v_exp_f32 v67, v67
    v_pk_add_f32 v[46:47], v[46:47], v[64:65]
    v_cvt_pk_bf16_f32 v64, v64, v65
    v_pk_fma_f32 v[68:69], v[68:69], v[40:41], v[44:45]
    v_exp_f32 v68, v68
    v_exp_f32 v69, v69
    v_pk_add_f32 v[46:47], v[46:47], v[66:67]
    v_cvt_pk_bf16_f32 v65, v66, v67
    v_pk_fma_f32 v[70:71], v[70:71], v[40:41], v[44:45]
    v_exp_f32 v70, v70
    v_exp_f32 v71, v71
    v_pk_add_f32 v[46:47], v[46:47], v[68:69]
    v_cvt_pk_bf16_f32 v66, v68, v69
    v_pk_fma_f32 v[72:73], v[72:73], v[40:41], v[44:45]
    v_exp_f32 v72, v72
    v_exp_f32 v73, v73
    v_pk_add_f32 v[46:47], v[46:47], v[70:71]
    v_cvt_pk_bf16_f32 v67, v70, v71
    v_pk_fma_f32 v[74:75], v[74:75], v[40:41], v[44:45]
    v_exp_f32 v74, v74
    v_exp_f32 v75, v75
    v_pk_add_f32 v[46:47], v[46:47], v[72:73]
    v_cvt_pk_bf16_f32 v68, v72, v73
    v_pk_fma_f32 v[76:77], v[76:77], v[40:41], v[44:45]
    v_exp_f32 v76, v76
    v_exp_f32 v77, v77
    v_pk_add_f32 v[46:47], v[46:47], v[74:75]
    v_cvt_pk_bf16_f32 v69, v74, v75
    v_pk_fma_f32 v[78:79], v[78:79], v[40:41], v[44:45]
    v_exp_f32 v78, v78
    v_exp_f32 v79, v79
    v_pk_add_f32 v[46:47], v[46:47], v[76:77]
    v_cvt_pk_bf16_f32 v70, v76, v77
    v_pk_fma_f32 v[80:81], v[80:81], v[40:41], v[44:45]
    v_exp_f32 v80, v80
    v_exp_f32 v81, v81
    v_pk_add_f32 v[46:47], v[46:47], v[78:79]
    v_cvt_pk_bf16_f32 v71, v78, v79
    v_pk_fma_f32 v[82:83], v[82:83], v[40:41], v[44:45]
    v_exp_f32 v82, v82
    v_exp_f32 v83, v83
    v_pk_add_f32 v[46:47], v[46:47], v[80:81]
    v_cvt_pk_bf16_f32 v80, v80, v81
    v_pk_fma_f32 v[84:85], v[84:85], v[40:41], v[44:45]
    v_exp_f32 v84, v84
    v_exp_f32 v85, v85
    v_pk_add_f32 v[46:47], v[46:47], v[82:83]
    v_cvt_pk_bf16_f32 v81, v82, v83
    v_pk_fma_f32 v[86:87], v[86:87], v[40:41], v[44:45]
    v_exp_f32 v86, v86
    v_exp_f32 v87, v87
    v_pk_add_f32 v[46:47], v[46:47], v[84:85]
    v_cvt_pk_bf16_f32 v82, v84, v85
    v_pk_fma_f32 v[88:89], v[88:89], v[40:41], v[44:45]
    v_exp_f32 v88, v88
    v_exp_f32 v89, v89
    v_pk_add_f32 v[46:47], v[46:47], v[86:87]
    v_cvt_pk_bf16_f32 v83, v86, v87
    v_pk_fma_f32 v[90:91], v[90:91], v[40:41], v[44:45]
    v_exp_f32 v90, v90
    v_exp_f32 v91, v91
    v_pk_add_f32 v[46:47], v[46:47], v[88:89]
    v_cvt_pk_bf16_f32 v84, v88, v89
    v_pk_fma_f32 v[92:93], v[92:93], v[40:41], v[44:45]
    v_exp_f32 v92, v92
    v_exp_f32 v93, v93
    v_pk_add_f32 v[46:47], v[46:47], v[90:91]
    v_cvt_pk_bf16_f32 v85, v90, v91
    v_pk_fma_f32 v[94:95], v[94:95], v[40:41], v[44:45]
    v_exp_f32 v94, v94
    v_exp_f32 v95, v95
    v_pk_add_f32 v[46:47], v[46:47], v[92:93]
    v_cvt_pk_bf16_f32 v86, v92, v93
    v_pk_fma_f32 v[96:97], v[96:97], v[40:41], v[44:45]
    v_exp_f32 v96, v96
    v_exp_f32 v97, v97
    v_pk_add_f32 v[46:47], v[46:47], v[94:95]
    v_cvt_pk_bf16_f32 v87, v94, v95
    v_pk_fma_f32 v[98:99], v[98:99], v[40:41], v[44:45]
    v_exp_f32 v98, v98
    v_exp_f32 v99, v99
    v_pk_add_f32 v[46:47], v[46:47], v[96:97]
    v_cvt_pk_bf16_f32 v96, v96, v97
    v_pk_fma_f32 v[100:101], v[100:101], v[40:41], v[44:45]
    v_exp_f32 v100, v100
    v_exp_f32 v101, v101
    v_pk_add_f32 v[46:47], v[46:47], v[98:99]
    v_cvt_pk_bf16_f32 v97, v98, v99
    v_pk_fma_f32 v[102:103], v[102:103], v[40:41], v[44:45]
    v_exp_f32 v102, v102
    v_exp_f32 v103, v103
    v_pk_add_f32 v[46:47], v[46:47], v[100:101]
    v_cvt_pk_bf16_f32 v98, v100, v101
    v_pk_fma_f32 v[104:105], v[104:105], v[40:41], v[44:45]
    v_exp_f32 v104, v104
    v_exp_f32 v105, v105
    v_pk_add_f32 v[46:47], v[46:47], v[102:103]
    v_cvt_pk_bf16_f32 v99, v102, v103
    v_pk_fma_f32 v[106:107], v[106:107], v[40:41], v[44:45]
    v_exp_f32 v106, v106
    v_exp_f32 v107, v107
    v_pk_add_f32 v[46:47], v[46:47], v[104:105]
    v_cvt_pk_bf16_f32 v100, v104, v105
    v_pk_fma_f32 v[108:109], v[108:109], v[40:41], v[44:45]
    v_exp_f32 v108, v108
    v_exp_f32 v109, v109
    v_pk_add_f32 v[46:47], v[46:47], v[106:107]
    v_cvt_pk_bf16_f32 v101, v106, v107
    v_pk_fma_f32 v[110:111], v[110:111], v[40:41], v[44:45]
    v_exp_f32 v110, v110
    v_exp_f32 v111, v111
    v_pk_add_f32 v[46:47], v[46:47], v[108:109]
    v_cvt_pk_bf16_f32 v102, v108, v109
    v_pk_fma_f32 v[112:113], v[112:113], v[40:41], v[44:45]
    v_exp_f32 v112, v112
    v_exp_f32 v113, v113
    v_pk_add_f32 v[46:47], v[46:47], v[110:111]
    v_cvt_pk_bf16_f32 v103, v110, v111
    v_pk_fma_f32 v[114:115], v[114:115], v[40:41], v[44:45]
    v_exp_f32 v114, v114
    v_exp_f32 v115, v115
    v_pk_add_f32 v[46:47], v[46:47], v[112:113]
    v_cvt_pk_bf16_f32 v112, v112, v113
    v_pk_fma_f32 v[116:117], v[116:117], v[40:41], v[44:45]
    v_exp_f32 v116, v116
    v_exp_f32 v117, v117
    v_pk_add_f32 v[46:47], v[46:47], v[114:115]
    v_cvt_pk_bf16_f32 v113, v114, v115
    v_pk_fma_f32 v[118:119], v[118:119], v[40:41], v[44:45]
    v_exp_f32 v118, v118
    v_exp_f32 v119, v119
    v_pk_add_f32 v[46:47], v[46:47], v[116:117]
    v_cvt_pk_bf16_f32 v114, v116, v117
    v_pk_fma_f32 v[120:121], v[120:121], v[40:41], v[44:45]
    v_exp_f32 v120, v120
    v_exp_f32 v121, v121
    v_pk_add_f32 v[46:47], v[46:47], v[118:119]
    v_cvt_pk_bf16_f32 v115, v118, v119
    v_pk_fma_f32 v[122:123], v[122:123], v[40:41], v[44:45]
    v_exp_f32 v122, v122
    v_exp_f32 v123, v123
    v_pk_add_f32 v[46:47], v[46:47], v[120:121]
    v_cvt_pk_bf16_f32 v116, v120, v121
    v_pk_fma_f32 v[124:125], v[124:125], v[40:41], v[44:45]
    v_exp_f32 v124, v124
    v_exp_f32 v125, v125
    v_pk_add_f32 v[46:47], v[46:47], v[122:123]
    v_cvt_pk_bf16_f32 v117, v122, v123
    v_pk_fma_f32 v[126:127], v[126:127], v[40:41], v[44:45]
    v_exp_f32 v126, v126
    v_exp_f32 v127, v127
    v_pk_add_f32 v[46:47], v[46:47], v[124:125]
    v_cvt_pk_bf16_f32 v118, v124, v125
    v_pk_fma_f32 v[128:129], v[128:129], v[40:41], v[44:45]
    v_exp_f32 v128, v128
    v_exp_f32 v129, v129
    v_pk_add_f32 v[46:47], v[46:47], v[126:127]
    v_cvt_pk_bf16_f32 v119, v126, v127
    v_pk_fma_f32 v[130:131], v[130:131], v[40:41], v[44:45]
    v_exp_f32 v130, v130
    v_exp_f32 v131, v131
    v_pk_add_f32 v[46:47], v[46:47], v[128:129]
    v_cvt_pk_bf16_f32 v128, v128, v129
    v_pk_fma_f32 v[132:133], v[132:133], v[40:41], v[44:45]
    v_exp_f32 v132, v132
    v_exp_f32 v133, v133
    v_pk_add_f32 v[46:47], v[46:47], v[130:131]
    v_cvt_pk_bf16_f32 v129, v130, v131
    v_pk_fma_f32 v[134:135], v[134:135], v[40:41], v[44:45]
    v_exp_f32 v134, v134
    v_exp_f32 v135, v135
    v_pk_add_f32 v[46:47], v[46:47], v[132:133]
    v_cvt_pk_bf16_f32 v130, v132, v133
    v_pk_fma_f32 v[136:137], v[136:137], v[40:41], v[44:45]
    v_exp_f32 v136, v136
    v_exp_f32 v137, v137
    v_pk_add_f32 v[46:47], v[46:47], v[134:135]
    v_cvt_pk_bf16_f32 v131, v134, v135
    v_pk_fma_f32 v[138:139], v[138:139], v[40:41], v[44:45]
    v_exp_f32 v138, v138
    v_exp_f32 v139, v139
    v_pk_add_f32 v[46:47], v[46:47], v[136:137]
    v_cvt_pk_bf16_f32 v132, v136, v137
    v_pk_fma_f32 v[140:141], v[140:141], v[40:41], v[44:45]
    v_exp_f32 v140, v140
    v_exp_f32 v141, v141
    v_pk_add_f32 v[46:47], v[46:47], v[138:139]
    v_cvt_pk_bf16_f32 v133, v138, v139
    v_pk_fma_f32 v[142:143], v[142:143], v[40:41], v[44:45]
    v_exp_f32 v142, v142
    v_exp_f32 v143, v143
    v_pk_add_f32 v[46:47], v[46:47], v[140:141]
    v_cvt_pk_bf16_f32 v134, v140, v141
    v_pk_fma_f32 v[144:145], v[144:145], v[40:41], v[44:45]
    v_exp_f32 v144, v144
    v_exp_f32 v145, v145
    v_pk_add_f32 v[46:47], v[46:47], v[142:143]
    v_cvt_pk_bf16_f32 v135, v142, v143
    v_pk_fma_f32 v[146:147], v[146:147], v[40:41], v[44:45]
    v_exp_f32 v146, v146
    v_exp_f32 v147, v147
    v_pk_add_f32 v[46:47], v[46:47], v[144:145]
    v_cvt_pk_bf16_f32 v144, v144, v145
    v_pk_fma_f32 v[148:149], v[148:149], v[40:41], v[44:45]
    v_exp_f32 v148, v148
    v_exp_f32 v149, v149
    v_pk_add_f32 v[46:47], v[46:47], v[146:147]
    v_cvt_pk_bf16_f32 v145, v146, v147
    v_pk_fma_f32 v[150:151], v[150:151], v[40:41], v[44:45]
    v_exp_f32 v150, v150
    v_exp_f32 v151, v151
    v_pk_add_f32 v[46:47], v[46:47], v[148:149]
    v_cvt_pk_bf16_f32 v146, v148, v149
    v_pk_fma_f32 v[152:153], v[152:153], v[40:41], v[44:45]
    v_exp_f32 v152, v152
    v_exp_f32 v153, v153
    v_pk_add_f32 v[46:47], v[46:47], v[150:151]
    v_cvt_pk_bf16_f32 v147, v150, v151
    v_pk_fma_f32 v[154:155], v[154:155], v[40:41], v[44:45]
    v_exp_f32 v154, v154
    v_exp_f32 v155, v155
    v_pk_add_f32 v[46:47], v[46:47], v[152:153]
    v_cvt_pk_bf16_f32 v148, v152, v153
    v_pk_fma_f32 v[156:157], v[156:157], v[40:41], v[44:45]
    v_exp_f32 v156, v156
    v_exp_f32 v157, v157
    v_pk_add_f32 v[46:47], v[46:47], v[154:155]
    v_cvt_pk_bf16_f32 v149, v154, v155
    v_pk_fma_f32 v[158:159], v[158:159], v[40:41], v[44:45]
    v_exp_f32 v158, v158
    v_exp_f32 v159, v159
    v_pk_add_f32 v[46:47], v[46:47], v[156:157]
    v_cvt_pk_bf16_f32 v150, v156, v157
    v_pk_fma_f32 v[160:161], v[160:161], v[40:41], v[44:45]
    v_exp_f32 v160, v160
    v_exp_f32 v161, v161
    v_pk_add_f32 v[46:47], v[46:47], v[158:159]
    v_cvt_pk_bf16_f32 v151, v158, v159
    v_pk_fma_f32 v[162:163], v[162:163], v[40:41], v[44:45]
    v_exp_f32 v162, v162
    v_exp_f32 v163, v163
    v_pk_add_f32 v[46:47], v[46:47], v[160:161]
    v_cvt_pk_bf16_f32 v160, v160, v161
    v_pk_fma_f32 v[164:165], v[164:165], v[40:41], v[44:45]
    v_exp_f32 v164, v164
    v_exp_f32 v165, v165
    v_pk_add_f32 v[46:47], v[46:47], v[162:163]
    v_cvt_pk_bf16_f32 v161, v162, v163
    v_pk_fma_f32 v[166:167], v[166:167], v[40:41], v[44:45]
    v_exp_f32 v166, v166
    v_exp_f32 v167, v167
    v_pk_add_f32 v[46:47], v[46:47], v[164:165]
    v_cvt_pk_bf16_f32 v162, v164, v165
    v_pk_fma_f32 v[168:169], v[168:169], v[40:41], v[44:45]
    v_exp_f32 v168, v168
    v_exp_f32 v169, v169
    v_pk_add_f32 v[46:47], v[46:47], v[166:167]
    v_cvt_pk_bf16_f32 v163, v166, v167
    v_pk_fma_f32 v[170:171], v[170:171], v[40:41], v[44:45]
    v_exp_f32 v170, v170
    v_exp_f32 v171, v171
    v_pk_add_f32 v[46:47], v[46:47], v[168:169]
    v_cvt_pk_bf16_f32 v164, v168, v169
    v_pk_fma_f32 v[172:173], v[172:173], v[40:41], v[44:45]
    v_exp_f32 v172, v172
    v_exp_f32 v173, v173
    v_pk_add_f32 v[46:47], v[46:47], v[170:171]
    v_cvt_pk_bf16_f32 v165, v170, v171
    v_pk_fma_f32 v[174:175], v[174:175], v[40:41], v[44:45]
    v_exp_f32 v174, v174
    v_exp_f32 v175, v175
    v_pk_add_f32 v[46:47], v[46:47], v[172:173]
    v_cvt_pk_bf16_f32 v166, v172, v173
    v_pk_fma_f32 v[176:177], v[176:177], v[40:41], v[44:45]
    v_exp_f32 v176, v176
    v_exp_f32 v177, v177
    v_pk_add_f32 v[46:47], v[46:47], v[174:175]
    v_cvt_pk_bf16_f32 v167, v174, v175
    v_pk_fma_f32 v[178:179], v[178:179], v[40:41], v[44:45]
    v_exp_f32 v178, v178
    v_exp_f32 v179, v179
    v_pk_add_f32 v[46:47], v[46:47], v[176:177]
    v_cvt_pk_bf16_f32 v176, v176, v177
    v_pk_fma_f32 v[180:181], v[180:181], v[40:41], v[44:45]
    v_exp_f32 v180, v180
    v_exp_f32 v181, v181
    v_pk_add_f32 v[46:47], v[46:47], v[178:179]
    v_cvt_pk_bf16_f32 v177, v178, v179
    v_pk_fma_f32 v[182:183], v[182:183], v[40:41], v[44:45]
    v_exp_f32 v182, v182
    v_exp_f32 v183, v183
    v_pk_add_f32 v[46:47], v[46:47], v[180:181]
    v_cvt_pk_bf16_f32 v178, v180, v181
    v_pk_fma_f32 v[184:185], v[184:185], v[40:41], v[44:45]
    v_exp_f32 v184, v184
    v_exp_f32 v185, v185
    v_pk_add_f32 v[46:47], v[46:47], v[182:183]
    v_cvt_pk_bf16_f32 v179, v182, v183
    v_pk_fma_f32 v[186:187], v[186:187], v[40:41], v[44:45]
    v_exp_f32 v186, v186
    v_exp_f32 v187, v187
    v_pk_add_f32 v[46:47], v[46:47], v[184:185]
    v_cvt_pk_bf16_f32 v180, v184, v185
    v_pk_fma_f32 v[188:189], v[188:189], v[40:41], v[44:45]
    v_exp_f32 v188, v188
    v_exp_f32 v189, v189
    v_pk_add_f32 v[46:47], v[46:47], v[186:187]
    v_cvt_pk_bf16_f32 v181, v186, v187
    v_pk_fma_f32 v[190:191], v[190:191], v[40:41], v[44:45]
    v_exp_f32 v190, v190
    v_exp_f32 v191, v191
    v_pk_add_f32 v[46:47], v[46:47], v[188:189]
    v_cvt_pk_bf16_f32 v182, v188, v189
    v_pk_fma_f32 v[192:193], v[192:193], v[40:41], v[44:45]
    v_exp_f32 v192, v192
    v_exp_f32 v193, v193
    v_pk_add_f32 v[46:47], v[46:47], v[190:191]
    v_cvt_pk_bf16_f32 v183, v190, v191
    v_pk_fma_f32 v[194:195], v[194:195], v[40:41], v[44:45]
    v_exp_f32 v194, v194
    v_exp_f32 v195, v195
    v_pk_add_f32 v[46:47], v[46:47], v[192:193]
    v_cvt_pk_bf16_f32 v192, v192, v193
    v_pk_fma_f32 v[196:197], v[196:197], v[40:41], v[44:45]
    v_exp_f32 v196, v196
    v_exp_f32 v197, v197
    v_pk_add_f32 v[46:47], v[46:47], v[194:195]
    v_cvt_pk_bf16_f32 v193, v194, v195
    v_pk_fma_f32 v[198:199], v[198:199], v[40:41], v[44:45]
    v_exp_f32 v198, v198
    v_exp_f32 v199, v199
    v_pk_add_f32 v[46:47], v[46:47], v[196:197]
    v_cvt_pk_bf16_f32 v194, v196, v197
    v_pk_fma_f32 v[200:201], v[200:201], v[40:41], v[44:45]
    v_exp_f32 v200, v200
    v_exp_f32 v201, v201
    v_pk_add_f32 v[46:47], v[46:47], v[198:199]
    v_cvt_pk_bf16_f32 v195, v198, v199
    v_pk_fma_f32 v[202:203], v[202:203], v[40:41], v[44:45]
    v_exp_f32 v202, v202
    v_exp_f32 v203, v203
    v_pk_add_f32 v[46:47], v[46:47], v[200:201]
    v_cvt_pk_bf16_f32 v196, v200, v201
    v_pk_fma_f32 v[204:205], v[204:205], v[40:41], v[44:45]
    v_exp_f32 v204, v204
    v_exp_f32 v205, v205
    v_pk_add_f32 v[46:47], v[46:47], v[202:203]
    v_cvt_pk_bf16_f32 v197, v202, v203
    v_pk_fma_f32 v[206:207], v[206:207], v[40:41], v[44:45]
    v_exp_f32 v206, v206
    v_exp_f32 v207, v207
    v_pk_add_f32 v[46:47], v[46:47], v[204:205]
    v_cvt_pk_bf16_f32 v198, v204, v205
    s_nop 0
    v_pk_add_f32 v[46:47], v[46:47], v[206:207]
    v_cvt_pk_bf16_f32 v199, v206, v207
    v_add_f32 v46, v46, v47
    v_mov_b32 v47, v46
    s_nop 1
    v_permlane32_swap_b32 v46, v47
    v_add_f32 v46, v46, v47
    v_rcp_f32 v46, v46
    s_nop 0
    v_mov_b32 v47, v46
    ds_read_b64_tr_b16 v[24:25], v17 offset:0
    ds_read_b64_tr_b16 v[26:27], v17 offset:320
    ds_read_b64_tr_b16 v[28:29], v17 offset:640
    ds_read_b64_tr_b16 v[30:31], v17 offset:960
    ds_read_b64_tr_b16 v[32:33], v17 offset:1280
    ds_read_b64_tr_b16 v[34:35], v17 offset:1600
    ds_read_b64_tr_b16 v[36:37], v17 offset:1920
    ds_read_b64_tr_b16 v[38:39], v17 offset:2240
    s_waitcnt lgkmcnt(4)
    v_mfma_f32_32x32x16_bf16 v[208:223], v[24:27], v[64:67], 0
    v_mfma_f32_32x32x16_bf16 v[208:223], v[28:31], v[68:71], v[208:223]
    ds_read_b64_tr_b16 v[24:25], v17 offset:2560
    ds_read_b64_tr_b16 v[26:27], v17 offset:2880
    ds_read_b64_tr_b16 v[28:29], v17 offset:3200
    ds_read_b64_tr_b16 v[30:31], v17 offset:3520
    s_waitcnt lgkmcnt(4)
    v_mfma_f32_32x32x16_bf16 v[208:223], v[32:35], v[80:83], v[208:223]
    v_mfma_f32_32x32x16_bf16 v[208:223], v[36:39], v[84:87], v[208:223]
    ds_read_b64_tr_b16 v[32:33], v17 offset:3840
    ds_read_b64_tr_b16 v[34:35], v17 offset:4160
    ds_read_b64_tr_b16 v[36:37], v17 offset:4480
    ds_read_b64_tr_b16 v[38:39], v17 offset:4800
    s_waitcnt lgkmcnt(4)
    v_mfma_f32_32x32x16_bf16 v[208:223], v[24:27], v[96:99], v[208:223]
    v_mfma_f32_32x32x16_bf16 v[208:223], v[28:31], v[100:103], v[208:223]
    ds_read_b64_tr_b16 v[24:25], v17 offset:5120
    ds_read_b64_tr_b16 v[26:27], v17 offset:5440
    ds_read_b64_tr_b16 v[28:29], v17 offset:5760
    ds_read_b64_tr_b16 v[30:31], v17 offset:6080
    s_waitcnt lgkmcnt(4)
    v_mfma_f32_32x32x16_bf16 v[208:223], v[32:35], v[112:115], v[208:223]
    v_mfma_f32_32x32x16_bf16 v[208:223], v[36:39], v[116:119], v[208:223]
    ds_read_b64_tr_b16 v[32:33], v17 offset:6400
    ds_read_b64_tr_b16 v[34:35], v17 offset:6720
    ds_read_b64_tr_b16 v[36:37], v17 offset:7040
    ds_read_b64_tr_b16 v[38:39], v17 offset:7360
    s_waitcnt lgkmcnt(4)
    v_mfma_f32_32x32x16_bf16 v[208:223], v[24:27], v[128:131], v[208:223]
    v_mfma_f32_32x32x16_bf16 v[208:223], v[28:31], v[132:135], v[208:223]
    ds_read_b64_tr_b16 v[24:25], v17 offset:7680
    ds_read_b64_tr_b16 v[26:27], v17 offset:8000
    ds_read_b64_tr_b16 v[28:29], v17 offset:8320
    ds_read_b64_tr_b16 v[30:31], v17 offset:8640
    s_waitcnt lgkmcnt(4)
    v_mfma_f32_32x32x16_bf16 v[208:223], v[32:35], v[144:147], v[208:223]
    v_mfma_f32_32x32x16_bf16 v[208:223], v[36:39], v[148:151], v[208:223]
    ds_read_b64_tr_b16 v[32:33], v17 offset:8960
    ds_read_b64_tr_b16 v[34:35], v17 offset:9280
    ds_read_b64_tr_b16 v[36:37], v17 offset:9600
    ds_read_b64_tr_b16 v[38:39], v17 offset:9920
    s_waitcnt lgkmcnt(4)
    v_mfma_f32_32x32x16_bf16 v[208:223], v[24:27], v[160:163], v[208:223]
    v_mfma_f32_32x32x16_bf16 v[208:223], v[28:31], v[164:167], v[208:223]
    ds_read_b64_tr_b16 v[24:25], v17 offset:10240
    ds_read_b64_tr_b16 v[26:27], v17 offset:10560
    ds_read_b64_tr_b16 v[28:29], v17 offset:10880
    ds_read_b64_tr_b16 v[30:31], v17 offset:11200
    s_waitcnt lgkmcnt(4)
    v_mfma_f32_32x32x16_bf16 v[208:223], v[32:35], v[176:179], v[208:223]
    v_mfma_f32_32x32x16_bf16 v[208:223], v[36:39], v[180:183], v[208:223]
    s_waitcnt lgkmcnt(0)
    v_mfma_f32_32x32x16_bf16 v[208:223], v[24:27], v[192:195], v[208:223]
    v_mfma_f32_32x32x16_bf16 v[208:223], v[28:31], v[196:199], v[208:223]
    s_mul_i32 s32, s29, 1536
    s_add_u32 s32, s32, 51328
    v_mul_u32_u24 v5, 48, v20
    v_lshl_add_u32 v5, v6, 3, v5
    v_add_u32 v5, s32, v5
    v_lshlrev_b32 v7, 4, v1
    v_add_u32 v2, s32, v7
    s_mul_i32 s33, s27, 98304
    s_lshl_b32 s32, s26, 8
    s_add_u32 s32, s32, s35
    s_mul_i32 s32, s32, 48
    s_add_u32 s33, s33, s32
    v_cmp_gt_u32 vcc, 32, v1
    s_nop 7
    s_nop 4
    v_pk_mul_f32 v[208:209], v[208:209], v[46:47]
    v_pk_mul_f32 v[210:211], v[210:211], v[46:47]
    v_cvt_pk_bf16_f32 v40, v208, v209
    v_cvt_pk_bf16_f32 v41, v210, v211
    v_pk_mul_f32 v[212:213], v[212:213], v[46:47]
    v_pk_mul_f32 v[214:215], v[214:215], v[46:47]
    v_cvt_pk_bf16_f32 v42, v212, v213
    v_cvt_pk_bf16_f32 v43, v214, v215
    v_pk_mul_f32 v[216:217], v[216:217], v[46:47]
    v_pk_mul_f32 v[218:219], v[218:219], v[46:47]
    v_cvt_pk_bf16_f32 v44, v216, v217
    v_cvt_pk_bf16_f32 v45, v218, v219
    v_cndmask_b32 v44, 0, v44, vcc
    v_cndmask_b32 v45, 0, v45, vcc
    ds_write_b64 v5, v[40:41] offset:0
    ds_write_b64 v5, v[42:43] offset:16
    ds_write_b64 v5, v[44:45] offset:32
    s_waitcnt lgkmcnt(0)
    ds_read_b128 v[48:51], v2
    ds_read_b128 v[52:55], v2 offset:1024
    s_waitcnt lgkmcnt(1)
    buffer_store_dwordx4 v[48:51], v7, s[16:19], s33 offen
    s_and_saveexec_b64 s[36:37], vcc
    s_waitcnt lgkmcnt(0)
    buffer_store_dwordx4 v[52:55], v7, s[16:19], s33 offen offset:1024
    s_mov_b64 exec, s[36:37]
    s_waitcnt vmcnt(0)
    s_barrier
    s_add_u32 s32, s26, 576
    s_cmp_lg_u32 s29, 0
    s_cbranch_scc1 nosig_mega_kernel_79
    s_lshl_b32 s38, s32, 7
    s_lshl_b32 s39, s27, 2
    s_add_u32 s38, s38, s39
    v_mov_b32 v24, s38
    v_mov_b32 v23, 1
    v_cmp_eq_u32 vcc, 0, v1
    s_and_saveexec_b64 s[36:37], vcc
    s_cbranch_execz nosig2_mega_kernel_80
    buffer_store_dword v23, v24, s[92:95], 0 offen
nosig2_mega_kernel_80:
    s_mov_b64 exec, s[36:37]
nosig_mega_kernel_79:
    s_and_b32 s24, s2, 7
    s_lshr_b32 s25, s2, 3
    s_lshl_b32 s26, s24, 2
    s_and_b32 s27, s25, 3
    s_add_u32 s26, s26, s27
    s_lshr_b32 s27, s25, 2
    s_add_u32 s4, s84, 0x2d9000
    s_addc_u32 s5, s85, 0
    s_mov_b32 s6, 3145728
    s_and_b32 s5, s5, 0xffff
    s_mov_b32 s7, 0x00020000
    s_add_u32 s12, s84, 0x59000
    s_addc_u32 s13, s85, 0
    s_mov_b32 s14, 2621440
    s_and_b32 s13, s13, 0xffff
    s_mov_b32 s15, 0x00020000
    s_add_u32 s16, s84, 0x59000
    s_addc_u32 s17, s85, 0
    s_mov_b32 s18, 2621440
    s_and_b32 s17, s17, 0xffff
    s_mov_b32 s19, 0x00020000
    s_add_u32 s20, s84, 0x39000
    s_addc_u32 s21, s85, 0
    s_mov_b32 s22, 131072
    s_and_b32 s21, s21, 0xffff
    s_mov_b32 s23, 0x00020000
    s_cmp_ge_u32 s29, 4
    s_cbranch_scc1 loader_mega_kernel_81
    v_and_b32 v25, 15, v1
    v_lshrrev_b32 v26, 4, v1
    s_lshl_b32 s32, s29, 2
    v_add_u32 v26, s32, v26
    v_xor_b32 v26, v26, v25
    v_lshlrev_b32 v26, 4, v26
    v_lshl_add_u32 v10, v25, 8, v26
    v_add_u32 v10, 0, v10
    v_lshrrev_b32 v26, 4, v1
    v_lshlrev_b32 v26, 3, v26
    v_bfe_u32 v27, v1, 2, 2
    v_add_u32 v26, v26, v27
    s_lshl_b32 s32, s29, 5
    v_add_u32 v26, s32, v26
    v_mul_u32_u24 v26, 160, v26
    v_and_b32 v27, 3, v1
    v_lshl_add_u32 v26, v27, 3, v26
    v_add_u32 v11, 65536, v26
    s_lshl_b32 s32, s26, 6
    s_lshl_b32 s33, s29, 4
    s_add_u32 s32, s32, s33
    v_add_u32 v28, s32, v25
    v_mul_u32_u24 v29, 1280, v28
    v_lshrrev_b32 v26, 4, v1
    v_lshl_add_u32 v29, v26, 3, v29
    s_mul_i32 s32, s27, 160
    v_add_u32 v29, s32, v29
    v_mov_b32 v104, 0
    v_mov_b32 v105, 0
    v_mov_b32 v106, 0
    v_mov_b32 v107, 0
    v_mov_b32 v108, 0
    v_mov_b32 v109, 0
    v_mov_b32 v110, 0
    v_mov_b32 v111, 0
    v_mov_b32 v112, 0
    v_mov_b32 v113, 0
    v_mov_b32 v114, 0
    v_mov_b32 v115, 0
    v_mov_b32 v116, 0
    v_mov_b32 v117, 0
    v_mov_b32 v118, 0
    v_mov_b32 v119, 0
    v_mov_b32 v120, 0
    v_mov_b32 v121, 0
    v_mov_b32 v122, 0
    v_mov_b32 v123, 0
    v_mov_b32 v124, 0
    v_mov_b32 v125, 0
    v_mov_b32 v126, 0
    v_mov_b32 v127, 0
    v_mov_b32 v128, 0
    v_mov_b32 v129, 0
    v_mov_b32 v130, 0
    v_mov_b32 v131, 0
    v_mov_b32 v132, 0
    v_mov_b32 v133, 0
    v_mov_b32 v134, 0
    v_mov_b32 v135, 0
    v_mov_b32 v136, 0
    v_mov_b32 v137, 0
    v_mov_b32 v138, 0
    v_mov_b32 v139, 0
    v_mov_b32 v140, 0
    v_mov_b32 v141, 0
    v_mov_b32 v142, 0
    v_mov_b32 v143, 0
    v_mov_b32 v144, 0
    v_mov_b32 v145, 0
    v_mov_b32 v146, 0
    v_mov_b32 v147, 0
    v_mov_b32 v148, 0
    v_mov_b32 v149, 0
    v_mov_b32 v150, 0
    v_mov_b32 v151, 0
    v_mov_b32 v152, 0
    v_mov_b32 v153, 0
    v_mov_b32 v154, 0
    v_mov_b32 v155, 0
    v_mov_b32 v156, 0
    v_mov_b32 v157, 0
    v_mov_b32 v158, 0
    v_mov_b32 v159, 0
    v_mov_b32 v160, 0
    v_mov_b32 v161, 0
    v_mov_b32 v162, 0
    v_mov_b32 v163, 0
    v_mov_b32 v164, 0
    v_mov_b32 v165, 0
    v_mov_b32 v166, 0
    v_mov_b32 v167, 0
    v_mov_b32 v168, 0
    v_mov_b32 v169, 0
    v_mov_b32 v170, 0
    v_mov_b32 v171, 0
    v_mov_b32 v172, 0
    v_mov_b32 v173, 0
    v_mov_b32 v174, 0
    v_mov_b32 v175, 0
    v_mov_b32 v176, 0
    v_mov_b32 v177, 0
    v_mov_b32 v178, 0
    v_mov_b32 v179, 0
    v_mov_b32 v180, 0
    v_mov_b32 v181, 0
    v_mov_b32 v182, 0
    v_mov_b32 v183, 0
    s_mul_i32 s32, s29, 15360
    s_nop 0
    v_mul_u32_u24 v30, 160, v25
    v_lshrrev_b32 v26, 4, v1
    v_lshl_add_u32 v30, v26, 3, v30
    v_add_u32 v30, s32, v30
    v_lshlrev_b32 v31, 4, v1
    v_add_u32 v31, s32, v31
    s_lshl_b32 s32, s26, 6
    s_lshl_b32 s33, s29, 4
    s_add_u32 s32, s32, s33
    s_mul_i32 s33, s27, 160
    s_mov_b32 s38, 52429
    v_add_u32 v26, 0, v1
    v_mul_lo_u32 v27, v26, s38
    v_lshrrev_b32 v27, 19, v27
    v_mul_u32_u24 v24, 10, v27
    v_sub_u32 v24, v26, v24
    v_add_u32 v27, s32, v27
    v_mul_u32_u24 v27, 1280, v27
    v_lshl_add_u32 v27, v24, 4, v27
    v_add_u32 v12, s33, v27
    v_add_u32 v26, 64, v1
    v_mul_lo_u32 v27, v26, s38
    v_lshrrev_b32 v27, 19, v27
    v_mul_u32_u24 v24, 10, v27
    v_sub_u32 v24, v26, v24
    v_add_u32 v27, s32, v27
    v_mul_u32_u24 v27, 1280, v27
    v_lshl_add_u32 v27, v24, 4, v27
    v_add_u32 v13, s33, v27
    v_add_u32 v26, 128, v1
    v_mul_lo_u32 v27, v26, s38
    v_lshrrev_b32 v27, 19, v27
    v_mul_u32_u24 v24, 10, v27
    v_sub_u32 v24, v26, v24
    v_add_u32 v27, s32, v27
    v_mul_u32_u24 v27, 1280, v27
    v_lshl_add_u32 v27, v24, 4, v27
    v_add_u32 v14, s33, v27
    s_cmp_lg_u32 s29, 3
    s_cbranch_scc1 pok_mega_kernel_84
    s_lshr_b32 s38, s26, 2
    s_add_u32 s38, s38, 576
    s_lshl_b32 s38, s38, 7
    v_and_b32 v24, 31, v1
    v_lshlrev_b32 v24, 2, v24
    v_add_u32 v24, s38, v24
    s_mov_b32 s38, 0
    buffer_load_dword v21, v24, s[92:95], 0 offen sc1
    s_sleep 3
    buffer_load_dword v22, v24, s[92:95], 0 offen sc1
    s_sleep 3
poll_mega_kernel_83:
    buffer_load_dword v23, v24, s[92:95], 0 offen sc1
    s_waitcnt vmcnt(2)
    v_cmp_gt_u32 vcc, 1, v21
    s_nop 4
    s_cbranch_vccz pok_mega_kernel_84
    s_sleep 2
    buffer_load_dword v21, v24, s[92:95], 0 offen sc1
    s_waitcnt vmcnt(2)
    v_cmp_gt_u32 vcc, 1, v22
    s_nop 4
    s_cbranch_vccz pok_mega_kernel_84
    s_sleep 2
    buffer_load_dword v22, v24, s[92:95], 0 offen sc1
    s_waitcnt vmcnt(2)
    v_cmp_gt_u32 vcc, 1, v23
    s_nop 4
    s_cbranch_vccz pok_mega_kernel_84
    s_sleep 2
    s_add_u32 s38, s38, 1
    s_cmp_gt_u32 s38, 4000
    s_cbranch_scc0 poll_mega_kernel_83
pok_mega_kernel_84:
    s_barrier
    buffer_load_dwordx2 v[184:185], v29, s[12:15], 0 offen offset:0 sc1
    buffer_load_dwordx2 v[186:187], v29, s[12:15], 0 offen offset:32 sc1
    buffer_load_dwordx2 v[188:189], v29, s[12:15], 0 offen offset:64 sc1
    buffer_load_dwordx2 v[190:191], v29, s[12:15], 0 offen offset:96 sc1
    buffer_load_dwordx2 v[192:193], v29, s[12:15], 0 offen offset:128 sc1
    s_barrier
    ds_read_b128 v[32:35], v10 offset:0
    ds_read_b128 v[36:39], v10 offset:4096
    ds_read_b128 v[40:43], v10 offset:8192
    ds_read_b128 v[44:47], v10 offset:12288
    ds_read_b64_tr_b16 v[48:49], v11 offset:0
    ds_read_b64_tr_b16 v[50:51], v11 offset:640
    ds_read_b64_tr_b16 v[52:53], v11 offset:32
    ds_read_b64_tr_b16 v[54:55], v11 offset:672
    ds_read_b64_tr_b16 v[56:57], v11 offset:64
    ds_read_b64_tr_b16 v[58:59], v11 offset:704
    ds_read_b64_tr_b16 v[60:61], v11 offset:96
    ds_read_b64_tr_b16 v[62:63], v11 offset:736
    ds_read_b64_tr_b16 v[64:65], v11 offset:128
    ds_read_b64_tr_b16 v[66:67], v11 offset:768
    s_waitcnt lgkmcnt(0)
    v_mfma_f32_16x16x32_bf16 v[104:107], v[48:51], v[32:35], v[104:107]
    s_barrier
    v_add_u32 v10, 0x4000, v10
    v_add_u32 v11, 0x6000, v11
    v_mfma_f32_16x16x32_bf16 v[108:111], v[48:51], v[36:39], v[108:111]
    ds_read_b128 v[68:71], v10 offset:0
    v_mfma_f32_16x16x32_bf16 v[112:115], v[48:51], v[40:43], v[112:115]
    ds_read_b128 v[72:75], v10 offset:4096
    v_mfma_f32_16x16x32_bf16 v[116:119], v[48:51], v[44:47], v[116:119]
    ds_read_b128 v[76:79], v10 offset:8192
    v_mfma_f32_16x16x32_bf16 v[120:123], v[52:55], v[32:35], v[120:123]
    ds_read_b128 v[80:83], v10 offset:12288
    v_mfma_f32_16x16x32_bf16 v[124:127], v[52:55], v[36:39], v[124:127]
    ds_read_b64_tr_b16 v[84:85], v11 offset:0
    v_mfma_f32_16x16x32_bf16 v[128:131], v[52:55], v[40:43], v[128:131]
    ds_read_b64_tr_b16 v[86:87], v11 offset:640
    v_mfma_f32_16x16x32_bf16 v[132:135], v[52:55], v[44:47], v[132:135]
    ds_read_b64_tr_b16 v[88:89], v11 offset:32
    v_mfma_f32_16x16x32_bf16 v[136:139], v[56:59], v[32:35], v[136:139]
    ds_read_b64_tr_b16 v[90:91], v11 offset:672
    v_mfma_f32_16x16x32_bf16 v[140:143], v[56:59], v[36:39], v[140:143]
    ds_read_b64_tr_b16 v[92:93], v11 offset:64
    v_mfma_f32_16x16x32_bf16 v[144:147], v[56:59], v[40:43], v[144:147]
    ds_read_b64_tr_b16 v[94:95], v11 offset:704
    v_mfma_f32_16x16x32_bf16 v[148:151], v[56:59], v[44:47], v[148:151]
    ds_read_b64_tr_b16 v[96:97], v11 offset:96
    v_mfma_f32_16x16x32_bf16 v[152:155], v[60:63], v[32:35], v[152:155]
    ds_read_b64_tr_b16 v[98:99], v11 offset:736
    v_mfma_f32_16x16x32_bf16 v[156:159], v[60:63], v[36:39], v[156:159]
    ds_read_b64_tr_b16 v[100:101], v11 offset:128
    v_mfma_f32_16x16x32_bf16 v[160:163], v[60:63], v[40:43], v[160:163]
    ds_read_b64_tr_b16 v[102:103], v11 offset:768
    v_mfma_f32_16x16x32_bf16 v[164:167], v[60:63], v[44:47], v[164:167]
    v_mfma_f32_16x16x32_bf16 v[168:171], v[64:67], v[32:35], v[168:171]
    v_mfma_f32_16x16x32_bf16 v[172:175], v[64:67], v[36:39], v[172:175]
    v_mfma_f32_16x16x32_bf16 v[176:179], v[64:67], v[40:43], v[176:179]
    v_mfma_f32_16x16x32_bf16 v[180:183], v[64:67], v[44:47], v[180:183]
    s_waitcnt lgkmcnt(0)
    v_mfma_f32_16x16x32_bf16 v[104:107], v[84:87], v[68:71], v[104:107]
    s_barrier
    v_add_u32 v10, 0x4000, v10
    v_add_u32 v11, 0x6000, v11
    v_mfma_f32_16x16x32_bf16 v[108:111], v[84:87], v[72:75], v[108:111]
    ds_read_b128 v[32:35], v10 offset:0
    v_mfma_f32_16x16x32_bf16 v[112:115], v[84:87], v[76:79], v[112:115]
    ds_read_b128 v[36:39], v10 offset:4096
    v_mfma_f32_16x16x32_bf16 v[116:119], v[84:87], v[80:83], v[116:119]
    ds_read_b128 v[40:43], v10 offset:8192
    v_mfma_f32_16x16x32_bf16 v[120:123], v[88:91], v[68:71], v[120:123]
    ds_read_b128 v[44:47], v10 offset:12288
    v_mfma_f32_16x16x32_bf16 v[124:127], v[88:91], v[72:75], v[124:127]
    ds_read_b64_tr_b16 v[48:49], v11 offset:0
    v_mfma_f32_16x16x32_bf16 v[128:131], v[88:91], v[76:79], v[128:131]
    ds_read_b64_tr_b16 v[50:51], v11 offset:640
    v_mfma_f32_16x16x32_bf16 v[132:135], v[88:91], v[80:83], v[132:135]
    ds_read_b64_tr_b16 v[52:53], v11 offset:32
    v_mfma_f32_16x16x32_bf16 v[136:139], v[92:95], v[68:71], v[136:139]
    ds_read_b64_tr_b16 v[54:55], v11 offset:672
    v_mfma_f32_16x16x32_bf16 v[140:143], v[92:95], v[72:75], v[140:143]
    ds_read_b64_tr_b16 v[56:57], v11 offset:64
    v_mfma_f32_16x16x32_bf16 v[144:147], v[92:95], v[76:79], v[144:147]
    ds_read_b64_tr_b16 v[58:59], v11 offset:704
    v_mfma_f32_16x16x32_bf16 v[148:151], v[92:95], v[80:83], v[148:151]
    ds_read_b64_tr_b16 v[60:61], v11 offset:96
    v_mfma_f32_16x16x32_bf16 v[152:155], v[96:99], v[68:71], v[152:155]
    ds_read_b64_tr_b16 v[62:63], v11 offset:736
    v_mfma_f32_16x16x32_bf16 v[156:159], v[96:99], v[72:75], v[156:159]
    ds_read_b64_tr_b16 v[64:65], v11 offset:128
    v_mfma_f32_16x16x32_bf16 v[160:163], v[96:99], v[76:79], v[160:163]
    ds_read_b64_tr_b16 v[66:67], v11 offset:768
    v_mfma_f32_16x16x32_bf16 v[164:167], v[96:99], v[80:83], v[164:167]
    v_mfma_f32_16x16x32_bf16 v[168:171], v[100:103], v[68:71], v[168:171]
    v_mfma_f32_16x16x32_bf16 v[172:175], v[100:103], v[72:75], v[172:175]
    v_mfma_f32_16x16x32_bf16 v[176:179], v[100:103], v[76:79], v[176:179]
    v_mfma_f32_16x16x32_bf16 v[180:183], v[100:103], v[80:83], v[180:183]
    s_waitcnt lgkmcnt(0)
    v_mfma_f32_16x16x32_bf16 v[104:107], v[48:51], v[32:35], v[104:107]
    s_barrier
    v_add_u32 v10, 0x4000, v10
    v_add_u32 v11, 0x6000, v11
    v_mfma_f32_16x16x32_bf16 v[108:111], v[48:51], v[36:39], v[108:111]
    ds_read_b128 v[68:71], v10 offset:0
    v_mfma_f32_16x16x32_bf16 v[112:115], v[48:51], v[40:43], v[112:115]
    ds_read_b128 v[72:75], v10 offset:4096
    v_mfma_f32_16x16x32_bf16 v[116:119], v[48:51], v[44:47], v[116:119]
    ds_read_b128 v[76:79], v10 offset:8192
    v_mfma_f32_16x16x32_bf16 v[120:123], v[52:55], v[32:35], v[120:123]
    ds_read_b128 v[80:83], v10 offset:12288
    v_mfma_f32_16x16x32_bf16 v[124:127], v[52:55], v[36:39], v[124:127]
    ds_read_b64_tr_b16 v[84:85], v11 offset:0
    v_mfma_f32_16x16x32_bf16 v[128:131], v[52:55], v[40:43], v[128:131]
    ds_read_b64_tr_b16 v[86:87], v11 offset:640
    v_mfma_f32_16x16x32_bf16 v[132:135], v[52:55], v[44:47], v[132:135]
    ds_read_b64_tr_b16 v[88:89], v11 offset:32
    v_mfma_f32_16x16x32_bf16 v[136:139], v[56:59], v[32:35], v[136:139]
    ds_read_b64_tr_b16 v[90:91], v11 offset:672
    v_mfma_f32_16x16x32_bf16 v[140:143], v[56:59], v[36:39], v[140:143]
    ds_read_b64_tr_b16 v[92:93], v11 offset:64
    v_mfma_f32_16x16x32_bf16 v[144:147], v[56:59], v[40:43], v[144:147]
    ds_read_b64_tr_b16 v[94:95], v11 offset:704
    v_mfma_f32_16x16x32_bf16 v[148:151], v[56:59], v[44:47], v[148:151]
    ds_read_b64_tr_b16 v[96:97], v11 offset:96
    v_mfma_f32_16x16x32_bf16 v[152:155], v[60:63], v[32:35], v[152:155]
    ds_read_b64_tr_b16 v[98:99], v11 offset:736
    v_mfma_f32_16x16x32_bf16 v[156:159], v[60:63], v[36:39], v[156:159]
    ds_read_b64_tr_b16 v[100:101], v11 offset:128
    v_mfma_f32_16x16x32_bf16 v[160:163], v[60:63], v[40:43], v[160:163]
    ds_read_b64_tr_b16 v[102:103], v11 offset:768
    v_mfma_f32_16x16x32_bf16 v[164:167], v[60:63], v[44:47], v[164:167]
    v_mfma_f32_16x16x32_bf16 v[168:171], v[64:67], v[32:35], v[168:171]
    v_mfma_f32_16x16x32_bf16 v[172:175], v[64:67], v[36:39], v[172:175]
    v_mfma_f32_16x16x32_bf16 v[176:179], v[64:67], v[40:43], v[176:179]
    v_mfma_f32_16x16x32_bf16 v[180:183], v[64:67], v[44:47], v[180:183]
    s_waitcnt lgkmcnt(0)
    v_mfma_f32_16x16x32_bf16 v[104:107], v[84:87], v[68:71], v[104:107]
    s_barrier
    v_add_u32 v10, 0xffff4000, v10
    v_add_u32 v11, 0xfffee000, v11
    v_mfma_f32_16x16x32_bf16 v[108:111], v[84:87], v[72:75], v[108:111]
    ds_read_b128 v[32:35], v10 offset:0
    v_mfma_f32_16x16x32_bf16 v[112:115], v[84:87], v[76:79], v[112:115]
    ds_read_b128 v[36:39], v10 offset:4096
    v_mfma_f32_16x16x32_bf16 v[116:119], v[84:87], v[80:83], v[116:119]
    ds_read_b128 v[40:43], v10 offset:8192
    v_mfma_f32_16x16x32_bf16 v[120:123], v[88:91], v[68:71], v[120:123]
    ds_read_b128 v[44:47], v10 offset:12288
    v_mfma_f32_16x16x32_bf16 v[124:127], v[88:91], v[72:75], v[124:127]
    ds_read_b64_tr_b16 v[48:49], v11 offset:0
    v_mfma_f32_16x16x32_bf16 v[128:131], v[88:91], v[76:79], v[128:131]
    ds_read_b64_tr_b16 v[50:51], v11 offset:640
    v_mfma_f32_16x16x32_bf16 v[132:135], v[88:91], v[80:83], v[132:135]
    ds_read_b64_tr_b16 v[52:53], v11 offset:32
    v_mfma_f32_16x16x32_bf16 v[136:139], v[92:95], v[68:71], v[136:139]
    ds_read_b64_tr_b16 v[54:55], v11 offset:672
    v_mfma_f32_16x16x32_bf16 v[140:143], v[92:95], v[72:75], v[140:143]
    ds_read_b64_tr_b16 v[56:57], v11 offset:64
    v_mfma_f32_16x16x32_bf16 v[144:147], v[92:95], v[76:79], v[144:147]
    ds_read_b64_tr_b16 v[58:59], v11 offset:704
    v_mfma_f32_16x16x32_bf16 v[148:151], v[92:95], v[80:83], v[148:151]
    ds_read_b64_tr_b16 v[60:61], v11 offset:96
    v_mfma_f32_16x16x32_bf16 v[152:155], v[96:99], v[68:71], v[152:155]
    ds_read_b64_tr_b16 v[62:63], v11 offset:736
    v_mfma_f32_16x16x32_bf16 v[156:159], v[96:99], v[72:75], v[156:159]
    ds_read_b64_tr_b16 v[64:65], v11 offset:128
    v_mfma_f32_16x16x32_bf16 v[160:163], v[96:99], v[76:79], v[160:163]
    ds_read_b64_tr_b16 v[66:67], v11 offset:768
    v_mfma_f32_16x16x32_bf16 v[164:167], v[96:99], v[80:83], v[164:167]
    v_mfma_f32_16x16x32_bf16 v[168:171], v[100:103], v[68:71], v[168:171]
    v_mfma_f32_16x16x32_bf16 v[172:175], v[100:103], v[72:75], v[172:175]
    v_mfma_f32_16x16x32_bf16 v[176:179], v[100:103], v[76:79], v[176:179]
    v_mfma_f32_16x16x32_bf16 v[180:183], v[100:103], v[80:83], v[180:183]
    s_waitcnt lgkmcnt(0)
    v_mfma_f32_16x16x32_bf16 v[104:107], v[48:51], v[32:35], v[104:107]
    s_barrier
    v_add_u32 v10, 0x4000, v10
    v_add_u32 v11, 0x6000, v11
    v_mfma_f32_16x16x32_bf16 v[108:111], v[48:51], v[36:39], v[108:111]
    ds_read_b128 v[68:71], v10 offset:0
    v_mfma_f32_16x16x32_bf16 v[112:115], v[48:51], v[40:43], v[112:115]
    ds_read_b128 v[72:75], v10 offset:4096
    v_mfma_f32_16x16x32_bf16 v[116:119], v[48:51], v[44:47], v[116:119]
    ds_read_b128 v[76:79], v10 offset:8192
    v_mfma_f32_16x16x32_bf16 v[120:123], v[52:55], v[32:35], v[120:123]
    ds_read_b128 v[80:83], v10 offset:12288
    v_mfma_f32_16x16x32_bf16 v[124:127], v[52:55], v[36:39], v[124:127]
    ds_read_b64_tr_b16 v[84:85], v11 offset:0
    v_mfma_f32_16x16x32_bf16 v[128:131], v[52:55], v[40:43], v[128:131]
    ds_read_b64_tr_b16 v[86:87], v11 offset:640
    v_mfma_f32_16x16x32_bf16 v[132:135], v[52:55], v[44:47], v[132:135]
    ds_read_b64_tr_b16 v[88:89], v11 offset:32
    v_mfma_f32_16x16x32_bf16 v[136:139], v[56:59], v[32:35], v[136:139]
    ds_read_b64_tr_b16 v[90:91], v11 offset:672
    v_mfma_f32_16x16x32_bf16 v[140:143], v[56:59], v[36:39], v[140:143]
    ds_read_b64_tr_b16 v[92:93], v11 offset:64
    v_mfma_f32_16x16x32_bf16 v[144:147], v[56:59], v[40:43], v[144:147]
    ds_read_b64_tr_b16 v[94:95], v11 offset:704
    v_mfma_f32_16x16x32_bf16 v[148:151], v[56:59], v[44:47], v[148:151]
    ds_read_b64_tr_b16 v[96:97], v11 offset:96
    v_mfma_f32_16x16x32_bf16 v[152:155], v[60:63], v[32:35], v[152:155]
    ds_read_b64_tr_b16 v[98:99], v11 offset:736
    v_mfma_f32_16x16x32_bf16 v[156:159], v[60:63], v[36:39], v[156:159]
    ds_read_b64_tr_b16 v[100:101], v11 offset:128
    v_mfma_f32_16x16x32_bf16 v[160:163], v[60:63], v[40:43], v[160:163]
    ds_read_b64_tr_b16 v[102:103], v11 offset:768
    v_mfma_f32_16x16x32_bf16 v[164:167], v[60:63], v[44:47], v[164:167]
    v_mfma_f32_16x16x32_bf16 v[168:171], v[64:67], v[32:35], v[168:171]
    v_mfma_f32_16x16x32_bf16 v[172:175], v[64:67], v[36:39], v[172:175]
    v_mfma_f32_16x16x32_bf16 v[176:179], v[64:67], v[40:43], v[176:179]
    v_mfma_f32_16x16x32_bf16 v[180:183], v[64:67], v[44:47], v[180:183]
    s_waitcnt lgkmcnt(0)
    v_mfma_f32_16x16x32_bf16 v[104:107], v[84:87], v[68:71], v[104:107]
    v_mfma_f32_16x16x32_bf16 v[108:111], v[84:87], v[72:75], v[108:111]
    v_mfma_f32_16x16x32_bf16 v[112:115], v[84:87], v[76:79], v[112:115]
    v_mfma_f32_16x16x32_bf16 v[116:119], v[84:87], v[80:83], v[116:119]
    v_mfma_f32_16x16x32_bf16 v[120:123], v[88:91], v[68:71], v[120:123]
    v_mfma_f32_16x16x32_bf16 v[124:127], v[88:91], v[72:75], v[124:127]
    v_mfma_f32_16x16x32_bf16 v[128:131], v[88:91], v[76:79], v[128:131]
    v_mfma_f32_16x16x32_bf16 v[132:135], v[88:91], v[80:83], v[132:135]
    v_mfma_f32_16x16x32_bf16 v[136:139], v[92:95], v[68:71], v[136:139]
    v_mfma_f32_16x16x32_bf16 v[140:143], v[92:95], v[72:75], v[140:143]
    v_mfma_f32_16x16x32_bf16 v[144:147], v[92:95], v[76:79], v[144:147]
    v_mfma_f32_16x16x32_bf16 v[148:151], v[92:95], v[80:83], v[148:151]
    v_mfma_f32_16x16x32_bf16 v[152:155], v[96:99], v[68:71], v[152:155]
    v_mfma_f32_16x16x32_bf16 v[156:159], v[96:99], v[72:75], v[156:159]
    v_mfma_f32_16x16x32_bf16 v[160:163], v[96:99], v[76:79], v[160:163]
    v_mfma_f32_16x16x32_bf16 v[164:167], v[96:99], v[80:83], v[164:167]
    v_mfma_f32_16x16x32_bf16 v[168:171], v[100:103], v[68:71], v[168:171]
    v_mfma_f32_16x16x32_bf16 v[172:175], v[100:103], v[72:75], v[172:175]
    v_mfma_f32_16x16x32_bf16 v[176:179], v[100:103], v[76:79], v[176:179]
    v_mfma_f32_16x16x32_bf16 v[180:183], v[100:103], v[80:83], v[180:183]
    s_barrier
    v_lshlrev_b32 v25, 4, v1
    s_mul_i32 s32, s29, 15360
    v_add_u32 v27, s32, v25
    s_nop 7
    s_cmp_eq_u32 s29, 0
    s_cbranch_scc1 rw_mega_kernel_85
    s_sub_u32 s32, s29, 1
    s_and_b32 s32, s32, 3
    s_mul_i32 s32, s32, 5120
    s_add_u32 s32, s32, 0
    v_add_u32 v26, s32, v25
    ds_write_b128 v26, v[104:107] offset:0
    ds_write_b128 v26, v[120:123] offset:1024
    ds_write_b128 v26, v[136:139] offset:2048
    ds_write_b128 v26, v[152:155] offset:3072
    ds_write_b128 v26, v[168:171] offset:4096
rw_mega_kernel_85:
    s_cmp_eq_u32 s29, 1
    s_cbranch_scc1 rw_mega_kernel_86
    s_sub_u32 s32, s29, 2
    s_and_b32 s32, s32, 3
    s_mul_i32 s32, s32, 5120
    s_add_u32 s32, s32, 15360
    v_add_u32 v26, s32, v25
    ds_write_b128 v26, v[108:111] offset:0
    ds_write_b128 v26, v[124:127] offset:1024
    ds_write_b128 v26, v[140:143] offset:2048
    ds_write_b128 v26, v[156:159] offset:3072
    ds_write_b128 v26, v[172:175] offset:4096
rw_mega_kernel_86:
    s_cmp_eq_u32 s29, 2
    s_cbranch_scc1 rw_mega_kernel_87
    s_sub_u32 s32, s29, 3
    s_and_b32 s32, s32, 3
    s_mul_i32 s32, s32, 5120
    s_add_u32 s32, s32, 30720
    v_add_u32 v26, s32, v25
    ds_write_b128 v26, v[112:115] offset:0
    ds_write_b128 v26, v[128:131] offset:1024
    ds_write_b128 v26, v[144:147] offset:2048
    ds_write_b128 v26, v[160:163] offset:3072
    ds_write_b128 v26, v[176:179] offset:4096
rw_mega_kernel_87:
    s_cmp_eq_u32 s29, 3
    s_cbranch_scc1 rw_mega_kernel_88
    s_sub_u32 s32, s29, 4
    s_and_b32 s32, s32, 3
    s_mul_i32 s32, s32, 5120
    s_add_u32 s32, s32, 46080
    v_add_u32 v26, s32, v25
    ds_write_b128 v26, v[116:119] offset:0
    ds_write_b128 v26, v[132:135] offset:1024
    ds_write_b128 v26, v[148:151] offset:2048
    ds_write_b128 v26, v[164:167] offset:3072
    ds_write_b128 v26, v[180:183] offset:4096
rw_mega_kernel_88:
    s_waitcnt lgkmcnt(0)
    s_barrier
    s_cmp_eq_u32 s29, 0
    s_cbranch_scc1 own_mega_kernel_90
    s_cmp_eq_u32 s29, 1
    s_cbranch_scc1 own_mega_kernel_91
    s_cmp_eq_u32 s29, 2
    s_cbranch_scc1 own_mega_kernel_92
    s_cmp_eq_u32 s29, 3
    s_cbranch_scc1 own_mega_kernel_93
own_mega_kernel_90:
    v_mov_b32 v32, v104
    v_mov_b32 v33, v105
    v_mov_b32 v34, v106
    v_mov_b32 v35, v107
    v_mov_b32 v36, v120
    v_mov_b32 v37, v121
    v_mov_b32 v38, v122
    v_mov_b32 v39, v123
    v_mov_b32 v40, v136
    v_mov_b32 v41, v137
    v_mov_b32 v42, v138
    v_mov_b32 v43, v139
    v_mov_b32 v44, v152
    v_mov_b32 v45, v153
    v_mov_b32 v46, v154
    v_mov_b32 v47, v155
    v_mov_b32 v48, v168
    v_mov_b32 v49, v169
    v_mov_b32 v50, v170
    v_mov_b32 v51, v171
    s_branch e_mega_kernel_89
own_mega_kernel_91:
    v_mov_b32 v32, v108
    v_mov_b32 v33, v109
    v_mov_b32 v34, v110
    v_mov_b32 v35, v111
    v_mov_b32 v36, v124
    v_mov_b32 v37, v125
    v_mov_b32 v38, v126
    v_mov_b32 v39, v127
    v_mov_b32 v40, v140
    v_mov_b32 v41, v141
    v_mov_b32 v42, v142
    v_mov_b32 v43, v143
    v_mov_b32 v44, v156
    v_mov_b32 v45, v157
    v_mov_b32 v46, v158
    v_mov_b32 v47, v159
    v_mov_b32 v48, v172
    v_mov_b32 v49, v173
    v_mov_b32 v50, v174
    v_mov_b32 v51, v175
    s_branch e_mega_kernel_89
own_mega_kernel_92:
    v_mov_b32 v32, v112
    v_mov_b32 v33, v113
    v_mov_b32 v34, v114
    v_mov_b32 v35, v115
    v_mov_b32 v36, v128
    v_mov_b32 v37, v129
    v_mov_b32 v38, v130
    v_mov_b32 v39, v131
    v_mov_b32 v40, v144
    v_mov_b32 v41, v145
    v_mov_b32 v42, v146
    v_mov_b32 v43, v147
    v_mov_b32 v44, v160
    v_mov_b32 v45, v161
    v_mov_b32 v46, v162
    v_mov_b32 v47, v163
    v_mov_b32 v48, v176
    v_mov_b32 v49, v177
    v_mov_b32 v50, v178
    v_mov_b32 v51, v179
    s_branch e_mega_kernel_89
own_mega_kernel_93:
    v_mov_b32 v32, v116
    v_mov_b32 v33, v117
    v_mov_b32 v34, v118
    v_mov_b32 v35, v119
    v_mov_b32 v36, v132
    v_mov_b32 v37, v133
    v_mov_b32 v38, v134
    v_mov_b32 v39, v135
    v_mov_b32 v40, v148
    v_mov_b32 v41, v149
    v_mov_b32 v42, v150
    v_mov_b32 v43, v151
    v_mov_b32 v44, v164
    v_mov_b32 v45, v165
    v_mov_b32 v46, v166
    v_mov_b32 v47, v167
    v_mov_b32 v48, v180
    v_mov_b32 v49, v181
    v_mov_b32 v50, v182
    v_mov_b32 v51, v183
    s_branch e_mega_kernel_89
e_mega_kernel_89:
    ds_read_b128 v[104:107], v27 offset:0
    ds_read_b128 v[108:111], v27 offset:1024
    ds_read_b128 v[112:115], v27 offset:2048
    ds_read_b128 v[116:119], v27 offset:3072
    ds_read_b128 v[120:123], v27 offset:4096
    ds_read_b128 v[124:127], v27 offset:5120
    ds_read_b128 v[128:131], v27 offset:6144
    ds_read_b128 v[132:135], v27 offset:7168
    ds_read_b128 v[136:139], v27 offset:8192
    ds_read_b128 v[140:143], v27 offset:9216
    ds_read_b128 v[144:147], v27 offset:10240
    ds_read_b128 v[148:151], v27 offset:11264
    ds_read_b128 v[152:155], v27 offset:12288
    ds_read_b128 v[156:159], v27 offset:13312
    ds_read_b128 v[160:163], v27 offset:14336
    s_waitcnt lgkmcnt(0) vmcnt(0)
    v_pk_add_f32 v[32:33], v[32:33], v[104:105]
    v_pk_add_f32 v[34:35], v[34:35], v[106:107]
    v_pk_add_f32 v[36:37], v[36:37], v[108:109]
    v_pk_add_f32 v[38:39], v[38:39], v[110:111]
    v_pk_add_f32 v[40:41], v[40:41], v[112:113]
    v_pk_add_f32 v[42:43], v[42:43], v[114:115]
    v_pk_add_f32 v[44:45], v[44:45], v[116:117]
    v_pk_add_f32 v[46:47], v[46:47], v[118:119]
    v_pk_add_f32 v[48:49], v[48:49], v[120:121]
    v_pk_add_f32 v[50:51], v[50:51], v[122:123]
    v_pk_add_f32 v[32:33], v[32:33], v[124:125]
    v_pk_add_f32 v[34:35], v[34:35], v[126:127]
    v_pk_add_f32 v[36:37], v[36:37], v[128:129]
    v_pk_add_f32 v[38:39], v[38:39], v[130:131]
    v_pk_add_f32 v[40:41], v[40:41], v[132:133]
    v_pk_add_f32 v[42:43], v[42:43], v[134:135]
    v_pk_add_f32 v[44:45], v[44:45], v[136:137]
    v_pk_add_f32 v[46:47], v[46:47], v[138:139]
    v_pk_add_f32 v[48:49], v[48:49], v[140:141]
    v_pk_add_f32 v[50:51], v[50:51], v[142:143]
    v_pk_add_f32 v[32:33], v[32:33], v[144:145]
    v_pk_add_f32 v[34:35], v[34:35], v[146:147]
    v_pk_add_f32 v[36:37], v[36:37], v[148:149]
    v_pk_add_f32 v[38:39], v[38:39], v[150:151]
    v_pk_add_f32 v[40:41], v[40:41], v[152:153]
    v_pk_add_f32 v[42:43], v[42:43], v[154:155]
    v_pk_add_f32 v[44:45], v[44:45], v[156:157]
    v_pk_add_f32 v[46:47], v[46:47], v[158:159]
    v_pk_add_f32 v[48:49], v[48:49], v[160:161]
    v_pk_add_f32 v[50:51], v[50:51], v[162:163]
    v_cvt_pk_bf16_f32 v20, v32, v33
    v_lshlrev_b32 v32, 16, v20
    v_and_b32 v33, 0xffff0000, v20
    v_lshlrev_b32 v21, 16, v184
    v_and_b32 v22, 0xffff0000, v184
    v_add_f32 v32, v32, v21
    v_add_f32 v33, v33, v22
    v_cvt_pk_bf16_f32 v184, v32, v33
    v_lshlrev_b32 v32, 16, v184
    v_and_b32 v33, 0xffff0000, v184
    v_cvt_pk_bf16_f32 v20, v34, v35
    v_lshlrev_b32 v34, 16, v20
    v_and_b32 v35, 0xffff0000, v20
    v_lshlrev_b32 v21, 16, v185
    v_and_b32 v22, 0xffff0000, v185
    v_add_f32 v34, v34, v21
    v_add_f32 v35, v35, v22
    v_cvt_pk_bf16_f32 v185, v34, v35
    v_lshlrev_b32 v34, 16, v185
    v_and_b32 v35, 0xffff0000, v185
    ds_write_b64 v30, v[184:185] offset:0
    v_cvt_pk_bf16_f32 v20, v36, v37
    v_lshlrev_b32 v36, 16, v20
    v_and_b32 v37, 0xffff0000, v20
    v_lshlrev_b32 v21, 16, v186
    v_and_b32 v22, 0xffff0000, v186
    v_add_f32 v36, v36, v21
    v_add_f32 v37, v37, v22
    v_cvt_pk_bf16_f32 v186, v36, v37
    v_lshlrev_b32 v36, 16, v186
    v_and_b32 v37, 0xffff0000, v186
    v_cvt_pk_bf16_f32 v20, v38, v39
    v_lshlrev_b32 v38, 16, v20
    v_and_b32 v39, 0xffff0000, v20
    v_lshlrev_b32 v21, 16, v187
    v_and_b32 v22, 0xffff0000, v187
    v_add_f32 v38, v38, v21
    v_add_f32 v39, v39, v22
    v_cvt_pk_bf16_f32 v187, v38, v39
    v_lshlrev_b32 v38, 16, v187
    v_and_b32 v39, 0xffff0000, v187
    ds_write_b64 v30, v[186:187] offset:32
    v_cvt_pk_bf16_f32 v20, v40, v41
    v_lshlrev_b32 v40, 16, v20
    v_and_b32 v41, 0xffff0000, v20
    v_lshlrev_b32 v21, 16, v188
    v_and_b32 v22, 0xffff0000, v188
    v_add_f32 v40, v40, v21
    v_add_f32 v41, v41, v22
    v_cvt_pk_bf16_f32 v188, v40, v41
    v_lshlrev_b32 v40, 16, v188
    v_and_b32 v41, 0xffff0000, v188
    v_cvt_pk_bf16_f32 v20, v42, v43
    v_lshlrev_b32 v42, 16, v20
    v_and_b32 v43, 0xffff0000, v20
    v_lshlrev_b32 v21, 16, v189
    v_and_b32 v22, 0xffff0000, v189
    v_add_f32 v42, v42, v21
    v_add_f32 v43, v43, v22
    v_cvt_pk_bf16_f32 v189, v42, v43
    v_lshlrev_b32 v42, 16, v189
    v_and_b32 v43, 0xffff0000, v189
    ds_write_b64 v30, v[188:189] offset:64
    v_cvt_pk_bf16_f32 v20, v44, v45
    v_lshlrev_b32 v44, 16, v20
    v_and_b32 v45, 0xffff0000, v20
    v_lshlrev_b32 v21, 16, v190
    v_and_b32 v22, 0xffff0000, v190
    v_add_f32 v44, v44, v21
    v_add_f32 v45, v45, v22
    v_cvt_pk_bf16_f32 v190, v44, v45
    v_lshlrev_b32 v44, 16, v190
    v_and_b32 v45, 0xffff0000, v190
    v_cvt_pk_bf16_f32 v20, v46, v47
    v_lshlrev_b32 v46, 16, v20
    v_and_b32 v47, 0xffff0000, v20
    v_lshlrev_b32 v21, 16, v191
    v_and_b32 v22, 0xffff0000, v191
    v_add_f32 v46, v46, v21
    v_add_f32 v47, v47, v22
    v_cvt_pk_bf16_f32 v191, v46, v47
    v_lshlrev_b32 v46, 16, v191
    v_and_b32 v47, 0xffff0000, v191
    ds_write_b64 v30, v[190:191] offset:96
    v_cvt_pk_bf16_f32 v20, v48, v49
    v_lshlrev_b32 v48, 16, v20
    v_and_b32 v49, 0xffff0000, v20
    v_lshlrev_b32 v21, 16, v192
    v_and_b32 v22, 0xffff0000, v192
    v_add_f32 v48, v48, v21
    v_add_f32 v49, v49, v22
    v_cvt_pk_bf16_f32 v192, v48, v49
    v_lshlrev_b32 v48, 16, v192
    v_and_b32 v49, 0xffff0000, v192
    v_cvt_pk_bf16_f32 v20, v50, v51
    v_lshlrev_b32 v50, 16, v20
    v_and_b32 v51, 0xffff0000, v20
    v_lshlrev_b32 v21, 16, v193
    v_and_b32 v22, 0xffff0000, v193
    v_add_f32 v50, v50, v21
    v_add_f32 v51, v51, v22
    v_cvt_pk_bf16_f32 v193, v50, v51
    v_lshlrev_b32 v50, 16, v193
    v_and_b32 v51, 0xffff0000, v193
    ds_write_b64 v30, v[192:193] offset:128
    s_waitcnt lgkmcnt(0)
    ds_read_b128 v[104:107], v31 offset:0
    ds_read_b128 v[108:111], v31 offset:1024
    ds_read_b128 v[112:115], v31 offset:2048
    v_cmp_gt_u32 vcc, 32, v1
    s_waitcnt lgkmcnt(2)
    buffer_store_dwordx4 v[104:107], v12, s[16:19], 0 offen
    s_waitcnt lgkmcnt(1)
    buffer_store_dwordx4 v[108:111], v13, s[16:19], 0 offen
    s_and_saveexec_b64 s[36:37], vcc
    s_waitcnt lgkmcnt(0)
    buffer_store_dwordx4 v[112:115], v14, s[16:19], 0 offen
    s_mov_b64 exec, s[36:37]
    v_add_f32 v20, v32, v33
    v_add_f32 v20, v20, v34
    v_add_f32 v20, v20, v35
    v_add_f32 v20, v20, v36
    v_add_f32 v20, v20, v37
    v_add_f32 v20, v20, v38
    v_add_f32 v20, v20, v39
    v_add_f32 v20, v20, v40
    v_add_f32 v20, v20, v41
    v_add_f32 v20, v20, v42
    v_add_f32 v20, v20, v43
    v_add_f32 v20, v20, v44
    v_add_f32 v20, v20, v45
    v_add_f32 v20, v20, v46
    v_add_f32 v20, v20, v47
    v_add_f32 v20, v20, v48
    v_add_f32 v20, v20, v49
    v_add_f32 v20, v20, v50
    v_add_f32 v20, v20, v51
    v_mov_b32 v22, v20
    s_nop 1
    v_permlane16_swap_b32 v20, v22
    v_add_f32 v20, v20, v22
    v_mov_b32 v22, v20
    s_nop 1
    v_permlane32_swap_b32 v20, v22
    v_add_f32 v20, v20, v22
    v_mul_f32 v23, 0x3c4ccccd, v20
    v_mov_b32 v21, 0
    v_sub_f32 v22, v32, v23
    v_fmac_f32 v21, v22, v22
    v_sub_f32 v22, v33, v23
    v_fmac_f32 v21, v22, v22
    v_sub_f32 v22, v34, v23
    v_fmac_f32 v21, v22, v22
    v_sub_f32 v22, v35, v23
    v_fmac_f32 v21, v22, v22
    v_sub_f32 v22, v36, v23
    v_fmac_f32 v21, v22, v22
    v_sub_f32 v22, v37, v23
    v_fmac_f32 v21, v22, v22
    v_sub_f32 v22, v38, v23
    v_fmac_f32 v21, v22, v22
    v_sub_f32 v22, v39, v23
    v_fmac_f32 v21, v22, v22
    v_sub_f32 v22, v40, v23
    v_fmac_f32 v21, v22, v22
    v_sub_f32 v22, v41, v23
    v_fmac_f32 v21, v22, v22
    v_sub_f32 v22, v42, v23
    v_fmac_f32 v21, v22, v22
    v_sub_f32 v22, v43, v23
    v_fmac_f32 v21, v22, v22
    v_sub_f32 v22, v44, v23
    v_fmac_f32 v21, v22, v22
    v_sub_f32 v22, v45, v23
    v_fmac_f32 v21, v22, v22
    v_sub_f32 v22, v46, v23
    v_fmac_f32 v21, v22, v22
    v_sub_f32 v22, v47, v23
    v_fmac_f32 v21, v22, v22
    v_sub_f32 v22, v48, v23
    v_fmac_f32 v21, v22, v22
    v_sub_f32 v22, v49, v23
    v_fmac_f32 v21, v22, v22
    v_sub_f32 v22, v50, v23
    v_fmac_f32 v21, v22, v22
    v_sub_f32 v22, v51, v23
    v_fmac_f32 v21, v22, v22
    v_mov_b32 v22, v21
    s_nop 1
    v_permlane16_swap_b32 v21, v22
    v_add_f32 v21, v21, v22
    v_mov_b32 v22, v21
    s_nop 1
    v_permlane32_swap_b32 v21, v22
    v_add_f32 v21, v21, v22
    v_lshlrev_b32 v28, 6, v28
    s_lshl_b32 s32, s27, 3
    v_add_u32 v28, s32, v28
    v_cmp_gt_u32 vcc, 16, v1
    s_and_saveexec_b64 s[36:37], vcc
    buffer_store_dwordx2 v[20:21], v28, s[20:23], 0 offen
    s_mov_b64 exec, s[36:37]
    s_waitcnt vmcnt(0)
    s_barrier
    s_lshr_b32 s32, s26, 1
    s_add_u32 s32, s32, 584
    s_and_b32 s33, s26, 1
    s_lshl_b32 s33, s33, 3
    s_add_u32 s33, s33, s27
    s_cmp_lg_u32 s29, 0
    s_cbranch_scc1 nosig_mega_kernel_94
    s_lshl_b32 s38, s32, 7
    s_lshl_b32 s39, s33, 2
    s_add_u32 s38, s38, s39
    v_mov_b32 v24, s38
    v_mov_b32 v23, 1
    v_cmp_eq_u32 vcc, 0, v1
    s_and_saveexec_b64 s[36:37], vcc
    s_cbranch_execz nosig2_mega_kernel_95
    buffer_store_dword v23, v24, s[92:95], 0 offen
nosig2_mega_kernel_95:
    s_mov_b64 exec, s[36:37]
nosig_mega_kernel_94:
    s_branch end_mega_kernel_82
loader_mega_kernel_81:
    s_lshl_b32 s32, s26, 6
    s_lshl_b32 s33, s28, 4
    s_add_u32 s32, s32, s33
    v_lshrrev_b32 v25, 4, v1
    v_and_b32 v26, 15, v1
    s_mov_b32 s33, 1536
    v_add_u32 v27, 0, v25
    v_xor_b32 v12, v26, v27
    v_add_u32 v27, s32, v27
    v_mul_u32_u24 v16, 48, v27
    v_add_u32 v27, 4, v25
    v_xor_b32 v13, v26, v27
    v_add_u32 v27, s32, v27
    v_mul_u32_u24 v17, 48, v27
    v_add_u32 v27, 8, v25
    v_xor_b32 v14, v26, v27
    v_add_u32 v27, s32, v27
    v_mul_u32_u24 v18, 48, v27
    v_add_u32 v27, 12, v25
    v_xor_b32 v15, v26, v27
    v_add_u32 v27, s32, v27
    v_mul_u32_u24 v19, 48, v27
    s_mov_b32 s39, 98304
    s_lshl_b32 s34, s28, 12
    s_add_u32 s76, s84, 0x2119000
    s_addc_u32 s77, s85, 0
    s_mov_b32 s78, 983040
    s_and_b32 s77, s77, 0xffff
    s_mov_b32 s79, 0x00020000
    s_lshr_b32 s82, s2, 5
    s_mul_i32 s82, s82, 122880
    s_mul_i32 s80, s28, 5120
    s_add_u32 s82, s82, s80
    v_lshlrev_b32 v8, 4, v1
    v_add_u32 v8, s82, v8
    v_add_u32 v9, 4096, v8
    s_barrier
    s_add_u32 m0, s34, 0
    v_add_u32 v25, 0, v12
    v_mul_u32_u24 v26, 171, v25
    v_lshrrev_b32 v26, 9, v26
    v_mul_u32_u24 v27, 3, v26
    v_sub_u32 v27, v25, v27
    v_mul_lo_u32 v26, v26, s39
    v_lshl_add_u32 v26, v27, 4, v26
    v_add_u32 v2, v26, v16
    buffer_load_dwordx4 v2, s[4:7], 0 offen sc1 lds
    s_add_u32 m0, s34, 1024
    v_add_u32 v25, 0, v13
    v_mul_u32_u24 v26, 171, v25
    v_lshrrev_b32 v26, 9, v26
    v_mul_u32_u24 v27, 3, v26
    v_sub_u32 v27, v25, v27
    v_mul_lo_u32 v26, v26, s39
    v_lshl_add_u32 v26, v27, 4, v26
    v_add_u32 v3, v26, v17
    buffer_load_dwordx4 v3, s[4:7], 0 offen sc1 lds
    s_add_u32 m0, s34, 2048
    v_add_u32 v25, 0, v14
    v_mul_u32_u24 v26, 171, v25
    v_lshrrev_b32 v26, 9, v26
    v_mul_u32_u24 v27, 3, v26
    v_sub_u32 v27, v25, v27
    v_mul_lo_u32 v26, v26, s39
    v_lshl_add_u32 v26, v27, 4, v26
    v_add_u32 v4, v26, v18
    buffer_load_dwordx4 v4, s[4:7], 0 offen sc1 lds
    s_add_u32 m0, s34, 3072
    v_add_u32 v25, 0, v15
    v_mul_u32_u24 v26, 171, v25
    v_lshrrev_b32 v26, 9, v26
    v_mul_u32_u24 v27, 3, v26
    v_sub_u32 v27, v25, v27
    v_mul_lo_u32 v26, v26, s39
    v_lshl_add_u32 v26, v27, 4, v26
    v_add_u32 v5, v26, v19
    buffer_load_dwordx4 v5, s[4:7], 0 offen sc1 lds
    s_add_u32 m0, s34, 16384
    v_add_u32 v25, 16, v12
    v_mul_u32_u24 v26, 171, v25
    v_lshrrev_b32 v26, 9, v26
    v_mul_u32_u24 v27, 3, v26
    v_sub_u32 v27, v25, v27
    v_mul_lo_u32 v26, v26, s39
    v_lshl_add_u32 v26, v27, 4, v26
    v_add_u32 v2, v26, v16
    buffer_load_dwordx4 v2, s[4:7], 0 offen sc1 lds
    s_add_u32 m0, s34, 17408
    v_add_u32 v25, 16, v13
    v_mul_u32_u24 v26, 171, v25
    v_lshrrev_b32 v26, 9, v26
    v_mul_u32_u24 v27, 3, v26
    v_sub_u32 v27, v25, v27
    v_mul_lo_u32 v26, v26, s39
    v_lshl_add_u32 v26, v27, 4, v26
    v_add_u32 v3, v26, v17
    buffer_load_dwordx4 v3, s[4:7], 0 offen sc1 lds
    s_add_u32 m0, s34, 18432
    v_add_u32 v25, 16, v14
    v_mul_u32_u24 v26, 171, v25
    v_lshrrev_b32 v26, 9, v26
    v_mul_u32_u24 v27, 3, v26
    v_sub_u32 v27, v25, v27
    v_mul_lo_u32 v26, v26, s39
    v_lshl_add_u32 v26, v27, 4, v26
    v_add_u32 v4, v26, v18
    buffer_load_dwordx4 v4, s[4:7], 0 offen sc1 lds
    s_add_u32 m0, s34, 19456
    v_add_u32 v25, 16, v15
    v_mul_u32_u24 v26, 171, v25
    v_lshrrev_b32 v26, 9, v26
    v_mul_u32_u24 v27, 3, v26
    v_sub_u32 v27, v25, v27
    v_mul_lo_u32 v26, v26, s39
    v_lshl_add_u32 v26, v27, 4, v26
    v_add_u32 v5, v26, v19
    buffer_load_dwordx4 v5, s[4:7], 0 offen sc1 lds
    s_waitcnt vmcnt(4)
    s_barrier
    s_add_u32 m0, s34, 32768
    v_add_u32 v25, 32, v12
    v_mul_u32_u24 v26, 171, v25
    v_lshrrev_b32 v26, 9, v26
    v_mul_u32_u24 v27, 3, v26
    v_sub_u32 v27, v25, v27
    v_mul_lo_u32 v26, v26, s39
    v_lshl_add_u32 v26, v27, 4, v26
    v_add_u32 v2, v26, v16
    buffer_load_dwordx4 v2, s[4:7], 0 offen sc1 lds
    s_add_u32 m0, s34, 33792
    v_add_u32 v25, 32, v13
    v_mul_u32_u24 v26, 171, v25
    v_lshrrev_b32 v26, 9, v26
    v_mul_u32_u24 v27, 3, v26
    v_sub_u32 v27, v25, v27
    v_mul_lo_u32 v26, v26, s39
    v_lshl_add_u32 v26, v27, 4, v26
    v_add_u32 v3, v26, v17
    buffer_load_dwordx4 v3, s[4:7], 0 offen sc1 lds
    s_add_u32 m0, s34, 34816
    v_add_u32 v25, 32, v14
    v_mul_u32_u24 v26, 171, v25
    v_lshrrev_b32 v26, 9, v26
    v_mul_u32_u24 v27, 3, v26
    v_sub_u32 v27, v25, v27
    v_mul_lo_u32 v26, v26, s39
    v_lshl_add_u32 v26, v27, 4, v26
    v_add_u32 v4, v26, v18
    buffer_load_dwordx4 v4, s[4:7], 0 offen sc1 lds
    s_add_u32 m0, s34, 35840
    v_add_u32 v25, 32, v15
    v_mul_u32_u24 v26, 171, v25
    v_lshrrev_b32 v26, 9, v26
    v_mul_u32_u24 v27, 3, v26
    v_sub_u32 v27, v25, v27
    v_mul_lo_u32 v26, v26, s39
    v_lshl_add_u32 v26, v27, 4, v26
    v_add_u32 v5, v26, v19
    buffer_load_dwordx4 v5, s[4:7], 0 offen sc1 lds
    s_add_u32 m0, s34, 49152
    v_add_u32 v25, 48, v12
    v_mul_u32_u24 v26, 171, v25
    v_lshrrev_b32 v26, 9, v26
    v_mul_u32_u24 v27, 3, v26
    v_sub_u32 v27, v25, v27
    v_mul_lo_u32 v26, v26, s39
    v_lshl_add_u32 v26, v27, 4, v26
    v_add_u32 v2, v26, v16
    buffer_load_dwordx4 v2, s[4:7], 0 offen sc1 lds
    s_add_u32 m0, s34, 50176
    v_add_u32 v25, 48, v13
    v_mul_u32_u24 v26, 171, v25
    v_lshrrev_b32 v26, 9, v26
    v_mul_u32_u24 v27, 3, v26
    v_sub_u32 v27, v25, v27
    v_mul_lo_u32 v26, v26, s39
    v_lshl_add_u32 v26, v27, 4, v26
    v_add_u32 v3, v26, v17
    buffer_load_dwordx4 v3, s[4:7], 0 offen sc1 lds
    s_add_u32 m0, s34, 51200
    v_add_u32 v25, 48, v14
    v_mul_u32_u24 v26, 171, v25
    v_lshrrev_b32 v26, 9, v26
    v_mul_u32_u24 v27, 3, v26
    v_sub_u32 v27, v25, v27
    v_mul_lo_u32 v26, v26, s39
    v_lshl_add_u32 v26, v27, 4, v26
    v_add_u32 v4, v26, v18
    buffer_load_dwordx4 v4, s[4:7], 0 offen sc1 lds
    s_add_u32 m0, s34, 52224
    v_add_u32 v25, 48, v15
    v_mul_u32_u24 v26, 171, v25
    v_lshrrev_b32 v26, 9, v26
    v_mul_u32_u24 v27, 3, v26
    v_sub_u32 v27, v25, v27
    v_mul_lo_u32 v26, v26, s39
    v_lshl_add_u32 v26, v27, 4, v26
    v_add_u32 v5, v26, v19
    buffer_load_dwordx4 v5, s[4:7], 0 offen sc1 lds
    s_waitcnt vmcnt(8)
    s_barrier
    s_add_u32 m0, s34, 0
    v_add_u32 v25, 64, v12
    v_mul_u32_u24 v26, 171, v25
    v_lshrrev_b32 v26, 9, v26
    v_mul_u32_u24 v27, 3, v26
    v_sub_u32 v27, v25, v27
    v_mul_lo_u32 v26, v26, s39
    v_lshl_add_u32 v26, v27, 4, v26
    v_add_u32 v2, v26, v16
    buffer_load_dwordx4 v2, s[4:7], 0 offen sc1 lds
    s_add_u32 m0, s34, 1024
    v_add_u32 v25, 64, v13
    v_mul_u32_u24 v26, 171, v25
    v_lshrrev_b32 v26, 9, v26
    v_mul_u32_u24 v27, 3, v26
    v_sub_u32 v27, v25, v27
    v_mul_lo_u32 v26, v26, s39
    v_lshl_add_u32 v26, v27, 4, v26
    v_add_u32 v3, v26, v17
    buffer_load_dwordx4 v3, s[4:7], 0 offen sc1 lds
    s_add_u32 m0, s34, 2048
    v_add_u32 v25, 64, v14
    v_mul_u32_u24 v26, 171, v25
    v_lshrrev_b32 v26, 9, v26
    v_mul_u32_u24 v27, 3, v26
    v_sub_u32 v27, v25, v27
    v_mul_lo_u32 v26, v26, s39
    v_lshl_add_u32 v26, v27, 4, v26
    v_add_u32 v4, v26, v18
    buffer_load_dwordx4 v4, s[4:7], 0 offen sc1 lds
    s_add_u32 m0, s34, 3072
    v_add_u32 v25, 64, v15
    v_mul_u32_u24 v26, 171, v25
    v_lshrrev_b32 v26, 9, v26
    v_mul_u32_u24 v27, 3, v26
    v_sub_u32 v27, v25, v27
    v_mul_lo_u32 v26, v26, s39
    v_lshl_add_u32 v26, v27, 4, v26
    v_add_u32 v5, v26, v19
    buffer_load_dwordx4 v5, s[4:7], 0 offen sc1 lds
    s_add_u32 m0, s80, 65536
    s_mov_b32 s81, 81920
    buffer_load_dwordx4 v8, s[76:79], s81 offen offset:0 sc1 lds
    buffer_load_dwordx4 v8, s[76:79], s81 offen offset:1024 sc1 lds
    buffer_load_dwordx4 v8, s[76:79], s81 offen offset:2048 sc1 lds
    buffer_load_dwordx4 v8, s[76:79], s81 offen offset:3072 sc1 lds
    s_add_u32 m0, s80, 69632
    s_nop 0
    buffer_load_dwordx4 v9, s[76:79], s81 offen offset:0 sc1 lds
    s_waitcnt vmcnt(13)
    s_barrier
    s_add_u32 m0, s34, 16384
    v_add_u32 v25, 80, v12
    v_mul_u32_u24 v26, 171, v25
    v_lshrrev_b32 v26, 9, v26
    v_mul_u32_u24 v27, 3, v26
    v_sub_u32 v27, v25, v27
    v_mul_lo_u32 v26, v26, s39
    v_lshl_add_u32 v26, v27, 4, v26
    v_add_u32 v2, v26, v16
    buffer_load_dwordx4 v2, s[4:7], 0 offen sc1 lds
    s_add_u32 m0, s34, 17408
    v_add_u32 v25, 80, v13
    v_mul_u32_u24 v26, 171, v25
    v_lshrrev_b32 v26, 9, v26
    v_mul_u32_u24 v27, 3, v26
    v_sub_u32 v27, v25, v27
    v_mul_lo_u32 v26, v26, s39
    v_lshl_add_u32 v26, v27, 4, v26
    v_add_u32 v3, v26, v17
    buffer_load_dwordx4 v3, s[4:7], 0 offen sc1 lds
    s_add_u32 m0, s34, 18432
    v_add_u32 v25, 80, v14
    v_mul_u32_u24 v26, 171, v25
    v_lshrrev_b32 v26, 9, v26
    v_mul_u32_u24 v27, 3, v26
    v_sub_u32 v27, v25, v27
    v_mul_lo_u32 v26, v26, s39
    v_lshl_add_u32 v26, v27, 4, v26
    v_add_u32 v4, v26, v18
    buffer_load_dwordx4 v4, s[4:7], 0 offen sc1 lds
    s_add_u32 m0, s34, 19456
    v_add_u32 v25, 80, v15
    v_mul_u32_u24 v26, 171, v25
    v_lshrrev_b32 v26, 9, v26
    v_mul_u32_u24 v27, 3, v26
    v_sub_u32 v27, v25, v27
    v_mul_lo_u32 v26, v26, s39
    v_lshl_add_u32 v26, v27, 4, v26
    v_add_u32 v5, v26, v19
    buffer_load_dwordx4 v5, s[4:7], 0 offen sc1 lds
    s_add_u32 m0, s80, 90112
    s_mov_b32 s81, 102400
    buffer_load_dwordx4 v8, s[76:79], s81 offen offset:0 sc1 lds
    buffer_load_dwordx4 v8, s[76:79], s81 offen offset:1024 sc1 lds
    buffer_load_dwordx4 v8, s[76:79], s81 offen offset:2048 sc1 lds
    buffer_load_dwordx4 v8, s[76:79], s81 offen offset:3072 sc1 lds
    s_add_u32 m0, s80, 94208
    s_nop 0
    buffer_load_dwordx4 v9, s[76:79], s81 offen offset:0 sc1 lds
    s_waitcnt vmcnt(18)
    s_barrier
    s_waitcnt vmcnt(9)
    s_barrier
    s_waitcnt vmcnt(0)
    s_barrier
    s_add_u32 s76, s84, 0x1d59000
    s_addc_u32 s77, s85, 0
    s_mov_b32 s78, 3932160
    s_and_b32 s77, s77, 0xffff
    s_mov_b32 s79, 0x00020000
    s_lshr_b32 s82, s2, 4
    s_mul_i32 s82, s82, 245760
    s_mul_i32 s80, s28, 6144
    s_add_u32 s82, s82, s80
    v_lshlrev_b32 v8, 4, v1
    v_add_u32 v8, s82, v8
    v_add_u32 v9, 4096, v8
    s_add_u32 m0, s80, 114688
    s_mov_b32 s81, 0
    buffer_load_dwordx4 v8, s[76:79], s81 offen offset:0 sc1 lds
    buffer_load_dwordx4 v8, s[76:79], s81 offen offset:1024 sc1 lds
    buffer_load_dwordx4 v8, s[76:79], s81 offen offset:2048 sc1 lds
    buffer_load_dwordx4 v8, s[76:79], s81 offen offset:3072 sc1 lds
    s_add_u32 m0, s80, 118784
    s_nop 0
    buffer_load_dwordx4 v9, s[76:79], s81 offen offset:0 sc1 lds
    buffer_load_dwordx4 v9, s[76:79], s81 offen offset:1024 sc1 lds
    s_add_u32 m0, s80, 139264
    s_mov_b32 s81, 24576
    buffer_load_dwordx4 v8, s[76:79], s81 offen offset:0 sc1 lds
    buffer_load_dwordx4 v8, s[76:79], s81 offen offset:1024 sc1 lds
    buffer_load_dwordx4 v8, s[76:79], s81 offen offset:2048 sc1 lds
    buffer_load_dwordx4 v8, s[76:79], s81 offen offset:3072 sc1 lds
    s_add_u32 m0, s80, 143360
    s_nop 0
    buffer_load_dwordx4 v9, s[76:79], s81 offen offset:0 sc1 lds
    buffer_load_dwordx4 v9, s[76:79], s81 offen offset:1024 sc1 lds
    s_add_u32 m0, s80, 65536
    s_mov_b32 s81, 49152
    buffer_load_dwordx4 v8, s[76:79], s81 offen offset:0 sc1 lds
    buffer_load_dwordx4 v8, s[76:79], s81 offen offset:1024 sc1 lds
    buffer_load_dwordx4 v8, s[76:79], s81 offen offset:2048 sc1 lds
    buffer_load_dwordx4 v8, s[76:79], s81 offen offset:3072 sc1 lds
    s_add_u32 m0, s80, 69632
    s_nop 0
    buffer_load_dwordx4 v9, s[76:79], s81 offen offset:0 sc1 lds
    buffer_load_dwordx4 v9, s[76:79], s81 offen offset:1024 sc1 lds
    s_barrier
    s_add_u32 m0, s80, 90112
    s_mov_b32 s81, 73728
    buffer_load_dwordx4 v8, s[76:79], s81 offen offset:0 sc1 lds
    buffer_load_dwordx4 v8, s[76:79], s81 offen offset:1024 sc1 lds
    buffer_load_dwordx4 v8, s[76:79], s81 offen offset:2048 sc1 lds
    buffer_load_dwordx4 v8, s[76:79], s81 offen offset:3072 sc1 lds
    s_add_u32 m0, s80, 94208
    s_nop 0
    buffer_load_dwordx4 v9, s[76:79], s81 offen offset:0 sc1 lds
    buffer_load_dwordx4 v9, s[76:79], s81 offen offset:1024 sc1 lds
    s_barrier
    s_barrier
end_mega_kernel_82:
    s_and_b32 s24, s2, 7
    s_lshr_b32 s25, s2, 3
    s_lshl_b32 s26, s24, 1
    s_and_b32 s27, s25, 1
    s_add_u32 s26, s26, s27
    s_lshr_b32 s27, s25, 1
    s_add_u32 s4, s84, 0x59000
    s_addc_u32 s5, s85, 0
    s_mov_b32 s6, 2621440
    s_and_b32 s5, s5, 0xffff
    s_mov_b32 s7, 0x00020000
    s_add_u32 s16, s84, 0x5d9000
    s_addc_u32 s17, s85, 0
    s_mov_b32 s18, 6291456
    s_and_b32 s17, s17, 0xffff
    s_mov_b32 s19, 0x00020000
    s_add_u32 s20, s84, 0x39000
    s_addc_u32 s21, s85, 0
    s_mov_b32 s22, 131072
    s_and_b32 s21, s21, 0xffff
    s_mov_b32 s23, 0x00020000
    s_add_u32 s68, s84, 0x14000
    s_addc_u32 s69, s85, 0
    s_mov_b32 s70, 20480
    s_and_b32 s69, s69, 0xffff
    s_mov_b32 s71, 0x00020000
    s_cmp_ge_u32 s29, 4
    s_cbranch_scc1 loader_mega_kernel_96
    v_and_b32 v25, 31, v1
    s_lshl_b32 s32, s26, 7
    s_lshl_b32 s33, s29, 5
    s_add_u32 s32, s32, s33
    v_add_u32 v28, s32, v25
    v_lshlrev_b32 v29, 6, v28
    v_lshrrev_b32 v30, 5, v1
    v_lshlrev_b32 v30, 4, v30
    s_mul_i32 s32, s27, 384
    s_add_u32 s32, s32, 8192
    v_add_u32 v30, s32, v30
    s_lshl_b32 s32, s29, 5
    v_add_u32 v26, s32, v25
    v_lshlrev_b32 v26, 7, v26
    v_lshrrev_b32 v25, 1, v25
    v_and_b32 v25, 7, v25
    v_lshrrev_b32 v27, 5, v1
    v_xor_b32 v25, v25, v27
    v_xor_b32 v27, 0, v25
    v_lshl_add_u32 v10, v27, 4, v26
    v_add_u32 v10, 32768, v10
    v_xor_b32 v27, 2, v25
    v_lshl_add_u32 v11, v27, 4, v26
    v_add_u32 v11, 32768, v11
    v_xor_b32 v27, 4, v25
    v_lshl_add_u32 v12, v27, 4, v26
    v_add_u32 v12, 32768, v12
    v_xor_b32 v27, 6, v25
    v_lshl_add_u32 v13, v27, 4, v26
    v_add_u32 v13, 32768, v13
    v_lshrrev_b32 v25, 5, v1
    v_lshlrev_b32 v25, 3, v25
    v_bfe_u32 v26, v1, 2, 2
    v_add_u32 v25, v25, v26
    v_mul_u32_u24 v25, 192, v25
    v_bfe_u32 v27, v1, 4, 1
    v_lshl_add_u32 v25, v27, 5, v25
    v_and_b32 v27, 3, v1
    v_lshl_add_u32 v25, v27, 3, v25
    v_add_u32 v14, 114688, v25
    v_mov_b32 v88, 0
    v_mov_b32 v89, 0
    v_mov_b32 v90, 0
    v_mov_b32 v91, 0
    v_mov_b32 v92, 0
    v_mov_b32 v93, 0
    v_mov_b32 v94, 0
    v_mov_b32 v95, 0
    v_mov_b32 v96, 0
    v_mov_b32 v97, 0
    v_mov_b32 v98, 0
    v_mov_b32 v99, 0
    v_mov_b32 v100, 0
    v_mov_b32 v101, 0
    v_mov_b32 v102, 0
    v_mov_b32 v103, 0
    v_mov_b32 v104, 0
    v_mov_b32 v105, 0
    v_mov_b32 v106, 0
    v_mov_b32 v107, 0
    v_mov_b32 v108, 0
    v_mov_b32 v109, 0
    v_mov_b32 v110, 0
    v_mov_b32 v111, 0
    v_mov_b32 v112, 0
    v_mov_b32 v113, 0
    v_mov_b32 v114, 0
    v_mov_b32 v115, 0
    v_mov_b32 v116, 0
    v_mov_b32 v117, 0
    v_mov_b32 v118, 0
    v_mov_b32 v119, 0
    v_mov_b32 v120, 0
    v_mov_b32 v121, 0
    v_mov_b32 v122, 0
    v_mov_b32 v123, 0
    v_mov_b32 v124, 0
    v_mov_b32 v125, 0
    v_mov_b32 v126, 0
    v_mov_b32 v127, 0
    v_mov_b32 v128, 0
    v_mov_b32 v129, 0
    v_mov_b32 v130, 0
    v_mov_b32 v131, 0
    v_mov_b32 v132, 0
    v_mov_b32 v133, 0
    v_mov_b32 v134, 0
    v_mov_b32 v135, 0
    v_mov_b32 v136, 0
    v_mov_b32 v137, 0
    v_mov_b32 v138, 0
    v_mov_b32 v139, 0
    v_mov_b32 v140, 0
    v_mov_b32 v141, 0
    v_mov_b32 v142, 0
    v_mov_b32 v143, 0
    v_mov_b32 v144, 0
    v_mov_b32 v145, 0
    v_mov_b32 v146, 0
    v_mov_b32 v147, 0
    v_mov_b32 v148, 0
    v_mov_b32 v149, 0
    v_mov_b32 v150, 0
    v_mov_b32 v151, 0
    v_mov_b32 v152, 0
    v_mov_b32 v153, 0
    v_mov_b32 v154, 0
    v_mov_b32 v155, 0
    v_mov_b32 v156, 0
    v_mov_b32 v157, 0
    v_mov_b32 v158, 0
    v_mov_b32 v159, 0
    v_mov_b32 v160, 0
    v_mov_b32 v161, 0
    v_mov_b32 v162, 0
    v_mov_b32 v163, 0
    v_mov_b32 v164, 0
    v_mov_b32 v165, 0
    v_mov_b32 v166, 0
    v_mov_b32 v167, 0
    v_mov_b32 v168, 0
    v_mov_b32 v169, 0
    v_mov_b32 v170, 0
    v_mov_b32 v171, 0
    v_mov_b32 v172, 0
    v_mov_b32 v173, 0
    v_mov_b32 v174, 0
    v_mov_b32 v175, 0
    v_mov_b32 v176, 0
    v_mov_b32 v177, 0
    v_mov_b32 v178, 0
    v_mov_b32 v179, 0
    v_mov_b32 v180, 0
    v_mov_b32 v181, 0
    v_mov_b32 v182, 0
    v_mov_b32 v183, 0
    v_add_u32 v31, 6144, v30
    s_cmp_lg_u32 s29, 3
    s_cbranch_scc1 pok_mega_kernel_99
    s_add_u32 s38, s26, 584
    s_lshl_b32 s38, s38, 7
    v_and_b32 v24, 15, v1
    v_lshlrev_b32 v24, 2, v24
    v_add_u32 v24, s38, v24
    s_mov_b32 s38, 0
    buffer_load_dword v21, v24, s[92:95], 0 offen sc1
    s_sleep 3
    buffer_load_dword v22, v24, s[92:95], 0 offen sc1
    s_sleep 3
poll_mega_kernel_98:
    buffer_load_dword v23, v24, s[92:95], 0 offen sc1
    s_waitcnt vmcnt(2)
    v_cmp_gt_u32 vcc, 1, v21
    s_nop 4
    s_cbranch_vccz pok_mega_kernel_99
    s_sleep 2
    buffer_load_dword v21, v24, s[92:95], 0 offen sc1
    s_waitcnt vmcnt(2)
    v_cmp_gt_u32 vcc, 1, v22
    s_nop 4
    s_cbranch_vccz pok_mega_kernel_99
    s_sleep 2
    buffer_load_dword v22, v24, s[92:95], 0 offen sc1
    s_waitcnt vmcnt(2)
    v_cmp_gt_u32 vcc, 1, v23
    s_nop 4
    s_cbranch_vccz pok_mega_kernel_99
    s_sleep 2
    s_add_u32 s38, s38, 1
    s_cmp_gt_u32 s38, 4000
    s_cbranch_scc0 poll_mega_kernel_98
pok_mega_kernel_99:
    s_barrier
    buffer_load_dwordx4 v[188:191], v30, s[68:71], 0 offen offset:0 sc1
    buffer_load_dwordx4 v[192:195], v30, s[68:71], 0 offen offset:32 sc1
    buffer_load_dwordx4 v[196:199], v30, s[68:71], 0 offen offset:64 sc1
    buffer_load_dwordx4 v[200:203], v30, s[68:71], 0 offen offset:96 sc1
    buffer_load_dwordx4 v[204:207], v31, s[68:71], 0 offen offset:0 sc1
    buffer_load_dwordx4 v[208:211], v31, s[68:71], 0 offen offset:32 sc1
    buffer_load_dwordx4 v[212:215], v31, s[68:71], 0 offen offset:64 sc1
    buffer_load_dwordx4 v[216:219], v31, s[68:71], 0 offen offset:96 sc1
    buffer_load_dwordx4 v[220:223], v30, s[68:71], 0 offen offset:128 sc1
    buffer_load_dwordx4 v[224:227], v30, s[68:71], 0 offen offset:160 sc1
    buffer_load_dwordx4 v[228:231], v30, s[68:71], 0 offen offset:192 sc1
    buffer_load_dwordx4 v[232:235], v30, s[68:71], 0 offen offset:224 sc1
    buffer_load_dwordx4 v[236:239], v29, s[20:23], 0 offen offset:0 sc1
    buffer_load_dwordx4 v[240:243], v29, s[20:23], 0 offen offset:16 sc1
    buffer_load_dwordx4 v[244:247], v29, s[20:23], 0 offen offset:32 sc1
    buffer_load_dwordx4 v[248:251], v29, s[20:23], 0 offen offset:48 sc1
    s_barrier
    ds_read_b128 v[32:35], v10
    ds_read_b64_tr_b16 v[36:37], v14 offset:0
    ds_read_b64_tr_b16 v[38:39], v14 offset:768
    ds_read_b64_tr_b16 v[40:41], v14 offset:64
    ds_read_b64_tr_b16 v[42:43], v14 offset:832
    ds_read_b64_tr_b16 v[44:45], v14 offset:128
    ds_read_b64_tr_b16 v[46:47], v14 offset:896
    ds_read_b64_tr_b16 v[48:49], v14 offset:12288
    ds_read_b64_tr_b16 v[50:51], v14 offset:13056
    ds_read_b64_tr_b16 v[52:53], v14 offset:12352
    ds_read_b64_tr_b16 v[54:55], v14 offset:13120
    ds_read_b64_tr_b16 v[56:57], v14 offset:12416
    ds_read_b64_tr_b16 v[58:59], v14 offset:13184
    s_waitcnt lgkmcnt(0)
    v_mfma_f32_32x32x16_bf16 v[88:103], v[36:39], v[32:35], v[88:103]
    ds_read_b128 v[60:63], v11
    ds_read_b64_tr_b16 v[64:65], v14 offset:3072
    ds_read_b64_tr_b16 v[66:67], v14 offset:3840
    ds_read_b64_tr_b16 v[68:69], v14 offset:3136
    ds_read_b64_tr_b16 v[70:71], v14 offset:3904
    v_mfma_f32_32x32x16_bf16 v[104:119], v[40:43], v[32:35], v[104:119]
    ds_read_b64_tr_b16 v[72:73], v14 offset:3200
    ds_read_b64_tr_b16 v[74:75], v14 offset:3968
    ds_read_b64_tr_b16 v[76:77], v14 offset:15360
    ds_read_b64_tr_b16 v[78:79], v14 offset:16128
    v_mfma_f32_32x32x16_bf16 v[120:135], v[44:47], v[32:35], v[120:135]
    ds_read_b64_tr_b16 v[80:81], v14 offset:15424
    ds_read_b64_tr_b16 v[82:83], v14 offset:16192
    ds_read_b64_tr_b16 v[84:85], v14 offset:15488
    ds_read_b64_tr_b16 v[86:87], v14 offset:16256
    v_mfma_f32_32x32x16_bf16 v[136:151], v[48:51], v[32:35], v[136:151]
    v_mfma_f32_32x32x16_bf16 v[152:167], v[52:55], v[32:35], v[152:167]
    v_mfma_f32_32x32x16_bf16 v[168:183], v[56:59], v[32:35], v[168:183]
    s_waitcnt lgkmcnt(0)
    v_mfma_f32_32x32x16_bf16 v[88:103], v[64:67], v[60:63], v[88:103]
    ds_read_b128 v[32:35], v12
    ds_read_b64_tr_b16 v[36:37], v14 offset:6144
    ds_read_b64_tr_b16 v[38:39], v14 offset:6912
    ds_read_b64_tr_b16 v[40:41], v14 offset:6208
    ds_read_b64_tr_b16 v[42:43], v14 offset:6976
    v_mfma_f32_32x32x16_bf16 v[104:119], v[68:71], v[60:63], v[104:119]
    ds_read_b64_tr_b16 v[44:45], v14 offset:6272
    ds_read_b64_tr_b16 v[46:47], v14 offset:7040
    ds_read_b64_tr_b16 v[48:49], v14 offset:18432
    ds_read_b64_tr_b16 v[50:51], v14 offset:19200
    v_mfma_f32_32x32x16_bf16 v[120:135], v[72:75], v[60:63], v[120:135]
    ds_read_b64_tr_b16 v[52:53], v14 offset:18496
    ds_read_b64_tr_b16 v[54:55], v14 offset:19264
    ds_read_b64_tr_b16 v[56:57], v14 offset:18560
    ds_read_b64_tr_b16 v[58:59], v14 offset:19328
    v_mfma_f32_32x32x16_bf16 v[136:151], v[76:79], v[60:63], v[136:151]
    v_mfma_f32_32x32x16_bf16 v[152:167], v[80:83], v[60:63], v[152:167]
    v_mfma_f32_32x32x16_bf16 v[168:183], v[84:87], v[60:63], v[168:183]
    s_waitcnt lgkmcnt(0)
    v_mfma_f32_32x32x16_bf16 v[88:103], v[36:39], v[32:35], v[88:103]
    ds_read_b128 v[60:63], v13
    ds_read_b64_tr_b16 v[64:65], v14 offset:9216
    ds_read_b64_tr_b16 v[66:67], v14 offset:9984
    ds_read_b64_tr_b16 v[68:69], v14 offset:9280
    ds_read_b64_tr_b16 v[70:71], v14 offset:10048
    v_mfma_f32_32x32x16_bf16 v[104:119], v[40:43], v[32:35], v[104:119]
    ds_read_b64_tr_b16 v[72:73], v14 offset:9344
    ds_read_b64_tr_b16 v[74:75], v14 offset:10112
    ds_read_b64_tr_b16 v[76:77], v14 offset:21504
    ds_read_b64_tr_b16 v[78:79], v14 offset:22272
    v_mfma_f32_32x32x16_bf16 v[120:135], v[44:47], v[32:35], v[120:135]
    ds_read_b64_tr_b16 v[80:81], v14 offset:21568
    ds_read_b64_tr_b16 v[82:83], v14 offset:22336
    ds_read_b64_tr_b16 v[84:85], v14 offset:21632
    ds_read_b64_tr_b16 v[86:87], v14 offset:22400
    v_mfma_f32_32x32x16_bf16 v[136:151], v[48:51], v[32:35], v[136:151]
    v_mfma_f32_32x32x16_bf16 v[152:167], v[52:55], v[32:35], v[152:167]
    v_mfma_f32_32x32x16_bf16 v[168:183], v[56:59], v[32:35], v[168:183]
    s_waitcnt lgkmcnt(0)
    v_mfma_f32_32x32x16_bf16 v[88:103], v[64:67], v[60:63], v[88:103]
    s_barrier
    v_add_u32 v10, 0x4000, v10
    v_add_u32 v11, 0x4000, v11
    v_add_u32 v12, 0x4000, v12
    v_add_u32 v13, 0x4000, v13
    v_add_u32 v14, 0x6000, v14
    v_mfma_f32_32x32x16_bf16 v[104:119], v[68:71], v[60:63], v[104:119]
    ds_read_b128 v[32:35], v10
    ds_read_b64_tr_b16 v[36:37], v14 offset:0
    ds_read_b64_tr_b16 v[38:39], v14 offset:768
    ds_read_b64_tr_b16 v[40:41], v14 offset:64
    ds_read_b64_tr_b16 v[42:43], v14 offset:832
    v_mfma_f32_32x32x16_bf16 v[120:135], v[72:75], v[60:63], v[120:135]
    ds_read_b64_tr_b16 v[44:45], v14 offset:128
    ds_read_b64_tr_b16 v[46:47], v14 offset:896
    ds_read_b64_tr_b16 v[48:49], v14 offset:12288
    ds_read_b64_tr_b16 v[50:51], v14 offset:13056
    v_mfma_f32_32x32x16_bf16 v[136:151], v[76:79], v[60:63], v[136:151]
    ds_read_b64_tr_b16 v[52:53], v14 offset:12352
    ds_read_b64_tr_b16 v[54:55], v14 offset:13120
    ds_read_b64_tr_b16 v[56:57], v14 offset:12416
    ds_read_b64_tr_b16 v[58:59], v14 offset:13184
    v_mfma_f32_32x32x16_bf16 v[152:167], v[80:83], v[60:63], v[152:167]
    v_mfma_f32_32x32x16_bf16 v[168:183], v[84:87], v[60:63], v[168:183]
    s_waitcnt lgkmcnt(0)
    v_mfma_f32_32x32x16_bf16 v[88:103], v[36:39], v[32:35], v[88:103]
    ds_read_b128 v[60:63], v11
    ds_read_b64_tr_b16 v[64:65], v14 offset:3072
    ds_read_b64_tr_b16 v[66:67], v14 offset:3840
    ds_read_b64_tr_b16 v[68:69], v14 offset:3136
    ds_read_b64_tr_b16 v[70:71], v14 offset:3904
    v_mfma_f32_32x32x16_bf16 v[104:119], v[40:43], v[32:35], v[104:119]
    ds_read_b64_tr_b16 v[72:73], v14 offset:3200
    ds_read_b64_tr_b16 v[74:75], v14 offset:3968
    ds_read_b64_tr_b16 v[76:77], v14 offset:15360
    ds_read_b64_tr_b16 v[78:79], v14 offset:16128
    v_mfma_f32_32x32x16_bf16 v[120:135], v[44:47], v[32:35], v[120:135]
    ds_read_b64_tr_b16 v[80:81], v14 offset:15424
    ds_read_b64_tr_b16 v[82:83], v14 offset:16192
    ds_read_b64_tr_b16 v[84:85], v14 offset:15488
    ds_read_b64_tr_b16 v[86:87], v14 offset:16256
    v_mfma_f32_32x32x16_bf16 v[136:151], v[48:51], v[32:35], v[136:151]
    v_mfma_f32_32x32x16_bf16 v[152:167], v[52:55], v[32:35], v[152:167]
    v_mfma_f32_32x32x16_bf16 v[168:183], v[56:59], v[32:35], v[168:183]
    s_waitcnt lgkmcnt(0)
    v_mfma_f32_32x32x16_bf16 v[88:103], v[64:67], v[60:63], v[88:103]
    ds_read_b128 v[32:35], v12
    ds_read_b64_tr_b16 v[36:37], v14 offset:6144
    ds_read_b64_tr_b16 v[38:39], v14 offset:6912
    ds_read_b64_tr_b16 v[40:41], v14 offset:6208
    ds_read_b64_tr_b16 v[42:43], v14 offset:6976
    v_mfma_f32_32x32x16_bf16 v[104:119], v[68:71], v[60:63], v[104:119]
    ds_read_b64_tr_b16 v[44:45], v14 offset:6272
    ds_read_b64_tr_b16 v[46:47], v14 offset:7040
    ds_read_b64_tr_b16 v[48:49], v14 offset:18432
    ds_read_b64_tr_b16 v[50:51], v14 offset:19200
    v_mfma_f32_32x32x16_bf16 v[120:135], v[72:75], v[60:63], v[120:135]
    ds_read_b64_tr_b16 v[52:53], v14 offset:18496
    ds_read_b64_tr_b16 v[54:55], v14 offset:19264
    ds_read_b64_tr_b16 v[56:57], v14 offset:18560
    ds_read_b64_tr_b16 v[58:59], v14 offset:19328
    v_mfma_f32_32x32x16_bf16 v[136:151], v[76:79], v[60:63], v[136:151]
    v_mfma_f32_32x32x16_bf16 v[152:167], v[80:83], v[60:63], v[152:167]
    v_mfma_f32_32x32x16_bf16 v[168:183], v[84:87], v[60:63], v[168:183]
    s_waitcnt lgkmcnt(0)
    v_mfma_f32_32x32x16_bf16 v[88:103], v[36:39], v[32:35], v[88:103]
    ds_read_b128 v[60:63], v13
    ds_read_b64_tr_b16 v[64:65], v14 offset:9216
    ds_read_b64_tr_b16 v[66:67], v14 offset:9984
    ds_read_b64_tr_b16 v[68:69], v14 offset:9280
    ds_read_b64_tr_b16 v[70:71], v14 offset:10048
    v_mfma_f32_32x32x16_bf16 v[104:119], v[40:43], v[32:35], v[104:119]
    ds_read_b64_tr_b16 v[72:73], v14 offset:9344
    ds_read_b64_tr_b16 v[74:75], v14 offset:10112
    ds_read_b64_tr_b16 v[76:77], v14 offset:21504
    ds_read_b64_tr_b16 v[78:79], v14 offset:22272
    v_mfma_f32_32x32x16_bf16 v[120:135], v[44:47], v[32:35], v[120:135]
    ds_read_b64_tr_b16 v[80:81], v14 offset:21568
    ds_read_b64_tr_b16 v[82:83], v14 offset:22336
    ds_read_b64_tr_b16 v[84:85], v14 offset:21632
    ds_read_b64_tr_b16 v[86:87], v14 offset:22400
    v_mfma_f32_32x32x16_bf16 v[136:151], v[48:51], v[32:35], v[136:151]
    v_mfma_f32_32x32x16_bf16 v[152:167], v[52:55], v[32:35], v[152:167]
    v_mfma_f32_32x32x16_bf16 v[168:183], v[56:59], v[32:35], v[168:183]
    s_waitcnt lgkmcnt(0)
    v_mfma_f32_32x32x16_bf16 v[88:103], v[64:67], v[60:63], v[88:103]
    s_barrier
    v_add_u32 v10, 0xffff4000, v10
    v_add_u32 v11, 0xffff4000, v11
    v_add_u32 v12, 0xffff4000, v12
    v_add_u32 v13, 0xffff4000, v13
    v_add_u32 v14, 0xfffee000, v14
    v_mfma_f32_32x32x16_bf16 v[104:119], v[68:71], v[60:63], v[104:119]
    ds_read_b128 v[32:35], v10
    ds_read_b64_tr_b16 v[36:37], v14 offset:0
    ds_read_b64_tr_b16 v[38:39], v14 offset:768
    ds_read_b64_tr_b16 v[40:41], v14 offset:64
    ds_read_b64_tr_b16 v[42:43], v14 offset:832
    v_mfma_f32_32x32x16_bf16 v[120:135], v[72:75], v[60:63], v[120:135]
    ds_read_b64_tr_b16 v[44:45], v14 offset:128
    ds_read_b64_tr_b16 v[46:47], v14 offset:896
    ds_read_b64_tr_b16 v[48:49], v14 offset:12288
    ds_read_b64_tr_b16 v[50:51], v14 offset:13056
    v_mfma_f32_32x32x16_bf16 v[136:151], v[76:79], v[60:63], v[136:151]
    ds_read_b64_tr_b16 v[52:53], v14 offset:12352
    ds_read_b64_tr_b16 v[54:55], v14 offset:13120
    ds_read_b64_tr_b16 v[56:57], v14 offset:12416
    ds_read_b64_tr_b16 v[58:59], v14 offset:13184
    v_mfma_f32_32x32x16_bf16 v[152:167], v[80:83], v[60:63], v[152:167]
    v_mfma_f32_32x32x16_bf16 v[168:183], v[84:87], v[60:63], v[168:183]
    s_waitcnt lgkmcnt(0)
    v_mfma_f32_32x32x16_bf16 v[88:103], v[36:39], v[32:35], v[88:103]
    ds_read_b128 v[60:63], v11
    ds_read_b64_tr_b16 v[64:65], v14 offset:3072
    ds_read_b64_tr_b16 v[66:67], v14 offset:3840
    ds_read_b64_tr_b16 v[68:69], v14 offset:3136
    ds_read_b64_tr_b16 v[70:71], v14 offset:3904
    v_mfma_f32_32x32x16_bf16 v[104:119], v[40:43], v[32:35], v[104:119]
    ds_read_b64_tr_b16 v[72:73], v14 offset:3200
    ds_read_b64_tr_b16 v[74:75], v14 offset:3968
    ds_read_b64_tr_b16 v[76:77], v14 offset:15360
    ds_read_b64_tr_b16 v[78:79], v14 offset:16128
    v_mfma_f32_32x32x16_bf16 v[120:135], v[44:47], v[32:35], v[120:135]
    ds_read_b64_tr_b16 v[80:81], v14 offset:15424
    ds_read_b64_tr_b16 v[82:83], v14 offset:16192
    ds_read_b64_tr_b16 v[84:85], v14 offset:15488
    ds_read_b64_tr_b16 v[86:87], v14 offset:16256
    v_mfma_f32_32x32x16_bf16 v[136:151], v[48:51], v[32:35], v[136:151]
    v_mfma_f32_32x32x16_bf16 v[152:167], v[52:55], v[32:35], v[152:167]
    v_mfma_f32_32x32x16_bf16 v[168:183], v[56:59], v[32:35], v[168:183]
    s_waitcnt lgkmcnt(0)
    v_mfma_f32_32x32x16_bf16 v[88:103], v[64:67], v[60:63], v[88:103]
    ds_read_b128 v[32:35], v12
    ds_read_b64_tr_b16 v[36:37], v14 offset:6144
    ds_read_b64_tr_b16 v[38:39], v14 offset:6912
    ds_read_b64_tr_b16 v[40:41], v14 offset:6208
    ds_read_b64_tr_b16 v[42:43], v14 offset:6976
    v_mfma_f32_32x32x16_bf16 v[104:119], v[68:71], v[60:63], v[104:119]
    ds_read_b64_tr_b16 v[44:45], v14 offset:6272
    ds_read_b64_tr_b16 v[46:47], v14 offset:7040
    ds_read_b64_tr_b16 v[48:49], v14 offset:18432
    ds_read_b64_tr_b16 v[50:51], v14 offset:19200
    v_mfma_f32_32x32x16_bf16 v[120:135], v[72:75], v[60:63], v[120:135]
    ds_read_b64_tr_b16 v[52:53], v14 offset:18496
    ds_read_b64_tr_b16 v[54:55], v14 offset:19264
    ds_read_b64_tr_b16 v[56:57], v14 offset:18560
    ds_read_b64_tr_b16 v[58:59], v14 offset:19328
    v_mfma_f32_32x32x16_bf16 v[136:151], v[76:79], v[60:63], v[136:151]
    v_mfma_f32_32x32x16_bf16 v[152:167], v[80:83], v[60:63], v[152:167]
    v_mfma_f32_32x32x16_bf16 v[168:183], v[84:87], v[60:63], v[168:183]
    s_waitcnt lgkmcnt(0)
    v_mfma_f32_32x32x16_bf16 v[88:103], v[36:39], v[32:35], v[88:103]
    ds_read_b128 v[60:63], v13
    ds_read_b64_tr_b16 v[64:65], v14 offset:9216
    ds_read_b64_tr_b16 v[66:67], v14 offset:9984
    ds_read_b64_tr_b16 v[68:69], v14 offset:9280
    ds_read_b64_tr_b16 v[70:71], v14 offset:10048
    v_mfma_f32_32x32x16_bf16 v[104:119], v[40:43], v[32:35], v[104:119]
    ds_read_b64_tr_b16 v[72:73], v14 offset:9344
    ds_read_b64_tr_b16 v[74:75], v14 offset:10112
    ds_read_b64_tr_b16 v[76:77], v14 offset:21504
    ds_read_b64_tr_b16 v[78:79], v14 offset:22272
    v_mfma_f32_32x32x16_bf16 v[120:135], v[44:47], v[32:35], v[120:135]
    ds_read_b64_tr_b16 v[80:81], v14 offset:21568
    ds_read_b64_tr_b16 v[82:83], v14 offset:22336
    ds_read_b64_tr_b16 v[84:85], v14 offset:21632
    ds_read_b64_tr_b16 v[86:87], v14 offset:22400
    v_mfma_f32_32x32x16_bf16 v[136:151], v[48:51], v[32:35], v[136:151]
    v_mfma_f32_32x32x16_bf16 v[152:167], v[52:55], v[32:35], v[152:167]
    v_mfma_f32_32x32x16_bf16 v[168:183], v[56:59], v[32:35], v[168:183]
    s_waitcnt lgkmcnt(0)
    v_mfma_f32_32x32x16_bf16 v[88:103], v[64:67], v[60:63], v[88:103]
    s_barrier
    v_add_u32 v10, 0x4000, v10
    v_add_u32 v11, 0x4000, v11
    v_add_u32 v12, 0x4000, v12
    v_add_u32 v13, 0x4000, v13
    v_add_u32 v14, 0x6000, v14
    v_mfma_f32_32x32x16_bf16 v[104:119], v[68:71], v[60:63], v[104:119]
    ds_read_b128 v[32:35], v10
    ds_read_b64_tr_b16 v[36:37], v14 offset:0
    ds_read_b64_tr_b16 v[38:39], v14 offset:768
    ds_read_b64_tr_b16 v[40:41], v14 offset:64
    ds_read_b64_tr_b16 v[42:43], v14 offset:832
    v_mfma_f32_32x32x16_bf16 v[120:135], v[72:75], v[60:63], v[120:135]
    ds_read_b64_tr_b16 v[44:45], v14 offset:128
    ds_read_b64_tr_b16 v[46:47], v14 offset:896
    ds_read_b64_tr_b16 v[48:49], v14 offset:12288
    ds_read_b64_tr_b16 v[50:51], v14 offset:13056
    v_mfma_f32_32x32x16_bf16 v[136:151], v[76:79], v[60:63], v[136:151]
    ds_read_b64_tr_b16 v[52:53], v14 offset:12352
    ds_read_b64_tr_b16 v[54:55], v14 offset:13120
    ds_read_b64_tr_b16 v[56:57], v14 offset:12416
    ds_read_b64_tr_b16 v[58:59], v14 offset:13184
    v_mfma_f32_32x32x16_bf16 v[152:167], v[80:83], v[60:63], v[152:167]
    v_mfma_f32_32x32x16_bf16 v[168:183], v[84:87], v[60:63], v[168:183]
    s_waitcnt lgkmcnt(0)
    v_mfma_f32_32x32x16_bf16 v[88:103], v[36:39], v[32:35], v[88:103]
    ds_read_b128 v[60:63], v11
    ds_read_b64_tr_b16 v[64:65], v14 offset:3072
    ds_read_b64_tr_b16 v[66:67], v14 offset:3840
    ds_read_b64_tr_b16 v[68:69], v14 offset:3136
    ds_read_b64_tr_b16 v[70:71], v14 offset:3904
    v_mfma_f32_32x32x16_bf16 v[104:119], v[40:43], v[32:35], v[104:119]
    ds_read_b64_tr_b16 v[72:73], v14 offset:3200
    ds_read_b64_tr_b16 v[74:75], v14 offset:3968
    ds_read_b64_tr_b16 v[76:77], v14 offset:15360
    ds_read_b64_tr_b16 v[78:79], v14 offset:16128
    v_mfma_f32_32x32x16_bf16 v[120:135], v[44:47], v[32:35], v[120:135]
    ds_read_b64_tr_b16 v[80:81], v14 offset:15424
    ds_read_b64_tr_b16 v[82:83], v14 offset:16192
    ds_read_b64_tr_b16 v[84:85], v14 offset:15488
    ds_read_b64_tr_b16 v[86:87], v14 offset:16256
    v_mfma_f32_32x32x16_bf16 v[136:151], v[48:51], v[32:35], v[136:151]
    v_mfma_f32_32x32x16_bf16 v[152:167], v[52:55], v[32:35], v[152:167]
    v_mfma_f32_32x32x16_bf16 v[168:183], v[56:59], v[32:35], v[168:183]
    s_waitcnt lgkmcnt(0)
    v_mfma_f32_32x32x16_bf16 v[88:103], v[64:67], v[60:63], v[88:103]
    ds_read_b128 v[32:35], v12
    ds_read_b64_tr_b16 v[36:37], v14 offset:6144
    ds_read_b64_tr_b16 v[38:39], v14 offset:6912
    ds_read_b64_tr_b16 v[40:41], v14 offset:6208
    ds_read_b64_tr_b16 v[42:43], v14 offset:6976
    v_mfma_f32_32x32x16_bf16 v[104:119], v[68:71], v[60:63], v[104:119]
    ds_read_b64_tr_b16 v[44:45], v14 offset:6272
    ds_read_b64_tr_b16 v[46:47], v14 offset:7040
    ds_read_b64_tr_b16 v[48:49], v14 offset:18432
    ds_read_b64_tr_b16 v[50:51], v14 offset:19200
    v_mfma_f32_32x32x16_bf16 v[120:135], v[72:75], v[60:63], v[120:135]
    ds_read_b64_tr_b16 v[52:53], v14 offset:18496
    ds_read_b64_tr_b16 v[54:55], v14 offset:19264
    ds_read_b64_tr_b16 v[56:57], v14 offset:18560
    ds_read_b64_tr_b16 v[58:59], v14 offset:19328
    v_mfma_f32_32x32x16_bf16 v[136:151], v[76:79], v[60:63], v[136:151]
    v_mfma_f32_32x32x16_bf16 v[152:167], v[80:83], v[60:63], v[152:167]
    v_mfma_f32_32x32x16_bf16 v[168:183], v[84:87], v[60:63], v[168:183]
    s_waitcnt lgkmcnt(0)
    v_mfma_f32_32x32x16_bf16 v[88:103], v[36:39], v[32:35], v[88:103]
    ds_read_b128 v[60:63], v13
    ds_read_b64_tr_b16 v[64:65], v14 offset:9216
    ds_read_b64_tr_b16 v[66:67], v14 offset:9984
    ds_read_b64_tr_b16 v[68:69], v14 offset:9280
    ds_read_b64_tr_b16 v[70:71], v14 offset:10048
    v_mfma_f32_32x32x16_bf16 v[104:119], v[40:43], v[32:35], v[104:119]
    ds_read_b64_tr_b16 v[72:73], v14 offset:9344
    ds_read_b64_tr_b16 v[74:75], v14 offset:10112
    ds_read_b64_tr_b16 v[76:77], v14 offset:21504
    ds_read_b64_tr_b16 v[78:79], v14 offset:22272
    v_mfma_f32_32x32x16_bf16 v[120:135], v[44:47], v[32:35], v[120:135]
    ds_read_b64_tr_b16 v[80:81], v14 offset:21568
    ds_read_b64_tr_b16 v[82:83], v14 offset:22336
    ds_read_b64_tr_b16 v[84:85], v14 offset:21632
    ds_read_b64_tr_b16 v[86:87], v14 offset:22400
    v_mfma_f32_32x32x16_bf16 v[136:151], v[48:51], v[32:35], v[136:151]
    v_mfma_f32_32x32x16_bf16 v[152:167], v[52:55], v[32:35], v[152:167]
    v_mfma_f32_32x32x16_bf16 v[168:183], v[56:59], v[32:35], v[168:183]
    s_waitcnt lgkmcnt(0)
    v_mfma_f32_32x32x16_bf16 v[88:103], v[64:67], v[60:63], v[88:103]
    s_barrier
    v_add_u32 v10, 0x4000, v10
    v_add_u32 v11, 0x4000, v11
    v_add_u32 v12, 0x4000, v12
    v_add_u32 v13, 0x4000, v13
    v_add_u32 v14, 0x6000, v14
    v_mfma_f32_32x32x16_bf16 v[104:119], v[68:71], v[60:63], v[104:119]
    ds_read_b128 v[32:35], v10
    ds_read_b64_tr_b16 v[36:37], v14 offset:0
    ds_read_b64_tr_b16 v[38:39], v14 offset:768
    ds_read_b64_tr_b16 v[40:41], v14 offset:64
    ds_read_b64_tr_b16 v[42:43], v14 offset:832
    v_mfma_f32_32x32x16_bf16 v[120:135], v[72:75], v[60:63], v[120:135]
    ds_read_b64_tr_b16 v[44:45], v14 offset:128
    ds_read_b64_tr_b16 v[46:47], v14 offset:896
    ds_read_b64_tr_b16 v[48:49], v14 offset:12288
    ds_read_b64_tr_b16 v[50:51], v14 offset:13056
    v_mfma_f32_32x32x16_bf16 v[136:151], v[76:79], v[60:63], v[136:151]
    ds_read_b64_tr_b16 v[52:53], v14 offset:12352
    ds_read_b64_tr_b16 v[54:55], v14 offset:13120
    ds_read_b64_tr_b16 v[56:57], v14 offset:12416
    ds_read_b64_tr_b16 v[58:59], v14 offset:13184
    v_mfma_f32_32x32x16_bf16 v[152:167], v[80:83], v[60:63], v[152:167]
    v_mfma_f32_32x32x16_bf16 v[168:183], v[84:87], v[60:63], v[168:183]
    s_waitcnt vmcnt(0)
    v_add_f32 v16, v236, v238
    v_add_f32 v16, v16, v240
    v_add_f32 v16, v16, v242
    v_add_f32 v16, v16, v244
    v_add_f32 v16, v16, v246
    v_add_f32 v16, v16, v248
    v_add_f32 v16, v16, v250
    v_mul_f32 v16, 0x3acccccd, v16
    v_add_f32 v17, v237, v239
    v_add_f32 v17, v17, v241
    v_add_f32 v17, v17, v243
    v_add_f32 v17, v17, v245
    v_add_f32 v17, v17, v247
    v_add_f32 v17, v17, v249
    v_add_f32 v17, v17, v251
    v_mov_b32 v18, 0
    v_mul_f32 v19, 0x3c4ccccd, v236
    v_sub_f32 v19, v19, v16
    v_fmac_f32 v18, v19, v19
    v_mul_f32 v19, 0x3c4ccccd, v238
    v_sub_f32 v19, v19, v16
    v_fmac_f32 v18, v19, v19
    v_mul_f32 v19, 0x3c4ccccd, v240
    v_sub_f32 v19, v19, v16
    v_fmac_f32 v18, v19, v19
    v_mul_f32 v19, 0x3c4ccccd, v242
    v_sub_f32 v19, v19, v16
    v_fmac_f32 v18, v19, v19
    v_mul_f32 v19, 0x3c4ccccd, v244
    v_sub_f32 v19, v19, v16
    v_fmac_f32 v18, v19, v19
    v_mul_f32 v19, 0x3c4ccccd, v246
    v_sub_f32 v19, v19, v16
    v_fmac_f32 v18, v19, v19
    v_mul_f32 v19, 0x3c4ccccd, v248
    v_sub_f32 v19, v19, v16
    v_fmac_f32 v18, v19, v19
    v_mul_f32 v19, 0x3c4ccccd, v250
    v_sub_f32 v19, v19, v16
    v_fmac_f32 v18, v19, v19
    v_mov_b32 v19, 0x42a00000
    v_fmac_f32 v17, v18, v19
    v_mul_f32 v17, 0x3acccccd, v17
    v_cvt_pk_bf16_f32 v184, v16, v16
    v_lshlrev_b32 v184, 16, v184
    v_cvt_pk_bf16_f32 v186, v17, v17
    v_lshlrev_b32 v186, 16, v186
    v_add_f32 v186, 0x3727c5ac, v186
    v_cvt_pk_bf16_f32 v186, v186, v186
    v_lshlrev_b32 v186, 16, v186
    v_sqrt_f32 v186, v186
    s_nop 0
    v_cvt_pk_bf16_f32 v186, v186, v186
    v_lshlrev_b32 v186, 16, v186
    v_rcp_f32 v186, v186
    s_nop 0
    v_mov_b32 v185, v184
    v_mov_b32 v187, v186
    buffer_load_dwordx4 v[236:239], v31, s[68:71], 0 offen offset:128 sc1
    buffer_load_dwordx4 v[240:243], v31, s[68:71], 0 offen offset:160 sc1
    buffer_load_dwordx4 v[244:247], v31, s[68:71], 0 offen offset:192 sc1
    buffer_load_dwordx4 v[248:251], v31, s[68:71], 0 offen offset:224 sc1
    s_waitcnt lgkmcnt(0)
    v_mfma_f32_32x32x16_bf16 v[88:103], v[36:39], v[32:35], v[88:103]
    ds_read_b128 v[60:63], v11
    ds_read_b64_tr_b16 v[64:65], v14 offset:3072
    ds_read_b64_tr_b16 v[66:67], v14 offset:3840
    ds_read_b64_tr_b16 v[68:69], v14 offset:3136
    ds_read_b64_tr_b16 v[70:71], v14 offset:3904
    v_mfma_f32_32x32x16_bf16 v[104:119], v[40:43], v[32:35], v[104:119]
    ds_read_b64_tr_b16 v[72:73], v14 offset:3200
    ds_read_b64_tr_b16 v[74:75], v14 offset:3968
    ds_read_b64_tr_b16 v[76:77], v14 offset:15360
    ds_read_b64_tr_b16 v[78:79], v14 offset:16128
    v_mfma_f32_32x32x16_bf16 v[120:135], v[44:47], v[32:35], v[120:135]
    ds_read_b64_tr_b16 v[80:81], v14 offset:15424
    ds_read_b64_tr_b16 v[82:83], v14 offset:16192
    ds_read_b64_tr_b16 v[84:85], v14 offset:15488
    ds_read_b64_tr_b16 v[86:87], v14 offset:16256
    v_mfma_f32_32x32x16_bf16 v[136:151], v[48:51], v[32:35], v[136:151]
    v_mfma_f32_32x32x16_bf16 v[152:167], v[52:55], v[32:35], v[152:167]
    v_mfma_f32_32x32x16_bf16 v[168:183], v[56:59], v[32:35], v[168:183]
    s_waitcnt lgkmcnt(0)
    v_mfma_f32_32x32x16_bf16 v[88:103], v[64:67], v[60:63], v[88:103]
    ds_read_b128 v[32:35], v12
    ds_read_b64_tr_b16 v[36:37], v14 offset:6144
    ds_read_b64_tr_b16 v[38:39], v14 offset:6912
    ds_read_b64_tr_b16 v[40:41], v14 offset:6208
    ds_read_b64_tr_b16 v[42:43], v14 offset:6976
    v_mfma_f32_32x32x16_bf16 v[104:119], v[68:71], v[60:63], v[104:119]
    ds_read_b64_tr_b16 v[44:45], v14 offset:6272
    ds_read_b64_tr_b16 v[46:47], v14 offset:7040
    ds_read_b64_tr_b16 v[48:49], v14 offset:18432
    ds_read_b64_tr_b16 v[50:51], v14 offset:19200
    v_mfma_f32_32x32x16_bf16 v[120:135], v[72:75], v[60:63], v[120:135]
    ds_read_b64_tr_b16 v[52:53], v14 offset:18496
    ds_read_b64_tr_b16 v[54:55], v14 offset:19264
    ds_read_b64_tr_b16 v[56:57], v14 offset:18560
    ds_read_b64_tr_b16 v[58:59], v14 offset:19328
    v_mfma_f32_32x32x16_bf16 v[136:151], v[76:79], v[60:63], v[136:151]
    v_mfma_f32_32x32x16_bf16 v[152:167], v[80:83], v[60:63], v[152:167]
    v_mfma_f32_32x32x16_bf16 v[168:183], v[84:87], v[60:63], v[168:183]
    s_waitcnt lgkmcnt(0)
    v_mfma_f32_32x32x16_bf16 v[88:103], v[36:39], v[32:35], v[88:103]
    ds_read_b128 v[60:63], v13
    ds_read_b64_tr_b16 v[64:65], v14 offset:9216
    ds_read_b64_tr_b16 v[66:67], v14 offset:9984
    ds_read_b64_tr_b16 v[68:69], v14 offset:9280
    ds_read_b64_tr_b16 v[70:71], v14 offset:10048
    v_mfma_f32_32x32x16_bf16 v[104:119], v[40:43], v[32:35], v[104:119]
    ds_read_b64_tr_b16 v[72:73], v14 offset:9344
    ds_read_b64_tr_b16 v[74:75], v14 offset:10112
    ds_read_b64_tr_b16 v[76:77], v14 offset:21504
    ds_read_b64_tr_b16 v[78:79], v14 offset:22272
    v_mfma_f32_32x32x16_bf16 v[120:135], v[44:47], v[32:35], v[120:135]
    ds_read_b64_tr_b16 v[80:81], v14 offset:21568
    ds_read_b64_tr_b16 v[82:83], v14 offset:22336
    ds_read_b64_tr_b16 v[84:85], v14 offset:21632
    ds_read_b64_tr_b16 v[86:87], v14 offset:22400
    v_mfma_f32_32x32x16_bf16 v[136:151], v[48:51], v[32:35], v[136:151]
    v_mfma_f32_32x32x16_bf16 v[152:167], v[52:55], v[32:35], v[152:167]
    v_mfma_f32_32x32x16_bf16 v[168:183], v[56:59], v[32:35], v[168:183]
    s_waitcnt lgkmcnt(0)
    v_mfma_f32_32x32x16_bf16 v[88:103], v[64:67], v[60:63], v[88:103]
    s_barrier
    v_add_u32 v10, 0x4000, v10
    v_add_u32 v11, 0x4000, v11
    v_add_u32 v12, 0x4000, v12
    v_add_u32 v13, 0x4000, v13
    v_add_u32 v14, 0x6000, v14
    v_mfma_f32_32x32x16_bf16 v[104:119], v[68:71], v[60:63], v[104:119]
    ds_read_b128 v[32:35], v10
    ds_read_b64_tr_b16 v[36:37], v14 offset:0
    ds_read_b64_tr_b16 v[38:39], v14 offset:768
    ds_read_b64_tr_b16 v[40:41], v14 offset:64
    ds_read_b64_tr_b16 v[42:43], v14 offset:832
    v_mfma_f32_32x32x16_bf16 v[120:135], v[72:75], v[60:63], v[120:135]
    ds_read_b64_tr_b16 v[44:45], v14 offset:128
    ds_read_b64_tr_b16 v[46:47], v14 offset:896
    ds_read_b64_tr_b16 v[48:49], v14 offset:12288
    ds_read_b64_tr_b16 v[50:51], v14 offset:13056
    v_mfma_f32_32x32x16_bf16 v[136:151], v[76:79], v[60:63], v[136:151]
    ds_read_b64_tr_b16 v[52:53], v14 offset:12352
    ds_read_b64_tr_b16 v[54:55], v14 offset:13120
    ds_read_b64_tr_b16 v[56:57], v14 offset:12416
    ds_read_b64_tr_b16 v[58:59], v14 offset:13184
    v_mfma_f32_32x32x16_bf16 v[152:167], v[80:83], v[60:63], v[152:167]
    v_mfma_f32_32x32x16_bf16 v[168:183], v[84:87], v[60:63], v[168:183]
    s_waitcnt lgkmcnt(0)
    v_mfma_f32_32x32x16_bf16 v[88:103], v[36:39], v[32:35], v[88:103]
    ds_read_b128 v[60:63], v11
    ds_read_b64_tr_b16 v[64:65], v14 offset:3072
    ds_read_b64_tr_b16 v[66:67], v14 offset:3840
    ds_read_b64_tr_b16 v[68:69], v14 offset:3136
    ds_read_b64_tr_b16 v[70:71], v14 offset:3904
    v_mfma_f32_32x32x16_bf16 v[104:119], v[40:43], v[32:35], v[104:119]
    ds_read_b64_tr_b16 v[72:73], v14 offset:3200
    ds_read_b64_tr_b16 v[74:75], v14 offset:3968
    ds_read_b64_tr_b16 v[76:77], v14 offset:15360
    ds_read_b64_tr_b16 v[78:79], v14 offset:16128
    v_mfma_f32_32x32x16_bf16 v[120:135], v[44:47], v[32:35], v[120:135]
    ds_read_b64_tr_b16 v[80:81], v14 offset:15424
    ds_read_b64_tr_b16 v[82:83], v14 offset:16192
    ds_read_b64_tr_b16 v[84:85], v14 offset:15488
    ds_read_b64_tr_b16 v[86:87], v14 offset:16256
    v_mfma_f32_32x32x16_bf16 v[136:151], v[48:51], v[32:35], v[136:151]
    v_mfma_f32_32x32x16_bf16 v[152:167], v[52:55], v[32:35], v[152:167]
    v_mfma_f32_32x32x16_bf16 v[168:183], v[56:59], v[32:35], v[168:183]
    s_waitcnt lgkmcnt(0)
    v_mfma_f32_32x32x16_bf16 v[88:103], v[64:67], v[60:63], v[88:103]
    ds_read_b128 v[32:35], v12
    ds_read_b64_tr_b16 v[36:37], v14 offset:6144
    ds_read_b64_tr_b16 v[38:39], v14 offset:6912
    ds_read_b64_tr_b16 v[40:41], v14 offset:6208
    ds_read_b64_tr_b16 v[42:43], v14 offset:6976
    v_mfma_f32_32x32x16_bf16 v[104:119], v[68:71], v[60:63], v[104:119]
    ds_read_b64_tr_b16 v[44:45], v14 offset:6272
    ds_read_b64_tr_b16 v[46:47], v14 offset:7040
    ds_read_b64_tr_b16 v[48:49], v14 offset:18432
    ds_read_b64_tr_b16 v[50:51], v14 offset:19200
    v_mfma_f32_32x32x16_bf16 v[120:135], v[72:75], v[60:63], v[120:135]
    ds_read_b64_tr_b16 v[52:53], v14 offset:18496
    ds_read_b64_tr_b16 v[54:55], v14 offset:19264
    ds_read_b64_tr_b16 v[56:57], v14 offset:18560
    ds_read_b64_tr_b16 v[58:59], v14 offset:19328
    v_mfma_f32_32x32x16_bf16 v[136:151], v[76:79], v[60:63], v[136:151]
    v_mfma_f32_32x32x16_bf16 v[152:167], v[80:83], v[60:63], v[152:167]
    v_mfma_f32_32x32x16_bf16 v[168:183], v[84:87], v[60:63], v[168:183]
    s_waitcnt lgkmcnt(0)
    v_mfma_f32_32x32x16_bf16 v[88:103], v[36:39], v[32:35], v[88:103]
    ds_read_b128 v[60:63], v13
    ds_read_b64_tr_b16 v[64:65], v14 offset:9216
    ds_read_b64_tr_b16 v[66:67], v14 offset:9984
    ds_read_b64_tr_b16 v[68:69], v14 offset:9280
    ds_read_b64_tr_b16 v[70:71], v14 offset:10048
    v_mfma_f32_32x32x16_bf16 v[104:119], v[40:43], v[32:35], v[104:119]
    ds_read_b64_tr_b16 v[72:73], v14 offset:9344
    ds_read_b64_tr_b16 v[74:75], v14 offset:10112
    ds_read_b64_tr_b16 v[76:77], v14 offset:21504
    ds_read_b64_tr_b16 v[78:79], v14 offset:22272
    v_mfma_f32_32x32x16_bf16 v[120:135], v[44:47], v[32:35], v[120:135]
    ds_read_b64_tr_b16 v[80:81], v14 offset:21568
    ds_read_b64_tr_b16 v[82:83], v14 offset:22336
    ds_read_b64_tr_b16 v[84:85], v14 offset:21632
    ds_read_b64_tr_b16 v[86:87], v14 offset:22400
    v_mfma_f32_32x32x16_bf16 v[136:151], v[48:51], v[32:35], v[136:151]
    v_mfma_f32_32x32x16_bf16 v[152:167], v[52:55], v[32:35], v[152:167]
    v_mfma_f32_32x32x16_bf16 v[168:183], v[56:59], v[32:35], v[168:183]
    s_waitcnt lgkmcnt(0)
    v_mfma_f32_32x32x16_bf16 v[88:103], v[64:67], v[60:63], v[88:103]
    s_barrier
    v_add_u32 v10, 0xffff4000, v10
    v_add_u32 v11, 0xffff4000, v11
    v_add_u32 v12, 0xffff4000, v12
    v_add_u32 v13, 0xffff4000, v13
    v_add_u32 v14, 0xfffee000, v14
    v_mfma_f32_32x32x16_bf16 v[104:119], v[68:71], v[60:63], v[104:119]
    ds_read_b128 v[32:35], v10
    ds_read_b64_tr_b16 v[36:37], v14 offset:0
    ds_read_b64_tr_b16 v[38:39], v14 offset:768
    ds_read_b64_tr_b16 v[40:41], v14 offset:64
    ds_read_b64_tr_b16 v[42:43], v14 offset:832
    v_mfma_f32_32x32x16_bf16 v[120:135], v[72:75], v[60:63], v[120:135]
    ds_read_b64_tr_b16 v[44:45], v14 offset:128
    ds_read_b64_tr_b16 v[46:47], v14 offset:896
    ds_read_b64_tr_b16 v[48:49], v14 offset:12288
    ds_read_b64_tr_b16 v[50:51], v14 offset:13056
    v_mfma_f32_32x32x16_bf16 v[136:151], v[76:79], v[60:63], v[136:151]
    ds_read_b64_tr_b16 v[52:53], v14 offset:12352
    ds_read_b64_tr_b16 v[54:55], v14 offset:13120
    ds_read_b64_tr_b16 v[56:57], v14 offset:12416
    ds_read_b64_tr_b16 v[58:59], v14 offset:13184
    v_mfma_f32_32x32x16_bf16 v[152:167], v[80:83], v[60:63], v[152:167]
    v_mfma_f32_32x32x16_bf16 v[168:183], v[84:87], v[60:63], v[168:183]
    s_waitcnt lgkmcnt(0)
    v_mfma_f32_32x32x16_bf16 v[88:103], v[36:39], v[32:35], v[88:103]
    ds_read_b128 v[60:63], v11
    ds_read_b64_tr_b16 v[64:65], v14 offset:3072
    ds_read_b64_tr_b16 v[66:67], v14 offset:3840
    ds_read_b64_tr_b16 v[68:69], v14 offset:3136
    ds_read_b64_tr_b16 v[70:71], v14 offset:3904
    v_mfma_f32_32x32x16_bf16 v[104:119], v[40:43], v[32:35], v[104:119]
    ds_read_b64_tr_b16 v[72:73], v14 offset:3200
    ds_read_b64_tr_b16 v[74:75], v14 offset:3968
    ds_read_b64_tr_b16 v[76:77], v14 offset:15360
    ds_read_b64_tr_b16 v[78:79], v14 offset:16128
    v_mfma_f32_32x32x16_bf16 v[120:135], v[44:47], v[32:35], v[120:135]
    ds_read_b64_tr_b16 v[80:81], v14 offset:15424
    ds_read_b64_tr_b16 v[82:83], v14 offset:16192
    ds_read_b64_tr_b16 v[84:85], v14 offset:15488
    ds_read_b64_tr_b16 v[86:87], v14 offset:16256
    v_mfma_f32_32x32x16_bf16 v[136:151], v[48:51], v[32:35], v[136:151]
    v_mfma_f32_32x32x16_bf16 v[152:167], v[52:55], v[32:35], v[152:167]
    v_mfma_f32_32x32x16_bf16 v[168:183], v[56:59], v[32:35], v[168:183]
    s_waitcnt lgkmcnt(0)
    v_mfma_f32_32x32x16_bf16 v[88:103], v[64:67], v[60:63], v[88:103]
    ds_read_b128 v[32:35], v12
    ds_read_b64_tr_b16 v[36:37], v14 offset:6144
    ds_read_b64_tr_b16 v[38:39], v14 offset:6912
    ds_read_b64_tr_b16 v[40:41], v14 offset:6208
    ds_read_b64_tr_b16 v[42:43], v14 offset:6976
    v_mfma_f32_32x32x16_bf16 v[104:119], v[68:71], v[60:63], v[104:119]
    ds_read_b64_tr_b16 v[44:45], v14 offset:6272
    ds_read_b64_tr_b16 v[46:47], v14 offset:7040
    ds_read_b64_tr_b16 v[48:49], v14 offset:18432
    ds_read_b64_tr_b16 v[50:51], v14 offset:19200
    v_mfma_f32_32x32x16_bf16 v[120:135], v[72:75], v[60:63], v[120:135]
    ds_read_b64_tr_b16 v[52:53], v14 offset:18496
    ds_read_b64_tr_b16 v[54:55], v14 offset:19264
    ds_read_b64_tr_b16 v[56:57], v14 offset:18560
    ds_read_b64_tr_b16 v[58:59], v14 offset:19328
    v_mfma_f32_32x32x16_bf16 v[136:151], v[76:79], v[60:63], v[136:151]
    v_mfma_f32_32x32x16_bf16 v[152:167], v[80:83], v[60:63], v[152:167]
    v_mfma_f32_32x32x16_bf16 v[168:183], v[84:87], v[60:63], v[168:183]
    s_waitcnt lgkmcnt(0)
    v_mfma_f32_32x32x16_bf16 v[88:103], v[36:39], v[32:35], v[88:103]
    ds_read_b128 v[60:63], v13
    ds_read_b64_tr_b16 v[64:65], v14 offset:9216
    ds_read_b64_tr_b16 v[66:67], v14 offset:9984
    ds_read_b64_tr_b16 v[68:69], v14 offset:9280
    ds_read_b64_tr_b16 v[70:71], v14 offset:10048
    v_mfma_f32_32x32x16_bf16 v[104:119], v[40:43], v[32:35], v[104:119]
    ds_read_b64_tr_b16 v[72:73], v14 offset:9344
    ds_read_b64_tr_b16 v[74:75], v14 offset:10112
    ds_read_b64_tr_b16 v[76:77], v14 offset:21504
    ds_read_b64_tr_b16 v[78:79], v14 offset:22272
    v_mfma_f32_32x32x16_bf16 v[120:135], v[44:47], v[32:35], v[120:135]
    ds_read_b64_tr_b16 v[80:81], v14 offset:21568
    ds_read_b64_tr_b16 v[82:83], v14 offset:22336
    ds_read_b64_tr_b16 v[84:85], v14 offset:21632
    ds_read_b64_tr_b16 v[86:87], v14 offset:22400
    v_mfma_f32_32x32x16_bf16 v[136:151], v[48:51], v[32:35], v[136:151]
    v_mfma_f32_32x32x16_bf16 v[152:167], v[52:55], v[32:35], v[152:167]
    v_mfma_f32_32x32x16_bf16 v[168:183], v[56:59], v[32:35], v[168:183]
    s_waitcnt lgkmcnt(0)
    v_mfma_f32_32x32x16_bf16 v[88:103], v[64:67], v[60:63], v[88:103]
    s_barrier
    v_add_u32 v10, 0x4000, v10
    v_add_u32 v11, 0x4000, v11
    v_add_u32 v12, 0x4000, v12
    v_add_u32 v13, 0x4000, v13
    v_add_u32 v14, 0x6000, v14
    v_mfma_f32_32x32x16_bf16 v[104:119], v[68:71], v[60:63], v[104:119]
    ds_read_b128 v[32:35], v10
    ds_read_b64_tr_b16 v[36:37], v14 offset:0
    ds_read_b64_tr_b16 v[38:39], v14 offset:768
    ds_read_b64_tr_b16 v[40:41], v14 offset:64
    ds_read_b64_tr_b16 v[42:43], v14 offset:832
    v_mfma_f32_32x32x16_bf16 v[120:135], v[72:75], v[60:63], v[120:135]
    ds_read_b64_tr_b16 v[44:45], v14 offset:128
    ds_read_b64_tr_b16 v[46:47], v14 offset:896
    ds_read_b64_tr_b16 v[48:49], v14 offset:12288
    ds_read_b64_tr_b16 v[50:51], v14 offset:13056
    v_mfma_f32_32x32x16_bf16 v[136:151], v[76:79], v[60:63], v[136:151]
    ds_read_b64_tr_b16 v[52:53], v14 offset:12352
    ds_read_b64_tr_b16 v[54:55], v14 offset:13120
    ds_read_b64_tr_b16 v[56:57], v14 offset:12416
    ds_read_b64_tr_b16 v[58:59], v14 offset:13184
    v_mfma_f32_32x32x16_bf16 v[152:167], v[80:83], v[60:63], v[152:167]
    v_mfma_f32_32x32x16_bf16 v[168:183], v[84:87], v[60:63], v[168:183]
    s_waitcnt lgkmcnt(0)
    v_mfma_f32_32x32x16_bf16 v[88:103], v[36:39], v[32:35], v[88:103]
    ds_read_b128 v[60:63], v11
    ds_read_b64_tr_b16 v[64:65], v14 offset:3072
    ds_read_b64_tr_b16 v[66:67], v14 offset:3840
    ds_read_b64_tr_b16 v[68:69], v14 offset:3136
    ds_read_b64_tr_b16 v[70:71], v14 offset:3904
    v_mfma_f32_32x32x16_bf16 v[104:119], v[40:43], v[32:35], v[104:119]
    ds_read_b64_tr_b16 v[72:73], v14 offset:3200
    ds_read_b64_tr_b16 v[74:75], v14 offset:3968
    ds_read_b64_tr_b16 v[76:77], v14 offset:15360
    ds_read_b64_tr_b16 v[78:79], v14 offset:16128
    v_mfma_f32_32x32x16_bf16 v[120:135], v[44:47], v[32:35], v[120:135]
    ds_read_b64_tr_b16 v[80:81], v14 offset:15424
    ds_read_b64_tr_b16 v[82:83], v14 offset:16192
    ds_read_b64_tr_b16 v[84:85], v14 offset:15488
    ds_read_b64_tr_b16 v[86:87], v14 offset:16256
    v_mfma_f32_32x32x16_bf16 v[136:151], v[48:51], v[32:35], v[136:151]
    v_mfma_f32_32x32x16_bf16 v[152:167], v[52:55], v[32:35], v[152:167]
    v_mfma_f32_32x32x16_bf16 v[168:183], v[56:59], v[32:35], v[168:183]
    s_waitcnt lgkmcnt(0)
    v_mfma_f32_32x32x16_bf16 v[88:103], v[64:67], v[60:63], v[88:103]
    ds_read_b128 v[32:35], v12
    ds_read_b64_tr_b16 v[36:37], v14 offset:6144
    ds_read_b64_tr_b16 v[38:39], v14 offset:6912
    ds_read_b64_tr_b16 v[40:41], v14 offset:6208
    ds_read_b64_tr_b16 v[42:43], v14 offset:6976
    v_mfma_f32_32x32x16_bf16 v[104:119], v[68:71], v[60:63], v[104:119]
    ds_read_b64_tr_b16 v[44:45], v14 offset:6272
    ds_read_b64_tr_b16 v[46:47], v14 offset:7040
    ds_read_b64_tr_b16 v[48:49], v14 offset:18432
    ds_read_b64_tr_b16 v[50:51], v14 offset:19200
    v_mfma_f32_32x32x16_bf16 v[120:135], v[72:75], v[60:63], v[120:135]
    ds_read_b64_tr_b16 v[52:53], v14 offset:18496
    ds_read_b64_tr_b16 v[54:55], v14 offset:19264
    ds_read_b64_tr_b16 v[56:57], v14 offset:18560
    ds_read_b64_tr_b16 v[58:59], v14 offset:19328
    v_mfma_f32_32x32x16_bf16 v[136:151], v[76:79], v[60:63], v[136:151]
    v_mfma_f32_32x32x16_bf16 v[152:167], v[80:83], v[60:63], v[152:167]
    v_mfma_f32_32x32x16_bf16 v[168:183], v[84:87], v[60:63], v[168:183]
    s_waitcnt lgkmcnt(0)
    v_mfma_f32_32x32x16_bf16 v[88:103], v[36:39], v[32:35], v[88:103]
    ds_read_b128 v[60:63], v13
    ds_read_b64_tr_b16 v[64:65], v14 offset:9216
    ds_read_b64_tr_b16 v[66:67], v14 offset:9984
    ds_read_b64_tr_b16 v[68:69], v14 offset:9280
    ds_read_b64_tr_b16 v[70:71], v14 offset:10048
    v_mfma_f32_32x32x16_bf16 v[104:119], v[40:43], v[32:35], v[104:119]
    ds_read_b64_tr_b16 v[72:73], v14 offset:9344
    ds_read_b64_tr_b16 v[74:75], v14 offset:10112
    ds_read_b64_tr_b16 v[76:77], v14 offset:21504
    ds_read_b64_tr_b16 v[78:79], v14 offset:22272
    v_mfma_f32_32x32x16_bf16 v[120:135], v[44:47], v[32:35], v[120:135]
    ds_read_b64_tr_b16 v[80:81], v14 offset:21568
    ds_read_b64_tr_b16 v[82:83], v14 offset:22336
    ds_read_b64_tr_b16 v[84:85], v14 offset:21632
    ds_read_b64_tr_b16 v[86:87], v14 offset:22400
    v_mfma_f32_32x32x16_bf16 v[136:151], v[48:51], v[32:35], v[136:151]
    v_mfma_f32_32x32x16_bf16 v[152:167], v[52:55], v[32:35], v[152:167]
    v_mfma_f32_32x32x16_bf16 v[168:183], v[56:59], v[32:35], v[168:183]
    s_waitcnt lgkmcnt(0)
    v_mfma_f32_32x32x16_bf16 v[88:103], v[64:67], v[60:63], v[88:103]
    s_barrier
    v_add_u32 v10, 0x4000, v10
    v_add_u32 v11, 0x4000, v11
    v_add_u32 v12, 0x4000, v12
    v_add_u32 v13, 0x4000, v13
    v_add_u32 v14, 0x6000, v14
    v_mfma_f32_32x32x16_bf16 v[104:119], v[68:71], v[60:63], v[104:119]
    ds_read_b128 v[32:35], v10
    ds_read_b64_tr_b16 v[36:37], v14 offset:0
    ds_read_b64_tr_b16 v[38:39], v14 offset:768
    ds_read_b64_tr_b16 v[40:41], v14 offset:64
    ds_read_b64_tr_b16 v[42:43], v14 offset:832
    v_mfma_f32_32x32x16_bf16 v[120:135], v[72:75], v[60:63], v[120:135]
    ds_read_b64_tr_b16 v[44:45], v14 offset:128
    ds_read_b64_tr_b16 v[46:47], v14 offset:896
    ds_read_b64_tr_b16 v[48:49], v14 offset:12288
    ds_read_b64_tr_b16 v[50:51], v14 offset:13056
    v_mfma_f32_32x32x16_bf16 v[136:151], v[76:79], v[60:63], v[136:151]
    ds_read_b64_tr_b16 v[52:53], v14 offset:12352
    ds_read_b64_tr_b16 v[54:55], v14 offset:13120
    ds_read_b64_tr_b16 v[56:57], v14 offset:12416
    ds_read_b64_tr_b16 v[58:59], v14 offset:13184
    v_mfma_f32_32x32x16_bf16 v[152:167], v[80:83], v[60:63], v[152:167]
    v_mfma_f32_32x32x16_bf16 v[168:183], v[84:87], v[60:63], v[168:183]
    s_waitcnt lgkmcnt(0)
    v_mfma_f32_32x32x16_bf16 v[88:103], v[36:39], v[32:35], v[88:103]
    ds_read_b128 v[60:63], v11
    ds_read_b64_tr_b16 v[64:65], v14 offset:3072
    ds_read_b64_tr_b16 v[66:67], v14 offset:3840
    ds_read_b64_tr_b16 v[68:69], v14 offset:3136
    ds_read_b64_tr_b16 v[70:71], v14 offset:3904
    v_mfma_f32_32x32x16_bf16 v[104:119], v[40:43], v[32:35], v[104:119]
    ds_read_b64_tr_b16 v[72:73], v14 offset:3200
    ds_read_b64_tr_b16 v[74:75], v14 offset:3968
    ds_read_b64_tr_b16 v[76:77], v14 offset:15360
    ds_read_b64_tr_b16 v[78:79], v14 offset:16128
    v_mfma_f32_32x32x16_bf16 v[120:135], v[44:47], v[32:35], v[120:135]
    ds_read_b64_tr_b16 v[80:81], v14 offset:15424
    ds_read_b64_tr_b16 v[82:83], v14 offset:16192
    ds_read_b64_tr_b16 v[84:85], v14 offset:15488
    ds_read_b64_tr_b16 v[86:87], v14 offset:16256
    v_mfma_f32_32x32x16_bf16 v[136:151], v[48:51], v[32:35], v[136:151]
    v_mfma_f32_32x32x16_bf16 v[152:167], v[52:55], v[32:35], v[152:167]
    v_mfma_f32_32x32x16_bf16 v[168:183], v[56:59], v[32:35], v[168:183]
    s_waitcnt lgkmcnt(0)
    v_mfma_f32_32x32x16_bf16 v[88:103], v[64:67], v[60:63], v[88:103]
    ds_read_b128 v[32:35], v12
    ds_read_b64_tr_b16 v[36:37], v14 offset:6144
    ds_read_b64_tr_b16 v[38:39], v14 offset:6912
    ds_read_b64_tr_b16 v[40:41], v14 offset:6208
    ds_read_b64_tr_b16 v[42:43], v14 offset:6976
    v_mfma_f32_32x32x16_bf16 v[104:119], v[68:71], v[60:63], v[104:119]
    ds_read_b64_tr_b16 v[44:45], v14 offset:6272
    ds_read_b64_tr_b16 v[46:47], v14 offset:7040
    ds_read_b64_tr_b16 v[48:49], v14 offset:18432
    ds_read_b64_tr_b16 v[50:51], v14 offset:19200
    v_mfma_f32_32x32x16_bf16 v[120:135], v[72:75], v[60:63], v[120:135]
    ds_read_b64_tr_b16 v[52:53], v14 offset:18496
    ds_read_b64_tr_b16 v[54:55], v14 offset:19264
    ds_read_b64_tr_b16 v[56:57], v14 offset:18560
    ds_read_b64_tr_b16 v[58:59], v14 offset:19328
    v_mfma_f32_32x32x16_bf16 v[136:151], v[76:79], v[60:63], v[136:151]
    v_mfma_f32_32x32x16_bf16 v[152:167], v[80:83], v[60:63], v[152:167]
    v_mfma_f32_32x32x16_bf16 v[168:183], v[84:87], v[60:63], v[168:183]
    s_waitcnt lgkmcnt(0)
    v_mfma_f32_32x32x16_bf16 v[88:103], v[36:39], v[32:35], v[88:103]
    ds_read_b128 v[60:63], v13
    ds_read_b64_tr_b16 v[64:65], v14 offset:9216
    ds_read_b64_tr_b16 v[66:67], v14 offset:9984
    ds_read_b64_tr_b16 v[68:69], v14 offset:9280
    ds_read_b64_tr_b16 v[70:71], v14 offset:10048
    v_mfma_f32_32x32x16_bf16 v[104:119], v[40:43], v[32:35], v[104:119]
    ds_read_b64_tr_b16 v[72:73], v14 offset:9344
    ds_read_b64_tr_b16 v[74:75], v14 offset:10112
    ds_read_b64_tr_b16 v[76:77], v14 offset:21504
    ds_read_b64_tr_b16 v[78:79], v14 offset:22272
    v_mfma_f32_32x32x16_bf16 v[120:135], v[44:47], v[32:35], v[120:135]
    ds_read_b64_tr_b16 v[80:81], v14 offset:21568
    ds_read_b64_tr_b16 v[82:83], v14 offset:22336
    ds_read_b64_tr_b16 v[84:85], v14 offset:21632
    ds_read_b64_tr_b16 v[86:87], v14 offset:22400
    v_mfma_f32_32x32x16_bf16 v[136:151], v[48:51], v[32:35], v[136:151]
    v_mfma_f32_32x32x16_bf16 v[152:167], v[52:55], v[32:35], v[152:167]
    v_mfma_f32_32x32x16_bf16 v[168:183], v[56:59], v[32:35], v[168:183]
    s_waitcnt lgkmcnt(0)
    v_mfma_f32_32x32x16_bf16 v[88:103], v[64:67], v[60:63], v[88:103]
    s_barrier
    v_add_u32 v10, 0x4000, v10
    v_add_u32 v11, 0x4000, v11
    v_add_u32 v12, 0x4000, v12
    v_add_u32 v13, 0x4000, v13
    v_add_u32 v14, 0x6000, v14
    v_mfma_f32_32x32x16_bf16 v[104:119], v[68:71], v[60:63], v[104:119]
    ds_read_b128 v[32:35], v10
    ds_read_b64_tr_b16 v[36:37], v14 offset:0
    ds_read_b64_tr_b16 v[38:39], v14 offset:768
    ds_read_b64_tr_b16 v[40:41], v14 offset:64
    ds_read_b64_tr_b16 v[42:43], v14 offset:832
    v_mfma_f32_32x32x16_bf16 v[120:135], v[72:75], v[60:63], v[120:135]
    ds_read_b64_tr_b16 v[44:45], v14 offset:128
    ds_read_b64_tr_b16 v[46:47], v14 offset:896
    ds_read_b64_tr_b16 v[48:49], v14 offset:12288
    ds_read_b64_tr_b16 v[50:51], v14 offset:13056
    v_mfma_f32_32x32x16_bf16 v[136:151], v[76:79], v[60:63], v[136:151]
    ds_read_b64_tr_b16 v[52:53], v14 offset:12352
    ds_read_b64_tr_b16 v[54:55], v14 offset:13120
    ds_read_b64_tr_b16 v[56:57], v14 offset:12416
    ds_read_b64_tr_b16 v[58:59], v14 offset:13184
    v_mfma_f32_32x32x16_bf16 v[152:167], v[80:83], v[60:63], v[152:167]
    v_mfma_f32_32x32x16_bf16 v[168:183], v[84:87], v[60:63], v[168:183]
    s_waitcnt lgkmcnt(0)
    v_mfma_f32_32x32x16_bf16 v[88:103], v[36:39], v[32:35], v[88:103]
    ds_read_b128 v[60:63], v11
    ds_read_b64_tr_b16 v[64:65], v14 offset:3072
    ds_read_b64_tr_b16 v[66:67], v14 offset:3840
    ds_read_b64_tr_b16 v[68:69], v14 offset:3136
    ds_read_b64_tr_b16 v[70:71], v14 offset:3904
    v_mfma_f32_32x32x16_bf16 v[104:119], v[40:43], v[32:35], v[104:119]
    ds_read_b64_tr_b16 v[72:73], v14 offset:3200
    ds_read_b64_tr_b16 v[74:75], v14 offset:3968
    ds_read_b64_tr_b16 v[76:77], v14 offset:15360
    ds_read_b64_tr_b16 v[78:79], v14 offset:16128
    v_mfma_f32_32x32x16_bf16 v[120:135], v[44:47], v[32:35], v[120:135]
    ds_read_b64_tr_b16 v[80:81], v14 offset:15424
    ds_read_b64_tr_b16 v[82:83], v14 offset:16192
    ds_read_b64_tr_b16 v[84:85], v14 offset:15488
    ds_read_b64_tr_b16 v[86:87], v14 offset:16256
    v_mfma_f32_32x32x16_bf16 v[136:151], v[48:51], v[32:35], v[136:151]
    v_mfma_f32_32x32x16_bf16 v[152:167], v[52:55], v[32:35], v[152:167]
    v_mfma_f32_32x32x16_bf16 v[168:183], v[56:59], v[32:35], v[168:183]
    s_waitcnt lgkmcnt(0)
    v_mfma_f32_32x32x16_bf16 v[88:103], v[64:67], v[60:63], v[88:103]
    ds_read_b128 v[32:35], v12
    ds_read_b64_tr_b16 v[36:37], v14 offset:6144
    ds_read_b64_tr_b16 v[38:39], v14 offset:6912
    ds_read_b64_tr_b16 v[40:41], v14 offset:6208
    ds_read_b64_tr_b16 v[42:43], v14 offset:6976
    v_mfma_f32_32x32x16_bf16 v[104:119], v[68:71], v[60:63], v[104:119]
    ds_read_b64_tr_b16 v[44:45], v14 offset:6272
    ds_read_b64_tr_b16 v[46:47], v14 offset:7040
    ds_read_b64_tr_b16 v[48:49], v14 offset:18432
    ds_read_b64_tr_b16 v[50:51], v14 offset:19200
    v_mfma_f32_32x32x16_bf16 v[120:135], v[72:75], v[60:63], v[120:135]
    ds_read_b64_tr_b16 v[52:53], v14 offset:18496
    ds_read_b64_tr_b16 v[54:55], v14 offset:19264
    ds_read_b64_tr_b16 v[56:57], v14 offset:18560
    ds_read_b64_tr_b16 v[58:59], v14 offset:19328
    v_mfma_f32_32x32x16_bf16 v[136:151], v[76:79], v[60:63], v[136:151]
    v_mfma_f32_32x32x16_bf16 v[152:167], v[80:83], v[60:63], v[152:167]
    v_mfma_f32_32x32x16_bf16 v[168:183], v[84:87], v[60:63], v[168:183]
    s_waitcnt lgkmcnt(0)
    v_mfma_f32_32x32x16_bf16 v[88:103], v[36:39], v[32:35], v[88:103]
    ds_read_b128 v[60:63], v13
    ds_read_b64_tr_b16 v[64:65], v14 offset:9216
    ds_read_b64_tr_b16 v[66:67], v14 offset:9984
    ds_read_b64_tr_b16 v[68:69], v14 offset:9280
    ds_read_b64_tr_b16 v[70:71], v14 offset:10048
    v_mfma_f32_32x32x16_bf16 v[104:119], v[40:43], v[32:35], v[104:119]
    ds_read_b64_tr_b16 v[72:73], v14 offset:9344
    ds_read_b64_tr_b16 v[74:75], v14 offset:10112
    ds_read_b64_tr_b16 v[76:77], v14 offset:21504
    ds_read_b64_tr_b16 v[78:79], v14 offset:22272
    v_mfma_f32_32x32x16_bf16 v[120:135], v[44:47], v[32:35], v[120:135]
    ds_read_b64_tr_b16 v[80:81], v14 offset:21568
    ds_read_b64_tr_b16 v[82:83], v14 offset:22336
    ds_read_b64_tr_b16 v[84:85], v14 offset:21632
    ds_read_b64_tr_b16 v[86:87], v14 offset:22400
    v_mfma_f32_32x32x16_bf16 v[136:151], v[48:51], v[32:35], v[136:151]
    v_mfma_f32_32x32x16_bf16 v[152:167], v[52:55], v[32:35], v[152:167]
    v_mfma_f32_32x32x16_bf16 v[168:183], v[56:59], v[32:35], v[168:183]
    s_waitcnt lgkmcnt(0)
    v_mfma_f32_32x32x16_bf16 v[88:103], v[64:67], v[60:63], v[88:103]
    v_mfma_f32_32x32x16_bf16 v[104:119], v[68:71], v[60:63], v[104:119]
    v_mfma_f32_32x32x16_bf16 v[120:135], v[72:75], v[60:63], v[120:135]
    v_mfma_f32_32x32x16_bf16 v[136:151], v[76:79], v[60:63], v[136:151]
    v_mfma_f32_32x32x16_bf16 v[152:167], v[80:83], v[60:63], v[152:167]
    v_mfma_f32_32x32x16_bf16 v[168:183], v[84:87], v[60:63], v[168:183]
    buffer_load_dwordx4 v[32:35], v30, s[68:71], 0 offen offset:256 sc1
    buffer_load_dwordx4 v[36:39], v30, s[68:71], 0 offen offset:288 sc1
    buffer_load_dwordx4 v[40:43], v30, s[68:71], 0 offen offset:320 sc1
    buffer_load_dwordx4 v[44:47], v30, s[68:71], 0 offen offset:352 sc1
    s_barrier
    buffer_load_dwordx4 v[60:63], v31, s[68:71], 0 offen offset:256 sc1
    buffer_load_dwordx4 v[64:67], v31, s[68:71], 0 offen offset:288 sc1
    buffer_load_dwordx4 v[68:71], v31, s[68:71], 0 offen offset:320 sc1
    buffer_load_dwordx4 v[72:75], v31, s[68:71], 0 offen offset:352 sc1
    s_mul_i32 s32, s29, 6656
    v_and_b32 v25, 31, v1
    v_mul_u32_u24 v25, 208, v25
    v_lshrrev_b32 v26, 5, v1
    v_lshl_add_u32 v25, v26, 3, v25
    v_add_u32 v25, s32, v25
    s_lshl_b32 s33, s26, 7
    s_lshl_b32 s38, s29, 5
    s_add_u32 s33, s33, s38
    s_mul_i32 s38, s27, 192
    s_mov_b32 s39, 43691
    v_mov_b32 v16, 0xbfb8aa3b
    v_mov_b32 v17, 0xbfb8aa3b
    v_mov_b32 v18, 1.0
    v_mov_b32 v19, 1.0
    s_waitcnt vmcnt(8)
    v_pk_fma_f32 v[88:89], v[184:185], v[188:189], v[88:89] neg_lo:[1,0,0] neg_hi:[1,0,0]
    v_pk_fma_f32 v[136:137], v[184:185], v[204:205], v[136:137] neg_lo:[1,0,0] neg_hi:[1,0,0]
    v_pk_mul_f32 v[88:89], v[88:89], v[186:187]
    v_pk_mul_f32 v[136:137], v[136:137], v[186:187]
    v_cvt_pk_bf16_f32 v20, v88, v89
    v_cvt_pk_bf16_f32 v21, v136, v137
    v_lshlrev_b32 v88, 16, v20
    v_and_b32 v89, 0xffff0000, v20
    v_lshlrev_b32 v136, 16, v21
    v_and_b32 v137, 0xffff0000, v21
    v_pk_mul_f32 v[88:89], v[88:89], v[16:17]
    v_exp_f32 v88, v88
    v_exp_f32 v89, v89
    s_nop 0
    v_pk_add_f32 v[88:89], v[88:89], v[18:19]
    v_rcp_f32 v88, v88
    v_rcp_f32 v89, v89
    s_nop 0
    v_cvt_pk_bf16_f32 v20, v88, v89
    v_lshlrev_b32 v88, 16, v20
    v_and_b32 v89, 0xffff0000, v20
    v_pk_mul_f32 v[88:89], v[88:89], v[136:137]
    v_pk_fma_f32 v[90:91], v[184:185], v[190:191], v[90:91] neg_lo:[1,0,0] neg_hi:[1,0,0]
    v_pk_fma_f32 v[138:139], v[184:185], v[206:207], v[138:139] neg_lo:[1,0,0] neg_hi:[1,0,0]
    v_pk_mul_f32 v[90:91], v[90:91], v[186:187]
    v_pk_mul_f32 v[138:139], v[138:139], v[186:187]
    v_cvt_pk_bf16_f32 v20, v90, v91
    v_cvt_pk_bf16_f32 v21, v138, v139
    v_lshlrev_b32 v90, 16, v20
    v_and_b32 v91, 0xffff0000, v20
    v_lshlrev_b32 v138, 16, v21
    v_and_b32 v139, 0xffff0000, v21
    v_pk_mul_f32 v[90:91], v[90:91], v[16:17]
    v_exp_f32 v90, v90
    v_exp_f32 v91, v91
    s_nop 0
    v_pk_add_f32 v[90:91], v[90:91], v[18:19]
    v_rcp_f32 v90, v90
    v_rcp_f32 v91, v91
    s_nop 0
    v_cvt_pk_bf16_f32 v20, v90, v91
    v_lshlrev_b32 v90, 16, v20
    v_and_b32 v91, 0xffff0000, v20
    v_pk_mul_f32 v[90:91], v[90:91], v[138:139]
    v_pk_fma_f32 v[92:93], v[184:185], v[192:193], v[92:93] neg_lo:[1,0,0] neg_hi:[1,0,0]
    v_pk_fma_f32 v[140:141], v[184:185], v[208:209], v[140:141] neg_lo:[1,0,0] neg_hi:[1,0,0]
    v_pk_mul_f32 v[92:93], v[92:93], v[186:187]
    v_pk_mul_f32 v[140:141], v[140:141], v[186:187]
    v_cvt_pk_bf16_f32 v20, v92, v93
    v_cvt_pk_bf16_f32 v21, v140, v141
    v_lshlrev_b32 v92, 16, v20
    v_and_b32 v93, 0xffff0000, v20
    v_lshlrev_b32 v140, 16, v21
    v_and_b32 v141, 0xffff0000, v21
    v_pk_mul_f32 v[92:93], v[92:93], v[16:17]
    v_exp_f32 v92, v92
    v_exp_f32 v93, v93
    s_nop 0
    v_pk_add_f32 v[92:93], v[92:93], v[18:19]
    v_rcp_f32 v92, v92
    v_rcp_f32 v93, v93
    s_nop 0
    v_cvt_pk_bf16_f32 v20, v92, v93
    v_lshlrev_b32 v92, 16, v20
    v_and_b32 v93, 0xffff0000, v20
    v_pk_mul_f32 v[92:93], v[92:93], v[140:141]
    v_pk_fma_f32 v[94:95], v[184:185], v[194:195], v[94:95] neg_lo:[1,0,0] neg_hi:[1,0,0]
    v_pk_fma_f32 v[142:143], v[184:185], v[210:211], v[142:143] neg_lo:[1,0,0] neg_hi:[1,0,0]
    v_pk_mul_f32 v[94:95], v[94:95], v[186:187]
    v_pk_mul_f32 v[142:143], v[142:143], v[186:187]
    v_cvt_pk_bf16_f32 v20, v94, v95
    v_cvt_pk_bf16_f32 v21, v142, v143
    v_lshlrev_b32 v94, 16, v20
    v_and_b32 v95, 0xffff0000, v20
    v_lshlrev_b32 v142, 16, v21
    v_and_b32 v143, 0xffff0000, v21
    v_pk_mul_f32 v[94:95], v[94:95], v[16:17]
    v_exp_f32 v94, v94
    v_exp_f32 v95, v95
    s_nop 0
    v_pk_add_f32 v[94:95], v[94:95], v[18:19]
    v_rcp_f32 v94, v94
    v_rcp_f32 v95, v95
    s_nop 0
    v_cvt_pk_bf16_f32 v20, v94, v95
    v_lshlrev_b32 v94, 16, v20
    v_and_b32 v95, 0xffff0000, v20
    v_pk_mul_f32 v[94:95], v[94:95], v[142:143]
    v_pk_fma_f32 v[96:97], v[184:185], v[196:197], v[96:97] neg_lo:[1,0,0] neg_hi:[1,0,0]
    v_pk_fma_f32 v[144:145], v[184:185], v[212:213], v[144:145] neg_lo:[1,0,0] neg_hi:[1,0,0]
    v_pk_mul_f32 v[96:97], v[96:97], v[186:187]
    v_pk_mul_f32 v[144:145], v[144:145], v[186:187]
    v_cvt_pk_bf16_f32 v20, v96, v97
    v_cvt_pk_bf16_f32 v21, v144, v145
    v_lshlrev_b32 v96, 16, v20
    v_and_b32 v97, 0xffff0000, v20
    v_lshlrev_b32 v144, 16, v21
    v_and_b32 v145, 0xffff0000, v21
    v_pk_mul_f32 v[96:97], v[96:97], v[16:17]
    v_exp_f32 v96, v96
    v_exp_f32 v97, v97
    s_nop 0
    v_pk_add_f32 v[96:97], v[96:97], v[18:19]
    v_rcp_f32 v96, v96
    v_rcp_f32 v97, v97
    s_nop 0
    v_cvt_pk_bf16_f32 v20, v96, v97
    v_lshlrev_b32 v96, 16, v20
    v_and_b32 v97, 0xffff0000, v20
    v_pk_mul_f32 v[96:97], v[96:97], v[144:145]
    v_pk_fma_f32 v[98:99], v[184:185], v[198:199], v[98:99] neg_lo:[1,0,0] neg_hi:[1,0,0]
    v_pk_fma_f32 v[146:147], v[184:185], v[214:215], v[146:147] neg_lo:[1,0,0] neg_hi:[1,0,0]
    v_pk_mul_f32 v[98:99], v[98:99], v[186:187]
    v_pk_mul_f32 v[146:147], v[146:147], v[186:187]
    v_cvt_pk_bf16_f32 v20, v98, v99
    v_cvt_pk_bf16_f32 v21, v146, v147
    v_lshlrev_b32 v98, 16, v20
    v_and_b32 v99, 0xffff0000, v20
    v_lshlrev_b32 v146, 16, v21
    v_and_b32 v147, 0xffff0000, v21
    v_pk_mul_f32 v[98:99], v[98:99], v[16:17]
    v_exp_f32 v98, v98
    v_exp_f32 v99, v99
    s_nop 0
    v_pk_add_f32 v[98:99], v[98:99], v[18:19]
    v_rcp_f32 v98, v98
    v_rcp_f32 v99, v99
    s_nop 0
    v_cvt_pk_bf16_f32 v20, v98, v99
    v_lshlrev_b32 v98, 16, v20
    v_and_b32 v99, 0xffff0000, v20
    v_pk_mul_f32 v[98:99], v[98:99], v[146:147]
    v_pk_fma_f32 v[100:101], v[184:185], v[200:201], v[100:101] neg_lo:[1,0,0] neg_hi:[1,0,0]
    v_pk_fma_f32 v[148:149], v[184:185], v[216:217], v[148:149] neg_lo:[1,0,0] neg_hi:[1,0,0]
    v_pk_mul_f32 v[100:101], v[100:101], v[186:187]
    v_pk_mul_f32 v[148:149], v[148:149], v[186:187]
    v_cvt_pk_bf16_f32 v20, v100, v101
    v_cvt_pk_bf16_f32 v21, v148, v149
    v_lshlrev_b32 v100, 16, v20
    v_and_b32 v101, 0xffff0000, v20
    v_lshlrev_b32 v148, 16, v21
    v_and_b32 v149, 0xffff0000, v21
    v_pk_mul_f32 v[100:101], v[100:101], v[16:17]
    v_exp_f32 v100, v100
    v_exp_f32 v101, v101
    s_nop 0
    v_pk_add_f32 v[100:101], v[100:101], v[18:19]
    v_rcp_f32 v100, v100
    v_rcp_f32 v101, v101
    s_nop 0
    v_cvt_pk_bf16_f32 v20, v100, v101
    v_lshlrev_b32 v100, 16, v20
    v_and_b32 v101, 0xffff0000, v20
    v_pk_mul_f32 v[100:101], v[100:101], v[148:149]
    v_pk_fma_f32 v[102:103], v[184:185], v[202:203], v[102:103] neg_lo:[1,0,0] neg_hi:[1,0,0]
    v_pk_fma_f32 v[150:151], v[184:185], v[218:219], v[150:151] neg_lo:[1,0,0] neg_hi:[1,0,0]
    v_pk_mul_f32 v[102:103], v[102:103], v[186:187]
    v_pk_mul_f32 v[150:151], v[150:151], v[186:187]
    v_cvt_pk_bf16_f32 v20, v102, v103
    v_cvt_pk_bf16_f32 v21, v150, v151
    v_lshlrev_b32 v102, 16, v20
    v_and_b32 v103, 0xffff0000, v20
    v_lshlrev_b32 v150, 16, v21
    v_and_b32 v151, 0xffff0000, v21
    v_pk_mul_f32 v[102:103], v[102:103], v[16:17]
    v_exp_f32 v102, v102
    v_exp_f32 v103, v103
    s_nop 0
    v_pk_add_f32 v[102:103], v[102:103], v[18:19]
    v_rcp_f32 v102, v102
    v_rcp_f32 v103, v103
    s_nop 0
    v_cvt_pk_bf16_f32 v20, v102, v103
    v_lshlrev_b32 v102, 16, v20
    v_and_b32 v103, 0xffff0000, v20
    v_pk_mul_f32 v[102:103], v[102:103], v[150:151]
    v_cvt_pk_bf16_f32 v2, v88, v89
    v_cvt_pk_bf16_f32 v3, v90, v91
    ds_write_b64 v25, v[2:3] offset:0
    v_cvt_pk_bf16_f32 v4, v92, v93
    v_cvt_pk_bf16_f32 v5, v94, v95
    ds_write_b64 v25, v[4:5] offset:16
    v_cvt_pk_bf16_f32 v6, v96, v97
    v_cvt_pk_bf16_f32 v7, v98, v99
    ds_write_b64 v25, v[6:7] offset:32
    v_cvt_pk_bf16_f32 v8, v100, v101
    v_cvt_pk_bf16_f32 v9, v102, v103
    ds_write_b64 v25, v[8:9] offset:48
    v_pk_fma_f32 v[104:105], v[184:185], v[220:221], v[104:105] neg_lo:[1,0,0] neg_hi:[1,0,0]
    v_pk_fma_f32 v[152:153], v[184:185], v[236:237], v[152:153] neg_lo:[1,0,0] neg_hi:[1,0,0]
    v_pk_mul_f32 v[104:105], v[104:105], v[186:187]
    v_pk_mul_f32 v[152:153], v[152:153], v[186:187]
    v_cvt_pk_bf16_f32 v20, v104, v105
    v_cvt_pk_bf16_f32 v21, v152, v153
    v_lshlrev_b32 v104, 16, v20
    v_and_b32 v105, 0xffff0000, v20
    v_lshlrev_b32 v152, 16, v21
    v_and_b32 v153, 0xffff0000, v21
    v_pk_mul_f32 v[104:105], v[104:105], v[16:17]
    v_exp_f32 v104, v104
    v_exp_f32 v105, v105
    s_nop 0
    v_pk_add_f32 v[104:105], v[104:105], v[18:19]
    v_rcp_f32 v104, v104
    v_rcp_f32 v105, v105
    s_nop 0
    v_cvt_pk_bf16_f32 v20, v104, v105
    v_lshlrev_b32 v104, 16, v20
    v_and_b32 v105, 0xffff0000, v20
    v_pk_mul_f32 v[104:105], v[104:105], v[152:153]
    v_pk_fma_f32 v[106:107], v[184:185], v[222:223], v[106:107] neg_lo:[1,0,0] neg_hi:[1,0,0]
    v_pk_fma_f32 v[154:155], v[184:185], v[238:239], v[154:155] neg_lo:[1,0,0] neg_hi:[1,0,0]
    v_pk_mul_f32 v[106:107], v[106:107], v[186:187]
    v_pk_mul_f32 v[154:155], v[154:155], v[186:187]
    v_cvt_pk_bf16_f32 v20, v106, v107
    v_cvt_pk_bf16_f32 v21, v154, v155
    v_lshlrev_b32 v106, 16, v20
    v_and_b32 v107, 0xffff0000, v20
    v_lshlrev_b32 v154, 16, v21
    v_and_b32 v155, 0xffff0000, v21
    v_pk_mul_f32 v[106:107], v[106:107], v[16:17]
    v_exp_f32 v106, v106
    v_exp_f32 v107, v107
    s_nop 0
    v_pk_add_f32 v[106:107], v[106:107], v[18:19]
    v_rcp_f32 v106, v106
    v_rcp_f32 v107, v107
    s_nop 0
    v_cvt_pk_bf16_f32 v20, v106, v107
    v_lshlrev_b32 v106, 16, v20
    v_and_b32 v107, 0xffff0000, v20
    v_pk_mul_f32 v[106:107], v[106:107], v[154:155]
    v_pk_fma_f32 v[108:109], v[184:185], v[224:225], v[108:109] neg_lo:[1,0,0] neg_hi:[1,0,0]
    v_pk_fma_f32 v[156:157], v[184:185], v[240:241], v[156:157] neg_lo:[1,0,0] neg_hi:[1,0,0]
    v_pk_mul_f32 v[108:109], v[108:109], v[186:187]
    v_pk_mul_f32 v[156:157], v[156:157], v[186:187]
    v_cvt_pk_bf16_f32 v20, v108, v109
    v_cvt_pk_bf16_f32 v21, v156, v157
    v_lshlrev_b32 v108, 16, v20
    v_and_b32 v109, 0xffff0000, v20
    v_lshlrev_b32 v156, 16, v21
    v_and_b32 v157, 0xffff0000, v21
    v_pk_mul_f32 v[108:109], v[108:109], v[16:17]
    v_exp_f32 v108, v108
    v_exp_f32 v109, v109
    s_nop 0
    v_pk_add_f32 v[108:109], v[108:109], v[18:19]
    v_rcp_f32 v108, v108
    v_rcp_f32 v109, v109
    s_nop 0
    v_cvt_pk_bf16_f32 v20, v108, v109
    v_lshlrev_b32 v108, 16, v20
    v_and_b32 v109, 0xffff0000, v20
    v_pk_mul_f32 v[108:109], v[108:109], v[156:157]
    v_pk_fma_f32 v[110:111], v[184:185], v[226:227], v[110:111] neg_lo:[1,0,0] neg_hi:[1,0,0]
    v_pk_fma_f32 v[158:159], v[184:185], v[242:243], v[158:159] neg_lo:[1,0,0] neg_hi:[1,0,0]
    v_pk_mul_f32 v[110:111], v[110:111], v[186:187]
    v_pk_mul_f32 v[158:159], v[158:159], v[186:187]
    v_cvt_pk_bf16_f32 v20, v110, v111
    v_cvt_pk_bf16_f32 v21, v158, v159
    v_lshlrev_b32 v110, 16, v20
    v_and_b32 v111, 0xffff0000, v20
    v_lshlrev_b32 v158, 16, v21
    v_and_b32 v159, 0xffff0000, v21
    v_pk_mul_f32 v[110:111], v[110:111], v[16:17]
    v_exp_f32 v110, v110
    v_exp_f32 v111, v111
    s_nop 0
    v_pk_add_f32 v[110:111], v[110:111], v[18:19]
    v_rcp_f32 v110, v110
    v_rcp_f32 v111, v111
    s_nop 0
    v_cvt_pk_bf16_f32 v20, v110, v111
    v_lshlrev_b32 v110, 16, v20
    v_and_b32 v111, 0xffff0000, v20
    v_pk_mul_f32 v[110:111], v[110:111], v[158:159]
    v_pk_fma_f32 v[112:113], v[184:185], v[228:229], v[112:113] neg_lo:[1,0,0] neg_hi:[1,0,0]
    v_pk_fma_f32 v[160:161], v[184:185], v[244:245], v[160:161] neg_lo:[1,0,0] neg_hi:[1,0,0]
    v_pk_mul_f32 v[112:113], v[112:113], v[186:187]
    v_pk_mul_f32 v[160:161], v[160:161], v[186:187]
    v_cvt_pk_bf16_f32 v20, v112, v113
    v_cvt_pk_bf16_f32 v21, v160, v161
    v_lshlrev_b32 v112, 16, v20
    v_and_b32 v113, 0xffff0000, v20
    v_lshlrev_b32 v160, 16, v21
    v_and_b32 v161, 0xffff0000, v21
    v_pk_mul_f32 v[112:113], v[112:113], v[16:17]
    v_exp_f32 v112, v112
    v_exp_f32 v113, v113
    s_nop 0
    v_pk_add_f32 v[112:113], v[112:113], v[18:19]
    v_rcp_f32 v112, v112
    v_rcp_f32 v113, v113
    s_nop 0
    v_cvt_pk_bf16_f32 v20, v112, v113
    v_lshlrev_b32 v112, 16, v20
    v_and_b32 v113, 0xffff0000, v20
    v_pk_mul_f32 v[112:113], v[112:113], v[160:161]
    v_pk_fma_f32 v[114:115], v[184:185], v[230:231], v[114:115] neg_lo:[1,0,0] neg_hi:[1,0,0]
    v_pk_fma_f32 v[162:163], v[184:185], v[246:247], v[162:163] neg_lo:[1,0,0] neg_hi:[1,0,0]
    v_pk_mul_f32 v[114:115], v[114:115], v[186:187]
    v_pk_mul_f32 v[162:163], v[162:163], v[186:187]
    v_cvt_pk_bf16_f32 v20, v114, v115
    v_cvt_pk_bf16_f32 v21, v162, v163
    v_lshlrev_b32 v114, 16, v20
    v_and_b32 v115, 0xffff0000, v20
    v_lshlrev_b32 v162, 16, v21
    v_and_b32 v163, 0xffff0000, v21
    v_pk_mul_f32 v[114:115], v[114:115], v[16:17]
    v_exp_f32 v114, v114
    v_exp_f32 v115, v115
    s_nop 0
    v_pk_add_f32 v[114:115], v[114:115], v[18:19]
    v_rcp_f32 v114, v114
    v_rcp_f32 v115, v115
    s_nop 0
    v_cvt_pk_bf16_f32 v20, v114, v115
    v_lshlrev_b32 v114, 16, v20
    v_and_b32 v115, 0xffff0000, v20
    v_pk_mul_f32 v[114:115], v[114:115], v[162:163]
    v_pk_fma_f32 v[116:117], v[184:185], v[232:233], v[116:117] neg_lo:[1,0,0] neg_hi:[1,0,0]
    v_pk_fma_f32 v[164:165], v[184:185], v[248:249], v[164:165] neg_lo:[1,0,0] neg_hi:[1,0,0]
    v_pk_mul_f32 v[116:117], v[116:117], v[186:187]
    v_pk_mul_f32 v[164:165], v[164:165], v[186:187]
    v_cvt_pk_bf16_f32 v20, v116, v117
    v_cvt_pk_bf16_f32 v21, v164, v165
    v_lshlrev_b32 v116, 16, v20
    v_and_b32 v117, 0xffff0000, v20
    v_lshlrev_b32 v164, 16, v21
    v_and_b32 v165, 0xffff0000, v21
    v_pk_mul_f32 v[116:117], v[116:117], v[16:17]
    v_exp_f32 v116, v116
    v_exp_f32 v117, v117
    s_nop 0
    v_pk_add_f32 v[116:117], v[116:117], v[18:19]
    v_rcp_f32 v116, v116
    v_rcp_f32 v117, v117
    s_nop 0
    v_cvt_pk_bf16_f32 v20, v116, v117
    v_lshlrev_b32 v116, 16, v20
    v_and_b32 v117, 0xffff0000, v20
    v_pk_mul_f32 v[116:117], v[116:117], v[164:165]
    v_pk_fma_f32 v[118:119], v[184:185], v[234:235], v[118:119] neg_lo:[1,0,0] neg_hi:[1,0,0]
    v_pk_fma_f32 v[166:167], v[184:185], v[250:251], v[166:167] neg_lo:[1,0,0] neg_hi:[1,0,0]
    v_pk_mul_f32 v[118:119], v[118:119], v[186:187]
    v_pk_mul_f32 v[166:167], v[166:167], v[186:187]
    v_cvt_pk_bf16_f32 v20, v118, v119
    v_cvt_pk_bf16_f32 v21, v166, v167
    v_lshlrev_b32 v118, 16, v20
    v_and_b32 v119, 0xffff0000, v20
    v_lshlrev_b32 v166, 16, v21
    v_and_b32 v167, 0xffff0000, v21
    v_pk_mul_f32 v[118:119], v[118:119], v[16:17]
    v_exp_f32 v118, v118
    v_exp_f32 v119, v119
    s_nop 0
    v_pk_add_f32 v[118:119], v[118:119], v[18:19]
    v_rcp_f32 v118, v118
    v_rcp_f32 v119, v119
    s_nop 0
    v_cvt_pk_bf16_f32 v20, v118, v119
    v_lshlrev_b32 v118, 16, v20
    v_and_b32 v119, 0xffff0000, v20
    v_pk_mul_f32 v[118:119], v[118:119], v[166:167]
    v_cvt_pk_bf16_f32 v2, v104, v105
    v_cvt_pk_bf16_f32 v3, v106, v107
    ds_write_b64 v25, v[2:3] offset:64
    v_cvt_pk_bf16_f32 v4, v108, v109
    v_cvt_pk_bf16_f32 v5, v110, v111
    ds_write_b64 v25, v[4:5] offset:80
    v_cvt_pk_bf16_f32 v6, v112, v113
    v_cvt_pk_bf16_f32 v7, v114, v115
    ds_write_b64 v25, v[6:7] offset:96
    v_cvt_pk_bf16_f32 v8, v116, v117
    v_cvt_pk_bf16_f32 v9, v118, v119
    ds_write_b64 v25, v[8:9] offset:112
    s_waitcnt vmcnt(0)
    v_pk_fma_f32 v[120:121], v[184:185], v[32:33], v[120:121] neg_lo:[1,0,0] neg_hi:[1,0,0]
    v_pk_fma_f32 v[168:169], v[184:185], v[60:61], v[168:169] neg_lo:[1,0,0] neg_hi:[1,0,0]
    v_pk_mul_f32 v[120:121], v[120:121], v[186:187]
    v_pk_mul_f32 v[168:169], v[168:169], v[186:187]
    v_cvt_pk_bf16_f32 v20, v120, v121
    v_cvt_pk_bf16_f32 v21, v168, v169
    v_lshlrev_b32 v120, 16, v20
    v_and_b32 v121, 0xffff0000, v20
    v_lshlrev_b32 v168, 16, v21
    v_and_b32 v169, 0xffff0000, v21
    v_pk_mul_f32 v[120:121], v[120:121], v[16:17]
    v_exp_f32 v120, v120
    v_exp_f32 v121, v121
    s_nop 0
    v_pk_add_f32 v[120:121], v[120:121], v[18:19]
    v_rcp_f32 v120, v120
    v_rcp_f32 v121, v121
    s_nop 0
    v_cvt_pk_bf16_f32 v20, v120, v121
    v_lshlrev_b32 v120, 16, v20
    v_and_b32 v121, 0xffff0000, v20
    v_pk_mul_f32 v[120:121], v[120:121], v[168:169]
    v_pk_fma_f32 v[122:123], v[184:185], v[34:35], v[122:123] neg_lo:[1,0,0] neg_hi:[1,0,0]
    v_pk_fma_f32 v[170:171], v[184:185], v[62:63], v[170:171] neg_lo:[1,0,0] neg_hi:[1,0,0]
    v_pk_mul_f32 v[122:123], v[122:123], v[186:187]
    v_pk_mul_f32 v[170:171], v[170:171], v[186:187]
    v_cvt_pk_bf16_f32 v20, v122, v123
    v_cvt_pk_bf16_f32 v21, v170, v171
    v_lshlrev_b32 v122, 16, v20
    v_and_b32 v123, 0xffff0000, v20
    v_lshlrev_b32 v170, 16, v21
    v_and_b32 v171, 0xffff0000, v21
    v_pk_mul_f32 v[122:123], v[122:123], v[16:17]
    v_exp_f32 v122, v122
    v_exp_f32 v123, v123
    s_nop 0
    v_pk_add_f32 v[122:123], v[122:123], v[18:19]
    v_rcp_f32 v122, v122
    v_rcp_f32 v123, v123
    s_nop 0
    v_cvt_pk_bf16_f32 v20, v122, v123
    v_lshlrev_b32 v122, 16, v20
    v_and_b32 v123, 0xffff0000, v20
    v_pk_mul_f32 v[122:123], v[122:123], v[170:171]
    v_pk_fma_f32 v[124:125], v[184:185], v[36:37], v[124:125] neg_lo:[1,0,0] neg_hi:[1,0,0]
    v_pk_fma_f32 v[172:173], v[184:185], v[64:65], v[172:173] neg_lo:[1,0,0] neg_hi:[1,0,0]
    v_pk_mul_f32 v[124:125], v[124:125], v[186:187]
    v_pk_mul_f32 v[172:173], v[172:173], v[186:187]
    v_cvt_pk_bf16_f32 v20, v124, v125
    v_cvt_pk_bf16_f32 v21, v172, v173
    v_lshlrev_b32 v124, 16, v20
    v_and_b32 v125, 0xffff0000, v20
    v_lshlrev_b32 v172, 16, v21
    v_and_b32 v173, 0xffff0000, v21
    v_pk_mul_f32 v[124:125], v[124:125], v[16:17]
    v_exp_f32 v124, v124
    v_exp_f32 v125, v125
    s_nop 0
    v_pk_add_f32 v[124:125], v[124:125], v[18:19]
    v_rcp_f32 v124, v124
    v_rcp_f32 v125, v125
    s_nop 0
    v_cvt_pk_bf16_f32 v20, v124, v125
    v_lshlrev_b32 v124, 16, v20
    v_and_b32 v125, 0xffff0000, v20
    v_pk_mul_f32 v[124:125], v[124:125], v[172:173]
    v_pk_fma_f32 v[126:127], v[184:185], v[38:39], v[126:127] neg_lo:[1,0,0] neg_hi:[1,0,0]
    v_pk_fma_f32 v[174:175], v[184:185], v[66:67], v[174:175] neg_lo:[1,0,0] neg_hi:[1,0,0]
    v_pk_mul_f32 v[126:127], v[126:127], v[186:187]
    v_pk_mul_f32 v[174:175], v[174:175], v[186:187]
    v_cvt_pk_bf16_f32 v20, v126, v127
    v_cvt_pk_bf16_f32 v21, v174, v175
    v_lshlrev_b32 v126, 16, v20
    v_and_b32 v127, 0xffff0000, v20
    v_lshlrev_b32 v174, 16, v21
    v_and_b32 v175, 0xffff0000, v21
    v_pk_mul_f32 v[126:127], v[126:127], v[16:17]
    v_exp_f32 v126, v126
    v_exp_f32 v127, v127
    s_nop 0
    v_pk_add_f32 v[126:127], v[126:127], v[18:19]
    v_rcp_f32 v126, v126
    v_rcp_f32 v127, v127
    s_nop 0
    v_cvt_pk_bf16_f32 v20, v126, v127
    v_lshlrev_b32 v126, 16, v20
    v_and_b32 v127, 0xffff0000, v20
    v_pk_mul_f32 v[126:127], v[126:127], v[174:175]
    v_pk_fma_f32 v[128:129], v[184:185], v[40:41], v[128:129] neg_lo:[1,0,0] neg_hi:[1,0,0]
    v_pk_fma_f32 v[176:177], v[184:185], v[68:69], v[176:177] neg_lo:[1,0,0] neg_hi:[1,0,0]
    v_pk_mul_f32 v[128:129], v[128:129], v[186:187]
    v_pk_mul_f32 v[176:177], v[176:177], v[186:187]
    v_cvt_pk_bf16_f32 v20, v128, v129
    v_cvt_pk_bf16_f32 v21, v176, v177
    v_lshlrev_b32 v128, 16, v20
    v_and_b32 v129, 0xffff0000, v20
    v_lshlrev_b32 v176, 16, v21
    v_and_b32 v177, 0xffff0000, v21
    v_pk_mul_f32 v[128:129], v[128:129], v[16:17]
    v_exp_f32 v128, v128
    v_exp_f32 v129, v129
    s_nop 0
    v_pk_add_f32 v[128:129], v[128:129], v[18:19]
    v_rcp_f32 v128, v128
    v_rcp_f32 v129, v129
    s_nop 0
    v_cvt_pk_bf16_f32 v20, v128, v129
    v_lshlrev_b32 v128, 16, v20
    v_and_b32 v129, 0xffff0000, v20
    v_pk_mul_f32 v[128:129], v[128:129], v[176:177]
    v_pk_fma_f32 v[130:131], v[184:185], v[42:43], v[130:131] neg_lo:[1,0,0] neg_hi:[1,0,0]
    v_pk_fma_f32 v[178:179], v[184:185], v[70:71], v[178:179] neg_lo:[1,0,0] neg_hi:[1,0,0]
    v_pk_mul_f32 v[130:131], v[130:131], v[186:187]
    v_pk_mul_f32 v[178:179], v[178:179], v[186:187]
    v_cvt_pk_bf16_f32 v20, v130, v131
    v_cvt_pk_bf16_f32 v21, v178, v179
    v_lshlrev_b32 v130, 16, v20
    v_and_b32 v131, 0xffff0000, v20
    v_lshlrev_b32 v178, 16, v21
    v_and_b32 v179, 0xffff0000, v21
    v_pk_mul_f32 v[130:131], v[130:131], v[16:17]
    v_exp_f32 v130, v130
    v_exp_f32 v131, v131
    s_nop 0
    v_pk_add_f32 v[130:131], v[130:131], v[18:19]
    v_rcp_f32 v130, v130
    v_rcp_f32 v131, v131
    s_nop 0
    v_cvt_pk_bf16_f32 v20, v130, v131
    v_lshlrev_b32 v130, 16, v20
    v_and_b32 v131, 0xffff0000, v20
    v_pk_mul_f32 v[130:131], v[130:131], v[178:179]
    v_pk_fma_f32 v[132:133], v[184:185], v[44:45], v[132:133] neg_lo:[1,0,0] neg_hi:[1,0,0]
    v_pk_fma_f32 v[180:181], v[184:185], v[72:73], v[180:181] neg_lo:[1,0,0] neg_hi:[1,0,0]
    v_pk_mul_f32 v[132:133], v[132:133], v[186:187]
    v_pk_mul_f32 v[180:181], v[180:181], v[186:187]
    v_cvt_pk_bf16_f32 v20, v132, v133
    v_cvt_pk_bf16_f32 v21, v180, v181
    v_lshlrev_b32 v132, 16, v20
    v_and_b32 v133, 0xffff0000, v20
    v_lshlrev_b32 v180, 16, v21
    v_and_b32 v181, 0xffff0000, v21
    v_pk_mul_f32 v[132:133], v[132:133], v[16:17]
    v_exp_f32 v132, v132
    v_exp_f32 v133, v133
    s_nop 0
    v_pk_add_f32 v[132:133], v[132:133], v[18:19]
    v_rcp_f32 v132, v132
    v_rcp_f32 v133, v133
    s_nop 0
    v_cvt_pk_bf16_f32 v20, v132, v133
    v_lshlrev_b32 v132, 16, v20
    v_and_b32 v133, 0xffff0000, v20
    v_pk_mul_f32 v[132:133], v[132:133], v[180:181]
    v_pk_fma_f32 v[134:135], v[184:185], v[46:47], v[134:135] neg_lo:[1,0,0] neg_hi:[1,0,0]
    v_pk_fma_f32 v[182:183], v[184:185], v[74:75], v[182:183] neg_lo:[1,0,0] neg_hi:[1,0,0]
    v_pk_mul_f32 v[134:135], v[134:135], v[186:187]
    v_pk_mul_f32 v[182:183], v[182:183], v[186:187]
    v_cvt_pk_bf16_f32 v20, v134, v135
    v_cvt_pk_bf16_f32 v21, v182, v183
    v_lshlrev_b32 v134, 16, v20
    v_and_b32 v135, 0xffff0000, v20
    v_lshlrev_b32 v182, 16, v21
    v_and_b32 v183, 0xffff0000, v21
    v_pk_mul_f32 v[134:135], v[134:135], v[16:17]
    v_exp_f32 v134, v134
    v_exp_f32 v135, v135
    s_nop 0
    v_pk_add_f32 v[134:135], v[134:135], v[18:19]
    v_rcp_f32 v134, v134
    v_rcp_f32 v135, v135
    s_nop 0
    v_cvt_pk_bf16_f32 v20, v134, v135
    v_lshlrev_b32 v134, 16, v20
    v_and_b32 v135, 0xffff0000, v20
    v_pk_mul_f32 v[134:135], v[134:135], v[182:183]
    v_cvt_pk_bf16_f32 v2, v120, v121
    v_cvt_pk_bf16_f32 v3, v122, v123
    ds_write_b64 v25, v[2:3] offset:128
    v_cvt_pk_bf16_f32 v4, v124, v125
    v_cvt_pk_bf16_f32 v5, v126, v127
    ds_write_b64 v25, v[4:5] offset:144
    v_cvt_pk_bf16_f32 v6, v128, v129
    v_cvt_pk_bf16_f32 v7, v130, v131
    ds_write_b64 v25, v[6:7] offset:160
    v_cvt_pk_bf16_f32 v8, v132, v133
    v_cvt_pk_bf16_f32 v9, v134, v135
    ds_write_b64 v25, v[8:9] offset:176
    v_add_u32 v26, 0, v1
    v_mul_lo_u32 v27, v26, s39
    v_lshrrev_b32 v27, 19, v27
    v_mul_u32_u24 v28, 12, v27
    v_sub_u32 v28, v26, v28
    v_mul_u32_u24 v26, 208, v27
    v_lshl_add_u32 v26, v28, 4, v26
    v_add_u32 v32, s32, v26
    v_add_u32 v27, s33, v27
    v_mul_u32_u24 v27, 3072, v27
    v_lshl_add_u32 v27, v28, 4, v27
    v_add_u32 v40, s38, v27
    v_add_u32 v26, 64, v1
    v_mul_lo_u32 v27, v26, s39
    v_lshrrev_b32 v27, 19, v27
    v_mul_u32_u24 v28, 12, v27
    v_sub_u32 v28, v26, v28
    v_mul_u32_u24 v26, 208, v27
    v_lshl_add_u32 v26, v28, 4, v26
    v_add_u32 v33, s32, v26
    v_add_u32 v27, s33, v27
    v_mul_u32_u24 v27, 3072, v27
    v_lshl_add_u32 v27, v28, 4, v27
    v_add_u32 v41, s38, v27
    v_add_u32 v26, 128, v1
    v_mul_lo_u32 v27, v26, s39
    v_lshrrev_b32 v27, 19, v27
    v_mul_u32_u24 v28, 12, v27
    v_sub_u32 v28, v26, v28
    v_mul_u32_u24 v26, 208, v27
    v_lshl_add_u32 v26, v28, 4, v26
    v_add_u32 v34, s32, v26
    v_add_u32 v27, s33, v27
    v_mul_u32_u24 v27, 3072, v27
    v_lshl_add_u32 v27, v28, 4, v27
    v_add_u32 v42, s38, v27
    v_add_u32 v26, 192, v1
    v_mul_lo_u32 v27, v26, s39
    v_lshrrev_b32 v27, 19, v27
    v_mul_u32_u24 v28, 12, v27
    v_sub_u32 v28, v26, v28
    v_mul_u32_u24 v26, 208, v27
    v_lshl_add_u32 v26, v28, 4, v26
    v_add_u32 v35, s32, v26
    v_add_u32 v27, s33, v27
    v_mul_u32_u24 v27, 3072, v27
    v_lshl_add_u32 v27, v28, 4, v27
    v_add_u32 v43, s38, v27
    v_add_u32 v26, 256, v1
    v_mul_lo_u32 v27, v26, s39
    v_lshrrev_b32 v27, 19, v27
    v_mul_u32_u24 v28, 12, v27
    v_sub_u32 v28, v26, v28
    v_mul_u32_u24 v26, 208, v27
    v_lshl_add_u32 v26, v28, 4, v26
    v_add_u32 v36, s32, v26
    v_add_u32 v27, s33, v27
    v_mul_u32_u24 v27, 3072, v27
    v_lshl_add_u32 v27, v28, 4, v27
    v_add_u32 v44, s38, v27
    v_add_u32 v26, 320, v1
    v_mul_lo_u32 v27, v26, s39
    v_lshrrev_b32 v27, 19, v27
    v_mul_u32_u24 v28, 12, v27
    v_sub_u32 v28, v26, v28
    v_mul_u32_u24 v26, 208, v27
    v_lshl_add_u32 v26, v28, 4, v26
    v_add_u32 v37, s32, v26
    v_add_u32 v27, s33, v27
    v_mul_u32_u24 v27, 3072, v27
    v_lshl_add_u32 v27, v28, 4, v27
    v_add_u32 v45, s38, v27
    s_waitcnt lgkmcnt(0)
    ds_read_b128 v[88:91], v32
    ds_read_b128 v[92:95], v33
    ds_read_b128 v[96:99], v34
    ds_read_b128 v[100:103], v35
    ds_read_b128 v[104:107], v36
    ds_read_b128 v[108:111], v37
    s_waitcnt lgkmcnt(5)
    buffer_store_dwordx4 v[88:91], v40, s[16:19], 0 offen
    s_waitcnt lgkmcnt(4)
    buffer_store_dwordx4 v[92:95], v41, s[16:19], 0 offen
    s_waitcnt lgkmcnt(3)
    buffer_store_dwordx4 v[96:99], v42, s[16:19], 0 offen
    s_waitcnt lgkmcnt(2)
    buffer_store_dwordx4 v[100:103], v43, s[16:19], 0 offen
    s_waitcnt lgkmcnt(1)
    buffer_store_dwordx4 v[104:107], v44, s[16:19], 0 offen
    s_waitcnt lgkmcnt(0)
    buffer_store_dwordx4 v[108:111], v45, s[16:19], 0 offen
    s_waitcnt vmcnt(0)
    s_barrier
    s_add_u32 s32, s26, 600
    s_cmp_lg_u32 s29, 0
    s_cbranch_scc1 nosig_mega_kernel_100
    s_lshl_b32 s38, s32, 7
    s_lshl_b32 s39, s27, 2
    s_add_u32 s38, s38, s39
    v_mov_b32 v24, s38
    v_mov_b32 v23, 1
    v_cmp_eq_u32 vcc, 0, v1
    s_and_saveexec_b64 s[36:37], vcc
    s_cbranch_execz nosig2_mega_kernel_101
    buffer_store_dword v23, v24, s[92:95], 0 offen
nosig2_mega_kernel_101:
    s_mov_b64 exec, s[36:37]
nosig_mega_kernel_100:
    s_branch end_mega_kernel_97
loader_mega_kernel_96:
    s_lshl_b32 s32, s26, 7
    s_lshl_b32 s33, s28, 5
    s_add_u32 s32, s32, s33
    v_lshrrev_b32 v25, 3, v1
    v_add_u32 v25, s32, v25
    v_mul_u32_u24 v25, 1280, v25
    v_and_b32 v26, 7, v1
    v_lshrrev_b32 v27, 4, v1
    v_xor_b32 v26, v26, v27
    v_lshlrev_b32 v26, 4, v26
    v_xor_b32 v27, 64, v26
    v_add_u32 v2, v25, v26
    v_add_u32 v3, v25, v27
    v_add_u32 v3, 9216, v3
    v_add_u32 v4, v25, v26
    v_add_u32 v4, 18432, v4
    v_add_u32 v5, v25, v27
    v_add_u32 v5, 27648, v5
    s_lshl_b32 s34, s28, 12
    s_add_u32 s76, s84, 0x1d59000
    s_addc_u32 s77, s85, 0
    s_mov_b32 s78, 3932160
    s_and_b32 s77, s77, 0xffff
    s_mov_b32 s79, 0x00020000
    s_lshr_b32 s82, s2, 4
    s_mul_i32 s82, s82, 245760
    s_mul_i32 s80, s28, 6144
    s_add_u32 s82, s82, s80
    v_lshlrev_b32 v8, 4, v1
    v_add_u32 v8, s82, v8
    v_add_u32 v9, 4096, v8
    s_barrier
    s_add_u32 m0, s34, 32768
    s_mov_b32 s35, 0
    buffer_load_dwordx4 v2, s[4:7], s35 offen offset:0 sc1 lds
    buffer_load_dwordx4 v3, s[4:7], s35 offen offset:1024 sc1 lds
    buffer_load_dwordx4 v4, s[4:7], s35 offen offset:2048 sc1 lds
    buffer_load_dwordx4 v5, s[4:7], s35 offen offset:3072 sc1 lds
    s_add_u32 m0, s34, 49152
    s_mov_b32 s35, 128
    buffer_load_dwordx4 v2, s[4:7], s35 offen offset:0 sc1 lds
    buffer_load_dwordx4 v3, s[4:7], s35 offen offset:1024 sc1 lds
    buffer_load_dwordx4 v4, s[4:7], s35 offen offset:2048 sc1 lds
    buffer_load_dwordx4 v5, s[4:7], s35 offen offset:3072 sc1 lds
    s_waitcnt vmcnt(4)
    s_barrier
    s_add_u32 m0, s34, 0
    s_mov_b32 s35, 256
    buffer_load_dwordx4 v2, s[4:7], s35 offen offset:0 sc1 lds
    buffer_load_dwordx4 v3, s[4:7], s35 offen offset:1024 sc1 lds
    buffer_load_dwordx4 v4, s[4:7], s35 offen offset:2048 sc1 lds
    buffer_load_dwordx4 v5, s[4:7], s35 offen offset:3072 sc1 lds
    s_add_u32 m0, s34, 16384
    s_mov_b32 s35, 384
    buffer_load_dwordx4 v2, s[4:7], s35 offen offset:0 sc1 lds
    buffer_load_dwordx4 v3, s[4:7], s35 offen offset:1024 sc1 lds
    buffer_load_dwordx4 v4, s[4:7], s35 offen offset:2048 sc1 lds
    buffer_load_dwordx4 v5, s[4:7], s35 offen offset:3072 sc1 lds
    s_waitcnt vmcnt(8)
    s_barrier
    s_add_u32 m0, s34, 32768
    s_mov_b32 s35, 512
    buffer_load_dwordx4 v2, s[4:7], s35 offen offset:0 sc1 lds
    buffer_load_dwordx4 v3, s[4:7], s35 offen offset:1024 sc1 lds
    buffer_load_dwordx4 v4, s[4:7], s35 offen offset:2048 sc1 lds
    buffer_load_dwordx4 v5, s[4:7], s35 offen offset:3072 sc1 lds
    s_add_u32 m0, s80, 114688
    s_mov_b32 s81, 98304
    buffer_load_dwordx4 v8, s[76:79], s81 offen offset:0 sc1 lds
    buffer_load_dwordx4 v8, s[76:79], s81 offen offset:1024 sc1 lds
    buffer_load_dwordx4 v8, s[76:79], s81 offen offset:2048 sc1 lds
    buffer_load_dwordx4 v8, s[76:79], s81 offen offset:3072 sc1 lds
    s_add_u32 m0, s80, 118784
    s_nop 0
    buffer_load_dwordx4 v9, s[76:79], s81 offen offset:0 sc1 lds
    buffer_load_dwordx4 v9, s[76:79], s81 offen offset:1024 sc1 lds
    s_waitcnt vmcnt(14)
    s_barrier
    s_add_u32 m0, s34, 49152
    s_mov_b32 s35, 640
    buffer_load_dwordx4 v2, s[4:7], s35 offen offset:0 sc1 lds
    buffer_load_dwordx4 v3, s[4:7], s35 offen offset:1024 sc1 lds
    buffer_load_dwordx4 v4, s[4:7], s35 offen offset:2048 sc1 lds
    buffer_load_dwordx4 v5, s[4:7], s35 offen offset:3072 sc1 lds
    s_add_u32 m0, s80, 139264
    s_mov_b32 s81, 122880
    buffer_load_dwordx4 v8, s[76:79], s81 offen offset:0 sc1 lds
    buffer_load_dwordx4 v8, s[76:79], s81 offen offset:1024 sc1 lds
    buffer_load_dwordx4 v8, s[76:79], s81 offen offset:2048 sc1 lds
    buffer_load_dwordx4 v8, s[76:79], s81 offen offset:3072 sc1 lds
    s_add_u32 m0, s80, 143360
    s_nop 0
    buffer_load_dwordx4 v9, s[76:79], s81 offen offset:0 sc1 lds
    buffer_load_dwordx4 v9, s[76:79], s81 offen offset:1024 sc1 lds
    s_waitcnt vmcnt(20)
    s_barrier
    s_add_u32 m0, s34, 0
    s_mov_b32 s35, 768
    buffer_load_dwordx4 v2, s[4:7], s35 offen offset:0 sc1 lds
    buffer_load_dwordx4 v3, s[4:7], s35 offen offset:1024 sc1 lds
    buffer_load_dwordx4 v4, s[4:7], s35 offen offset:2048 sc1 lds
    buffer_load_dwordx4 v5, s[4:7], s35 offen offset:3072 sc1 lds
    s_add_u32 m0, s80, 65536
    s_mov_b32 s81, 147456
    buffer_load_dwordx4 v8, s[76:79], s81 offen offset:0 sc1 lds
    buffer_load_dwordx4 v8, s[76:79], s81 offen offset:1024 sc1 lds
    buffer_load_dwordx4 v8, s[76:79], s81 offen offset:2048 sc1 lds
    buffer_load_dwordx4 v8, s[76:79], s81 offen offset:3072 sc1 lds
    s_add_u32 m0, s80, 69632
    s_nop 0
    buffer_load_dwordx4 v9, s[76:79], s81 offen offset:0 sc1 lds
    buffer_load_dwordx4 v9, s[76:79], s81 offen offset:1024 sc1 lds
    s_waitcnt vmcnt(20)
    s_barrier
    s_add_u32 m0, s34, 16384
    s_mov_b32 s35, 896
    buffer_load_dwordx4 v2, s[4:7], s35 offen offset:0 sc1 lds
    buffer_load_dwordx4 v3, s[4:7], s35 offen offset:1024 sc1 lds
    buffer_load_dwordx4 v4, s[4:7], s35 offen offset:2048 sc1 lds
    buffer_load_dwordx4 v5, s[4:7], s35 offen offset:3072 sc1 lds
    s_add_u32 m0, s80, 90112
    s_mov_b32 s81, 172032
    buffer_load_dwordx4 v8, s[76:79], s81 offen offset:0 sc1 lds
    buffer_load_dwordx4 v8, s[76:79], s81 offen offset:1024 sc1 lds
    buffer_load_dwordx4 v8, s[76:79], s81 offen offset:2048 sc1 lds
    buffer_load_dwordx4 v8, s[76:79], s81 offen offset:3072 sc1 lds
    s_add_u32 m0, s80, 94208
    s_nop 0
    buffer_load_dwordx4 v9, s[76:79], s81 offen offset:0 sc1 lds
    buffer_load_dwordx4 v9, s[76:79], s81 offen offset:1024 sc1 lds
    s_waitcnt vmcnt(20)
    s_barrier
    s_add_u32 m0, s34, 32768
    s_mov_b32 s35, 1024
    buffer_load_dwordx4 v2, s[4:7], s35 offen offset:0 sc1 lds
    buffer_load_dwordx4 v3, s[4:7], s35 offen offset:1024 sc1 lds
    buffer_load_dwordx4 v4, s[4:7], s35 offen offset:2048 sc1 lds
    buffer_load_dwordx4 v5, s[4:7], s35 offen offset:3072 sc1 lds
    s_add_u32 m0, s80, 114688
    s_mov_b32 s81, 196608
    buffer_load_dwordx4 v8, s[76:79], s81 offen offset:0 sc1 lds
    buffer_load_dwordx4 v8, s[76:79], s81 offen offset:1024 sc1 lds
    buffer_load_dwordx4 v8, s[76:79], s81 offen offset:2048 sc1 lds
    buffer_load_dwordx4 v8, s[76:79], s81 offen offset:3072 sc1 lds
    s_add_u32 m0, s80, 118784
    s_nop 0
    buffer_load_dwordx4 v9, s[76:79], s81 offen offset:0 sc1 lds
    buffer_load_dwordx4 v9, s[76:79], s81 offen offset:1024 sc1 lds
    s_waitcnt vmcnt(20)
    s_barrier
    s_add_u32 m0, s34, 49152
    s_mov_b32 s35, 1152
    buffer_load_dwordx4 v2, s[4:7], s35 offen offset:0 sc1 lds
    buffer_load_dwordx4 v3, s[4:7], s35 offen offset:1024 sc1 lds
    buffer_load_dwordx4 v4, s[4:7], s35 offen offset:2048 sc1 lds
    buffer_load_dwordx4 v5, s[4:7], s35 offen offset:3072 sc1 lds
    s_add_u32 m0, s80, 139264
    s_mov_b32 s81, 221184
    buffer_load_dwordx4 v8, s[76:79], s81 offen offset:0 sc1 lds
    buffer_load_dwordx4 v8, s[76:79], s81 offen offset:1024 sc1 lds
    buffer_load_dwordx4 v8, s[76:79], s81 offen offset:2048 sc1 lds
    buffer_load_dwordx4 v8, s[76:79], s81 offen offset:3072 sc1 lds
    s_add_u32 m0, s80, 143360
    s_nop 0
    buffer_load_dwordx4 v9, s[76:79], s81 offen offset:0 sc1 lds
    buffer_load_dwordx4 v9, s[76:79], s81 offen offset:1024 sc1 lds
    s_waitcnt vmcnt(20)
    s_barrier
    s_waitcnt vmcnt(10)
    s_barrier
    s_waitcnt vmcnt(0)
    s_barrier
    s_add_u32 s76, s84, 0x2209000
    s_addc_u32 s77, s85, 0
    s_mov_b32 s78, 1966080
    s_and_b32 s77, s77, 0xffff
    s_mov_b32 s79, 0x00020000
    s_lshr_b32 s82, s2, 5
    s_mul_i32 s82, s82, 245760
    s_mul_i32 s80, s28, 5120
    s_add_u32 s82, s82, s80
    v_lshlrev_b32 v8, 4, v1
    v_add_u32 v8, s82, v8
    v_add_u32 v9, 4096, v8
    s_add_u32 m0, s80, 65536
    s_mov_b32 s81, 0
    buffer_load_dwordx4 v8, s[76:79], s81 offen offset:0 sc1 lds
    buffer_load_dwordx4 v8, s[76:79], s81 offen offset:1024 sc1 lds
    buffer_load_dwordx4 v8, s[76:79], s81 offen offset:2048 sc1 lds
    buffer_load_dwordx4 v8, s[76:79], s81 offen offset:3072 sc1 lds
    s_add_u32 m0, s80, 69632
    s_nop 0
    buffer_load_dwordx4 v9, s[76:79], s81 offen offset:0 sc1 lds
    s_add_u32 m0, s80, 90112
    s_mov_b32 s81, 20480
    buffer_load_dwordx4 v8, s[76:79], s81 offen offset:0 sc1 lds
    buffer_load_dwordx4 v8, s[76:79], s81 offen offset:1024 sc1 lds
    buffer_load_dwordx4 v8, s[76:79], s81 offen offset:2048 sc1 lds
    buffer_load_dwordx4 v8, s[76:79], s81 offen offset:3072 sc1 lds
    s_add_u32 m0, s80, 94208
    s_nop 0
    buffer_load_dwordx4 v9, s[76:79], s81 offen offset:0 sc1 lds
    s_add_u32 m0, s80, 114688
    s_mov_b32 s81, 40960
    buffer_load_dwordx4 v8, s[76:79], s81 offen offset:0 sc1 lds
    buffer_load_dwordx4 v8, s[76:79], s81 offen offset:1024 sc1 lds
    buffer_load_dwordx4 v8, s[76:79], s81 offen offset:2048 sc1 lds
    buffer_load_dwordx4 v8, s[76:79], s81 offen offset:3072 sc1 lds
    s_add_u32 m0, s80, 118784
    s_nop 0
    buffer_load_dwordx4 v9, s[76:79], s81 offen offset:0 sc1 lds
    s_barrier
    s_add_u32 m0, s80, 139264
    s_mov_b32 s81, 61440
    buffer_load_dwordx4 v8, s[76:79], s81 offen offset:0 sc1 lds
    buffer_load_dwordx4 v8, s[76:79], s81 offen offset:1024 sc1 lds
    buffer_load_dwordx4 v8, s[76:79], s81 offen offset:2048 sc1 lds
    buffer_load_dwordx4 v8, s[76:79], s81 offen offset:3072 sc1 lds
    s_add_u32 m0, s80, 143360
    s_nop 0
    buffer_load_dwordx4 v9, s[76:79], s81 offen offset:0 sc1 lds
    s_barrier
end_mega_kernel_97:
    s_and_b32 s24, s2, 7
    s_lshr_b32 s25, s2, 3
    s_lshl_b32 s26, s24, 2
    s_and_b32 s27, s25, 3
    s_add_u32 s26, s26, s27
    s_lshr_b32 s27, s25, 2
    s_add_u32 s4, s84, 0x5d9000
    s_addc_u32 s5, s85, 0
    s_mov_b32 s6, 6291456
    s_and_b32 s5, s5, 0xffff
    s_mov_b32 s7, 0x00020000
    s_add_u32 s12, s84, 0x59000
    s_addc_u32 s13, s85, 0
    s_mov_b32 s14, 2621440
    s_and_b32 s13, s13, 0xffff
    s_mov_b32 s15, 0x00020000
    s_mov_b32 s16, s88
    s_mov_b32 s17, s89
    s_mov_b32 s18, 2621440
    s_and_b32 s17, s17, 0xffff
    s_mov_b32 s19, 0x00020000
    s_cmp_ge_u32 s29, 4
    s_cbranch_scc1 loader_mega_kernel_102
    v_and_b32 v25, 15, v1
    v_lshrrev_b32 v26, 4, v1
    s_lshl_b32 s32, s29, 2
    v_add_u32 v26, s32, v26
    v_xor_b32 v26, v26, v25
    v_lshlrev_b32 v26, 4, v26
    v_lshl_add_u32 v10, v25, 8, v26
    v_add_u32 v10, 0, v10
    v_lshrrev_b32 v26, 4, v1
    v_lshlrev_b32 v26, 3, v26
    v_bfe_u32 v27, v1, 2, 2
    v_add_u32 v26, v26, v27
    s_lshl_b32 s32, s29, 5
    v_add_u32 v26, s32, v26
    v_mul_u32_u24 v26, 160, v26
    v_and_b32 v27, 3, v1
    v_lshl_add_u32 v26, v27, 3, v26
    v_add_u32 v11, 65536, v26
    s_lshl_b32 s32, s26, 6
    s_lshl_b32 s33, s29, 4
    s_add_u32 s32, s32, s33
    v_add_u32 v28, s32, v25
    v_mul_u32_u24 v29, 1280, v28
    v_lshrrev_b32 v26, 4, v1
    v_lshl_add_u32 v29, v26, 3, v29
    s_mul_i32 s32, s27, 160
    v_add_u32 v29, s32, v29
    v_mov_b32 v104, 0
    v_mov_b32 v105, 0
    v_mov_b32 v106, 0
    v_mov_b32 v107, 0
    v_mov_b32 v108, 0
    v_mov_b32 v109, 0
    v_mov_b32 v110, 0
    v_mov_b32 v111, 0
    v_mov_b32 v112, 0
    v_mov_b32 v113, 0
    v_mov_b32 v114, 0
    v_mov_b32 v115, 0
    v_mov_b32 v116, 0
    v_mov_b32 v117, 0
    v_mov_b32 v118, 0
    v_mov_b32 v119, 0
    v_mov_b32 v120, 0
    v_mov_b32 v121, 0
    v_mov_b32 v122, 0
    v_mov_b32 v123, 0
    v_mov_b32 v124, 0
    v_mov_b32 v125, 0
    v_mov_b32 v126, 0
    v_mov_b32 v127, 0
    v_mov_b32 v128, 0
    v_mov_b32 v129, 0
    v_mov_b32 v130, 0
    v_mov_b32 v131, 0
    v_mov_b32 v132, 0
    v_mov_b32 v133, 0
    v_mov_b32 v134, 0
    v_mov_b32 v135, 0
    v_mov_b32 v136, 0
    v_mov_b32 v137, 0
    v_mov_b32 v138, 0
    v_mov_b32 v139, 0
    v_mov_b32 v140, 0
    v_mov_b32 v141, 0
    v_mov_b32 v142, 0
    v_mov_b32 v143, 0
    v_mov_b32 v144, 0
    v_mov_b32 v145, 0
    v_mov_b32 v146, 0
    v_mov_b32 v147, 0
    v_mov_b32 v148, 0
    v_mov_b32 v149, 0
    v_mov_b32 v150, 0
    v_mov_b32 v151, 0
    v_mov_b32 v152, 0
    v_mov_b32 v153, 0
    v_mov_b32 v154, 0
    v_mov_b32 v155, 0
    v_mov_b32 v156, 0
    v_mov_b32 v157, 0
    v_mov_b32 v158, 0
    v_mov_b32 v159, 0
    v_mov_b32 v160, 0
    v_mov_b32 v161, 0
    v_mov_b32 v162, 0
    v_mov_b32 v163, 0
    v_mov_b32 v164, 0
    v_mov_b32 v165, 0
    v_mov_b32 v166, 0
    v_mov_b32 v167, 0
    v_mov_b32 v168, 0
    v_mov_b32 v169, 0
    v_mov_b32 v170, 0
    v_mov_b32 v171, 0
    v_mov_b32 v172, 0
    v_mov_b32 v173, 0
    v_mov_b32 v174, 0
    v_mov_b32 v175, 0
    v_mov_b32 v176, 0
    v_mov_b32 v177, 0
    v_mov_b32 v178, 0
    v_mov_b32 v179, 0
    v_mov_b32 v180, 0
    v_mov_b32 v181, 0
    v_mov_b32 v182, 0
    v_mov_b32 v183, 0
    s_mul_i32 s32, s29, 15360
    s_nop 0
    v_mul_u32_u24 v30, 160, v25
    v_lshrrev_b32 v26, 4, v1
    v_lshl_add_u32 v30, v26, 3, v30
    v_add_u32 v30, s32, v30
    v_lshlrev_b32 v31, 4, v1
    v_add_u32 v31, s32, v31
    s_lshl_b32 s32, s26, 6
    s_lshl_b32 s33, s29, 4
    s_add_u32 s32, s32, s33
    s_mul_i32 s33, s27, 160
    s_mov_b32 s38, 52429
    v_add_u32 v26, 0, v1
    v_mul_lo_u32 v27, v26, s38
    v_lshrrev_b32 v27, 19, v27
    v_mul_u32_u24 v24, 10, v27
    v_sub_u32 v24, v26, v24
    v_add_u32 v27, s32, v27
    v_mul_u32_u24 v27, 1280, v27
    v_lshl_add_u32 v27, v24, 4, v27
    v_add_u32 v12, s33, v27
    v_add_u32 v26, 64, v1
    v_mul_lo_u32 v27, v26, s38
    v_lshrrev_b32 v27, 19, v27
    v_mul_u32_u24 v24, 10, v27
    v_sub_u32 v24, v26, v24
    v_add_u32 v27, s32, v27
    v_mul_u32_u24 v27, 1280, v27
    v_lshl_add_u32 v27, v24, 4, v27
    v_add_u32 v13, s33, v27
    v_add_u32 v26, 128, v1
    v_mul_lo_u32 v27, v26, s38
    v_lshrrev_b32 v27, 19, v27
    v_mul_u32_u24 v24, 10, v27
    v_sub_u32 v24, v26, v24
    v_add_u32 v27, s32, v27
    v_mul_u32_u24 v27, 1280, v27
    v_lshl_add_u32 v27, v24, 4, v27
    v_add_u32 v14, s33, v27
    buffer_load_dword v200, v12, s[16:19], 0 offen
    buffer_load_dword v201, v13, s[16:19], 0 offen
    buffer_load_dword v202, v14, s[16:19], 0 offen
    s_cmp_lg_u32 s29, 3
    s_cbranch_scc1 pok_mega_kernel_105
    s_lshr_b32 s38, s26, 1
    s_add_u32 s38, s38, 600
    s_lshl_b32 s38, s38, 7
    v_and_b32 v24, 15, v1
    v_lshlrev_b32 v24, 2, v24
    v_add_u32 v24, s38, v24
    s_mov_b32 s38, 0
    buffer_load_dword v21, v24, s[92:95], 0 offen sc1
    s_sleep 3
    buffer_load_dword v22, v24, s[92:95], 0 offen sc1
    s_sleep 3
poll_mega_kernel_104:
    buffer_load_dword v23, v24, s[92:95], 0 offen sc1
    s_waitcnt vmcnt(2)
    v_cmp_gt_u32 vcc, 1, v21
    s_nop 4
    s_cbranch_vccz pok_mega_kernel_105
    s_sleep 2
    buffer_load_dword v21, v24, s[92:95], 0 offen sc1
    s_waitcnt vmcnt(2)
    v_cmp_gt_u32 vcc, 1, v22
    s_nop 4
    s_cbranch_vccz pok_mega_kernel_105
    s_sleep 2
    buffer_load_dword v22, v24, s[92:95], 0 offen sc1
    s_waitcnt vmcnt(2)
    v_cmp_gt_u32 vcc, 1, v23
    s_nop 4
    s_cbranch_vccz pok_mega_kernel_105
    s_sleep 2
    s_add_u32 s38, s38, 1
    s_cmp_gt_u32 s38, 4000
    s_cbranch_scc0 poll_mega_kernel_104
pok_mega_kernel_105:
    s_barrier
    buffer_load_dwordx2 v[184:185], v29, s[12:15], 0 offen offset:0 sc1
    buffer_load_dwordx2 v[186:187], v29, s[12:15], 0 offen offset:32 sc1
    buffer_load_dwordx2 v[188:189], v29, s[12:15], 0 offen offset:64 sc1
    buffer_load_dwordx2 v[190:191], v29, s[12:15], 0 offen offset:96 sc1
    buffer_load_dwordx2 v[192:193], v29, s[12:15], 0 offen offset:128 sc1
    s_barrier
    ds_read_b128 v[32:35], v10 offset:0
    ds_read_b128 v[36:39], v10 offset:4096
    ds_read_b128 v[40:43], v10 offset:8192
    ds_read_b128 v[44:47], v10 offset:12288
    ds_read_b64_tr_b16 v[48:49], v11 offset:0
    ds_read_b64_tr_b16 v[50:51], v11 offset:640
    ds_read_b64_tr_b16 v[52:53], v11 offset:32
    ds_read_b64_tr_b16 v[54:55], v11 offset:672
    ds_read_b64_tr_b16 v[56:57], v11 offset:64
    ds_read_b64_tr_b16 v[58:59], v11 offset:704
    ds_read_b64_tr_b16 v[60:61], v11 offset:96
    ds_read_b64_tr_b16 v[62:63], v11 offset:736
    ds_read_b64_tr_b16 v[64:65], v11 offset:128
    ds_read_b64_tr_b16 v[66:67], v11 offset:768
    s_waitcnt lgkmcnt(0)
    v_mfma_f32_16x16x32_bf16 v[104:107], v[48:51], v[32:35], v[104:107]
    s_barrier
    v_add_u32 v10, 0x4000, v10
    v_add_u32 v11, 0x6000, v11
    v_mfma_f32_16x16x32_bf16 v[108:111], v[48:51], v[36:39], v[108:111]
    ds_read_b128 v[68:71], v10 offset:0
    v_mfma_f32_16x16x32_bf16 v[112:115], v[48:51], v[40:43], v[112:115]
    ds_read_b128 v[72:75], v10 offset:4096
    v_mfma_f32_16x16x32_bf16 v[116:119], v[48:51], v[44:47], v[116:119]
    ds_read_b128 v[76:79], v10 offset:8192
    v_mfma_f32_16x16x32_bf16 v[120:123], v[52:55], v[32:35], v[120:123]
    ds_read_b128 v[80:83], v10 offset:12288
    v_mfma_f32_16x16x32_bf16 v[124:127], v[52:55], v[36:39], v[124:127]
    ds_read_b64_tr_b16 v[84:85], v11 offset:0
    v_mfma_f32_16x16x32_bf16 v[128:131], v[52:55], v[40:43], v[128:131]
    ds_read_b64_tr_b16 v[86:87], v11 offset:640
    v_mfma_f32_16x16x32_bf16 v[132:135], v[52:55], v[44:47], v[132:135]
    ds_read_b64_tr_b16 v[88:89], v11 offset:32
    v_mfma_f32_16x16x32_bf16 v[136:139], v[56:59], v[32:35], v[136:139]
    ds_read_b64_tr_b16 v[90:91], v11 offset:672
    v_mfma_f32_16x16x32_bf16 v[140:143], v[56:59], v[36:39], v[140:143]
    ds_read_b64_tr_b16 v[92:93], v11 offset:64
    v_mfma_f32_16x16x32_bf16 v[144:147], v[56:59], v[40:43], v[144:147]
    ds_read_b64_tr_b16 v[94:95], v11 offset:704
    v_mfma_f32_16x16x32_bf16 v[148:151], v[56:59], v[44:47], v[148:151]
    ds_read_b64_tr_b16 v[96:97], v11 offset:96
    v_mfma_f32_16x16x32_bf16 v[152:155], v[60:63], v[32:35], v[152:155]
    ds_read_b64_tr_b16 v[98:99], v11 offset:736
    v_mfma_f32_16x16x32_bf16 v[156:159], v[60:63], v[36:39], v[156:159]
    ds_read_b64_tr_b16 v[100:101], v11 offset:128
    v_mfma_f32_16x16x32_bf16 v[160:163], v[60:63], v[40:43], v[160:163]
    ds_read_b64_tr_b16 v[102:103], v11 offset:768
    v_mfma_f32_16x16x32_bf16 v[164:167], v[60:63], v[44:47], v[164:167]
    v_mfma_f32_16x16x32_bf16 v[168:171], v[64:67], v[32:35], v[168:171]
    v_mfma_f32_16x16x32_bf16 v[172:175], v[64:67], v[36:39], v[172:175]
    v_mfma_f32_16x16x32_bf16 v[176:179], v[64:67], v[40:43], v[176:179]
    v_mfma_f32_16x16x32_bf16 v[180:183], v[64:67], v[44:47], v[180:183]
    s_waitcnt lgkmcnt(0)
    v_mfma_f32_16x16x32_bf16 v[104:107], v[84:87], v[68:71], v[104:107]
    s_barrier
    v_add_u32 v10, 0x4000, v10
    v_add_u32 v11, 0x6000, v11
    v_mfma_f32_16x16x32_bf16 v[108:111], v[84:87], v[72:75], v[108:111]
    ds_read_b128 v[32:35], v10 offset:0
    v_mfma_f32_16x16x32_bf16 v[112:115], v[84:87], v[76:79], v[112:115]
    ds_read_b128 v[36:39], v10 offset:4096
    v_mfma_f32_16x16x32_bf16 v[116:119], v[84:87], v[80:83], v[116:119]
    ds_read_b128 v[40:43], v10 offset:8192
    v_mfma_f32_16x16x32_bf16 v[120:123], v[88:91], v[68:71], v[120:123]
    ds_read_b128 v[44:47], v10 offset:12288
    v_mfma_f32_16x16x32_bf16 v[124:127], v[88:91], v[72:75], v[124:127]
    ds_read_b64_tr_b16 v[48:49], v11 offset:0
    v_mfma_f32_16x16x32_bf16 v[128:131], v[88:91], v[76:79], v[128:131]
    ds_read_b64_tr_b16 v[50:51], v11 offset:640
    v_mfma_f32_16x16x32_bf16 v[132:135], v[88:91], v[80:83], v[132:135]
    ds_read_b64_tr_b16 v[52:53], v11 offset:32
    v_mfma_f32_16x16x32_bf16 v[136:139], v[92:95], v[68:71], v[136:139]
    ds_read_b64_tr_b16 v[54:55], v11 offset:672
    v_mfma_f32_16x16x32_bf16 v[140:143], v[92:95], v[72:75], v[140:143]
    ds_read_b64_tr_b16 v[56:57], v11 offset:64
    v_mfma_f32_16x16x32_bf16 v[144:147], v[92:95], v[76:79], v[144:147]
    ds_read_b64_tr_b16 v[58:59], v11 offset:704
    v_mfma_f32_16x16x32_bf16 v[148:151], v[92:95], v[80:83], v[148:151]
    ds_read_b64_tr_b16 v[60:61], v11 offset:96
    v_mfma_f32_16x16x32_bf16 v[152:155], v[96:99], v[68:71], v[152:155]
    ds_read_b64_tr_b16 v[62:63], v11 offset:736
    v_mfma_f32_16x16x32_bf16 v[156:159], v[96:99], v[72:75], v[156:159]
    ds_read_b64_tr_b16 v[64:65], v11 offset:128
    v_mfma_f32_16x16x32_bf16 v[160:163], v[96:99], v[76:79], v[160:163]
    ds_read_b64_tr_b16 v[66:67], v11 offset:768
    v_mfma_f32_16x16x32_bf16 v[164:167], v[96:99], v[80:83], v[164:167]
    v_mfma_f32_16x16x32_bf16 v[168:171], v[100:103], v[68:71], v[168:171]
    v_mfma_f32_16x16x32_bf16 v[172:175], v[100:103], v[72:75], v[172:175]
    v_mfma_f32_16x16x32_bf16 v[176:179], v[100:103], v[76:79], v[176:179]
    v_mfma_f32_16x16x32_bf16 v[180:183], v[100:103], v[80:83], v[180:183]
    s_waitcnt lgkmcnt(0)
    v_mfma_f32_16x16x32_bf16 v[104:107], v[48:51], v[32:35], v[104:107]
    s_barrier
    v_add_u32 v10, 0x4000, v10
    v_add_u32 v11, 0x6000, v11
    v_mfma_f32_16x16x32_bf16 v[108:111], v[48:51], v[36:39], v[108:111]
    ds_read_b128 v[68:71], v10 offset:0
    v_mfma_f32_16x16x32_bf16 v[112:115], v[48:51], v[40:43], v[112:115]
    ds_read_b128 v[72:75], v10 offset:4096
    v_mfma_f32_16x16x32_bf16 v[116:119], v[48:51], v[44:47], v[116:119]
    ds_read_b128 v[76:79], v10 offset:8192
    v_mfma_f32_16x16x32_bf16 v[120:123], v[52:55], v[32:35], v[120:123]
    ds_read_b128 v[80:83], v10 offset:12288
    v_mfma_f32_16x16x32_bf16 v[124:127], v[52:55], v[36:39], v[124:127]
    ds_read_b64_tr_b16 v[84:85], v11 offset:0
    v_mfma_f32_16x16x32_bf16 v[128:131], v[52:55], v[40:43], v[128:131]
    ds_read_b64_tr_b16 v[86:87], v11 offset:640
    v_mfma_f32_16x16x32_bf16 v[132:135], v[52:55], v[44:47], v[132:135]
    ds_read_b64_tr_b16 v[88:89], v11 offset:32
    v_mfma_f32_16x16x32_bf16 v[136:139], v[56:59], v[32:35], v[136:139]
    ds_read_b64_tr_b16 v[90:91], v11 offset:672
    v_mfma_f32_16x16x32_bf16 v[140:143], v[56:59], v[36:39], v[140:143]
    ds_read_b64_tr_b16 v[92:93], v11 offset:64
    v_mfma_f32_16x16x32_bf16 v[144:147], v[56:59], v[40:43], v[144:147]
    ds_read_b64_tr_b16 v[94:95], v11 offset:704
    v_mfma_f32_16x16x32_bf16 v[148:151], v[56:59], v[44:47], v[148:151]
    ds_read_b64_tr_b16 v[96:97], v11 offset:96
    v_mfma_f32_16x16x32_bf16 v[152:155], v[60:63], v[32:35], v[152:155]
    ds_read_b64_tr_b16 v[98:99], v11 offset:736
    v_mfma_f32_16x16x32_bf16 v[156:159], v[60:63], v[36:39], v[156:159]
    ds_read_b64_tr_b16 v[100:101], v11 offset:128
    v_mfma_f32_16x16x32_bf16 v[160:163], v[60:63], v[40:43], v[160:163]
    ds_read_b64_tr_b16 v[102:103], v11 offset:768
    v_mfma_f32_16x16x32_bf16 v[164:167], v[60:63], v[44:47], v[164:167]
    v_mfma_f32_16x16x32_bf16 v[168:171], v[64:67], v[32:35], v[168:171]
    v_mfma_f32_16x16x32_bf16 v[172:175], v[64:67], v[36:39], v[172:175]
    v_mfma_f32_16x16x32_bf16 v[176:179], v[64:67], v[40:43], v[176:179]
    v_mfma_f32_16x16x32_bf16 v[180:183], v[64:67], v[44:47], v[180:183]
    s_waitcnt lgkmcnt(0)
    v_mfma_f32_16x16x32_bf16 v[104:107], v[84:87], v[68:71], v[104:107]
    s_barrier
    v_add_u32 v10, 0xffff4000, v10
    v_add_u32 v11, 0xfffee000, v11
    v_mfma_f32_16x16x32_bf16 v[108:111], v[84:87], v[72:75], v[108:111]
    ds_read_b128 v[32:35], v10 offset:0
    v_mfma_f32_16x16x32_bf16 v[112:115], v[84:87], v[76:79], v[112:115]
    ds_read_b128 v[36:39], v10 offset:4096
    v_mfma_f32_16x16x32_bf16 v[116:119], v[84:87], v[80:83], v[116:119]
    ds_read_b128 v[40:43], v10 offset:8192
    v_mfma_f32_16x16x32_bf16 v[120:123], v[88:91], v[68:71], v[120:123]
    ds_read_b128 v[44:47], v10 offset:12288
    v_mfma_f32_16x16x32_bf16 v[124:127], v[88:91], v[72:75], v[124:127]
    ds_read_b64_tr_b16 v[48:49], v11 offset:0
    v_mfma_f32_16x16x32_bf16 v[128:131], v[88:91], v[76:79], v[128:131]
    ds_read_b64_tr_b16 v[50:51], v11 offset:640
    v_mfma_f32_16x16x32_bf16 v[132:135], v[88:91], v[80:83], v[132:135]
    ds_read_b64_tr_b16 v[52:53], v11 offset:32
    v_mfma_f32_16x16x32_bf16 v[136:139], v[92:95], v[68:71], v[136:139]
    ds_read_b64_tr_b16 v[54:55], v11 offset:672
    v_mfma_f32_16x16x32_bf16 v[140:143], v[92:95], v[72:75], v[140:143]
    ds_read_b64_tr_b16 v[56:57], v11 offset:64
    v_mfma_f32_16x16x32_bf16 v[144:147], v[92:95], v[76:79], v[144:147]
    ds_read_b64_tr_b16 v[58:59], v11 offset:704
    v_mfma_f32_16x16x32_bf16 v[148:151], v[92:95], v[80:83], v[148:151]
    ds_read_b64_tr_b16 v[60:61], v11 offset:96
    v_mfma_f32_16x16x32_bf16 v[152:155], v[96:99], v[68:71], v[152:155]
    ds_read_b64_tr_b16 v[62:63], v11 offset:736
    v_mfma_f32_16x16x32_bf16 v[156:159], v[96:99], v[72:75], v[156:159]
    ds_read_b64_tr_b16 v[64:65], v11 offset:128
    v_mfma_f32_16x16x32_bf16 v[160:163], v[96:99], v[76:79], v[160:163]
    ds_read_b64_tr_b16 v[66:67], v11 offset:768
    v_mfma_f32_16x16x32_bf16 v[164:167], v[96:99], v[80:83], v[164:167]
    v_mfma_f32_16x16x32_bf16 v[168:171], v[100:103], v[68:71], v[168:171]
    v_mfma_f32_16x16x32_bf16 v[172:175], v[100:103], v[72:75], v[172:175]
    v_mfma_f32_16x16x32_bf16 v[176:179], v[100:103], v[76:79], v[176:179]
    v_mfma_f32_16x16x32_bf16 v[180:183], v[100:103], v[80:83], v[180:183]
    s_waitcnt lgkmcnt(0)
    v_mfma_f32_16x16x32_bf16 v[104:107], v[48:51], v[32:35], v[104:107]
    s_barrier
    v_add_u32 v10, 0x4000, v10
    v_add_u32 v11, 0x6000, v11
    v_mfma_f32_16x16x32_bf16 v[108:111], v[48:51], v[36:39], v[108:111]
    ds_read_b128 v[68:71], v10 offset:0
    v_mfma_f32_16x16x32_bf16 v[112:115], v[48:51], v[40:43], v[112:115]
    ds_read_b128 v[72:75], v10 offset:4096
    v_mfma_f32_16x16x32_bf16 v[116:119], v[48:51], v[44:47], v[116:119]
    ds_read_b128 v[76:79], v10 offset:8192
    v_mfma_f32_16x16x32_bf16 v[120:123], v[52:55], v[32:35], v[120:123]
    ds_read_b128 v[80:83], v10 offset:12288
    v_mfma_f32_16x16x32_bf16 v[124:127], v[52:55], v[36:39], v[124:127]
    ds_read_b64_tr_b16 v[84:85], v11 offset:0
    v_mfma_f32_16x16x32_bf16 v[128:131], v[52:55], v[40:43], v[128:131]
    ds_read_b64_tr_b16 v[86:87], v11 offset:640
    v_mfma_f32_16x16x32_bf16 v[132:135], v[52:55], v[44:47], v[132:135]
    ds_read_b64_tr_b16 v[88:89], v11 offset:32
    v_mfma_f32_16x16x32_bf16 v[136:139], v[56:59], v[32:35], v[136:139]
    ds_read_b64_tr_b16 v[90:91], v11 offset:672
    v_mfma_f32_16x16x32_bf16 v[140:143], v[56:59], v[36:39], v[140:143]
    ds_read_b64_tr_b16 v[92:93], v11 offset:64
    v_mfma_f32_16x16x32_bf16 v[144:147], v[56:59], v[40:43], v[144:147]
    ds_read_b64_tr_b16 v[94:95], v11 offset:704
    v_mfma_f32_16x16x32_bf16 v[148:151], v[56:59], v[44:47], v[148:151]
    ds_read_b64_tr_b16 v[96:97], v11 offset:96
    v_mfma_f32_16x16x32_bf16 v[152:155], v[60:63], v[32:35], v[152:155]
    ds_read_b64_tr_b16 v[98:99], v11 offset:736
    v_mfma_f32_16x16x32_bf16 v[156:159], v[60:63], v[36:39], v[156:159]
    ds_read_b64_tr_b16 v[100:101], v11 offset:128
    v_mfma_f32_16x16x32_bf16 v[160:163], v[60:63], v[40:43], v[160:163]
    ds_read_b64_tr_b16 v[102:103], v11 offset:768
    v_mfma_f32_16x16x32_bf16 v[164:167], v[60:63], v[44:47], v[164:167]
    v_mfma_f32_16x16x32_bf16 v[168:171], v[64:67], v[32:35], v[168:171]
    v_mfma_f32_16x16x32_bf16 v[172:175], v[64:67], v[36:39], v[172:175]
    v_mfma_f32_16x16x32_bf16 v[176:179], v[64:67], v[40:43], v[176:179]
    v_mfma_f32_16x16x32_bf16 v[180:183], v[64:67], v[44:47], v[180:183]
    s_waitcnt lgkmcnt(0)
    v_mfma_f32_16x16x32_bf16 v[104:107], v[84:87], v[68:71], v[104:107]
    s_barrier
    v_add_u32 v10, 0x4000, v10
    v_add_u32 v11, 0x6000, v11
    v_mfma_f32_16x16x32_bf16 v[108:111], v[84:87], v[72:75], v[108:111]
    ds_read_b128 v[32:35], v10 offset:0
    v_mfma_f32_16x16x32_bf16 v[112:115], v[84:87], v[76:79], v[112:115]
    ds_read_b128 v[36:39], v10 offset:4096
    v_mfma_f32_16x16x32_bf16 v[116:119], v[84:87], v[80:83], v[116:119]
    ds_read_b128 v[40:43], v10 offset:8192
    v_mfma_f32_16x16x32_bf16 v[120:123], v[88:91], v[68:71], v[120:123]
    ds_read_b128 v[44:47], v10 offset:12288
    v_mfma_f32_16x16x32_bf16 v[124:127], v[88:91], v[72:75], v[124:127]
    ds_read_b64_tr_b16 v[48:49], v11 offset:0
    v_mfma_f32_16x16x32_bf16 v[128:131], v[88:91], v[76:79], v[128:131]
    ds_read_b64_tr_b16 v[50:51], v11 offset:640
    v_mfma_f32_16x16x32_bf16 v[132:135], v[88:91], v[80:83], v[132:135]
    ds_read_b64_tr_b16 v[52:53], v11 offset:32
    v_mfma_f32_16x16x32_bf16 v[136:139], v[92:95], v[68:71], v[136:139]
    ds_read_b64_tr_b16 v[54:55], v11 offset:672
    v_mfma_f32_16x16x32_bf16 v[140:143], v[92:95], v[72:75], v[140:143]
    ds_read_b64_tr_b16 v[56:57], v11 offset:64
    v_mfma_f32_16x16x32_bf16 v[144:147], v[92:95], v[76:79], v[144:147]
    ds_read_b64_tr_b16 v[58:59], v11 offset:704
    v_mfma_f32_16x16x32_bf16 v[148:151], v[92:95], v[80:83], v[148:151]
    ds_read_b64_tr_b16 v[60:61], v11 offset:96
    v_mfma_f32_16x16x32_bf16 v[152:155], v[96:99], v[68:71], v[152:155]
    ds_read_b64_tr_b16 v[62:63], v11 offset:736
    v_mfma_f32_16x16x32_bf16 v[156:159], v[96:99], v[72:75], v[156:159]
    ds_read_b64_tr_b16 v[64:65], v11 offset:128
    v_mfma_f32_16x16x32_bf16 v[160:163], v[96:99], v[76:79], v[160:163]
    ds_read_b64_tr_b16 v[66:67], v11 offset:768
    v_mfma_f32_16x16x32_bf16 v[164:167], v[96:99], v[80:83], v[164:167]
    v_mfma_f32_16x16x32_bf16 v[168:171], v[100:103], v[68:71], v[168:171]
    v_mfma_f32_16x16x32_bf16 v[172:175], v[100:103], v[72:75], v[172:175]
    v_mfma_f32_16x16x32_bf16 v[176:179], v[100:103], v[76:79], v[176:179]
    v_mfma_f32_16x16x32_bf16 v[180:183], v[100:103], v[80:83], v[180:183]
    s_waitcnt lgkmcnt(0)
    v_mfma_f32_16x16x32_bf16 v[104:107], v[48:51], v[32:35], v[104:107]
    s_barrier
    v_add_u32 v10, 0x4000, v10
    v_add_u32 v11, 0x6000, v11
    v_mfma_f32_16x16x32_bf16 v[108:111], v[48:51], v[36:39], v[108:111]
    ds_read_b128 v[68:71], v10 offset:0
    v_mfma_f32_16x16x32_bf16 v[112:115], v[48:51], v[40:43], v[112:115]
    ds_read_b128 v[72:75], v10 offset:4096
    v_mfma_f32_16x16x32_bf16 v[116:119], v[48:51], v[44:47], v[116:119]
    ds_read_b128 v[76:79], v10 offset:8192
    v_mfma_f32_16x16x32_bf16 v[120:123], v[52:55], v[32:35], v[120:123]
    ds_read_b128 v[80:83], v10 offset:12288
    v_mfma_f32_16x16x32_bf16 v[124:127], v[52:55], v[36:39], v[124:127]
    ds_read_b64_tr_b16 v[84:85], v11 offset:0
    v_mfma_f32_16x16x32_bf16 v[128:131], v[52:55], v[40:43], v[128:131]
    ds_read_b64_tr_b16 v[86:87], v11 offset:640
    v_mfma_f32_16x16x32_bf16 v[132:135], v[52:55], v[44:47], v[132:135]
    ds_read_b64_tr_b16 v[88:89], v11 offset:32
    v_mfma_f32_16x16x32_bf16 v[136:139], v[56:59], v[32:35], v[136:139]
    ds_read_b64_tr_b16 v[90:91], v11 offset:672
    v_mfma_f32_16x16x32_bf16 v[140:143], v[56:59], v[36:39], v[140:143]
    ds_read_b64_tr_b16 v[92:93], v11 offset:64
    v_mfma_f32_16x16x32_bf16 v[144:147], v[56:59], v[40:43], v[144:147]
    ds_read_b64_tr_b16 v[94:95], v11 offset:704
    v_mfma_f32_16x16x32_bf16 v[148:151], v[56:59], v[44:47], v[148:151]
    ds_read_b64_tr_b16 v[96:97], v11 offset:96
    v_mfma_f32_16x16x32_bf16 v[152:155], v[60:63], v[32:35], v[152:155]
    ds_read_b64_tr_b16 v[98:99], v11 offset:736
    v_mfma_f32_16x16x32_bf16 v[156:159], v[60:63], v[36:39], v[156:159]
    ds_read_b64_tr_b16 v[100:101], v11 offset:128
    v_mfma_f32_16x16x32_bf16 v[160:163], v[60:63], v[40:43], v[160:163]
    ds_read_b64_tr_b16 v[102:103], v11 offset:768
    v_mfma_f32_16x16x32_bf16 v[164:167], v[60:63], v[44:47], v[164:167]
    v_mfma_f32_16x16x32_bf16 v[168:171], v[64:67], v[32:35], v[168:171]
    v_mfma_f32_16x16x32_bf16 v[172:175], v[64:67], v[36:39], v[172:175]
    v_mfma_f32_16x16x32_bf16 v[176:179], v[64:67], v[40:43], v[176:179]
    v_mfma_f32_16x16x32_bf16 v[180:183], v[64:67], v[44:47], v[180:183]
    s_waitcnt lgkmcnt(0)
    v_mfma_f32_16x16x32_bf16 v[104:107], v[84:87], v[68:71], v[104:107]
    s_barrier
    v_add_u32 v10, 0xffff4000, v10
    v_add_u32 v11, 0xfffee000, v11
    v_mfma_f32_16x16x32_bf16 v[108:111], v[84:87], v[72:75], v[108:111]
    ds_read_b128 v[32:35], v10 offset:0
    v_mfma_f32_16x16x32_bf16 v[112:115], v[84:87], v[76:79], v[112:115]
    ds_read_b128 v[36:39], v10 offset:4096
    v_mfma_f32_16x16x32_bf16 v[116:119], v[84:87], v[80:83], v[116:119]
    ds_read_b128 v[40:43], v10 offset:8192
    v_mfma_f32_16x16x32_bf16 v[120:123], v[88:91], v[68:71], v[120:123]
    ds_read_b128 v[44:47], v10 offset:12288
    v_mfma_f32_16x16x32_bf16 v[124:127], v[88:91], v[72:75], v[124:127]
    ds_read_b64_tr_b16 v[48:49], v11 offset:0
    v_mfma_f32_16x16x32_bf16 v[128:131], v[88:91], v[76:79], v[128:131]
    ds_read_b64_tr_b16 v[50:51], v11 offset:640
    v_mfma_f32_16x16x32_bf16 v[132:135], v[88:91], v[80:83], v[132:135]
    ds_read_b64_tr_b16 v[52:53], v11 offset:32
    v_mfma_f32_16x16x32_bf16 v[136:139], v[92:95], v[68:71], v[136:139]
    ds_read_b64_tr_b16 v[54:55], v11 offset:672
    v_mfma_f32_16x16x32_bf16 v[140:143], v[92:95], v[72:75], v[140:143]
    ds_read_b64_tr_b16 v[56:57], v11 offset:64
    v_mfma_f32_16x16x32_bf16 v[144:147], v[92:95], v[76:79], v[144:147]
    ds_read_b64_tr_b16 v[58:59], v11 offset:704
    v_mfma_f32_16x16x32_bf16 v[148:151], v[92:95], v[80:83], v[148:151]
    ds_read_b64_tr_b16 v[60:61], v11 offset:96
    v_mfma_f32_16x16x32_bf16 v[152:155], v[96:99], v[68:71], v[152:155]
    ds_read_b64_tr_b16 v[62:63], v11 offset:736
    v_mfma_f32_16x16x32_bf16 v[156:159], v[96:99], v[72:75], v[156:159]
    ds_read_b64_tr_b16 v[64:65], v11 offset:128
    v_mfma_f32_16x16x32_bf16 v[160:163], v[96:99], v[76:79], v[160:163]
    ds_read_b64_tr_b16 v[66:67], v11 offset:768
    v_mfma_f32_16x16x32_bf16 v[164:167], v[96:99], v[80:83], v[164:167]
    v_mfma_f32_16x16x32_bf16 v[168:171], v[100:103], v[68:71], v[168:171]
    v_mfma_f32_16x16x32_bf16 v[172:175], v[100:103], v[72:75], v[172:175]
    v_mfma_f32_16x16x32_bf16 v[176:179], v[100:103], v[76:79], v[176:179]
    v_mfma_f32_16x16x32_bf16 v[180:183], v[100:103], v[80:83], v[180:183]
    s_waitcnt lgkmcnt(0)
    v_mfma_f32_16x16x32_bf16 v[104:107], v[48:51], v[32:35], v[104:107]
    s_barrier
    v_add_u32 v10, 0x4000, v10
    v_add_u32 v11, 0x6000, v11
    v_mfma_f32_16x16x32_bf16 v[108:111], v[48:51], v[36:39], v[108:111]
    ds_read_b128 v[68:71], v10 offset:0
    v_mfma_f32_16x16x32_bf16 v[112:115], v[48:51], v[40:43], v[112:115]
    ds_read_b128 v[72:75], v10 offset:4096
    v_mfma_f32_16x16x32_bf16 v[116:119], v[48:51], v[44:47], v[116:119]
    ds_read_b128 v[76:79], v10 offset:8192
    v_mfma_f32_16x16x32_bf16 v[120:123], v[52:55], v[32:35], v[120:123]
    ds_read_b128 v[80:83], v10 offset:12288
    v_mfma_f32_16x16x32_bf16 v[124:127], v[52:55], v[36:39], v[124:127]
    ds_read_b64_tr_b16 v[84:85], v11 offset:0
    v_mfma_f32_16x16x32_bf16 v[128:131], v[52:55], v[40:43], v[128:131]
    ds_read_b64_tr_b16 v[86:87], v11 offset:640
    v_mfma_f32_16x16x32_bf16 v[132:135], v[52:55], v[44:47], v[132:135]
    ds_read_b64_tr_b16 v[88:89], v11 offset:32
    v_mfma_f32_16x16x32_bf16 v[136:139], v[56:59], v[32:35], v[136:139]
    ds_read_b64_tr_b16 v[90:91], v11 offset:672
    v_mfma_f32_16x16x32_bf16 v[140:143], v[56:59], v[36:39], v[140:143]
    ds_read_b64_tr_b16 v[92:93], v11 offset:64
    v_mfma_f32_16x16x32_bf16 v[144:147], v[56:59], v[40:43], v[144:147]
    ds_read_b64_tr_b16 v[94:95], v11 offset:704
    v_mfma_f32_16x16x32_bf16 v[148:151], v[56:59], v[44:47], v[148:151]
    ds_read_b64_tr_b16 v[96:97], v11 offset:96
    v_mfma_f32_16x16x32_bf16 v[152:155], v[60:63], v[32:35], v[152:155]
    ds_read_b64_tr_b16 v[98:99], v11 offset:736
    v_mfma_f32_16x16x32_bf16 v[156:159], v[60:63], v[36:39], v[156:159]
    ds_read_b64_tr_b16 v[100:101], v11 offset:128
    v_mfma_f32_16x16x32_bf16 v[160:163], v[60:63], v[40:43], v[160:163]
    ds_read_b64_tr_b16 v[102:103], v11 offset:768
    v_mfma_f32_16x16x32_bf16 v[164:167], v[60:63], v[44:47], v[164:167]
    v_mfma_f32_16x16x32_bf16 v[168:171], v[64:67], v[32:35], v[168:171]
    v_mfma_f32_16x16x32_bf16 v[172:175], v[64:67], v[36:39], v[172:175]
    v_mfma_f32_16x16x32_bf16 v[176:179], v[64:67], v[40:43], v[176:179]
    v_mfma_f32_16x16x32_bf16 v[180:183], v[64:67], v[44:47], v[180:183]
    s_waitcnt lgkmcnt(0)
    v_mfma_f32_16x16x32_bf16 v[104:107], v[84:87], v[68:71], v[104:107]
    s_barrier
    v_add_u32 v10, 0x4000, v10
    v_add_u32 v11, 0x6000, v11
    v_mfma_f32_16x16x32_bf16 v[108:111], v[84:87], v[72:75], v[108:111]
    ds_read_b128 v[32:35], v10 offset:0
    v_mfma_f32_16x16x32_bf16 v[112:115], v[84:87], v[76:79], v[112:115]
    ds_read_b128 v[36:39], v10 offset:4096
    v_mfma_f32_16x16x32_bf16 v[116:119], v[84:87], v[80:83], v[116:119]
    ds_read_b128 v[40:43], v10 offset:8192
    v_mfma_f32_16x16x32_bf16 v[120:123], v[88:91], v[68:71], v[120:123]
    ds_read_b128 v[44:47], v10 offset:12288
    v_mfma_f32_16x16x32_bf16 v[124:127], v[88:91], v[72:75], v[124:127]
    ds_read_b64_tr_b16 v[48:49], v11 offset:0
    v_mfma_f32_16x16x32_bf16 v[128:131], v[88:91], v[76:79], v[128:131]
    ds_read_b64_tr_b16 v[50:51], v11 offset:640
    v_mfma_f32_16x16x32_bf16 v[132:135], v[88:91], v[80:83], v[132:135]
    ds_read_b64_tr_b16 v[52:53], v11 offset:32
    v_mfma_f32_16x16x32_bf16 v[136:139], v[92:95], v[68:71], v[136:139]
    ds_read_b64_tr_b16 v[54:55], v11 offset:672
    v_mfma_f32_16x16x32_bf16 v[140:143], v[92:95], v[72:75], v[140:143]
    ds_read_b64_tr_b16 v[56:57], v11 offset:64
    v_mfma_f32_16x16x32_bf16 v[144:147], v[92:95], v[76:79], v[144:147]
    ds_read_b64_tr_b16 v[58:59], v11 offset:704
    v_mfma_f32_16x16x32_bf16 v[148:151], v[92:95], v[80:83], v[148:151]
    ds_read_b64_tr_b16 v[60:61], v11 offset:96
    v_mfma_f32_16x16x32_bf16 v[152:155], v[96:99], v[68:71], v[152:155]
    ds_read_b64_tr_b16 v[62:63], v11 offset:736
    v_mfma_f32_16x16x32_bf16 v[156:159], v[96:99], v[72:75], v[156:159]
    ds_read_b64_tr_b16 v[64:65], v11 offset:128
    v_mfma_f32_16x16x32_bf16 v[160:163], v[96:99], v[76:79], v[160:163]
    ds_read_b64_tr_b16 v[66:67], v11 offset:768
    v_mfma_f32_16x16x32_bf16 v[164:167], v[96:99], v[80:83], v[164:167]
    v_mfma_f32_16x16x32_bf16 v[168:171], v[100:103], v[68:71], v[168:171]
    v_mfma_f32_16x16x32_bf16 v[172:175], v[100:103], v[72:75], v[172:175]
    v_mfma_f32_16x16x32_bf16 v[176:179], v[100:103], v[76:79], v[176:179]
    v_mfma_f32_16x16x32_bf16 v[180:183], v[100:103], v[80:83], v[180:183]
    s_waitcnt lgkmcnt(0)
    v_mfma_f32_16x16x32_bf16 v[104:107], v[48:51], v[32:35], v[104:107]
    s_barrier
    v_add_u32 v10, 0x4000, v10
    v_add_u32 v11, 0x6000, v11
    v_mfma_f32_16x16x32_bf16 v[108:111], v[48:51], v[36:39], v[108:111]
    ds_read_b128 v[68:71], v10 offset:0
    v_mfma_f32_16x16x32_bf16 v[112:115], v[48:51], v[40:43], v[112:115]
    ds_read_b128 v[72:75], v10 offset:4096
    v_mfma_f32_16x16x32_bf16 v[116:119], v[48:51], v[44:47], v[116:119]
    ds_read_b128 v[76:79], v10 offset:8192
    v_mfma_f32_16x16x32_bf16 v[120:123], v[52:55], v[32:35], v[120:123]
    ds_read_b128 v[80:83], v10 offset:12288
    v_mfma_f32_16x16x32_bf16 v[124:127], v[52:55], v[36:39], v[124:127]
    ds_read_b64_tr_b16 v[84:85], v11 offset:0
    v_mfma_f32_16x16x32_bf16 v[128:131], v[52:55], v[40:43], v[128:131]
    ds_read_b64_tr_b16 v[86:87], v11 offset:640
    v_mfma_f32_16x16x32_bf16 v[132:135], v[52:55], v[44:47], v[132:135]
    ds_read_b64_tr_b16 v[88:89], v11 offset:32
    v_mfma_f32_16x16x32_bf16 v[136:139], v[56:59], v[32:35], v[136:139]
    ds_read_b64_tr_b16 v[90:91], v11 offset:672
    v_mfma_f32_16x16x32_bf16 v[140:143], v[56:59], v[36:39], v[140:143]
    ds_read_b64_tr_b16 v[92:93], v11 offset:64
    v_mfma_f32_16x16x32_bf16 v[144:147], v[56:59], v[40:43], v[144:147]
    ds_read_b64_tr_b16 v[94:95], v11 offset:704
    v_mfma_f32_16x16x32_bf16 v[148:151], v[56:59], v[44:47], v[148:151]
    ds_read_b64_tr_b16 v[96:97], v11 offset:96
    v_mfma_f32_16x16x32_bf16 v[152:155], v[60:63], v[32:35], v[152:155]
    ds_read_b64_tr_b16 v[98:99], v11 offset:736
    v_mfma_f32_16x16x32_bf16 v[156:159], v[60:63], v[36:39], v[156:159]
    ds_read_b64_tr_b16 v[100:101], v11 offset:128
    v_mfma_f32_16x16x32_bf16 v[160:163], v[60:63], v[40:43], v[160:163]
    ds_read_b64_tr_b16 v[102:103], v11 offset:768
    v_mfma_f32_16x16x32_bf16 v[164:167], v[60:63], v[44:47], v[164:167]
    v_mfma_f32_16x16x32_bf16 v[168:171], v[64:67], v[32:35], v[168:171]
    v_mfma_f32_16x16x32_bf16 v[172:175], v[64:67], v[36:39], v[172:175]
    v_mfma_f32_16x16x32_bf16 v[176:179], v[64:67], v[40:43], v[176:179]
    v_mfma_f32_16x16x32_bf16 v[180:183], v[64:67], v[44:47], v[180:183]
    s_waitcnt lgkmcnt(0)
    v_mfma_f32_16x16x32_bf16 v[104:107], v[84:87], v[68:71], v[104:107]
    v_mfma_f32_16x16x32_bf16 v[108:111], v[84:87], v[72:75], v[108:111]
    v_mfma_f32_16x16x32_bf16 v[112:115], v[84:87], v[76:79], v[112:115]
    v_mfma_f32_16x16x32_bf16 v[116:119], v[84:87], v[80:83], v[116:119]
    v_mfma_f32_16x16x32_bf16 v[120:123], v[88:91], v[68:71], v[120:123]
    v_mfma_f32_16x16x32_bf16 v[124:127], v[88:91], v[72:75], v[124:127]
    v_mfma_f32_16x16x32_bf16 v[128:131], v[88:91], v[76:79], v[128:131]
    v_mfma_f32_16x16x32_bf16 v[132:135], v[88:91], v[80:83], v[132:135]
    v_mfma_f32_16x16x32_bf16 v[136:139], v[92:95], v[68:71], v[136:139]
    v_mfma_f32_16x16x32_bf16 v[140:143], v[92:95], v[72:75], v[140:143]
    v_mfma_f32_16x16x32_bf16 v[144:147], v[92:95], v[76:79], v[144:147]
    v_mfma_f32_16x16x32_bf16 v[148:151], v[92:95], v[80:83], v[148:151]
    v_mfma_f32_16x16x32_bf16 v[152:155], v[96:99], v[68:71], v[152:155]
    v_mfma_f32_16x16x32_bf16 v[156:159], v[96:99], v[72:75], v[156:159]
    v_mfma_f32_16x16x32_bf16 v[160:163], v[96:99], v[76:79], v[160:163]
    v_mfma_f32_16x16x32_bf16 v[164:167], v[96:99], v[80:83], v[164:167]
    v_mfma_f32_16x16x32_bf16 v[168:171], v[100:103], v[68:71], v[168:171]
    v_mfma_f32_16x16x32_bf16 v[172:175], v[100:103], v[72:75], v[172:175]
    v_mfma_f32_16x16x32_bf16 v[176:179], v[100:103], v[76:79], v[176:179]
    v_mfma_f32_16x16x32_bf16 v[180:183], v[100:103], v[80:83], v[180:183]
    s_barrier
    v_lshlrev_b32 v25, 4, v1
    s_mul_i32 s32, s29, 15360
    v_add_u32 v27, s32, v25
    s_nop 7
    s_cmp_eq_u32 s29, 0
    s_cbranch_scc1 rw_mega_kernel_106
    s_sub_u32 s32, s29, 1
    s_and_b32 s32, s32, 3
    s_mul_i32 s32, s32, 5120
    s_add_u32 s32, s32, 0
    v_add_u32 v26, s32, v25
    ds_write_b128 v26, v[104:107] offset:0
    ds_write_b128 v26, v[120:123] offset:1024
    ds_write_b128 v26, v[136:139] offset:2048
    ds_write_b128 v26, v[152:155] offset:3072
    ds_write_b128 v26, v[168:171] offset:4096
rw_mega_kernel_106:
    s_cmp_eq_u32 s29, 1
    s_cbranch_scc1 rw_mega_kernel_107
    s_sub_u32 s32, s29, 2
    s_and_b32 s32, s32, 3
    s_mul_i32 s32, s32, 5120
    s_add_u32 s32, s32, 15360
    v_add_u32 v26, s32, v25
    ds_write_b128 v26, v[108:111] offset:0
    ds_write_b128 v26, v[124:127] offset:1024
    ds_write_b128 v26, v[140:143] offset:2048
    ds_write_b128 v26, v[156:159] offset:3072
    ds_write_b128 v26, v[172:175] offset:4096
rw_mega_kernel_107:
    s_cmp_eq_u32 s29, 2
    s_cbranch_scc1 rw_mega_kernel_108
    s_sub_u32 s32, s29, 3
    s_and_b32 s32, s32, 3
    s_mul_i32 s32, s32, 5120
    s_add_u32 s32, s32, 30720
    v_add_u32 v26, s32, v25
    ds_write_b128 v26, v[112:115] offset:0
    ds_write_b128 v26, v[128:131] offset:1024
    ds_write_b128 v26, v[144:147] offset:2048
    ds_write_b128 v26, v[160:163] offset:3072
    ds_write_b128 v26, v[176:179] offset:4096
rw_mega_kernel_108:
    s_cmp_eq_u32 s29, 3
    s_cbranch_scc1 rw_mega_kernel_109
    s_sub_u32 s32, s29, 4
    s_and_b32 s32, s32, 3
    s_mul_i32 s32, s32, 5120
    s_add_u32 s32, s32, 46080
    v_add_u32 v26, s32, v25
    ds_write_b128 v26, v[116:119] offset:0
    ds_write_b128 v26, v[132:135] offset:1024
    ds_write_b128 v26, v[148:151] offset:2048
    ds_write_b128 v26, v[164:167] offset:3072
    ds_write_b128 v26, v[180:183] offset:4096
rw_mega_kernel_109:
    s_waitcnt lgkmcnt(0)
    s_barrier
    s_cmp_eq_u32 s29, 0
    s_cbranch_scc1 own_mega_kernel_111
    s_cmp_eq_u32 s29, 1
    s_cbranch_scc1 own_mega_kernel_112
    s_cmp_eq_u32 s29, 2
    s_cbranch_scc1 own_mega_kernel_113
    s_cmp_eq_u32 s29, 3
    s_cbranch_scc1 own_mega_kernel_114
own_mega_kernel_111:
    v_mov_b32 v32, v104
    v_mov_b32 v33, v105
    v_mov_b32 v34, v106
    v_mov_b32 v35, v107
    v_mov_b32 v36, v120
    v_mov_b32 v37, v121
    v_mov_b32 v38, v122
    v_mov_b32 v39, v123
    v_mov_b32 v40, v136
    v_mov_b32 v41, v137
    v_mov_b32 v42, v138
    v_mov_b32 v43, v139
    v_mov_b32 v44, v152
    v_mov_b32 v45, v153
    v_mov_b32 v46, v154
    v_mov_b32 v47, v155
    v_mov_b32 v48, v168
    v_mov_b32 v49, v169
    v_mov_b32 v50, v170
    v_mov_b32 v51, v171
    s_branch e_mega_kernel_110
own_mega_kernel_112:
    v_mov_b32 v32, v108
    v_mov_b32 v33, v109
    v_mov_b32 v34, v110
    v_mov_b32 v35, v111
    v_mov_b32 v36, v124
    v_mov_b32 v37, v125
    v_mov_b32 v38, v126
    v_mov_b32 v39, v127
    v_mov_b32 v40, v140
    v_mov_b32 v41, v141
    v_mov_b32 v42, v142
    v_mov_b32 v43, v143
    v_mov_b32 v44, v156
    v_mov_b32 v45, v157
    v_mov_b32 v46, v158
    v_mov_b32 v47, v159
    v_mov_b32 v48, v172
    v_mov_b32 v49, v173
    v_mov_b32 v50, v174
    v_mov_b32 v51, v175
    s_branch e_mega_kernel_110
own_mega_kernel_113:
    v_mov_b32 v32, v112
    v_mov_b32 v33, v113
    v_mov_b32 v34, v114
    v_mov_b32 v35, v115
    v_mov_b32 v36, v128
    v_mov_b32 v37, v129
    v_mov_b32 v38, v130
    v_mov_b32 v39, v131
    v_mov_b32 v40, v144
    v_mov_b32 v41, v145
    v_mov_b32 v42, v146
    v_mov_b32 v43, v147
    v_mov_b32 v44, v160
    v_mov_b32 v45, v161
    v_mov_b32 v46, v162
    v_mov_b32 v47, v163
    v_mov_b32 v48, v176
    v_mov_b32 v49, v177
    v_mov_b32 v50, v178
    v_mov_b32 v51, v179
    s_branch e_mega_kernel_110
own_mega_kernel_114:
    v_mov_b32 v32, v116
    v_mov_b32 v33, v117
    v_mov_b32 v34, v118
    v_mov_b32 v35, v119
    v_mov_b32 v36, v132
    v_mov_b32 v37, v133
    v_mov_b32 v38, v134
    v_mov_b32 v39, v135
    v_mov_b32 v40, v148
    v_mov_b32 v41, v149
    v_mov_b32 v42, v150
    v_mov_b32 v43, v151
    v_mov_b32 v44, v164
    v_mov_b32 v45, v165
    v_mov_b32 v46, v166
    v_mov_b32 v47, v167
    v_mov_b32 v48, v180
    v_mov_b32 v49, v181
    v_mov_b32 v50, v182
    v_mov_b32 v51, v183
    s_branch e_mega_kernel_110
e_mega_kernel_110:
    ds_read_b128 v[104:107], v27 offset:0
    ds_read_b128 v[108:111], v27 offset:1024
    ds_read_b128 v[112:115], v27 offset:2048
    ds_read_b128 v[116:119], v27 offset:3072
    ds_read_b128 v[120:123], v27 offset:4096
    ds_read_b128 v[124:127], v27 offset:5120
    ds_read_b128 v[128:131], v27 offset:6144
    ds_read_b128 v[132:135], v27 offset:7168
    ds_read_b128 v[136:139], v27 offset:8192
    ds_read_b128 v[140:143], v27 offset:9216
    ds_read_b128 v[144:147], v27 offset:10240
    ds_read_b128 v[148:151], v27 offset:11264
    ds_read_b128 v[152:155], v27 offset:12288
    ds_read_b128 v[156:159], v27 offset:13312
    ds_read_b128 v[160:163], v27 offset:14336
    s_waitcnt lgkmcnt(0) vmcnt(0)
    v_pk_add_f32 v[32:33], v[32:33], v[104:105]
    v_pk_add_f32 v[34:35], v[34:35], v[106:107]
    v_pk_add_f32 v[36:37], v[36:37], v[108:109]
    v_pk_add_f32 v[38:39], v[38:39], v[110:111]
    v_pk_add_f32 v[40:41], v[40:41], v[112:113]
    v_pk_add_f32 v[42:43], v[42:43], v[114:115]
    v_pk_add_f32 v[44:45], v[44:45], v[116:117]
    v_pk_add_f32 v[46:47], v[46:47], v[118:119]
    v_pk_add_f32 v[48:49], v[48:49], v[120:121]
    v_pk_add_f32 v[50:51], v[50:51], v[122:123]
    v_pk_add_f32 v[32:33], v[32:33], v[124:125]
    v_pk_add_f32 v[34:35], v[34:35], v[126:127]
    v_pk_add_f32 v[36:37], v[36:37], v[128:129]
    v_pk_add_f32 v[38:39], v[38:39], v[130:131]
    v_pk_add_f32 v[40:41], v[40:41], v[132:133]
    v_pk_add_f32 v[42:43], v[42:43], v[134:135]
    v_pk_add_f32 v[44:45], v[44:45], v[136:137]
    v_pk_add_f32 v[46:47], v[46:47], v[138:139]
    v_pk_add_f32 v[48:49], v[48:49], v[140:141]
    v_pk_add_f32 v[50:51], v[50:51], v[142:143]
    v_pk_add_f32 v[32:33], v[32:33], v[144:145]
    v_pk_add_f32 v[34:35], v[34:35], v[146:147]
    v_pk_add_f32 v[36:37], v[36:37], v[148:149]
    v_pk_add_f32 v[38:39], v[38:39], v[150:151]
    v_pk_add_f32 v[40:41], v[40:41], v[152:153]
    v_pk_add_f32 v[42:43], v[42:43], v[154:155]
    v_pk_add_f32 v[44:45], v[44:45], v[156:157]
    v_pk_add_f32 v[46:47], v[46:47], v[158:159]
    v_pk_add_f32 v[48:49], v[48:49], v[160:161]
    v_pk_add_f32 v[50:51], v[50:51], v[162:163]
    v_cvt_pk_bf16_f32 v20, v32, v33
    v_lshlrev_b32 v32, 16, v20
    v_and_b32 v33, 0xffff0000, v20
    v_lshlrev_b32 v21, 16, v184
    v_and_b32 v22, 0xffff0000, v184
    v_add_f32 v32, v32, v21
    v_add_f32 v33, v33, v22
    v_cvt_pk_bf16_f32 v184, v32, v33
    v_cvt_pk_bf16_f32 v20, v34, v35
    v_lshlrev_b32 v34, 16, v20
    v_and_b32 v35, 0xffff0000, v20
    v_lshlrev_b32 v21, 16, v185
    v_and_b32 v22, 0xffff0000, v185
    v_add_f32 v34, v34, v21
    v_add_f32 v35, v35, v22
    v_cvt_pk_bf16_f32 v185, v34, v35
    ds_write_b64 v30, v[184:185] offset:0
    v_cvt_pk_bf16_f32 v20, v36, v37
    v_lshlrev_b32 v36, 16, v20
    v_and_b32 v37, 0xffff0000, v20
    v_lshlrev_b32 v21, 16, v186
    v_and_b32 v22, 0xffff0000, v186
    v_add_f32 v36, v36, v21
    v_add_f32 v37, v37, v22
    v_cvt_pk_bf16_f32 v186, v36, v37
    v_cvt_pk_bf16_f32 v20, v38, v39
    v_lshlrev_b32 v38, 16, v20
    v_and_b32 v39, 0xffff0000, v20
    v_lshlrev_b32 v21, 16, v187
    v_and_b32 v22, 0xffff0000, v187
    v_add_f32 v38, v38, v21
    v_add_f32 v39, v39, v22
    v_cvt_pk_bf16_f32 v187, v38, v39
    ds_write_b64 v30, v[186:187] offset:32
    v_cvt_pk_bf16_f32 v20, v40, v41
    v_lshlrev_b32 v40, 16, v20
    v_and_b32 v41, 0xffff0000, v20
    v_lshlrev_b32 v21, 16, v188
    v_and_b32 v22, 0xffff0000, v188
    v_add_f32 v40, v40, v21
    v_add_f32 v41, v41, v22
    v_cvt_pk_bf16_f32 v188, v40, v41
    v_cvt_pk_bf16_f32 v20, v42, v43
    v_lshlrev_b32 v42, 16, v20
    v_and_b32 v43, 0xffff0000, v20
    v_lshlrev_b32 v21, 16, v189
    v_and_b32 v22, 0xffff0000, v189
    v_add_f32 v42, v42, v21
    v_add_f32 v43, v43, v22
    v_cvt_pk_bf16_f32 v189, v42, v43
    ds_write_b64 v30, v[188:189] offset:64
    v_cvt_pk_bf16_f32 v20, v44, v45
    v_lshlrev_b32 v44, 16, v20
    v_and_b32 v45, 0xffff0000, v20
    v_lshlrev_b32 v21, 16, v190
    v_and_b32 v22, 0xffff0000, v190
    v_add_f32 v44, v44, v21
    v_add_f32 v45, v45, v22
    v_cvt_pk_bf16_f32 v190, v44, v45
    v_cvt_pk_bf16_f32 v20, v46, v47
    v_lshlrev_b32 v46, 16, v20
    v_and_b32 v47, 0xffff0000, v20
    v_lshlrev_b32 v21, 16, v191
    v_and_b32 v22, 0xffff0000, v191
    v_add_f32 v46, v46, v21
    v_add_f32 v47, v47, v22
    v_cvt_pk_bf16_f32 v191, v46, v47
    ds_write_b64 v30, v[190:191] offset:96
    v_cvt_pk_bf16_f32 v20, v48, v49
    v_lshlrev_b32 v48, 16, v20
    v_and_b32 v49, 0xffff0000, v20
    v_lshlrev_b32 v21, 16, v192
    v_and_b32 v22, 0xffff0000, v192
    v_add_f32 v48, v48, v21
    v_add_f32 v49, v49, v22
    v_cvt_pk_bf16_f32 v192, v48, v49
    v_cvt_pk_bf16_f32 v20, v50, v51
    v_lshlrev_b32 v50, 16, v20
    v_and_b32 v51, 0xffff0000, v20
    v_lshlrev_b32 v21, 16, v193
    v_and_b32 v22, 0xffff0000, v193
    v_add_f32 v50, v50, v21
    v_add_f32 v51, v51, v22
    v_cvt_pk_bf16_f32 v193, v50, v51
    ds_write_b64 v30, v[192:193] offset:128
    s_waitcnt lgkmcnt(0)
    ds_read_b128 v[104:107], v31 offset:0
    ds_read_b128 v[108:111], v31 offset:1024
    ds_read_b128 v[112:115], v31 offset:2048
    v_cmp_gt_u32 vcc, 32, v1
    s_waitcnt lgkmcnt(2)
    buffer_store_dwordx4 v[104:107], v12, s[16:19], 0 offen
    s_waitcnt lgkmcnt(1)
    buffer_store_dwordx4 v[108:111], v13, s[16:19], 0 offen
    s_and_saveexec_b64 s[36:37], vcc
    s_waitcnt lgkmcnt(0)
    buffer_store_dwordx4 v[112:115], v14, s[16:19], 0 offen
    s_mov_b64 exec, s[36:37]
    s_waitcnt vmcnt(0)
    s_barrier
    s_branch end_mega_kernel_103
loader_mega_kernel_102:
    s_lshl_b32 s32, s26, 6
    s_lshl_b32 s33, s28, 4
    s_add_u32 s32, s32, s33
    v_lshrrev_b32 v25, 4, v1
    v_and_b32 v26, 15, v1
    s_mov_b32 s33, 3072
    v_add_u32 v27, 0, v25
    v_xor_b32 v28, v26, v27
    v_add_u32 v27, s32, v27
    v_mul_lo_u32 v27, v27, s33
    v_lshl_add_u32 v27, v28, 4, v27
    v_subrev_u32 v2, 0, v27
    v_add_u32 v27, 4, v25
    v_xor_b32 v28, v26, v27
    v_add_u32 v27, s32, v27
    v_mul_lo_u32 v27, v27, s33
    v_lshl_add_u32 v27, v28, 4, v27
    v_subrev_u32 v3, 1024, v27
    v_add_u32 v27, 8, v25
    v_xor_b32 v28, v26, v27
    v_add_u32 v27, s32, v27
    v_mul_lo_u32 v27, v27, s33
    v_lshl_add_u32 v27, v28, 4, v27
    v_subrev_u32 v4, 2048, v27
    v_add_u32 v27, 12, v25
    v_xor_b32 v28, v26, v27
    v_add_u32 v27, s32, v27
    v_mul_lo_u32 v27, v27, s33
    v_lshl_add_u32 v27, v28, 4, v27
    v_subrev_u32 v5, 3072, v27
    s_mov_b32 s39, 98304
    s_lshl_b32 s34, s28, 12
    s_add_u32 s76, s84, 0x2209000
    s_addc_u32 s77, s85, 0
    s_mov_b32 s78, 1966080
    s_and_b32 s77, s77, 0xffff
    s_mov_b32 s79, 0x00020000
    s_lshr_b32 s82, s2, 5
    s_mul_i32 s82, s82, 245760
    s_mul_i32 s80, s28, 5120
    s_add_u32 s82, s82, s80
    v_lshlrev_b32 v8, 4, v1
    v_add_u32 v8, s82, v8
    v_add_u32 v9, 4096, v8
    s_barrier
    s_add_u32 m0, s34, 0
    s_mov_b32 s35, 0
    buffer_load_dwordx4 v2, s[4:7], s35 offen offset:0 sc1 lds
    buffer_load_dwordx4 v3, s[4:7], s35 offen offset:1024 sc1 lds
    buffer_load_dwordx4 v4, s[4:7], s35 offen offset:2048 sc1 lds
    buffer_load_dwordx4 v5, s[4:7], s35 offen offset:3072 sc1 lds
    s_add_u32 m0, s34, 16384
    s_mov_b32 s35, 256
    buffer_load_dwordx4 v2, s[4:7], s35 offen offset:0 sc1 lds
    buffer_load_dwordx4 v3, s[4:7], s35 offen offset:1024 sc1 lds
    buffer_load_dwordx4 v4, s[4:7], s35 offen offset:2048 sc1 lds
    buffer_load_dwordx4 v5, s[4:7], s35 offen offset:3072 sc1 lds
    s_waitcnt vmcnt(4)
    s_barrier
    s_add_u32 m0, s34, 32768
    s_mov_b32 s35, 512
    buffer_load_dwordx4 v2, s[4:7], s35 offen offset:0 sc1 lds
    buffer_load_dwordx4 v3, s[4:7], s35 offen offset:1024 sc1 lds
    buffer_load_dwordx4 v4, s[4:7], s35 offen offset:2048 sc1 lds
    buffer_load_dwordx4 v5, s[4:7], s35 offen offset:3072 sc1 lds
    s_add_u32 m0, s34, 49152
    s_mov_b32 s35, 768
    buffer_load_dwordx4 v2, s[4:7], s35 offen offset:0 sc1 lds
    buffer_load_dwordx4 v3, s[4:7], s35 offen offset:1024 sc1 lds
    buffer_load_dwordx4 v4, s[4:7], s35 offen offset:2048 sc1 lds
    buffer_load_dwordx4 v5, s[4:7], s35 offen offset:3072 sc1 lds
    s_waitcnt vmcnt(8)
    s_barrier
    s_add_u32 m0, s34, 0
    s_mov_b32 s35, 1024
    buffer_load_dwordx4 v2, s[4:7], s35 offen offset:0 sc1 lds
    buffer_load_dwordx4 v3, s[4:7], s35 offen offset:1024 sc1 lds
    buffer_load_dwordx4 v4, s[4:7], s35 offen offset:2048 sc1 lds
    buffer_load_dwordx4 v5, s[4:7], s35 offen offset:3072 sc1 lds
    s_add_u32 m0, s80, 65536
    s_mov_b32 s81, 81920
    buffer_load_dwordx4 v8, s[76:79], s81 offen offset:0 sc1 lds
    buffer_load_dwordx4 v8, s[76:79], s81 offen offset:1024 sc1 lds
    buffer_load_dwordx4 v8, s[76:79], s81 offen offset:2048 sc1 lds
    buffer_load_dwordx4 v8, s[76:79], s81 offen offset:3072 sc1 lds
    s_add_u32 m0, s80, 69632
    s_nop 0
    buffer_load_dwordx4 v9, s[76:79], s81 offen offset:0 sc1 lds
    s_waitcnt vmcnt(13)
    s_barrier
    s_add_u32 m0, s34, 16384
    s_mov_b32 s35, 1280
    buffer_load_dwordx4 v2, s[4:7], s35 offen offset:0 sc1 lds
    buffer_load_dwordx4 v3, s[4:7], s35 offen offset:1024 sc1 lds
    buffer_load_dwordx4 v4, s[4:7], s35 offen offset:2048 sc1 lds
    buffer_load_dwordx4 v5, s[4:7], s35 offen offset:3072 sc1 lds
    s_add_u32 m0, s80, 90112
    s_mov_b32 s81, 102400
    buffer_load_dwordx4 v8, s[76:79], s81 offen offset:0 sc1 lds
    buffer_load_dwordx4 v8, s[76:79], s81 offen offset:1024 sc1 lds
    buffer_load_dwordx4 v8, s[76:79], s81 offen offset:2048 sc1 lds
    buffer_load_dwordx4 v8, s[76:79], s81 offen offset:3072 sc1 lds
    s_add_u32 m0, s80, 94208
    s_nop 0
    buffer_load_dwordx4 v9, s[76:79], s81 offen offset:0 sc1 lds
    s_waitcnt vmcnt(18)
    s_barrier
    s_add_u32 m0, s34, 32768
    s_mov_b32 s35, 1536
    buffer_load_dwordx4 v2, s[4:7], s35 offen offset:0 sc1 lds
    buffer_load_dwordx4 v3, s[4:7], s35 offen offset:1024 sc1 lds
    buffer_load_dwordx4 v4, s[4:7], s35 offen offset:2048 sc1 lds
    buffer_load_dwordx4 v5, s[4:7], s35 offen offset:3072 sc1 lds
    s_add_u32 m0, s80, 114688
    s_mov_b32 s81, 122880
    buffer_load_dwordx4 v8, s[76:79], s81 offen offset:0 sc1 lds
    buffer_load_dwordx4 v8, s[76:79], s81 offen offset:1024 sc1 lds
    buffer_load_dwordx4 v8, s[76:79], s81 offen offset:2048 sc1 lds
    buffer_load_dwordx4 v8, s[76:79], s81 offen offset:3072 sc1 lds
    s_add_u32 m0, s80, 118784
    s_nop 0
    buffer_load_dwordx4 v9, s[76:79], s81 offen offset:0 sc1 lds
    s_waitcnt vmcnt(18)
    s_barrier
    s_add_u32 m0, s34, 49152
    s_mov_b32 s35, 1792
    buffer_load_dwordx4 v2, s[4:7], s35 offen offset:0 sc1 lds
    buffer_load_dwordx4 v3, s[4:7], s35 offen offset:1024 sc1 lds
    buffer_load_dwordx4 v4, s[4:7], s35 offen offset:2048 sc1 lds
    buffer_load_dwordx4 v5, s[4:7], s35 offen offset:3072 sc1 lds
    s_add_u32 m0, s80, 139264
    s_mov_b32 s81, 143360
    buffer_load_dwordx4 v8, s[76:79], s81 offen offset:0 sc1 lds
    buffer_load_dwordx4 v8, s[76:79], s81 offen offset:1024 sc1 lds
    buffer_load_dwordx4 v8, s[76:79], s81 offen offset:2048 sc1 lds
    buffer_load_dwordx4 v8, s[76:79], s81 offen offset:3072 sc1 lds
    s_add_u32 m0, s80, 143360
    s_nop 0
    buffer_load_dwordx4 v9, s[76:79], s81 offen offset:0 sc1 lds
    s_waitcnt vmcnt(18)
    s_barrier
    s_add_u32 m0, s34, 0
    s_mov_b32 s35, 2048
    buffer_load_dwordx4 v2, s[4:7], s35 offen offset:0 sc1 lds
    buffer_load_dwordx4 v3, s[4:7], s35 offen offset:1024 sc1 lds
    buffer_load_dwordx4 v4, s[4:7], s35 offen offset:2048 sc1 lds
    buffer_load_dwordx4 v5, s[4:7], s35 offen offset:3072 sc1 lds
    s_add_u32 m0, s80, 65536
    s_mov_b32 s81, 163840
    buffer_load_dwordx4 v8, s[76:79], s81 offen offset:0 sc1 lds
    buffer_load_dwordx4 v8, s[76:79], s81 offen offset:1024 sc1 lds
    buffer_load_dwordx4 v8, s[76:79], s81 offen offset:2048 sc1 lds
    buffer_load_dwordx4 v8, s[76:79], s81 offen offset:3072 sc1 lds
    s_add_u32 m0, s80, 69632
    s_nop 0
    buffer_load_dwordx4 v9, s[76:79], s81 offen offset:0 sc1 lds
    s_waitcnt vmcnt(18)
    s_barrier
    s_add_u32 m0, s34, 16384
    s_mov_b32 s35, 2304
    buffer_load_dwordx4 v2, s[4:7], s35 offen offset:0 sc1 lds
    buffer_load_dwordx4 v3, s[4:7], s35 offen offset:1024 sc1 lds
    buffer_load_dwordx4 v4, s[4:7], s35 offen offset:2048 sc1 lds
    buffer_load_dwordx4 v5, s[4:7], s35 offen offset:3072 sc1 lds
    s_add_u32 m0, s80, 90112
    s_mov_b32 s81, 184320
    buffer_load_dwordx4 v8, s[76:79], s81 offen offset:0 sc1 lds
    buffer_load_dwordx4 v8, s[76:79], s81 offen offset:1024 sc1 lds
    buffer_load_dwordx4 v8, s[76:79], s81 offen offset:2048 sc1 lds
    buffer_load_dwordx4 v8, s[76:79], s81 offen offset:3072 sc1 lds
    s_add_u32 m0, s80, 94208
    s_nop 0
    buffer_load_dwordx4 v9, s[76:79], s81 offen offset:0 sc1 lds
    s_waitcnt vmcnt(18)
    s_barrier
    s_add_u32 m0, s34, 32768
    s_mov_b32 s35, 2560
    buffer_load_dwordx4 v2, s[4:7], s35 offen offset:0 sc1 lds
    buffer_load_dwordx4 v3, s[4:7], s35 offen offset:1024 sc1 lds
    buffer_load_dwordx4 v4, s[4:7], s35 offen offset:2048 sc1 lds
    buffer_load_dwordx4 v5, s[4:7], s35 offen offset:3072 sc1 lds
    s_add_u32 m0, s80, 114688
    s_mov_b32 s81, 204800
    buffer_load_dwordx4 v8, s[76:79], s81 offen offset:0 sc1 lds
    buffer_load_dwordx4 v8, s[76:79], s81 offen offset:1024 sc1 lds
    buffer_load_dwordx4 v8, s[76:79], s81 offen offset:2048 sc1 lds
    buffer_load_dwordx4 v8, s[76:79], s81 offen offset:3072 sc1 lds
    s_add_u32 m0, s80, 118784
    s_nop 0
    buffer_load_dwordx4 v9, s[76:79], s81 offen offset:0 sc1 lds
    s_waitcnt vmcnt(18)
    s_barrier
    s_add_u32 m0, s34, 49152
    s_mov_b32 s35, 2816
    buffer_load_dwordx4 v2, s[4:7], s35 offen offset:0 sc1 lds
    buffer_load_dwordx4 v3, s[4:7], s35 offen offset:1024 sc1 lds
    buffer_load_dwordx4 v4, s[4:7], s35 offen offset:2048 sc1 lds
    buffer_load_dwordx4 v5, s[4:7], s35 offen offset:3072 sc1 lds
    s_add_u32 m0, s80, 139264
    s_mov_b32 s81, 225280
    buffer_load_dwordx4 v8, s[76:79], s81 offen offset:0 sc1 lds
    buffer_load_dwordx4 v8, s[76:79], s81 offen offset:1024 sc1 lds
    buffer_load_dwordx4 v8, s[76:79], s81 offen offset:2048 sc1 lds
    buffer_load_dwordx4 v8, s[76:79], s81 offen offset:3072 sc1 lds
    s_add_u32 m0, s80, 143360
    s_nop 0
    buffer_load_dwordx4 v9, s[76:79], s81 offen offset:0 sc1 lds
    s_waitcnt vmcnt(18)
    s_barrier
    s_waitcnt vmcnt(9)
    s_barrier
    s_waitcnt vmcnt(0)
    s_barrier
    s_barrier
    s_barrier
    s_barrier
end_mega_kernel_103:
done_mega_kernel_1:
    s_endpgm
.section .rodata,"a"
.p2align 6
.amdhsa_kernel prep_kernel
  .amdhsa_next_free_vgpr 128
  .amdhsa_next_free_sgpr 96
  .amdhsa_accum_offset 128
  .amdhsa_group_segment_fixed_size 0
  .amdhsa_kernarg_size 80
  .amdhsa_user_sgpr_count 2
  .amdhsa_user_sgpr_kernarg_segment_ptr 1
  .amdhsa_system_sgpr_workgroup_id_x 1
.end_amdhsa_kernel
.p2align 6
.amdhsa_kernel mega_kernel
  .amdhsa_next_free_vgpr 256
  .amdhsa_next_free_sgpr 102
  .amdhsa_accum_offset 256
  .amdhsa_group_segment_fixed_size 0
  .amdhsa_kernarg_size 80
  .amdhsa_user_sgpr_count 2
  .amdhsa_user_sgpr_kernarg_segment_ptr 1
  .amdhsa_system_sgpr_workgroup_id_x 1
.end_amdhsa_kernel
```
